```python
import torch

def _softmax(x, axis=-1):
    return torch.softmax(x, dim=axis)
def _gelu(x):
    return torch.nn.functional.gelu(x, approximate="tanh")
def _silu(x):
    return torch.nn.functional.silu(x)
def _sigmoid(x):
    return torch.sigmoid(x)
def _layernorm(x, axis=-1, eps=1e-5):
    m = x.mean(dim=axis, keepdim=True)
    v = x.var(dim=axis, keepdim=True, unbiased=False)
    return (x - m) / torch.sqrt(v + eps)
def _scatter_add(tgt, idx, src, axis=0):
    return tgt.clone().index_add_(axis, idx, src)
def _segment_sum(src, seg, n):
    out = torch.zeros((n,) + src.shape[1:], dtype=src.dtype)
    return out.index_add_(0, seg, src)
def _pad(x, pw):
    flat = tuple(v for pair in reversed(pw) for v in pair)
    return torch.nn.functional.pad(x, flat)

kernel_name = 'concat_heads__ssm_conv_s5__compressed_kv_cla__prompt'

def setup_inputs():

    _w = (lambda a: (lambda t: t.to(torch.bfloat16) if t.is_floating_point() else t)(torch.as_tensor(a)))
    def _A_setup():
        B, S, D = 1, 2048, 640
        P = D
        Lambda_re = -0.5 * (lambda _x: torch.exp(torch.as_tensor(_x)))((lambda *s: torch.randn(*s, dtype=torch.bfloat16) * 0.2)(P))
        Lambda_im = (lambda *s: torch.randn(*s, dtype=torch.bfloat16) * 0.4)(P) * 1.0
        B_re = (lambda *s: torch.randn(*s, dtype=torch.bfloat16) * 0.2)(P, D) * (D ** -0.5)
        B_im = (lambda *s: torch.randn(*s, dtype=torch.bfloat16) * 0.2)(P, D) * (D ** -0.5)
        C_re = (lambda *s: torch.randn(*s, dtype=torch.bfloat16) * 0.2)(D, P) * (P ** -0.5)
        C_im = (lambda *s: torch.randn(*s, dtype=torch.bfloat16) * 0.2)(D, P) * (P ** -0.5)
        log_dt = (lambda *s: torch.randn(*s, dtype=torch.bfloat16) * 0.2)(P) * 0.3 - 2.0
        Dskip = (lambda *s: torch.randn(*s, dtype=torch.bfloat16) * 0.05)(D)
        return {
            "x": _w((lambda *s: torch.randn(*s, dtype=torch.bfloat16) * 0.05)(B, S, D)),
            "Lambda_re": _w(Lambda_re),
            "Lambda_im": _w(Lambda_im),
            "B_re": _w(B_re),
            "B_im": _w(B_im),
            "C_re": _w(C_re),
            "C_im": _w(C_im),
            "log_dt": _w(log_dt),
            "Dskip": _w(Dskip),
        }
    _A_in = _A_setup()

    def _B_setup():
        B, H, Sq, Sk, D, M = 1, 32, 2048, 2048, 128, 640
        Dc = 4 * D
        return {
            "x": _w((lambda *s: torch.randn(*s, dtype=torch.bfloat16) * 0.8)(B, Sq, M)),
            "c_kv": _w((lambda *s: torch.randn(*s, dtype=torch.bfloat16) * 0.2)(B, Sk, Dc)),
            "w_q": _w((lambda *s: torch.randn(*s, dtype=torch.bfloat16) * 3.2)(M, H, D) * (M ** -0.5)),
            "w_uk": _w((lambda *s: torch.randn(*s, dtype=torch.bfloat16) * 3.2)(Dc, H, D) * (Dc ** -0.5)),
            "w_uv": _w((lambda *s: torch.randn(*s, dtype=torch.bfloat16) * 0.2)(Dc, H, D) * (Dc ** -0.5)),
            "w_o": _w((lambda *s: torch.randn(*s, dtype=torch.bfloat16) * 0.2)(H, D, M) * ((H * D) ** -0.5)),
        }
    _B_in = _B_setup()

    return {
        "A_x": _A_in["x"],
        "A_Lambda_re": _A_in["Lambda_re"],
        "A_Lambda_im": _A_in["Lambda_im"],
        "A_B_re": _A_in["B_re"],
        "A_B_im": _A_in["B_im"],
        "A_C_re": _A_in["C_re"],
        "A_C_im": _A_in["C_im"],
        "A_log_dt": _A_in["log_dt"],
        "A_Dskip": _A_in["Dskip"],
        "B_x": _B_in["x"],
        "B_c_kv": _B_in["c_kv"],
        "B_w_q": _B_in["w_q"],
        "B_w_uk": _B_in["w_uk"],
        "B_w_uv": _B_in["w_uv"],
        "B_w_o": _B_in["w_o"],
    }

def reference(A_x, A_Lambda_re, A_Lambda_im, A_B_re, A_B_im, A_C_re, A_C_im, A_log_dt, A_Dskip, B_x, B_c_kv, B_w_q, B_w_uk, B_w_uv, B_w_o):
    def _A_ref(x, Lambda_re, Lambda_im, B_re, B_im, C_re, C_im, log_dt, Dskip):
        Bsz, L, H = x.shape
        Lam = Lambda_re + 1j * Lambda_im
        Bmat = B_re + 1j * B_im
        Cmat = C_re + 1j * C_im
        dt = torch.exp(log_dt)
        Lam_bar = torch.exp(dt * Lam)
        B_bar = ((Lam_bar - 1.0) / Lam)[:, None] * Bmat
        Bu = torch.einsum("bld,pd->blp", x + 0j, B_bar)
        h = torch.zeros_like(Bu[:, 0, :])
        hs = []
        for t in range(L):
            h = Lam_bar[None, :] * h + Bu[:, t, :]
            hs.append(h)
        hseq = torch.stack(hs, 1)
        y = 2.0 * torch.einsum("blp,dp->bld", hseq, Cmat).real + x * Dskip[None, None, :]
        return y

    def _B_ref(x, c_kv, w_q, w_uk, w_uv, w_o):
        B, Sq, M = x.shape[0], x.shape[1], x.shape[2]
        Sk = c_kv.shape[1]
        H, D = w_q.shape[1], w_q.shape[2]
        q = torch.einsum("bqm,mhd->bhqd", x, w_q)
        k = torch.einsum("bkc,chd->bhkd", c_kv, w_uk)
        v = torch.einsum("bkc,chd->bhkd", c_kv, w_uv)
        scores = torch.einsum("bhqd,bhkd->bhqk", q, k) * (D ** -0.5)
        off = Sk - Sq
        qi = torch.arange(Sq)[:, None]
        kj = torch.arange(Sk)[None, :]
        cmask = kj <= (qi + off)
        scores = torch.where(cmask[None, None], scores, -1e9)
        p = _softmax(scores, axis=-1)
        ctx = torch.einsum("bhqk,bhkd->bhqd", p, v)
        return torch.einsum("bhqd,hdm->bqm", ctx, w_o)

    a = _A_ref(A_x, A_Lambda_re, A_Lambda_im, A_B_re, A_B_im, A_C_re, A_C_im, A_log_dt, A_Dskip)
    b = _B_ref(B_x, B_c_kv, B_w_q, B_w_uk, B_w_uv, B_w_o)
    return torch.concatenate([a, b], axis=-1)
```

```asm
; @launch kernel=fu_kernel grid=(256,1,1) block=(512,1,1) lds=163840
.amdgcn_target "amdgcn-amd-amdhsa--gfx950"
.text
.globl fu_kernel
.p2align 8
.type fu_kernel,@function
fu_kernel:
  s_cmp_lt_u32 s2, 256
  s_cbranch_scc1 .Lgo
  s_endpgm
.Lgo:
  s_load_dwordx2 s[4:5], s[0:1], 80
  s_load_dwordx2 s[8:9], s[0:1], 96
  s_load_dwordx2 s[12:13], s[0:1], 104
  s_load_dwordx2 s[16:17], s[0:1], 136
  s_load_dwordx2 s[20:21], s[0:1], 0
  v_lshrrev_b32 v1, 6, v0
  s_nop 0
  v_readfirstlane_b32 s52, v1
  v_and_b32 v0, 63, v0
  s_and_b32 s53, s2, 7
  s_lshl_b32 s53, s53, 2
  s_bfe_u32 s55, s2, 0x20003
  s_add_u32 s53, s53, s55
  s_lshr_b32 s54, s2, 5
  v_lshrrev_b32 v1, 4, v0
  v_and_b32 v3, 7, v0
  v_xor_b32 v3, v3, v1
  v_lshlrev_b32 v44, 4, v3
  v_lshrrev_b32 v45, 3, v0
  v_lshl_add_u32 v2, v45, 10, v44
  s_lshl_b32 s55, s54, 18
  s_and_b32 s73, s52, 3
  s_lshl_b32 s56, s73, 15
  s_add_u32 s55, s55, s56
  v_add_u32 v4, s55, v2
  v_xor_b32 v2, 64, v4
  v_add_u32 v5, 7168, v2
  v_add_u32 v6, 14336, v4
  v_add_u32 v7, 21504, v2
  v_bfe_u32 v2, v0, 2, 2
  v_xor_b32 v2, v2, v1
  v_and_b32 v3, 3, v0
  v_lshlrev_b32 v3, 4, v3
  v_lshl_add_u32 v46, v2, 6, v3
  v_lshl_add_u32 v2, v1, 13, v46
  s_lshl_b32 s55, s73, 17
  s_lshl_b32 s56, s53, 8
  s_add_u32 s55, s55, s56
  v_add_u32 v8, s55, v2
  v_add_u32 v9, 31744, v8
  v_add_u32 v10, 63488, v8
  v_add_u32 v11, 95232, v8
  s_lshl_b32 s58, s73, 12
  s_mov_b32 s6, 2097152
  s_mov_b32 s7, 0x00020000
  s_mov_b32 s10, 4194304
  s_mov_b32 s11, 0x00020000
  s_mov_b32 s14, 4194304
  s_mov_b32 s15, 0x00020000
  s_waitcnt lgkmcnt(0)
  s_cmp_ge_u32 s52, 4
  s_cbranch_scc1 .Lk1_i0
  s_add_u32 m0, s58, 0
  s_mov_b32 s57, 0
  buffer_load_dwordx4 v4, s[4:7], s57 offen offset:0 lds
  buffer_load_dwordx4 v5, s[4:7], s57 offen offset:1024 lds
  buffer_load_dwordx4 v6, s[4:7], s57 offen offset:2048 lds
  buffer_load_dwordx4 v7, s[4:7], s57 offen offset:3072 lds
  s_add_u32 m0, s58, 32768
  s_mov_b32 s57, 0
  buffer_load_dwordx4 v8, s[8:11], s57 offen offset:0 lds
  buffer_load_dwordx4 v9, s[8:11], s57 offen offset:1024 lds
  buffer_load_dwordx4 v10, s[8:11], s57 offen offset:2048 lds
  buffer_load_dwordx4 v11, s[8:11], s57 offen offset:3072 lds
  s_branch .Lk1_j0
.Lk1_i0:
  s_add_u32 m0, s58, 16384
  s_mov_b32 s57, 131072
  buffer_load_dwordx4 v4, s[4:7], s57 offen offset:0 lds
  buffer_load_dwordx4 v5, s[4:7], s57 offen offset:1024 lds
  buffer_load_dwordx4 v6, s[4:7], s57 offen offset:2048 lds
  buffer_load_dwordx4 v7, s[4:7], s57 offen offset:3072 lds
  s_add_u32 m0, s58, 49152
  s_mov_b32 s57, 0
  buffer_load_dwordx4 v8, s[12:15], s57 offen offset:0 lds
  buffer_load_dwordx4 v9, s[12:15], s57 offen offset:1024 lds
  buffer_load_dwordx4 v10, s[12:15], s57 offen offset:2048 lds
  buffer_load_dwordx4 v11, s[12:15], s57 offen offset:3072 lds
.Lk1_j0:
  s_load_dwordx2 s[24:25], s[0:1], 24
  s_load_dwordx2 s[28:29], s[0:1], 32
  s_load_dwordx2 s[32:33], s[0:1], 72
  s_load_dwordx2 s[40:41], s[0:1], 8
  s_load_dwordx2 s[44:45], s[0:1], 16
  s_load_dwordx2 s[48:49], s[0:1], 56
  s_load_dwordx2 s[64:65], s[0:1], 88
  s_load_dwordx2 s[68:69], s[0:1], 112
  s_load_dwordx2 s[80:81], s[0:1], 0
  s_load_dwordx2 s[82:83], s[0:1], 24
  s_load_dwordx2 s[84:85], s[0:1], 32
  s_load_dwordx2 s[90:91], s[0:1], 128
  s_load_dwordx2 s[70:71], s[0:1], 120
  s_load_dwordx2 s[86:87], s[0:1], 64
  s_waitcnt lgkmcnt(0)
  v_lshlrev_b32 v32, 4, v0
  s_cmp_ge_u32 s2, 160
  s_cbranch_scc1 .Lk1_role2
  s_lshr_b32 s55, s2, 3
  s_mul_i32 s60, s55, 0xcccd
  s_lshr_b32 s60, s60, 18
  s_mul_i32 s56, s60, 5
  s_sub_u32 s61, s55, s56
  s_bfe_u32 s55, s2, 0x20001
  s_lshl_b32 s55, s55, 2
  s_add_u32 s60, s60, s55
  s_and_b32 s55, s2, 1
  s_mul_i32 s55, s55, 5
  s_add_u32 s61, s61, s55
  s_bitcmp1_b32 s52, 1
  s_cselect_b32 s24, s28, s24
  s_cselect_b32 s25, s29, s25
  s_mov_b32 s22, 2621440
  s_mov_b32 s23, 0x00020000
  s_mov_b32 s26, 819200
  s_mov_b32 s27, 0x00020000
  v_lshrrev_b32 v2, 5, v0
  v_and_b32 v3, 3, v45
  v_lshl_add_u32 v2, v2, 4, v3
  v_mul_u32_u24 v2, 1280, v2
  s_lshl_b32 s55, s60, 2
  s_add_u32 s55, s55, s73
  s_mul_i32 s55, s55, 40960
  v_add_u32 v2, s55, v2
  v_xor_b32 v47, 64, v44
  v_add_u32 v12, v2, v44
  v_add_u32 v13, v2, v47
  v_add_u32 v14, 8192, v12
  v_add_u32 v15, 12288, v13
  v_add_u32 v13, 4096, v13
  v_mul_u32_u24 v2, 1280, v45
  s_lshl_b32 s55, s61, 1
  s_and_b32 s57, s52, 1
  s_add_u32 s55, s55, s57
  s_lshl_b32 s62, s55, 5
  s_mul_i32 s55, s62, 1280
  v_add_u32 v2, s55, v2
  v_add_u32 v16, v2, v44
  v_add_u32 v17, v2, v47
  v_add_u32 v18, 18432, v16
  v_add_u32 v19, 27648, v17
  v_add_u32 v17, 9216, v17
  v_and_b32 v2, 31, v0
  v_add_u32 v2, s62, v2
  v_lshlrev_b32 v2, 1, v2
  s_movk_i32 s75, 128
  s_mov_b32 s68, s22
  s_mov_b32 s69, s26
  s_mov_b32 s3, s60
  s_branch .Lk1_rolej
.Lk1_role2:
  s_sub_u32 s20, s68, 768
  s_subb_u32 s21, s69, 0
  s_mov_b32 s24, s20
  s_mov_b32 s25, s21
  s_mov_b32 s22, 5243648
  s_mov_b32 s23, 0x00020000
  s_mov_b32 s26, 5243648
  s_mov_b32 s27, 0x00020000
  s_sub_u32 s60, s2, 176
  s_cselect_b32 s60, 0, s60
  s_cselect_b32 s22, 0, s22
  s_cselect_b32 s26, 0, s26
  s_mov_b32 s68, s22
  s_mov_b32 s69, s26
  s_lshl_b32 s60, s60, 1
  v_mul_u32_u24 v2, 1280, v1
  v_add_u32 v2, v2, v46
  s_mul_i32 s57, s73, 20480
  s_add_u32 s55, s60, 0
  s_mul_i32 s76, s55, 0xcccd
  s_lshr_b32 s76, s76, 18
  s_mul_i32 s56, s76, 5
  s_sub_u32 s77, s55, s56
  s_mul_i32 s55, s76, 163840
  s_lshl_b32 s56, s77, 8
  s_add_u32 s55, s55, s56
  s_add_u32 s55, s55, s57
  v_add_u32 v12, s55, v2
  v_add_u32 v13, 4096, v12
  v_add_u32 v14, 8192, v12
  v_add_u32 v15, 12288, v12
  s_add_u32 s55, s60, 1
  s_mul_i32 s78, s55, 0xcccd
  s_lshr_b32 s78, s78, 18
  s_mul_i32 s56, s78, 5
  s_sub_u32 s79, s55, s56
  s_mul_i32 s55, s78, 163840
  s_lshl_b32 s56, s79, 8
  s_add_u32 s55, s55, s56
  s_add_u32 s55, s55, s57
  v_add_u32 v16, s55, v2
  v_add_u32 v17, 4096, v16
  v_add_u32 v18, 8192, v16
  v_add_u32 v19, 12288, v16
  v_mov_b32 v2, 0
  s_mov_b32 s62, 0
  s_mov_b32 s61, 0
  s_mov_b32 s75, 81920
  s_mov_b32 s3, -1
.Lk1_rolej:
  s_mov_b32 s42, 1280
  s_mov_b32 s43, 0x00020000
  s_mov_b32 s46, 1280
  s_mov_b32 s47, 0x00020000
  s_mov_b32 s50, 1280
  s_mov_b32 s51, 0x00020000
  buffer_load_ushort v33, v2, s[40:43], 0 offen
  buffer_load_ushort v34, v2, s[44:47], 0 offen
  buffer_load_ushort v35, v2, s[48:51], 0 offen
  s_cmp_ge_u32 s52, 4
  s_cbranch_scc1 .Lk1_i1
  s_add_u32 m0, s58, 65536
  s_mov_b32 s57, 128
  buffer_load_dwordx4 v4, s[4:7], s57 offen offset:0 lds
  buffer_load_dwordx4 v5, s[4:7], s57 offen offset:1024 lds
  buffer_load_dwordx4 v6, s[4:7], s57 offen offset:2048 lds
  buffer_load_dwordx4 v7, s[4:7], s57 offen offset:3072 lds
  s_add_u32 m0, s58, 98304
  s_mov_b32 s57, 524288
  buffer_load_dwordx4 v8, s[8:11], s57 offen offset:0 lds
  buffer_load_dwordx4 v9, s[8:11], s57 offen offset:1024 lds
  buffer_load_dwordx4 v10, s[8:11], s57 offen offset:2048 lds
  buffer_load_dwordx4 v11, s[8:11], s57 offen offset:3072 lds
  s_add_u32 m0, s58, 131072
  s_cmp_lt_u32 s2, 160
  s_cselect_b32 s22, s68, 0
  s_mov_b32 s57, 0
  buffer_load_dwordx4 v12, s[20:23], s57 offen offset:0 lds
  buffer_load_dwordx4 v13, s[20:23], s57 offen offset:1024 lds
  buffer_load_dwordx4 v14, s[20:23], s57 offen offset:2048 lds
  buffer_load_dwordx4 v15, s[20:23], s57 offen offset:3072 lds
  s_branch .Lk1_j1
.Lk1_i1:
  s_add_u32 m0, s58, 81920
  s_mov_b32 s57, 131200
  buffer_load_dwordx4 v4, s[4:7], s57 offen offset:0 lds
  buffer_load_dwordx4 v5, s[4:7], s57 offen offset:1024 lds
  buffer_load_dwordx4 v6, s[4:7], s57 offen offset:2048 lds
  buffer_load_dwordx4 v7, s[4:7], s57 offen offset:3072 lds
  s_add_u32 m0, s58, 114688
  s_mov_b32 s57, 524288
  buffer_load_dwordx4 v8, s[12:15], s57 offen offset:0 lds
  buffer_load_dwordx4 v9, s[12:15], s57 offen offset:1024 lds
  buffer_load_dwordx4 v10, s[12:15], s57 offen offset:2048 lds
  buffer_load_dwordx4 v11, s[12:15], s57 offen offset:3072 lds
  s_add_u32 m0, s58, 147456
  s_cmp_lt_u32 s2, 160
  s_cselect_b32 s22, s68, 0
  s_add_u32 s57, s75, 0
  buffer_load_dwordx4 v12, s[20:23], s57 offen offset:0 lds
  buffer_load_dwordx4 v13, s[20:23], s57 offen offset:1024 lds
  buffer_load_dwordx4 v14, s[20:23], s57 offen offset:2048 lds
  buffer_load_dwordx4 v15, s[20:23], s57 offen offset:3072 lds
.Lk1_j1:
  s_mov_b32 s36, s16
  s_mov_b32 s37, s17
  s_mov_b32 s28, s90
  s_mov_b32 s29, s91
  s_mov_b32 s18, 134217728
  s_mov_b32 s19, 0x00020000
  s_mov_b32 s30, 256
  s_mov_b32 s31, 0x00020000
  s_add_u32 s36, s36, 41943040
  s_addc_u32 s37, s37, 0
  s_mov_b32 s38, 7340032
  s_mov_b32 s39, 0x00020000
  s_cmp_ge_u32 s2, 160
  s_cselect_b32 s38, 0, s38
  s_mov_b32 s34, 2621440
  s_mov_b32 s35, 0x00020000
  s_mov_b32 s66, 5242880
  s_mov_b32 s67, 0x00020000
  s_getreg_b32 s100, hwreg(HW_REG_XCC_ID, 0, 4)
  s_add_u32 s100, s100, 1
  s_mov_b32 s95, 32768
  s_lshl_b32 s101, s2, 3
  s_add_u32 s101, s101, s52
  s_cmp_lg_u32 s52, 7
  s_cbranch_scc1 .Lk1_reg2
  s_cmp_eq_u32 s2, 255
  s_cbranch_scc1 .Lk1_reg1
  s_lshl_b32 s55, s53, 3
  s_add_u32 s55, s55, s54
  v_mov_b32 v2, s100
  s_mov_b64 exec, 1
  buffer_store_byte v2, off, s[28:31], s55 sc0 sc1
  s_mov_b64 exec, -1
  s_branch .Lk1_reg2
.Lk1_reg1:
  v_lshlrev_b32 v2, 8, v0
  v_mov_b32 v96, 0
  v_mov_b32 v97, 0
  v_mov_b32 v98, 0
  v_mov_b32 v99, 0
  s_mov_b32 s55, 48234496
  buffer_store_dwordx4 v[96:99], v2, s[16:19], s55 offen offset:0 sc0 sc1
  buffer_store_dwordx4 v[96:99], v2, s[16:19], s55 offen offset:16 sc0 sc1
  s_add_u32 s55, s55, 16384
  buffer_store_dwordx4 v[96:99], v2, s[16:19], s55 offen offset:0 sc0 sc1
  buffer_store_dwordx4 v[96:99], v2, s[16:19], s55 offen offset:16 sc0 sc1
  s_add_u32 s55, s55, 16384
  buffer_store_dwordx4 v[96:99], v2, s[16:19], s55 offen offset:0 sc0 sc1
  buffer_store_dwordx4 v[96:99], v2, s[16:19], s55 offen offset:16 sc0 sc1
  s_add_u32 s55, s55, 16384
  buffer_store_dwordx4 v[96:99], v2, s[16:19], s55 offen offset:0 sc0 sc1
  buffer_store_dwordx4 v[96:99], v2, s[16:19], s55 offen offset:16 sc0 sc1
.Lk1_reg2:
  s_mul_i32 s100, s100, 0x01010101
  s_mul_i32 s93, s54, 163840
  s_sub_u32 s92, 2457600, s93
  v_mul_u32_u24 v2, 1280, v45
  s_mul_i32 s55, s73, 40960
  v_add_u32 v2, s55, v2
  v_xor_b32 v47, 64, v44
  v_add_u32 v36, v2, v44
  v_add_u32 v37, v2, v47
  v_add_u32 v38, 18432, v36
  v_add_u32 v39, 27648, v37
  v_add_u32 v37, 9216, v37
  v_lshrrev_b32 v2, 5, v0
  v_bfe_u32 v46, v0, 2, 2
  v_lshl_add_u32 v2, v2, 3, v46
  v_lshlrev_b32 v2, 8, v2
  v_bfe_u32 v47, v0, 4, 1
  v_lshl_add_u32 v2, v47, 5, v2
  v_and_b32 v47, 3, v0
  v_lshl_add_u32 v2, v47, 3, v2
  s_lshr_b32 s55, s52, 2
  s_lshl_b32 s55, s55, 14
  s_add_u32 s55, s55, 32768
  v_add_u32 v2, s55, v2
  v_xor_b32 v47, 0, v46
  v_lshl_add_u32 v24, v47, 6, v2
  v_xor_b32 v47, 1, v46
  v_lshl_add_u32 v25, v47, 6, v2
  v_xor_b32 v47, 2, v46
  v_lshl_add_u32 v26, v47, 6, v2
  v_xor_b32 v47, 3, v46
  v_lshl_add_u32 v27, v47, 6, v2
  v_and_b32 v2, 31, v0
  v_lshlrev_b32 v2, 7, v2
  s_lshl_b32 s55, s73, 13
  s_add_u32 s56, s55, 0
  v_add_u32 v2, s56, v2
  v_bfe_u32 v46, v0, 1, 3
  v_lshrrev_b32 v47, 5, v0
  v_xor_b32 v46, v46, v47
  v_xor_b32 v47, 0, v46
  v_lshl_add_u32 v20, v47, 4, v2
  v_xor_b32 v47, 2, v46
  v_lshl_add_u32 v21, v47, 4, v2
  v_xor_b32 v47, 4, v46
  v_lshl_add_u32 v22, v47, 4, v2
  v_xor_b32 v47, 6, v46
  v_lshl_add_u32 v23, v47, 4, v2
  s_lshr_b32 s56, s52, 1
  s_lshl_b32 s56, s56, 12
  s_sub_u32 s63, s56, s55
  s_and_b32 s72, s52, 1
  s_lshl_b32 s72, s72, 12
  s_sub_u32 s72, s72, s56
  s_lshl_b32 s56, s52, 12
  s_sub_u32 s74, 45056, s56
  s_cmp_lt_u32 s52, 4
  s_cselect_b32 s74, s56, s74
  s_sub_u32 s74, s74, s55
  s_lshl_b32 s59, s53, 6
  s_lshl_b32 s55, s54, 3
  s_add_u32 s59, s59, s55
  s_lshl_b32 s55, s73, 1
  s_add_u32 s59, s59, s55
  s_lshl_b32 s59, s59, 1
  s_lshr_b32 s55, s52, 2
  s_add_u32 s59, s59, s55
  s_lshl_b32 s59, s59, 13
  s_cmp_ge_u32 s52, 4
  s_cbranch_scc1 .Lm1
  s_waitcnt vmcnt(15)
  s_barrier
  ds_read_b128 v[48:51], v20 offset:0
  ds_read_b64_tr_b16 v[56:57], v24 offset:0
  ds_read_b64_tr_b16 v[58:59], v24 offset:1024
  ds_read_b128 v[52:55], v20 offset:4096
  ds_read_b64_tr_b16 v[60:61], v25 offset:0
  ds_read_b64_tr_b16 v[62:63], v25 offset:1024
  ds_read_b64_tr_b16 v[64:65], v26 offset:0
  ds_read_b64_tr_b16 v[66:67], v26 offset:1024
  ds_read_b64_tr_b16 v[68:69], v27 offset:0
  ds_read_b64_tr_b16 v[70:71], v27 offset:1024
  s_waitcnt lgkmcnt(7)
  v_mfma_f32_32x32x16_bf16 v[128:143], v[56:59], v[48:51], 0
  ds_read_b128 v[72:75], v21 offset:0
  s_waitcnt lgkmcnt(7)
  v_mfma_f32_32x32x16_bf16 v[192:207], v[56:59], v[52:55], 0
  ds_read_b64_tr_b16 v[80:81], v24 offset:4096
  ds_read_b64_tr_b16 v[82:83], v24 offset:5120
  s_waitcnt lgkmcnt(7)
  v_mfma_f32_32x32x16_bf16 v[144:159], v[60:63], v[48:51], 0
  ds_read_b128 v[76:79], v21 offset:4096
  s_cmp_lg_u32 s73, 0
  s_cbranch_scc1 .Lk1t2
  v_lshrrev_b32 v3, 3, v0
  v_lshlrev_b32 v3, 6, v3
  v_and_or_b32 v3, v0, 7, v3
  v_lshlrev_b32 v3, 7, v3
  s_and_b32 s55, s2, 7
  s_lshl_b32 s55, s55, 10
  v_add_u32 v3, s55, v3
  s_lshr_b32 s56, s2, 3
  s_mov_b32 s88, s8
  s_mov_b32 s89, s9
  s_mov_b32 s90, 4194304
  s_mov_b32 s55, 16
  s_cmp_ge_u32 s56, 16
  s_cselect_b32 s88, s12, s88
  s_cselect_b32 s89, s13, s89
  s_cselect_b32 s90, 4194304, s90
  s_cselect_b32 s55, 0, s55
  s_mov_b32 s91, 0x00020000
  s_add_u32 s55, s55, s56
  s_lshl_b32 s55, s55, 16
  v_add_u32 v3, s55, v3
  buffer_load_dword v43, v3, s[88:91], 0 offen
.Lk1t2:
  v_mfma_f32_32x32x16_bf16 v[208:223], v[60:63], v[52:55], 0
  ds_read_b64_tr_b16 v[84:85], v25 offset:4096
  ds_read_b64_tr_b16 v[86:87], v25 offset:5120
  s_waitcnt lgkmcnt(8)
  v_mfma_f32_32x32x16_bf16 v[160:175], v[64:67], v[48:51], 0
  ds_read_b64_tr_b16 v[88:89], v26 offset:4096
  ds_read_b64_tr_b16 v[90:91], v26 offset:5120
  v_mfma_f32_32x32x16_bf16 v[224:239], v[64:67], v[52:55], 0
  ds_read_b64_tr_b16 v[92:93], v27 offset:4096
  ds_read_b64_tr_b16 v[94:95], v27 offset:5120
  s_waitcnt lgkmcnt(10)
  v_mfma_f32_32x32x16_bf16 v[176:191], v[68:71], v[48:51], 0
  v_mfma_f32_32x32x16_bf16 v[240:255], v[68:71], v[52:55], 0
  s_waitcnt lgkmcnt(7)
  v_mfma_f32_32x32x16_bf16 v[128:143], v[80:83], v[72:75], v[128:143]
  ds_read_b128 v[48:51], v22 offset:0
  s_waitcnt lgkmcnt(7)
  v_mfma_f32_32x32x16_bf16 v[192:207], v[80:83], v[76:79], v[192:207]
  ds_read_b64_tr_b16 v[56:57], v24 offset:8192
  ds_read_b64_tr_b16 v[58:59], v24 offset:9216
  s_waitcnt lgkmcnt(7)
  v_mfma_f32_32x32x16_bf16 v[144:159], v[84:87], v[72:75], v[144:159]
  ds_read_b128 v[52:55], v22 offset:4096
  v_mfma_f32_32x32x16_bf16 v[208:223], v[84:87], v[76:79], v[208:223]
  ds_read_b64_tr_b16 v[60:61], v25 offset:8192
  ds_read_b64_tr_b16 v[62:63], v25 offset:9216
  s_waitcnt lgkmcnt(8)
  v_mfma_f32_32x32x16_bf16 v[160:175], v[88:91], v[72:75], v[160:175]
  ds_read_b64_tr_b16 v[64:65], v26 offset:8192
  ds_read_b64_tr_b16 v[66:67], v26 offset:9216
  v_mfma_f32_32x32x16_bf16 v[224:239], v[88:91], v[76:79], v[224:239]
  ds_read_b64_tr_b16 v[68:69], v27 offset:8192
  ds_read_b64_tr_b16 v[70:71], v27 offset:9216
  s_waitcnt lgkmcnt(10)
  v_mfma_f32_32x32x16_bf16 v[176:191], v[92:95], v[72:75], v[176:191]
  s_cmp_lg_u32 s73, 1
  s_cbranch_scc1 .Lk1t3
  v_lshlrev_b32 v3, 7, v0
  s_mov_b32 s88, s4
  s_mov_b32 s89, s5
  s_mov_b32 s90, 2097152
  s_mov_b32 s55, 0
  s_mov_b32 s91, 0x00020000
  s_add_u32 s55, s55, s2
  s_lshl_b32 s55, s55, 13
  v_add_u32 v3, s55, v3
  buffer_load_dword v43, v3, s[88:91], 0 offen
.Lk1t3:
  v_mfma_f32_32x32x16_bf16 v[240:255], v[92:95], v[76:79], v[240:255]
  s_waitcnt lgkmcnt(7)
  v_mfma_f32_32x32x16_bf16 v[128:143], v[56:59], v[48:51], v[128:143]
  ds_read_b128 v[72:75], v23 offset:0
  s_waitcnt lgkmcnt(7)
  v_mfma_f32_32x32x16_bf16 v[192:207], v[56:59], v[52:55], v[192:207]
  ds_read_b64_tr_b16 v[80:81], v24 offset:12288
  ds_read_b64_tr_b16 v[82:83], v24 offset:13312
  s_waitcnt lgkmcnt(7)
  v_mfma_f32_32x32x16_bf16 v[144:159], v[60:63], v[48:51], v[144:159]
  ds_read_b128 v[76:79], v23 offset:4096
  v_mfma_f32_32x32x16_bf16 v[208:223], v[60:63], v[52:55], v[208:223]
  ds_read_b64_tr_b16 v[84:85], v25 offset:12288
  ds_read_b64_tr_b16 v[86:87], v25 offset:13312
  s_waitcnt lgkmcnt(8)
  v_mfma_f32_32x32x16_bf16 v[160:175], v[64:67], v[48:51], v[160:175]
  ds_read_b64_tr_b16 v[88:89], v26 offset:12288
  ds_read_b64_tr_b16 v[90:91], v26 offset:13312
  v_mfma_f32_32x32x16_bf16 v[224:239], v[64:67], v[52:55], v[224:239]
  ds_read_b64_tr_b16 v[92:93], v27 offset:12288
  ds_read_b64_tr_b16 v[94:95], v27 offset:13312
  s_waitcnt lgkmcnt(10)
  v_mfma_f32_32x32x16_bf16 v[176:191], v[68:71], v[48:51], v[176:191]
  v_mfma_f32_32x32x16_bf16 v[240:255], v[68:71], v[52:55], v[240:255]
  s_waitcnt lgkmcnt(7)
  v_mfma_f32_32x32x16_bf16 v[128:143], v[80:83], v[72:75], v[128:143]
  s_waitcnt lgkmcnt(6)
  v_mfma_f32_32x32x16_bf16 v[192:207], v[80:83], v[76:79], v[192:207]
  v_add_u32 v20, 0x10000, v20
  v_add_u32 v21, 0x10000, v21
  v_add_u32 v22, 0x10000, v22
  v_add_u32 v23, 0x10000, v23
  v_add_u32 v24, 0x10000, v24
  v_add_u32 v25, 0x10000, v25
  v_add_u32 v26, 0x10000, v26
  v_add_u32 v27, 0x10000, v27
  s_waitcnt lgkmcnt(0)
  s_waitcnt vmcnt(4)
  s_barrier
  ds_read_b128 v[48:51], v20 offset:0
  s_add_u32 m0, s58, 0
  s_cmp_lt_u32 s2, 160
  s_cselect_b32 s26, s69, 0
  s_mov_b32 s57, 0
  buffer_load_dwordx4 v16, s[24:27], s57 offen offset:0 lds
  v_mfma_f32_32x32x16_bf16 v[144:159], v[84:87], v[72:75], v[144:159]
  ds_read_b64_tr_b16 v[56:57], v24 offset:0
  ds_read_b64_tr_b16 v[58:59], v24 offset:1024
  s_cmp_lg_u32 s73, 2
  s_cbranch_scc1 .Lk1t4
  v_lshlrev_b32 v3, 7, v0
  s_mov_b32 s88, s80
  s_mov_b32 s89, s81
  s_mov_b32 s90, 2621440
  s_mov_b32 s91, 0x00020000
  s_bfe_u32 s55, s2, 0x20001
  s_mul_i32 s55, s55, 80
  s_lshr_b32 s56, s2, 3
  s_lshl_b32 s56, s56, 1
  s_add_u32 s55, s55, s56
  s_and_b32 s56, s2, 1
  s_add_u32 s55, s55, s56
  s_lshl_b32 s55, s55, 13
  buffer_load_dword v43, v3, s[88:91], s55 offen
.Lk1t4:
  buffer_load_dwordx4 v17, s[24:27], s57 offen offset:1024 lds
  v_mfma_f32_32x32x16_bf16 v[208:223], v[84:87], v[76:79], v[208:223]
  ds_read_b128 v[52:55], v20 offset:4096
  buffer_load_dwordx4 v18, s[24:27], s57 offen offset:2048 lds
  v_mfma_f32_32x32x16_bf16 v[160:175], v[88:91], v[72:75], v[160:175]
  ds_read_b64_tr_b16 v[60:61], v25 offset:0
  ds_read_b64_tr_b16 v[62:63], v25 offset:1024
  buffer_load_dwordx4 v19, s[24:27], s57 offen offset:3072 lds
  v_mfma_f32_32x32x16_bf16 v[224:239], v[88:91], v[76:79], v[224:239]
  ds_read_b64_tr_b16 v[64:65], v26 offset:0
  ds_read_b64_tr_b16 v[66:67], v26 offset:1024
  v_mfma_f32_32x32x16_bf16 v[176:191], v[92:95], v[72:75], v[176:191]
  ds_read_b64_tr_b16 v[68:69], v27 offset:0
  ds_read_b64_tr_b16 v[70:71], v27 offset:1024
  s_add_u32 m0, s58, 32768
  s_mov_b32 s57, 256
  buffer_load_dwordx4 v4, s[4:7], s57 offen offset:0 lds
  v_mfma_f32_32x32x16_bf16 v[240:255], v[92:95], v[76:79], v[240:255]
  s_waitcnt lgkmcnt(7)
  v_mfma_f32_32x32x16_bf16 v[128:143], v[56:59], v[48:51], v[128:143]
  ds_read_b128 v[72:75], v21 offset:0
  s_waitcnt lgkmcnt(7)
  v_mfma_f32_32x32x16_bf16 v[192:207], v[56:59], v[52:55], v[192:207]
  ds_read_b64_tr_b16 v[80:81], v24 offset:4096
  ds_read_b64_tr_b16 v[82:83], v24 offset:5120
  buffer_load_dwordx4 v5, s[4:7], s57 offen offset:1024 lds
  s_waitcnt lgkmcnt(7)
  v_mfma_f32_32x32x16_bf16 v[144:159], v[60:63], v[48:51], v[144:159]
  ds_read_b128 v[76:79], v21 offset:4096
  v_mfma_f32_32x32x16_bf16 v[208:223], v[60:63], v[52:55], v[208:223]
  ds_read_b64_tr_b16 v[84:85], v25 offset:4096
  ds_read_b64_tr_b16 v[86:87], v25 offset:5120
  s_waitcnt lgkmcnt(8)
  v_mfma_f32_32x32x16_bf16 v[160:175], v[64:67], v[48:51], v[160:175]
  ds_read_b64_tr_b16 v[88:89], v26 offset:4096
  ds_read_b64_tr_b16 v[90:91], v26 offset:5120
  buffer_load_dwordx4 v6, s[4:7], s57 offen offset:2048 lds
  v_mfma_f32_32x32x16_bf16 v[224:239], v[64:67], v[52:55], v[224:239]
  ds_read_b64_tr_b16 v[92:93], v27 offset:4096
  ds_read_b64_tr_b16 v[94:95], v27 offset:5120
  s_waitcnt lgkmcnt(10)
  v_mfma_f32_32x32x16_bf16 v[176:191], v[68:71], v[48:51], v[176:191]
  s_cmp_lg_u32 s73, 3
  s_cbranch_scc1 .Lk1t5
  v_lshlrev_b32 v3, 7, v0
  s_mov_b32 s88, s80
  s_mov_b32 s89, s81
  s_mov_b32 s90, 2621440
  s_mov_b32 s91, 0x00020000
  s_bfe_u32 s55, s2, 0x20001
  s_mul_i32 s55, s55, 80
  s_lshr_b32 s56, s2, 3
  s_lshl_b32 s56, s56, 1
  s_add_u32 s55, s55, s56
  s_and_b32 s56, s2, 1
  s_add_u32 s55, s55, s56
  s_add_u32 s55, s55, 64
  s_cmp_lt_u32 s2, 64
  s_cbranch_scc1 .Lk1t5g
  s_mul_i32 s56, s56, 50
  s_lshr_b32 s55, s2, 1
  s_sub_u32 s55, s55, 32
  s_add_u32 s55, s55, s56
  s_mov_b32 s90, 819200
  s_cmp_ge_u32 s2, 160
  s_cselect_b32 s88, s84, s82
  s_cselect_b32 s89, s85, s83
  s_cselect_b32 s56, 48, 0
  s_sub_u32 s55, s55, s56
.Lk1t5g:
  s_lshl_b32 s55, s55, 13
  buffer_load_dword v43, v3, s[88:91], s55 offen
.Lk1t5:
  v_mfma_f32_32x32x16_bf16 v[240:255], v[68:71], v[52:55], v[240:255]
  buffer_load_dwordx4 v7, s[4:7], s57 offen offset:3072 lds
  s_waitcnt lgkmcnt(7)
  v_mfma_f32_32x32x16_bf16 v[128:143], v[80:83], v[72:75], v[128:143]
  ds_read_b128 v[48:51], v22 offset:0
  s_waitcnt lgkmcnt(7)
  v_mfma_f32_32x32x16_bf16 v[192:207], v[80:83], v[76:79], v[192:207]
  ds_read_b64_tr_b16 v[56:57], v24 offset:8192
  ds_read_b64_tr_b16 v[58:59], v24 offset:9216
  s_waitcnt lgkmcnt(7)
  v_mfma_f32_32x32x16_bf16 v[144:159], v[84:87], v[72:75], v[144:159]
  ds_read_b128 v[52:55], v22 offset:4096
  v_mfma_f32_32x32x16_bf16 v[208:223], v[84:87], v[76:79], v[208:223]
  ds_read_b64_tr_b16 v[60:61], v25 offset:8192
  ds_read_b64_tr_b16 v[62:63], v25 offset:9216
  s_waitcnt lgkmcnt(8)
  v_mfma_f32_32x32x16_bf16 v[160:175], v[88:91], v[72:75], v[160:175]
  ds_read_b64_tr_b16 v[64:65], v26 offset:8192
  ds_read_b64_tr_b16 v[66:67], v26 offset:9216
  v_mfma_f32_32x32x16_bf16 v[224:239], v[88:91], v[76:79], v[224:239]
  ds_read_b64_tr_b16 v[68:69], v27 offset:8192
  ds_read_b64_tr_b16 v[70:71], v27 offset:9216
  s_waitcnt lgkmcnt(10)
  v_mfma_f32_32x32x16_bf16 v[176:191], v[92:95], v[72:75], v[176:191]
  v_mfma_f32_32x32x16_bf16 v[240:255], v[92:95], v[76:79], v[240:255]
  s_waitcnt lgkmcnt(7)
  v_mfma_f32_32x32x16_bf16 v[128:143], v[56:59], v[48:51], v[128:143]
  ds_read_b128 v[72:75], v23 offset:0
  s_waitcnt lgkmcnt(7)
  v_mfma_f32_32x32x16_bf16 v[192:207], v[56:59], v[52:55], v[192:207]
  ds_read_b64_tr_b16 v[80:81], v24 offset:12288
  ds_read_b64_tr_b16 v[82:83], v24 offset:13312
  s_waitcnt lgkmcnt(7)
  v_mfma_f32_32x32x16_bf16 v[144:159], v[60:63], v[48:51], v[144:159]
  ds_read_b128 v[76:79], v23 offset:4096
  v_mfma_f32_32x32x16_bf16 v[208:223], v[60:63], v[52:55], v[208:223]
  ds_read_b64_tr_b16 v[84:85], v25 offset:12288
  ds_read_b64_tr_b16 v[86:87], v25 offset:13312
  s_waitcnt lgkmcnt(8)
  v_mfma_f32_32x32x16_bf16 v[160:175], v[64:67], v[48:51], v[160:175]
  ds_read_b64_tr_b16 v[88:89], v26 offset:12288
  ds_read_b64_tr_b16 v[90:91], v26 offset:13312
  v_mfma_f32_32x32x16_bf16 v[224:239], v[64:67], v[52:55], v[224:239]
  ds_read_b64_tr_b16 v[92:93], v27 offset:12288
  ds_read_b64_tr_b16 v[94:95], v27 offset:13312
  s_waitcnt lgkmcnt(10)
  v_mfma_f32_32x32x16_bf16 v[176:191], v[68:71], v[48:51], v[176:191]
  v_mfma_f32_32x32x16_bf16 v[240:255], v[68:71], v[52:55], v[240:255]
  s_waitcnt lgkmcnt(7)
  v_mfma_f32_32x32x16_bf16 v[128:143], v[80:83], v[72:75], v[128:143]
  s_waitcnt lgkmcnt(6)
  v_mfma_f32_32x32x16_bf16 v[192:207], v[80:83], v[76:79], v[192:207]
  s_add_u32 s55, s63, 0x10000
  v_add_u32 v20, s55, v20
  v_add_u32 v21, s55, v21
  v_add_u32 v22, s55, v22
  v_add_u32 v23, s55, v23
  s_add_u32 s55, s72, 0xfffe0000
  v_add_u32 v28, s55, v20
  v_add_u32 v29, s55, v21
  v_add_u32 v30, s55, v22
  v_add_u32 v31, s55, v23
  s_waitcnt lgkmcnt(0)
  s_waitcnt vmcnt(4)
  s_barrier
  ds_read_b128 v[48:51], v20 offset:0
  s_add_u32 m0, s58, 65536
  s_mov_b32 s57, 1048576
  buffer_load_dwordx4 v8, s[8:11], s57 offen offset:0 lds
  v_mfma_f32_32x32x16_bf16 v[144:159], v[84:87], v[72:75], v[144:159]
  ds_read_b128 v[52:55], v28 offset:0
  buffer_load_dwordx4 v9, s[8:11], s57 offen offset:1024 lds
  v_mfma_f32_32x32x16_bf16 v[208:223], v[84:87], v[76:79], v[208:223]
  ds_read_b128 v[56:59], v28 offset:8192
  buffer_load_dwordx4 v10, s[8:11], s57 offen offset:2048 lds
  v_mfma_f32_32x32x16_bf16 v[160:175], v[88:91], v[72:75], v[160:175]
  ds_read_b128 v[60:63], v21 offset:0
  buffer_load_dwordx4 v11, s[8:11], s57 offen offset:3072 lds
  v_mfma_f32_32x32x16_bf16 v[224:239], v[88:91], v[76:79], v[224:239]
  ds_read_b128 v[64:67], v29 offset:0
  s_add_u32 m0, s58, 98304
  s_cmp_lt_u32 s2, 160
  s_cselect_b32 s22, s68, 0
  s_mov_b32 s57, 256
  buffer_load_dwordx4 v12, s[20:23], s57 offen offset:0 lds
  v_mfma_f32_32x32x16_bf16 v[176:191], v[92:95], v[72:75], v[176:191]
  ds_read_b128 v[68:71], v29 offset:8192
  buffer_load_dwordx4 v13, s[20:23], s57 offen offset:1024 lds
  v_mfma_f32_32x32x16_bf16 v[240:255], v[92:95], v[76:79], v[240:255]
  buffer_load_dwordx4 v14, s[20:23], s57 offen offset:2048 lds
  s_cmp_ge_u32 s2, 160
  s_cbranch_scc1 .Lk1_s0_2
  s_waitcnt lgkmcnt(4)
  v_mfma_f32_32x32x16_bf16 v[96:111], v[48:51], v[52:55], 0
  ds_read_b128 v[72:75], v22 offset:0
  ds_read_b128 v[76:79], v30 offset:0
  buffer_load_dwordx4 v15, s[20:23], s57 offen offset:3072 lds
  s_waitcnt lgkmcnt(5)
  v_mfma_f32_32x32x16_bf16 v[112:127], v[48:51], v[56:59], 0
  ds_read_b128 v[80:83], v30 offset:8192
  s_waitcnt lgkmcnt(4)
  v_mfma_f32_32x32x16_bf16 v[96:111], v[60:63], v[64:67], v[96:111]
  ds_read_b128 v[84:87], v23 offset:0
  ds_read_b128 v[88:91], v31 offset:0
  s_waitcnt lgkmcnt(5)
  v_mfma_f32_32x32x16_bf16 v[112:127], v[60:63], v[68:71], v[112:127]
  ds_read_b128 v[92:95], v31 offset:8192
  s_waitcnt lgkmcnt(4)
  v_mfma_f32_32x32x16_bf16 v[96:111], v[72:75], v[76:79], v[96:111]
  ds_read_b128 v[48:51], v20 offset:16384
  ds_read_b128 v[52:55], v28 offset:16384
  s_waitcnt lgkmcnt(5)
  v_mfma_f32_32x32x16_bf16 v[112:127], v[72:75], v[80:83], v[112:127]
  ds_read_b128 v[56:59], v28 offset:24576
  s_waitcnt lgkmcnt(4)
  v_mfma_f32_32x32x16_bf16 v[96:111], v[84:87], v[88:91], v[96:111]
  ds_read_b128 v[60:63], v21 offset:16384
  ds_read_b128 v[64:67], v29 offset:16384
  s_waitcnt lgkmcnt(5)
  v_mfma_f32_32x32x16_bf16 v[112:127], v[84:87], v[92:95], v[112:127]
  ds_read_b128 v[68:71], v29 offset:24576
  s_waitcnt lgkmcnt(4)
  v_mfma_f32_32x32x16_bf16 v[96:111], v[48:51], v[52:55], v[96:111]
  ds_read_b128 v[72:75], v22 offset:16384
  ds_read_b128 v[76:79], v30 offset:16384
  s_waitcnt lgkmcnt(5)
  v_mfma_f32_32x32x16_bf16 v[112:127], v[48:51], v[56:59], v[112:127]
  ds_read_b128 v[80:83], v30 offset:24576
  s_waitcnt lgkmcnt(4)
  v_mfma_f32_32x32x16_bf16 v[96:111], v[60:63], v[64:67], v[96:111]
  ds_read_b128 v[84:87], v23 offset:16384
  ds_read_b128 v[88:91], v31 offset:16384
  s_waitcnt lgkmcnt(5)
  v_mfma_f32_32x32x16_bf16 v[112:127], v[60:63], v[68:71], v[112:127]
  ds_read_b128 v[92:95], v31 offset:24576
  s_waitcnt lgkmcnt(4)
  v_mfma_f32_32x32x16_bf16 v[96:111], v[72:75], v[76:79], v[96:111]
  s_sub_u32 s55, 0xfffe8000, s63
  v_add_u32 v20, s55, v20
  v_add_u32 v21, s55, v21
  v_add_u32 v22, s55, v22
  v_add_u32 v23, s55, v23
  v_add_u32 v24, 0xffff8000, v24
  v_add_u32 v25, 0xffff8000, v25
  v_add_u32 v26, 0xffff8000, v26
  v_add_u32 v27, 0xffff8000, v27
  s_waitcnt lgkmcnt(0)
  s_waitcnt vmcnt(4)
  s_barrier
  ds_read_b128 v[48:51], v20 offset:0
  ds_read_b64_tr_b16 v[56:57], v24 offset:0
  ds_read_b64_tr_b16 v[58:59], v24 offset:1024
  s_add_u32 m0, s58, 131072
  s_cmp_lt_u32 s2, 160
  s_cselect_b32 s26, s69, 0
  s_mov_b32 s57, 256
  buffer_load_dwordx4 v16, s[24:27], s57 offen offset:0 lds
  v_mfma_f32_32x32x16_bf16 v[112:127], v[72:75], v[80:83], v[112:127]
  ds_read_b128 v[52:55], v20 offset:4096
  ds_read_b64_tr_b16 v[60:61], v25 offset:0
  ds_read_b64_tr_b16 v[62:63], v25 offset:1024
  buffer_load_dwordx4 v17, s[24:27], s57 offen offset:1024 lds
  v_mfma_f32_32x32x16_bf16 v[96:111], v[84:87], v[88:91], v[96:111]
  ds_read_b64_tr_b16 v[64:65], v26 offset:0
  ds_read_b64_tr_b16 v[66:67], v26 offset:1024
  ds_read_b64_tr_b16 v[68:69], v27 offset:0
  ds_read_b64_tr_b16 v[70:71], v27 offset:1024
  buffer_load_dwordx4 v18, s[24:27], s57 offen offset:2048 lds
  v_mfma_f32_32x32x16_bf16 v[112:127], v[84:87], v[92:95], v[112:127]
  buffer_load_dwordx4 v19, s[24:27], s57 offen offset:3072 lds
.Lk1_s0_2r:
  s_waitcnt lgkmcnt(7)
  v_mfma_f32_32x32x16_bf16 v[128:143], v[56:59], v[48:51], v[128:143]
  ds_read_b128 v[72:75], v21 offset:0
  s_waitcnt lgkmcnt(7)
  v_mfma_f32_32x32x16_bf16 v[192:207], v[56:59], v[52:55], v[192:207]
  ds_read_b64_tr_b16 v[80:81], v24 offset:4096
  ds_read_b64_tr_b16 v[82:83], v24 offset:5120
  s_add_u32 m0, s58, 0
  s_mov_b32 s57, 384
  buffer_load_dwordx4 v4, s[4:7], s57 offen offset:0 lds
  s_waitcnt lgkmcnt(7)
  v_mfma_f32_32x32x16_bf16 v[144:159], v[60:63], v[48:51], v[144:159]
  ds_read_b128 v[76:79], v21 offset:4096
  v_mfma_f32_32x32x16_bf16 v[208:223], v[60:63], v[52:55], v[208:223]
  ds_read_b64_tr_b16 v[84:85], v25 offset:4096
  ds_read_b64_tr_b16 v[86:87], v25 offset:5120
  s_waitcnt lgkmcnt(8)
  v_mfma_f32_32x32x16_bf16 v[160:175], v[64:67], v[48:51], v[160:175]
  ds_read_b64_tr_b16 v[88:89], v26 offset:4096
  ds_read_b64_tr_b16 v[90:91], v26 offset:5120
  buffer_load_dwordx4 v5, s[4:7], s57 offen offset:1024 lds
  v_mfma_f32_32x32x16_bf16 v[224:239], v[64:67], v[52:55], v[224:239]
  ds_read_b64_tr_b16 v[92:93], v27 offset:4096
  ds_read_b64_tr_b16 v[94:95], v27 offset:5120
  s_waitcnt lgkmcnt(10)
  v_mfma_f32_32x32x16_bf16 v[176:191], v[68:71], v[48:51], v[176:191]
  v_mfma_f32_32x32x16_bf16 v[240:255], v[68:71], v[52:55], v[240:255]
  buffer_load_dwordx4 v6, s[4:7], s57 offen offset:2048 lds
  s_waitcnt lgkmcnt(7)
  v_mfma_f32_32x32x16_bf16 v[128:143], v[80:83], v[72:75], v[128:143]
  ds_read_b128 v[48:51], v22 offset:0
  s_waitcnt lgkmcnt(7)
  v_mfma_f32_32x32x16_bf16 v[192:207], v[80:83], v[76:79], v[192:207]
  ds_read_b64_tr_b16 v[56:57], v24 offset:8192
  ds_read_b64_tr_b16 v[58:59], v24 offset:9216
  s_waitcnt lgkmcnt(7)
  v_mfma_f32_32x32x16_bf16 v[144:159], v[84:87], v[72:75], v[144:159]
  ds_read_b128 v[52:55], v22 offset:4096
  buffer_load_dwordx4 v7, s[4:7], s57 offen offset:3072 lds
  v_mfma_f32_32x32x16_bf16 v[208:223], v[84:87], v[76:79], v[208:223]
  ds_read_b64_tr_b16 v[60:61], v25 offset:8192
  ds_read_b64_tr_b16 v[62:63], v25 offset:9216
  s_waitcnt lgkmcnt(8)
  v_mfma_f32_32x32x16_bf16 v[160:175], v[88:91], v[72:75], v[160:175]
  ds_read_b64_tr_b16 v[64:65], v26 offset:8192
  ds_read_b64_tr_b16 v[66:67], v26 offset:9216
  v_mfma_f32_32x32x16_bf16 v[224:239], v[88:91], v[76:79], v[224:239]
  ds_read_b64_tr_b16 v[68:69], v27 offset:8192
  ds_read_b64_tr_b16 v[70:71], v27 offset:9216
  s_waitcnt lgkmcnt(10)
  v_mfma_f32_32x32x16_bf16 v[176:191], v[92:95], v[72:75], v[176:191]
  v_mfma_f32_32x32x16_bf16 v[240:255], v[92:95], v[76:79], v[240:255]
  s_waitcnt lgkmcnt(7)
  v_mfma_f32_32x32x16_bf16 v[128:143], v[56:59], v[48:51], v[128:143]
  ds_read_b128 v[72:75], v23 offset:0
  s_waitcnt lgkmcnt(7)
  v_mfma_f32_32x32x16_bf16 v[192:207], v[56:59], v[52:55], v[192:207]
  ds_read_b64_tr_b16 v[80:81], v24 offset:12288
  ds_read_b64_tr_b16 v[82:83], v24 offset:13312
  s_waitcnt lgkmcnt(7)
  v_mfma_f32_32x32x16_bf16 v[144:159], v[60:63], v[48:51], v[144:159]
  ds_read_b128 v[76:79], v23 offset:4096
  v_mfma_f32_32x32x16_bf16 v[208:223], v[60:63], v[52:55], v[208:223]
  ds_read_b64_tr_b16 v[84:85], v25 offset:12288
  ds_read_b64_tr_b16 v[86:87], v25 offset:13312
  s_waitcnt lgkmcnt(8)
  v_mfma_f32_32x32x16_bf16 v[160:175], v[64:67], v[48:51], v[160:175]
  ds_read_b64_tr_b16 v[88:89], v26 offset:12288
  ds_read_b64_tr_b16 v[90:91], v26 offset:13312
  v_mfma_f32_32x32x16_bf16 v[224:239], v[64:67], v[52:55], v[224:239]
  ds_read_b64_tr_b16 v[92:93], v27 offset:12288
  ds_read_b64_tr_b16 v[94:95], v27 offset:13312
  s_waitcnt lgkmcnt(10)
  v_mfma_f32_32x32x16_bf16 v[176:191], v[68:71], v[48:51], v[176:191]
  v_mfma_f32_32x32x16_bf16 v[240:255], v[68:71], v[52:55], v[240:255]
  s_waitcnt lgkmcnt(7)
  v_mfma_f32_32x32x16_bf16 v[128:143], v[80:83], v[72:75], v[128:143]
  s_waitcnt lgkmcnt(6)
  v_mfma_f32_32x32x16_bf16 v[192:207], v[80:83], v[76:79], v[192:207]
  s_add_u32 s55, s63, 0x10000
  v_add_u32 v20, s55, v20
  v_add_u32 v21, s55, v21
  v_add_u32 v22, s55, v22
  v_add_u32 v23, s55, v23
  s_add_u32 s55, s72, 0x8000
  v_add_u32 v28, s55, v20
  v_add_u32 v29, s55, v21
  v_add_u32 v30, s55, v22
  v_add_u32 v31, s55, v23
  s_waitcnt lgkmcnt(0)
  s_waitcnt vmcnt(4)
  s_barrier
  ds_read_b128 v[48:51], v20 offset:0
  s_add_u32 m0, s58, 32768
  s_mov_b32 s57, 1572864
  buffer_load_dwordx4 v8, s[8:11], s57 offen offset:0 lds
  v_mfma_f32_32x32x16_bf16 v[144:159], v[84:87], v[72:75], v[144:159]
  ds_read_b128 v[52:55], v28 offset:0
  buffer_load_dwordx4 v9, s[8:11], s57 offen offset:1024 lds
  v_mfma_f32_32x32x16_bf16 v[208:223], v[84:87], v[76:79], v[208:223]
  ds_read_b128 v[56:59], v28 offset:8192
  buffer_load_dwordx4 v10, s[8:11], s57 offen offset:2048 lds
  v_mfma_f32_32x32x16_bf16 v[160:175], v[88:91], v[72:75], v[160:175]
  ds_read_b128 v[60:63], v21 offset:0
  buffer_load_dwordx4 v11, s[8:11], s57 offen offset:3072 lds
  v_mfma_f32_32x32x16_bf16 v[224:239], v[88:91], v[76:79], v[224:239]
  ds_read_b128 v[64:67], v29 offset:0
  s_add_u32 m0, s58, 65536
  s_cmp_lt_u32 s2, 160
  s_cselect_b32 s22, s68, 0
  s_mov_b32 s57, 512
  buffer_load_dwordx4 v12, s[20:23], s57 offen offset:0 lds
  v_mfma_f32_32x32x16_bf16 v[176:191], v[92:95], v[72:75], v[176:191]
  ds_read_b128 v[68:71], v29 offset:8192
  buffer_load_dwordx4 v13, s[20:23], s57 offen offset:1024 lds
  v_mfma_f32_32x32x16_bf16 v[240:255], v[92:95], v[76:79], v[240:255]
  buffer_load_dwordx4 v14, s[20:23], s57 offen offset:2048 lds
  s_cmp_ge_u32 s2, 160
  s_cbranch_scc1 .Lk1_s0_4
  s_waitcnt lgkmcnt(4)
  v_mfma_f32_32x32x16_bf16 v[96:111], v[48:51], v[52:55], v[96:111]
  ds_read_b128 v[72:75], v22 offset:0
  ds_read_b128 v[76:79], v30 offset:0
  buffer_load_dwordx4 v15, s[20:23], s57 offen offset:3072 lds
  s_waitcnt lgkmcnt(5)
  v_mfma_f32_32x32x16_bf16 v[112:127], v[48:51], v[56:59], v[112:127]
  ds_read_b128 v[80:83], v30 offset:8192
  s_waitcnt lgkmcnt(4)
  v_mfma_f32_32x32x16_bf16 v[96:111], v[60:63], v[64:67], v[96:111]
  ds_read_b128 v[84:87], v23 offset:0
  ds_read_b128 v[88:91], v31 offset:0
  s_waitcnt lgkmcnt(5)
  v_mfma_f32_32x32x16_bf16 v[112:127], v[60:63], v[68:71], v[112:127]
  ds_read_b128 v[92:95], v31 offset:8192
  s_waitcnt lgkmcnt(4)
  v_mfma_f32_32x32x16_bf16 v[96:111], v[72:75], v[76:79], v[96:111]
  ds_read_b128 v[48:51], v20 offset:16384
  ds_read_b128 v[52:55], v28 offset:16384
  s_waitcnt lgkmcnt(5)
  v_mfma_f32_32x32x16_bf16 v[112:127], v[72:75], v[80:83], v[112:127]
  ds_read_b128 v[56:59], v28 offset:24576
  s_waitcnt lgkmcnt(4)
  v_mfma_f32_32x32x16_bf16 v[96:111], v[84:87], v[88:91], v[96:111]
  ds_read_b128 v[60:63], v21 offset:16384
  ds_read_b128 v[64:67], v29 offset:16384
  s_waitcnt lgkmcnt(5)
  v_mfma_f32_32x32x16_bf16 v[112:127], v[84:87], v[92:95], v[112:127]
  ds_read_b128 v[68:71], v29 offset:24576
  s_waitcnt lgkmcnt(4)
  v_mfma_f32_32x32x16_bf16 v[96:111], v[48:51], v[52:55], v[96:111]
  ds_read_b128 v[72:75], v22 offset:16384
  ds_read_b128 v[76:79], v30 offset:16384
  s_waitcnt lgkmcnt(5)
  v_mfma_f32_32x32x16_bf16 v[112:127], v[48:51], v[56:59], v[112:127]
  ds_read_b128 v[80:83], v30 offset:24576
  s_waitcnt lgkmcnt(4)
  v_mfma_f32_32x32x16_bf16 v[96:111], v[60:63], v[64:67], v[96:111]
  ds_read_b128 v[84:87], v23 offset:16384
  ds_read_b128 v[88:91], v31 offset:16384
  s_waitcnt lgkmcnt(5)
  v_mfma_f32_32x32x16_bf16 v[112:127], v[60:63], v[68:71], v[112:127]
  ds_read_b128 v[92:95], v31 offset:24576
  s_waitcnt lgkmcnt(4)
  v_mfma_f32_32x32x16_bf16 v[96:111], v[72:75], v[76:79], v[96:111]
  s_sub_u32 s55, 0xfffe8000, s63
  v_add_u32 v20, s55, v20
  v_add_u32 v21, s55, v21
  v_add_u32 v22, s55, v22
  v_add_u32 v23, s55, v23
  v_add_u32 v24, 0xffff8000, v24
  v_add_u32 v25, 0xffff8000, v25
  v_add_u32 v26, 0xffff8000, v26
  v_add_u32 v27, 0xffff8000, v27
  s_waitcnt lgkmcnt(0)
  s_waitcnt vmcnt(4)
  s_barrier
  ds_read_b128 v[48:51], v20 offset:0
  ds_read_b64_tr_b16 v[56:57], v24 offset:0
  ds_read_b64_tr_b16 v[58:59], v24 offset:1024
  s_add_u32 m0, s58, 98304
  s_cmp_lt_u32 s2, 160
  s_cselect_b32 s26, s69, 0
  s_mov_b32 s57, 512
  buffer_load_dwordx4 v16, s[24:27], s57 offen offset:0 lds
  v_mfma_f32_32x32x16_bf16 v[112:127], v[72:75], v[80:83], v[112:127]
  ds_read_b128 v[52:55], v20 offset:4096
  ds_read_b64_tr_b16 v[60:61], v25 offset:0
  ds_read_b64_tr_b16 v[62:63], v25 offset:1024
  buffer_load_dwordx4 v17, s[24:27], s57 offen offset:1024 lds
  v_mfma_f32_32x32x16_bf16 v[96:111], v[84:87], v[88:91], v[96:111]
  ds_read_b64_tr_b16 v[64:65], v26 offset:0
  ds_read_b64_tr_b16 v[66:67], v26 offset:1024
  ds_read_b64_tr_b16 v[68:69], v27 offset:0
  ds_read_b64_tr_b16 v[70:71], v27 offset:1024
  buffer_load_dwordx4 v18, s[24:27], s57 offen offset:2048 lds
  v_mfma_f32_32x32x16_bf16 v[112:127], v[84:87], v[92:95], v[112:127]
  buffer_load_dwordx4 v19, s[24:27], s57 offen offset:3072 lds
.Lk1_s0_4r:
  s_waitcnt lgkmcnt(7)
  v_mfma_f32_32x32x16_bf16 v[128:143], v[56:59], v[48:51], v[128:143]
  ds_read_b128 v[72:75], v21 offset:0
  s_waitcnt lgkmcnt(7)
  v_mfma_f32_32x32x16_bf16 v[192:207], v[56:59], v[52:55], v[192:207]
  ds_read_b64_tr_b16 v[80:81], v24 offset:4096
  ds_read_b64_tr_b16 v[82:83], v24 offset:5120
  s_add_u32 m0, s58, 131072
  s_mov_b32 s57, 512
  buffer_load_dwordx4 v4, s[4:7], s57 offen offset:0 lds
  s_waitcnt lgkmcnt(7)
  v_mfma_f32_32x32x16_bf16 v[144:159], v[60:63], v[48:51], v[144:159]
  ds_read_b128 v[76:79], v21 offset:4096
  v_mfma_f32_32x32x16_bf16 v[208:223], v[60:63], v[52:55], v[208:223]
  ds_read_b64_tr_b16 v[84:85], v25 offset:4096
  ds_read_b64_tr_b16 v[86:87], v25 offset:5120
  s_waitcnt lgkmcnt(8)
  v_mfma_f32_32x32x16_bf16 v[160:175], v[64:67], v[48:51], v[160:175]
  ds_read_b64_tr_b16 v[88:89], v26 offset:4096
  ds_read_b64_tr_b16 v[90:91], v26 offset:5120
  buffer_load_dwordx4 v5, s[4:7], s57 offen offset:1024 lds
  v_mfma_f32_32x32x16_bf16 v[224:239], v[64:67], v[52:55], v[224:239]
  ds_read_b64_tr_b16 v[92:93], v27 offset:4096
  ds_read_b64_tr_b16 v[94:95], v27 offset:5120
  s_waitcnt lgkmcnt(10)
  v_mfma_f32_32x32x16_bf16 v[176:191], v[68:71], v[48:51], v[176:191]
  v_mfma_f32_32x32x16_bf16 v[240:255], v[68:71], v[52:55], v[240:255]
  buffer_load_dwordx4 v6, s[4:7], s57 offen offset:2048 lds
  s_waitcnt lgkmcnt(7)
  v_mfma_f32_32x32x16_bf16 v[128:143], v[80:83], v[72:75], v[128:143]
  ds_read_b128 v[48:51], v22 offset:0
  s_waitcnt lgkmcnt(7)
  v_mfma_f32_32x32x16_bf16 v[192:207], v[80:83], v[76:79], v[192:207]
  ds_read_b64_tr_b16 v[56:57], v24 offset:8192
  ds_read_b64_tr_b16 v[58:59], v24 offset:9216
  s_waitcnt lgkmcnt(7)
  v_mfma_f32_32x32x16_bf16 v[144:159], v[84:87], v[72:75], v[144:159]
  ds_read_b128 v[52:55], v22 offset:4096
  buffer_load_dwordx4 v7, s[4:7], s57 offen offset:3072 lds
  v_mfma_f32_32x32x16_bf16 v[208:223], v[84:87], v[76:79], v[208:223]
  ds_read_b64_tr_b16 v[60:61], v25 offset:8192
  ds_read_b64_tr_b16 v[62:63], v25 offset:9216
  s_waitcnt lgkmcnt(8)
  v_mfma_f32_32x32x16_bf16 v[160:175], v[88:91], v[72:75], v[160:175]
  ds_read_b64_tr_b16 v[64:65], v26 offset:8192
  ds_read_b64_tr_b16 v[66:67], v26 offset:9216
  v_mfma_f32_32x32x16_bf16 v[224:239], v[88:91], v[76:79], v[224:239]
  ds_read_b64_tr_b16 v[68:69], v27 offset:8192
  ds_read_b64_tr_b16 v[70:71], v27 offset:9216
  s_waitcnt lgkmcnt(10)
  v_mfma_f32_32x32x16_bf16 v[176:191], v[92:95], v[72:75], v[176:191]
  v_mfma_f32_32x32x16_bf16 v[240:255], v[92:95], v[76:79], v[240:255]
  s_waitcnt lgkmcnt(7)
  v_mfma_f32_32x32x16_bf16 v[128:143], v[56:59], v[48:51], v[128:143]
  ds_read_b128 v[72:75], v23 offset:0
  s_waitcnt lgkmcnt(7)
  v_mfma_f32_32x32x16_bf16 v[192:207], v[56:59], v[52:55], v[192:207]
  ds_read_b64_tr_b16 v[80:81], v24 offset:12288
  ds_read_b64_tr_b16 v[82:83], v24 offset:13312
  s_waitcnt lgkmcnt(7)
  v_mfma_f32_32x32x16_bf16 v[144:159], v[60:63], v[48:51], v[144:159]
  ds_read_b128 v[76:79], v23 offset:4096
  v_mfma_f32_32x32x16_bf16 v[208:223], v[60:63], v[52:55], v[208:223]
  ds_read_b64_tr_b16 v[84:85], v25 offset:12288
  ds_read_b64_tr_b16 v[86:87], v25 offset:13312
  s_waitcnt lgkmcnt(8)
  v_mfma_f32_32x32x16_bf16 v[160:175], v[64:67], v[48:51], v[160:175]
  ds_read_b64_tr_b16 v[88:89], v26 offset:12288
  ds_read_b64_tr_b16 v[90:91], v26 offset:13312
  v_mfma_f32_32x32x16_bf16 v[224:239], v[64:67], v[52:55], v[224:239]
  ds_read_b64_tr_b16 v[92:93], v27 offset:12288
  ds_read_b64_tr_b16 v[94:95], v27 offset:13312
  s_waitcnt lgkmcnt(10)
  v_mfma_f32_32x32x16_bf16 v[176:191], v[68:71], v[48:51], v[176:191]
  v_mfma_f32_32x32x16_bf16 v[240:255], v[68:71], v[52:55], v[240:255]
  s_waitcnt lgkmcnt(7)
  v_mfma_f32_32x32x16_bf16 v[128:143], v[80:83], v[72:75], v[128:143]
  s_waitcnt lgkmcnt(6)
  v_mfma_f32_32x32x16_bf16 v[192:207], v[80:83], v[76:79], v[192:207]
  s_add_u32 s55, s63, 0x10000
  v_add_u32 v20, s55, v20
  v_add_u32 v21, s55, v21
  v_add_u32 v22, s55, v22
  v_add_u32 v23, s55, v23
  s_add_u32 s55, s72, 0x8000
  v_add_u32 v28, s55, v20
  v_add_u32 v29, s55, v21
  v_add_u32 v30, s55, v22
  v_add_u32 v31, s55, v23
  s_waitcnt lgkmcnt(0)
  s_waitcnt vmcnt(4)
  s_barrier
  ds_read_b128 v[48:51], v20 offset:0
  s_add_u32 m0, s58, 0
  s_mov_b32 s57, 2097152
  buffer_load_dwordx4 v8, s[8:11], s57 offen offset:0 lds
  v_mfma_f32_32x32x16_bf16 v[144:159], v[84:87], v[72:75], v[144:159]
  ds_read_b128 v[52:55], v28 offset:0
  buffer_load_dwordx4 v9, s[8:11], s57 offen offset:1024 lds
  v_mfma_f32_32x32x16_bf16 v[208:223], v[84:87], v[76:79], v[208:223]
  ds_read_b128 v[56:59], v28 offset:8192
  buffer_load_dwordx4 v10, s[8:11], s57 offen offset:2048 lds
  v_mfma_f32_32x32x16_bf16 v[160:175], v[88:91], v[72:75], v[160:175]
  ds_read_b128 v[60:63], v21 offset:0
  buffer_load_dwordx4 v11, s[8:11], s57 offen offset:3072 lds
  v_mfma_f32_32x32x16_bf16 v[224:239], v[88:91], v[76:79], v[224:239]
  ds_read_b128 v[64:67], v29 offset:0
  s_add_u32 m0, s58, 32768
  s_mov_b32 s22, s68
  s_mov_b32 s57, 768
  buffer_load_dwordx4 v12, s[20:23], s57 offen offset:0 lds
  v_mfma_f32_32x32x16_bf16 v[176:191], v[92:95], v[72:75], v[176:191]
  ds_read_b128 v[68:71], v29 offset:8192
  buffer_load_dwordx4 v13, s[20:23], s57 offen offset:1024 lds
  v_mfma_f32_32x32x16_bf16 v[240:255], v[92:95], v[76:79], v[240:255]
  buffer_load_dwordx4 v14, s[20:23], s57 offen offset:2048 lds
  s_cmp_ge_u32 s2, 160
  s_cbranch_scc1 .Lk1_s0_6
  s_waitcnt lgkmcnt(4)
  v_mfma_f32_32x32x16_bf16 v[96:111], v[48:51], v[52:55], v[96:111]
  ds_read_b128 v[72:75], v22 offset:0
  ds_read_b128 v[76:79], v30 offset:0
  buffer_load_dwordx4 v15, s[20:23], s57 offen offset:3072 lds
  s_waitcnt lgkmcnt(5)
  v_mfma_f32_32x32x16_bf16 v[112:127], v[48:51], v[56:59], v[112:127]
  ds_read_b128 v[80:83], v30 offset:8192
  s_waitcnt lgkmcnt(4)
  v_mfma_f32_32x32x16_bf16 v[96:111], v[60:63], v[64:67], v[96:111]
  ds_read_b128 v[84:87], v23 offset:0
  ds_read_b128 v[88:91], v31 offset:0
  s_waitcnt lgkmcnt(5)
  v_mfma_f32_32x32x16_bf16 v[112:127], v[60:63], v[68:71], v[112:127]
  ds_read_b128 v[92:95], v31 offset:8192
  s_waitcnt lgkmcnt(4)
  v_mfma_f32_32x32x16_bf16 v[96:111], v[72:75], v[76:79], v[96:111]
  ds_read_b128 v[48:51], v20 offset:16384
  ds_read_b128 v[52:55], v28 offset:16384
  s_waitcnt lgkmcnt(5)
  v_mfma_f32_32x32x16_bf16 v[112:127], v[72:75], v[80:83], v[112:127]
  ds_read_b128 v[56:59], v28 offset:24576
  s_waitcnt lgkmcnt(4)
  v_mfma_f32_32x32x16_bf16 v[96:111], v[84:87], v[88:91], v[96:111]
  ds_read_b128 v[60:63], v21 offset:16384
  ds_read_b128 v[64:67], v29 offset:16384
  s_waitcnt lgkmcnt(5)
  v_mfma_f32_32x32x16_bf16 v[112:127], v[84:87], v[92:95], v[112:127]
  ds_read_b128 v[68:71], v29 offset:24576
  s_waitcnt lgkmcnt(4)
  v_mfma_f32_32x32x16_bf16 v[96:111], v[48:51], v[52:55], v[96:111]
  ds_read_b128 v[72:75], v22 offset:16384
  ds_read_b128 v[76:79], v30 offset:16384
  s_waitcnt lgkmcnt(5)
  v_mfma_f32_32x32x16_bf16 v[112:127], v[48:51], v[56:59], v[112:127]
  ds_read_b128 v[80:83], v30 offset:24576
  s_waitcnt lgkmcnt(4)
  v_mfma_f32_32x32x16_bf16 v[96:111], v[60:63], v[64:67], v[96:111]
  ds_read_b128 v[84:87], v23 offset:16384
  ds_read_b128 v[88:91], v31 offset:16384
  s_waitcnt lgkmcnt(5)
  v_mfma_f32_32x32x16_bf16 v[112:127], v[60:63], v[68:71], v[112:127]
  ds_read_b128 v[92:95], v31 offset:24576
  s_waitcnt lgkmcnt(4)
  v_mfma_f32_32x32x16_bf16 v[96:111], v[72:75], v[76:79], v[96:111]
  s_sub_u32 s55, 0x10000, s63
  v_add_u32 v20, s55, v20
  v_add_u32 v21, s55, v21
  v_add_u32 v22, s55, v22
  v_add_u32 v23, s55, v23
  v_add_u32 v24, 0xffff8000, v24
  v_add_u32 v25, 0xffff8000, v25
  v_add_u32 v26, 0xffff8000, v26
  v_add_u32 v27, 0xffff8000, v27
  s_waitcnt lgkmcnt(0)
  s_waitcnt vmcnt(4)
  s_barrier
  ds_read_b128 v[48:51], v20 offset:0
  ds_read_b64_tr_b16 v[56:57], v24 offset:0
  ds_read_b64_tr_b16 v[58:59], v24 offset:1024
  s_add_u32 m0, s58, 65536
  s_mov_b32 s26, s69
  s_mov_b32 s57, 768
  buffer_load_dwordx4 v16, s[24:27], s57 offen offset:0 lds
  v_mfma_f32_32x32x16_bf16 v[112:127], v[72:75], v[80:83], v[112:127]
  ds_read_b128 v[52:55], v20 offset:4096
  ds_read_b64_tr_b16 v[60:61], v25 offset:0
  ds_read_b64_tr_b16 v[62:63], v25 offset:1024
  buffer_load_dwordx4 v17, s[24:27], s57 offen offset:1024 lds
  v_mfma_f32_32x32x16_bf16 v[96:111], v[84:87], v[88:91], v[96:111]
  ds_read_b64_tr_b16 v[64:65], v26 offset:0
  ds_read_b64_tr_b16 v[66:67], v26 offset:1024
  ds_read_b64_tr_b16 v[68:69], v27 offset:0
  ds_read_b64_tr_b16 v[70:71], v27 offset:1024
  buffer_load_dwordx4 v18, s[24:27], s57 offen offset:2048 lds
  v_mfma_f32_32x32x16_bf16 v[112:127], v[84:87], v[92:95], v[112:127]
  buffer_load_dwordx4 v19, s[24:27], s57 offen offset:3072 lds
.Lk1_s0_6r:
  s_waitcnt lgkmcnt(7)
  v_mfma_f32_32x32x16_bf16 v[128:143], v[56:59], v[48:51], v[128:143]
  ds_read_b128 v[72:75], v21 offset:0
  s_waitcnt lgkmcnt(7)
  v_mfma_f32_32x32x16_bf16 v[192:207], v[56:59], v[52:55], v[192:207]
  ds_read_b64_tr_b16 v[80:81], v24 offset:4096
  ds_read_b64_tr_b16 v[82:83], v24 offset:5120
  s_add_u32 m0, s58, 98304
  s_mov_b32 s57, 640
  buffer_load_dwordx4 v4, s[4:7], s57 offen offset:0 lds
  s_waitcnt lgkmcnt(7)
  v_mfma_f32_32x32x16_bf16 v[144:159], v[60:63], v[48:51], v[144:159]
  ds_read_b128 v[76:79], v21 offset:4096
  v_mfma_f32_32x32x16_bf16 v[208:223], v[60:63], v[52:55], v[208:223]
  ds_read_b64_tr_b16 v[84:85], v25 offset:4096
  ds_read_b64_tr_b16 v[86:87], v25 offset:5120
  s_waitcnt lgkmcnt(8)
  v_mfma_f32_32x32x16_bf16 v[160:175], v[64:67], v[48:51], v[160:175]
  ds_read_b64_tr_b16 v[88:89], v26 offset:4096
  ds_read_b64_tr_b16 v[90:91], v26 offset:5120
  buffer_load_dwordx4 v5, s[4:7], s57 offen offset:1024 lds
  v_mfma_f32_32x32x16_bf16 v[224:239], v[64:67], v[52:55], v[224:239]
  ds_read_b64_tr_b16 v[92:93], v27 offset:4096
  ds_read_b64_tr_b16 v[94:95], v27 offset:5120
  s_waitcnt lgkmcnt(10)
  v_mfma_f32_32x32x16_bf16 v[176:191], v[68:71], v[48:51], v[176:191]
  v_mfma_f32_32x32x16_bf16 v[240:255], v[68:71], v[52:55], v[240:255]
  buffer_load_dwordx4 v6, s[4:7], s57 offen offset:2048 lds
  s_waitcnt lgkmcnt(7)
  v_mfma_f32_32x32x16_bf16 v[128:143], v[80:83], v[72:75], v[128:143]
  ds_read_b128 v[48:51], v22 offset:0
  s_waitcnt lgkmcnt(7)
  v_mfma_f32_32x32x16_bf16 v[192:207], v[80:83], v[76:79], v[192:207]
  ds_read_b64_tr_b16 v[56:57], v24 offset:8192
  ds_read_b64_tr_b16 v[58:59], v24 offset:9216
  s_waitcnt lgkmcnt(7)
  v_mfma_f32_32x32x16_bf16 v[144:159], v[84:87], v[72:75], v[144:159]
  ds_read_b128 v[52:55], v22 offset:4096
  buffer_load_dwordx4 v7, s[4:7], s57 offen offset:3072 lds
  v_mfma_f32_32x32x16_bf16 v[208:223], v[84:87], v[76:79], v[208:223]
  ds_read_b64_tr_b16 v[60:61], v25 offset:8192
  ds_read_b64_tr_b16 v[62:63], v25 offset:9216
  s_waitcnt lgkmcnt(8)
  v_mfma_f32_32x32x16_bf16 v[160:175], v[88:91], v[72:75], v[160:175]
  ds_read_b64_tr_b16 v[64:65], v26 offset:8192
  ds_read_b64_tr_b16 v[66:67], v26 offset:9216
  v_mfma_f32_32x32x16_bf16 v[224:239], v[88:91], v[76:79], v[224:239]
  ds_read_b64_tr_b16 v[68:69], v27 offset:8192
  ds_read_b64_tr_b16 v[70:71], v27 offset:9216
  s_waitcnt lgkmcnt(10)
  v_mfma_f32_32x32x16_bf16 v[176:191], v[92:95], v[72:75], v[176:191]
  v_mfma_f32_32x32x16_bf16 v[240:255], v[92:95], v[76:79], v[240:255]
  s_waitcnt lgkmcnt(7)
  v_mfma_f32_32x32x16_bf16 v[128:143], v[56:59], v[48:51], v[128:143]
  ds_read_b128 v[72:75], v23 offset:0
  s_waitcnt lgkmcnt(7)
  v_mfma_f32_32x32x16_bf16 v[192:207], v[56:59], v[52:55], v[192:207]
  ds_read_b64_tr_b16 v[80:81], v24 offset:12288
  ds_read_b64_tr_b16 v[82:83], v24 offset:13312
  s_waitcnt lgkmcnt(7)
  v_mfma_f32_32x32x16_bf16 v[144:159], v[60:63], v[48:51], v[144:159]
  ds_read_b128 v[76:79], v23 offset:4096
  v_mfma_f32_32x32x16_bf16 v[208:223], v[60:63], v[52:55], v[208:223]
  ds_read_b64_tr_b16 v[84:85], v25 offset:12288
  ds_read_b64_tr_b16 v[86:87], v25 offset:13312
  s_waitcnt lgkmcnt(8)
  v_mfma_f32_32x32x16_bf16 v[160:175], v[64:67], v[48:51], v[160:175]
  ds_read_b64_tr_b16 v[88:89], v26 offset:12288
  ds_read_b64_tr_b16 v[90:91], v26 offset:13312
  v_mfma_f32_32x32x16_bf16 v[224:239], v[64:67], v[52:55], v[224:239]
  ds_read_b64_tr_b16 v[92:93], v27 offset:12288
  ds_read_b64_tr_b16 v[94:95], v27 offset:13312
  s_waitcnt lgkmcnt(10)
  v_mfma_f32_32x32x16_bf16 v[176:191], v[68:71], v[48:51], v[176:191]
  v_mfma_f32_32x32x16_bf16 v[240:255], v[68:71], v[52:55], v[240:255]
  s_waitcnt lgkmcnt(7)
  v_mfma_f32_32x32x16_bf16 v[128:143], v[80:83], v[72:75], v[128:143]
  s_waitcnt lgkmcnt(6)
  v_mfma_f32_32x32x16_bf16 v[192:207], v[80:83], v[76:79], v[192:207]
  s_add_u32 s55, s63, 0xfffe8000
  v_add_u32 v20, s55, v20
  v_add_u32 v21, s55, v21
  v_add_u32 v22, s55, v22
  v_add_u32 v23, s55, v23
  s_add_u32 s55, s72, 0x8000
  v_add_u32 v28, s55, v20
  v_add_u32 v29, s55, v21
  v_add_u32 v30, s55, v22
  v_add_u32 v31, s55, v23
  s_waitcnt lgkmcnt(0)
  s_waitcnt vmcnt(4)
  s_barrier
  ds_read_b128 v[48:51], v20 offset:0
  s_add_u32 m0, s58, 131072
  s_mov_b32 s57, 2621440
  buffer_load_dwordx4 v8, s[8:11], s57 offen offset:0 lds
  v_mfma_f32_32x32x16_bf16 v[144:159], v[84:87], v[72:75], v[144:159]
  ds_read_b128 v[52:55], v28 offset:0
  buffer_load_dwordx4 v9, s[8:11], s57 offen offset:1024 lds
  v_mfma_f32_32x32x16_bf16 v[208:223], v[84:87], v[76:79], v[208:223]
  ds_read_b128 v[56:59], v28 offset:8192
  buffer_load_dwordx4 v10, s[8:11], s57 offen offset:2048 lds
  v_mfma_f32_32x32x16_bf16 v[160:175], v[88:91], v[72:75], v[160:175]
  ds_read_b128 v[60:63], v21 offset:0
  buffer_load_dwordx4 v11, s[8:11], s57 offen offset:3072 lds
  v_mfma_f32_32x32x16_bf16 v[224:239], v[88:91], v[76:79], v[224:239]
  ds_read_b128 v[64:67], v29 offset:0
  s_add_u32 m0, s58, 0
  s_cmp_lt_u32 s2, 160
  s_cselect_b32 s22, s68, 0
  s_mov_b32 s57, 1024
  buffer_load_dwordx4 v12, s[20:23], s57 offen offset:0 lds
  v_mfma_f32_32x32x16_bf16 v[176:191], v[92:95], v[72:75], v[176:191]
  ds_read_b128 v[68:71], v29 offset:8192
  buffer_load_dwordx4 v13, s[20:23], s57 offen offset:1024 lds
  v_mfma_f32_32x32x16_bf16 v[240:255], v[92:95], v[76:79], v[240:255]
  buffer_load_dwordx4 v14, s[20:23], s57 offen offset:2048 lds
  s_cmp_ge_u32 s2, 160
  s_cbranch_scc1 .Lk1_s0_8
  s_waitcnt lgkmcnt(4)
  v_mfma_f32_32x32x16_bf16 v[96:111], v[48:51], v[52:55], v[96:111]
  ds_read_b128 v[72:75], v22 offset:0
  ds_read_b128 v[76:79], v30 offset:0
  buffer_load_dwordx4 v15, s[20:23], s57 offen offset:3072 lds
  s_waitcnt lgkmcnt(5)
  v_mfma_f32_32x32x16_bf16 v[112:127], v[48:51], v[56:59], v[112:127]
  ds_read_b128 v[80:83], v30 offset:8192
  s_waitcnt lgkmcnt(4)
  v_mfma_f32_32x32x16_bf16 v[96:111], v[60:63], v[64:67], v[96:111]
  ds_read_b128 v[84:87], v23 offset:0
  ds_read_b128 v[88:91], v31 offset:0
  s_waitcnt lgkmcnt(5)
  v_mfma_f32_32x32x16_bf16 v[112:127], v[60:63], v[68:71], v[112:127]
  ds_read_b128 v[92:95], v31 offset:8192
  s_waitcnt lgkmcnt(4)
  v_mfma_f32_32x32x16_bf16 v[96:111], v[72:75], v[76:79], v[96:111]
  ds_read_b128 v[48:51], v20 offset:16384
  ds_read_b128 v[52:55], v28 offset:16384
  s_waitcnt lgkmcnt(5)
  v_mfma_f32_32x32x16_bf16 v[112:127], v[72:75], v[80:83], v[112:127]
  ds_read_b128 v[56:59], v28 offset:24576
  s_waitcnt lgkmcnt(4)
  v_mfma_f32_32x32x16_bf16 v[96:111], v[84:87], v[88:91], v[96:111]
  ds_read_b128 v[60:63], v21 offset:16384
  ds_read_b128 v[64:67], v29 offset:16384
  s_waitcnt lgkmcnt(5)
  v_mfma_f32_32x32x16_bf16 v[112:127], v[84:87], v[92:95], v[112:127]
  ds_read_b128 v[68:71], v29 offset:24576
  s_waitcnt lgkmcnt(4)
  v_mfma_f32_32x32x16_bf16 v[96:111], v[48:51], v[52:55], v[96:111]
  ds_read_b128 v[72:75], v22 offset:16384
  ds_read_b128 v[76:79], v30 offset:16384
  s_waitcnt lgkmcnt(5)
  v_mfma_f32_32x32x16_bf16 v[112:127], v[48:51], v[56:59], v[112:127]
  ds_read_b128 v[80:83], v30 offset:24576
  s_waitcnt lgkmcnt(4)
  v_mfma_f32_32x32x16_bf16 v[96:111], v[60:63], v[64:67], v[96:111]
  ds_read_b128 v[84:87], v23 offset:16384
  ds_read_b128 v[88:91], v31 offset:16384
  s_waitcnt lgkmcnt(5)
  v_mfma_f32_32x32x16_bf16 v[112:127], v[60:63], v[68:71], v[112:127]
  ds_read_b128 v[92:95], v31 offset:24576
  s_waitcnt lgkmcnt(4)
  v_mfma_f32_32x32x16_bf16 v[96:111], v[72:75], v[76:79], v[96:111]
  s_sub_u32 s55, 0x10000, s63
  v_add_u32 v20, s55, v20
  v_add_u32 v21, s55, v21
  v_add_u32 v22, s55, v22
  v_add_u32 v23, s55, v23
  v_add_u32 v24, 0x20000, v24
  v_add_u32 v25, 0x20000, v25
  v_add_u32 v26, 0x20000, v26
  v_add_u32 v27, 0x20000, v27
  s_waitcnt lgkmcnt(0)
  s_waitcnt vmcnt(4)
  s_barrier
  ds_read_b128 v[48:51], v20 offset:0
  ds_read_b64_tr_b16 v[56:57], v24 offset:0
  ds_read_b64_tr_b16 v[58:59], v24 offset:1024
  s_add_u32 m0, s58, 32768
  s_cmp_lt_u32 s2, 160
  s_cselect_b32 s26, s69, 0
  s_mov_b32 s57, 1024
  buffer_load_dwordx4 v16, s[24:27], s57 offen offset:0 lds
  v_mfma_f32_32x32x16_bf16 v[112:127], v[72:75], v[80:83], v[112:127]
  ds_read_b128 v[52:55], v20 offset:4096
  ds_read_b64_tr_b16 v[60:61], v25 offset:0
  ds_read_b64_tr_b16 v[62:63], v25 offset:1024
  buffer_load_dwordx4 v17, s[24:27], s57 offen offset:1024 lds
  v_mfma_f32_32x32x16_bf16 v[96:111], v[84:87], v[88:91], v[96:111]
  ds_read_b64_tr_b16 v[64:65], v26 offset:0
  ds_read_b64_tr_b16 v[66:67], v26 offset:1024
  ds_read_b64_tr_b16 v[68:69], v27 offset:0
  ds_read_b64_tr_b16 v[70:71], v27 offset:1024
  buffer_load_dwordx4 v18, s[24:27], s57 offen offset:2048 lds
  v_mfma_f32_32x32x16_bf16 v[112:127], v[84:87], v[92:95], v[112:127]
  buffer_load_dwordx4 v19, s[24:27], s57 offen offset:3072 lds
.Lk1_s0_8r:
  s_waitcnt lgkmcnt(7)
  v_mfma_f32_32x32x16_bf16 v[128:143], v[56:59], v[48:51], v[128:143]
  ds_read_b128 v[72:75], v21 offset:0
  v_lshlrev_b32 v33, 16, v33
  v_lshlrev_b32 v34, 16, v34
  v_lshlrev_b32 v35, 16, v35
  v_mul_f32 v35, 0x3fb8aa3b, v35
  s_waitcnt lgkmcnt(7)
  v_mfma_f32_32x32x16_bf16 v[192:207], v[56:59], v[52:55], v[192:207]
  ds_read_b64_tr_b16 v[80:81], v24 offset:4096
  ds_read_b64_tr_b16 v[82:83], v24 offset:5120
  s_add_u32 m0, s58, 65536
  s_mov_b32 s57, 768
  buffer_load_dwordx4 v4, s[4:7], s57 offen offset:0 lds
  v_exp_f32 v35, v35
  s_nop 0
  v_cvt_pk_bf16_f32 v35, v35, v35
  v_and_b32 v35, 0xffff0000, v35
  v_mul_f32 v1, v35, v33
  s_waitcnt lgkmcnt(7)
  v_mfma_f32_32x32x16_bf16 v[144:159], v[60:63], v[48:51], v[144:159]
  ds_read_b128 v[76:79], v21 offset:4096
  v_mul_f32 v2, v35, v34
  v_mul_f32 v1, 0x3fb8aa3b, v1
  v_exp_f32 v1, v1
  v_mul_f32 v2, 0x3e22f983, v2
  v_mfma_f32_32x32x16_bf16 v[208:223], v[60:63], v[52:55], v[208:223]
  ds_read_b64_tr_b16 v[84:85], v25 offset:4096
  ds_read_b64_tr_b16 v[86:87], v25 offset:5120
  v_cos_f32 v44, v2
  v_sin_f32 v45, v2
  v_mul_f32 v44, v44, v1
  v_mul_f32 v45, v45, v1
  s_waitcnt lgkmcnt(8)
  v_mfma_f32_32x32x16_bf16 v[160:175], v[64:67], v[48:51], v[160:175]
  ds_read_b64_tr_b16 v[88:89], v26 offset:4096
  ds_read_b64_tr_b16 v[90:91], v26 offset:5120
  buffer_load_dwordx4 v5, s[4:7], s57 offen offset:1024 lds
  v_add_f32 v1, -1.0, v44
  v_mul_f32 v2, v33, v33
  v_fmac_f32 v2, v34, v34
  v_rcp_f32 v2, v2
  v_mfma_f32_32x32x16_bf16 v[224:239], v[64:67], v[52:55], v[224:239]
  ds_read_b64_tr_b16 v[92:93], v27 offset:4096
  ds_read_b64_tr_b16 v[94:95], v27 offset:5120
  v_mul_f32 v46, v1, v33
  v_fmac_f32 v46, v45, v34
  v_mul_f32 v47, v45, v33
  v_fma_f32 v47, -v1, v34, v47
  s_waitcnt lgkmcnt(10)
  v_mfma_f32_32x32x16_bf16 v[176:191], v[68:71], v[48:51], v[176:191]
  v_add_f32 v2, v2, v2
  v_mul_f32 v46, v46, v2
  v_mul_f32 v47, v47, v2
  v_mov_b32 v12, v44
  v_mfma_f32_32x32x16_bf16 v[240:255], v[68:71], v[52:55], v[240:255]
  buffer_load_dwordx4 v6, s[4:7], s57 offen offset:2048 lds
  v_mov_b32 v13, v45
  v_mul_f32 v1, v13, v13
  v_mul_f32 v13, v12, v13
  v_fma_f32 v12, v12, v12, -v1
  s_waitcnt lgkmcnt(7)
  v_mfma_f32_32x32x16_bf16 v[128:143], v[80:83], v[72:75], v[128:143]
  ds_read_b128 v[48:51], v22 offset:0
  v_add_f32 v13, v13, v13
  v_mul_f32 v1, v13, v13
  v_mul_f32 v13, v12, v13
  v_fma_f32 v12, v12, v12, -v1
  s_waitcnt lgkmcnt(7)
  v_mfma_f32_32x32x16_bf16 v[192:207], v[80:83], v[76:79], v[192:207]
  ds_read_b64_tr_b16 v[56:57], v24 offset:8192
  ds_read_b64_tr_b16 v[58:59], v24 offset:9216
  v_add_f32 v13, v13, v13
  v_mul_f32 v1, v13, v13
  v_mul_f32 v13, v12, v13
  v_fma_f32 v12, v12, v12, -v1
  s_waitcnt lgkmcnt(7)
  v_mfma_f32_32x32x16_bf16 v[144:159], v[84:87], v[72:75], v[144:159]
  ds_read_b128 v[52:55], v22 offset:4096
  buffer_load_dwordx4 v7, s[4:7], s57 offen offset:3072 lds
  v_add_f32 v13, v13, v13
  v_mul_f32 v1, v13, v13
  v_mul_f32 v13, v12, v13
  v_fma_f32 v12, v12, v12, -v1
  v_mfma_f32_32x32x16_bf16 v[208:223], v[84:87], v[76:79], v[208:223]
  ds_read_b64_tr_b16 v[60:61], v25 offset:8192
  ds_read_b64_tr_b16 v[62:63], v25 offset:9216
  v_add_f32 v13, v13, v13
  s_waitcnt lgkmcnt(8)
  v_mfma_f32_32x32x16_bf16 v[160:175], v[88:91], v[72:75], v[160:175]
  ds_read_b64_tr_b16 v[64:65], v26 offset:8192
  ds_read_b64_tr_b16 v[66:67], v26 offset:9216
  v_mfma_f32_32x32x16_bf16 v[224:239], v[88:91], v[76:79], v[224:239]
  ds_read_b64_tr_b16 v[68:69], v27 offset:8192
  ds_read_b64_tr_b16 v[70:71], v27 offset:9216
  s_waitcnt lgkmcnt(10)
  v_mfma_f32_32x32x16_bf16 v[176:191], v[92:95], v[72:75], v[176:191]
  v_mfma_f32_32x32x16_bf16 v[240:255], v[92:95], v[76:79], v[240:255]
  s_waitcnt lgkmcnt(7)
  v_mfma_f32_32x32x16_bf16 v[128:143], v[56:59], v[48:51], v[128:143]
  ds_read_b128 v[72:75], v23 offset:0
  s_waitcnt lgkmcnt(7)
  v_mfma_f32_32x32x16_bf16 v[192:207], v[56:59], v[52:55], v[192:207]
  ds_read_b64_tr_b16 v[80:81], v24 offset:12288
  ds_read_b64_tr_b16 v[82:83], v24 offset:13312
  s_waitcnt lgkmcnt(7)
  v_mfma_f32_32x32x16_bf16 v[144:159], v[60:63], v[48:51], v[144:159]
  ds_read_b128 v[76:79], v23 offset:4096
  v_mfma_f32_32x32x16_bf16 v[208:223], v[60:63], v[52:55], v[208:223]
  ds_read_b64_tr_b16 v[84:85], v25 offset:12288
  ds_read_b64_tr_b16 v[86:87], v25 offset:13312
  s_waitcnt lgkmcnt(8)
  v_mfma_f32_32x32x16_bf16 v[160:175], v[64:67], v[48:51], v[160:175]
  ds_read_b64_tr_b16 v[88:89], v26 offset:12288
  ds_read_b64_tr_b16 v[90:91], v26 offset:13312
  v_mfma_f32_32x32x16_bf16 v[224:239], v[64:67], v[52:55], v[224:239]
  ds_read_b64_tr_b16 v[92:93], v27 offset:12288
  ds_read_b64_tr_b16 v[94:95], v27 offset:13312
  s_waitcnt lgkmcnt(10)
  v_mfma_f32_32x32x16_bf16 v[176:191], v[68:71], v[48:51], v[176:191]
  v_mfma_f32_32x32x16_bf16 v[240:255], v[68:71], v[52:55], v[240:255]
  s_waitcnt lgkmcnt(7)
  v_mfma_f32_32x32x16_bf16 v[128:143], v[80:83], v[72:75], v[128:143]
  s_cmp_lg_u32 s73, 2
  s_cbranch_scc1 .Lk1t6
  v_lshlrev_b32 v3, 7, v0
  s_mov_b32 s88, s32
  s_mov_b32 s89, s33
  s_mov_b32 s90, 2621440
  s_mov_b32 s55, 256
  s_cmp_ge_u32 s2, 64
  s_cbranch_scc1 .Lk1t6
  s_mov_b32 s91, 0x00020000
  s_add_u32 s55, s55, s2
  s_lshl_b32 s55, s55, 13
  v_add_u32 v3, s55, v3
  buffer_load_dword v43, v3, s[88:91], 0 offen
.Lk1t6:
  s_waitcnt lgkmcnt(6)
  v_mfma_f32_32x32x16_bf16 v[192:207], v[80:83], v[76:79], v[192:207]
  s_add_u32 s55, s63, 0xfffe8000
  v_add_u32 v20, s55, v20
  v_add_u32 v21, s55, v21
  v_add_u32 v22, s55, v22
  v_add_u32 v23, s55, v23
  s_add_u32 s55, s72, 0x8000
  v_add_u32 v28, s55, v20
  v_add_u32 v29, s55, v21
  v_add_u32 v30, s55, v22
  v_add_u32 v31, s55, v23
  s_waitcnt lgkmcnt(0)
  s_waitcnt vmcnt(4)
  s_barrier
  ds_read_b128 v[48:51], v20 offset:0
  s_add_u32 m0, s58, 98304
  s_mov_b32 s57, 3145728
  buffer_load_dwordx4 v8, s[8:11], s57 offen offset:0 lds
  v_mfma_f32_32x32x16_bf16 v[144:159], v[84:87], v[72:75], v[144:159]
  ds_read_b128 v[52:55], v28 offset:0
  buffer_load_dwordx4 v9, s[8:11], s57 offen offset:1024 lds
  v_mfma_f32_32x32x16_bf16 v[208:223], v[84:87], v[76:79], v[208:223]
  ds_read_b128 v[56:59], v28 offset:8192
  buffer_load_dwordx4 v10, s[8:11], s57 offen offset:2048 lds
  v_mfma_f32_32x32x16_bf16 v[160:175], v[88:91], v[72:75], v[160:175]
  ds_read_b128 v[60:63], v21 offset:0
  buffer_load_dwordx4 v11, s[8:11], s57 offen offset:3072 lds
  v_mfma_f32_32x32x16_bf16 v[224:239], v[88:91], v[76:79], v[224:239]
  ds_read_b128 v[64:67], v29 offset:0
  s_add_u32 m0, s58, 131072
  s_mov_b32 s57, 896
  buffer_load_dwordx4 v4, s[4:7], s57 offen offset:0 lds
  v_mfma_f32_32x32x16_bf16 v[176:191], v[92:95], v[72:75], v[176:191]
  ds_read_b128 v[68:71], v29 offset:8192
  buffer_load_dwordx4 v5, s[4:7], s57 offen offset:1024 lds
  v_mfma_f32_32x32x16_bf16 v[240:255], v[92:95], v[76:79], v[240:255]
  buffer_load_dwordx4 v6, s[4:7], s57 offen offset:2048 lds
  s_cmp_ge_u32 s2, 160
  s_cbranch_scc1 .Lk1_s0_10
  s_waitcnt lgkmcnt(4)
  v_mfma_f32_32x32x16_bf16 v[96:111], v[48:51], v[52:55], v[96:111]
  ds_read_b128 v[72:75], v22 offset:0
  ds_read_b128 v[76:79], v30 offset:0
  buffer_load_dwordx4 v7, s[4:7], s57 offen offset:3072 lds
  s_waitcnt lgkmcnt(5)
  v_mfma_f32_32x32x16_bf16 v[112:127], v[48:51], v[56:59], v[112:127]
  ds_read_b128 v[80:83], v30 offset:8192
  s_waitcnt lgkmcnt(4)
  v_mfma_f32_32x32x16_bf16 v[96:111], v[60:63], v[64:67], v[96:111]
  ds_read_b128 v[84:87], v23 offset:0
  ds_read_b128 v[88:91], v31 offset:0
  s_waitcnt lgkmcnt(5)
  v_mfma_f32_32x32x16_bf16 v[112:127], v[60:63], v[68:71], v[112:127]
  ds_read_b128 v[92:95], v31 offset:8192
  s_waitcnt lgkmcnt(4)
  v_mfma_f32_32x32x16_bf16 v[96:111], v[72:75], v[76:79], v[96:111]
  ds_read_b128 v[48:51], v20 offset:16384
  ds_read_b128 v[52:55], v28 offset:16384
  s_waitcnt lgkmcnt(5)
  v_mfma_f32_32x32x16_bf16 v[112:127], v[72:75], v[80:83], v[112:127]
  ds_read_b128 v[56:59], v28 offset:24576
  s_waitcnt lgkmcnt(4)
  v_mfma_f32_32x32x16_bf16 v[96:111], v[84:87], v[88:91], v[96:111]
  ds_read_b128 v[60:63], v21 offset:16384
  ds_read_b128 v[64:67], v29 offset:16384
  s_waitcnt lgkmcnt(5)
  v_mfma_f32_32x32x16_bf16 v[112:127], v[84:87], v[92:95], v[112:127]
  ds_read_b128 v[68:71], v29 offset:24576
  s_waitcnt lgkmcnt(4)
  v_mfma_f32_32x32x16_bf16 v[96:111], v[48:51], v[52:55], v[96:111]
  ds_read_b128 v[72:75], v22 offset:16384
  ds_read_b128 v[76:79], v30 offset:16384
  s_waitcnt lgkmcnt(5)
  v_mfma_f32_32x32x16_bf16 v[112:127], v[48:51], v[56:59], v[112:127]
  ds_read_b128 v[80:83], v30 offset:24576
  s_waitcnt lgkmcnt(4)
  v_mfma_f32_32x32x16_bf16 v[96:111], v[60:63], v[64:67], v[96:111]
  ds_read_b128 v[84:87], v23 offset:16384
  ds_read_b128 v[88:91], v31 offset:16384
  s_waitcnt lgkmcnt(5)
  v_mfma_f32_32x32x16_bf16 v[112:127], v[60:63], v[68:71], v[112:127]
  ds_read_b128 v[92:95], v31 offset:24576
  s_waitcnt lgkmcnt(4)
  v_mfma_f32_32x32x16_bf16 v[96:111], v[72:75], v[76:79], v[96:111]
  s_sub_u32 s55, 0x10000, s63
  v_add_u32 v20, s55, v20
  v_add_u32 v21, s55, v21
  v_add_u32 v22, s55, v22
  v_add_u32 v23, s55, v23
  v_add_u32 v24, 0xffff8000, v24
  v_add_u32 v25, 0xffff8000, v25
  v_add_u32 v26, 0xffff8000, v26
  v_add_u32 v27, 0xffff8000, v27
  s_waitcnt lgkmcnt(0)
  s_waitcnt vmcnt(4)
  s_barrier
  ds_read_b128 v[48:51], v20 offset:0
  ds_read_b64_tr_b16 v[56:57], v24 offset:0
  ds_read_b64_tr_b16 v[58:59], v24 offset:1024
  s_add_u32 m0, s58, 0
  s_mov_b32 s57, 3670016
  buffer_load_dwordx4 v8, s[8:11], s57 offen offset:0 lds
  v_mfma_f32_32x32x16_bf16 v[112:127], v[72:75], v[80:83], v[112:127]
  ds_read_b128 v[52:55], v20 offset:4096
  ds_read_b64_tr_b16 v[60:61], v25 offset:0
  ds_read_b64_tr_b16 v[62:63], v25 offset:1024
  buffer_load_dwordx4 v9, s[8:11], s57 offen offset:1024 lds
  v_mfma_f32_32x32x16_bf16 v[96:111], v[84:87], v[88:91], v[96:111]
  ds_read_b64_tr_b16 v[64:65], v26 offset:0
  ds_read_b64_tr_b16 v[66:67], v26 offset:1024
  ds_read_b64_tr_b16 v[68:69], v27 offset:0
  ds_read_b64_tr_b16 v[70:71], v27 offset:1024
  buffer_load_dwordx4 v10, s[8:11], s57 offen offset:2048 lds
  v_mfma_f32_32x32x16_bf16 v[112:127], v[84:87], v[92:95], v[112:127]
  buffer_load_dwordx4 v11, s[8:11], s57 offen offset:3072 lds
.Lk1_s0_10r:
  s_waitcnt lgkmcnt(7)
  v_mfma_f32_32x32x16_bf16 v[128:143], v[56:59], v[48:51], v[128:143]
  ds_read_b128 v[72:75], v21 offset:0
  v_subrev_u32 v33, 32, v0
  v_lshlrev_b32 v33, 3, v33
  v_and_b32 v33, 0x7fffffff, v33
  v_fma_f32 v1, v44, v96, v97
  s_nop 3
  v_fma_f32 v2, v44, v112, v113
  v_fma_f32 v30, -v45, v112, v1
  s_waitcnt lgkmcnt(7)
  v_mfma_f32_32x32x16_bf16 v[192:207], v[56:59], v[52:55], v[192:207]
  ds_read_b64_tr_b16 v[80:81], v24 offset:4096
  ds_read_b64_tr_b16 v[82:83], v24 offset:5120
  s_add_u32 m0, s58, 32768
  s_add_u32 s57, s92, 0
  buffer_load_dwordx4 v36, s[32:35], s57 offen offset:0 lds
  v_fma_f32 v31, v45, v96, v2
  v_fma_f32 v1, v44, v30, v98
  v_fma_f32 v2, v44, v31, v114
  v_fma_f32 v28, -v45, v31, v1
  v_fma_f32 v29, v45, v30, v2
  v_fma_f32 v1, v44, v28, v99
  s_waitcnt lgkmcnt(7)
  v_mfma_f32_32x32x16_bf16 v[144:159], v[60:63], v[48:51], v[144:159]
  ds_read_b128 v[76:79], v21 offset:4096
  v_fma_f32 v2, v44, v29, v115
  v_fma_f32 v30, -v45, v29, v1
  v_fma_f32 v31, v45, v28, v2
  v_fma_f32 v1, v44, v30, v100
  v_fma_f32 v2, v44, v31, v116
  v_fma_f32 v28, -v45, v31, v1
  v_mfma_f32_32x32x16_bf16 v[208:223], v[60:63], v[52:55], v[208:223]
  ds_read_b64_tr_b16 v[84:85], v25 offset:4096
  ds_read_b64_tr_b16 v[86:87], v25 offset:5120
  v_fma_f32 v29, v45, v30, v2
  v_fma_f32 v1, v44, v28, v101
  v_fma_f32 v2, v44, v29, v117
  v_fma_f32 v30, -v45, v29, v1
  v_fma_f32 v31, v45, v28, v2
  v_fma_f32 v1, v44, v30, v102
  s_waitcnt lgkmcnt(8)
  v_mfma_f32_32x32x16_bf16 v[160:175], v[64:67], v[48:51], v[160:175]
  ds_read_b64_tr_b16 v[88:89], v26 offset:4096
  ds_read_b64_tr_b16 v[90:91], v26 offset:5120
  buffer_load_dwordx4 v37, s[32:35], s57 offen offset:1024 lds
  v_fma_f32 v2, v44, v31, v118
  v_fma_f32 v28, -v45, v31, v1
  v_fma_f32 v29, v45, v30, v2
  v_fma_f32 v1, v44, v28, v103
  v_fma_f32 v2, v44, v29, v119
  v_fma_f32 v30, -v45, v29, v1
  v_mfma_f32_32x32x16_bf16 v[224:239], v[64:67], v[52:55], v[224:239]
  ds_read_b64_tr_b16 v[92:93], v27 offset:4096
  ds_read_b64_tr_b16 v[94:95], v27 offset:5120
  v_fma_f32 v31, v45, v28, v2
  v_fma_f32 v1, v44, v30, v104
  v_fma_f32 v2, v44, v31, v120
  v_fma_f32 v28, -v45, v31, v1
  v_fma_f32 v29, v45, v30, v2
  v_fma_f32 v1, v44, v28, v105
  s_waitcnt lgkmcnt(10)
  v_mfma_f32_32x32x16_bf16 v[176:191], v[68:71], v[48:51], v[176:191]
  s_cmp_lg_u32 s73, 0
  s_cbranch_scc1 .Lk1t7
  v_lshrrev_b32 v3, 3, v0
  v_lshlrev_b32 v3, 6, v3
  v_and_or_b32 v3, v0, 7, v3
  v_lshlrev_b32 v3, 7, v3
  s_and_b32 s55, s2, 7
  s_lshl_b32 s55, s55, 10
  v_add_u32 v3, s55, v3
  s_lshr_b32 s56, s2, 3
  s_mov_b32 s88, s64
  s_mov_b32 s89, s65
  s_mov_b32 s90, 5242880
  s_mov_b32 s55, 32
  s_mov_b32 s91, 0x00020000
  s_add_u32 s55, s55, s56
  s_lshl_b32 s55, s55, 16
  v_add_u32 v3, s55, v3
  buffer_load_dword v43, v3, s[88:91], 0 offen
.Lk1t7:
  v_fma_f32 v2, v44, v29, v121
  v_fma_f32 v30, -v45, v29, v1
  v_fma_f32 v31, v45, v28, v2
  v_fma_f32 v1, v44, v30, v106
  v_fma_f32 v2, v44, v31, v122
  v_fma_f32 v28, -v45, v31, v1
  v_mfma_f32_32x32x16_bf16 v[240:255], v[68:71], v[52:55], v[240:255]
  buffer_load_dwordx4 v38, s[32:35], s57 offen offset:2048 lds
  v_fma_f32 v29, v45, v30, v2
  v_fma_f32 v1, v44, v28, v107
  v_fma_f32 v2, v44, v29, v123
  v_fma_f32 v30, -v45, v29, v1
  v_fma_f32 v31, v45, v28, v2
  v_fma_f32 v1, v44, v30, v108
  s_waitcnt lgkmcnt(7)
  v_mfma_f32_32x32x16_bf16 v[128:143], v[80:83], v[72:75], v[128:143]
  ds_read_b128 v[48:51], v22 offset:0
  v_fma_f32 v2, v44, v31, v124
  v_fma_f32 v28, -v45, v31, v1
  v_fma_f32 v29, v45, v30, v2
  v_fma_f32 v1, v44, v28, v109
  v_fma_f32 v2, v44, v29, v125
  v_fma_f32 v30, -v45, v29, v1
  s_waitcnt lgkmcnt(7)
  v_mfma_f32_32x32x16_bf16 v[192:207], v[80:83], v[76:79], v[192:207]
  ds_read_b64_tr_b16 v[56:57], v24 offset:8192
  ds_read_b64_tr_b16 v[58:59], v24 offset:9216
  v_fma_f32 v31, v45, v28, v2
  v_fma_f32 v1, v44, v30, v110
  v_fma_f32 v2, v44, v31, v126
  v_fma_f32 v28, -v45, v31, v1
  v_fma_f32 v29, v45, v30, v2
  v_fma_f32 v1, v44, v28, v111
  s_waitcnt lgkmcnt(7)
  v_mfma_f32_32x32x16_bf16 v[144:159], v[84:87], v[72:75], v[144:159]
  ds_read_b128 v[52:55], v22 offset:4096
  buffer_load_dwordx4 v39, s[32:35], s57 offen offset:3072 lds
  v_fma_f32 v2, v44, v29, v127
  v_fma_f32 v30, -v45, v29, v1
  v_fma_f32 v31, v45, v28, v2
  v_mov_b32 v28, 0
  v_mov_b32 v29, 0
  s_nop 0
  v_permlane32_swap_b32 v28, v30
  v_mfma_f32_32x32x16_bf16 v[208:223], v[84:87], v[76:79], v[208:223]
  ds_read_b64_tr_b16 v[60:61], v25 offset:8192
  ds_read_b64_tr_b16 v[62:63], v25 offset:9216
  v_permlane32_swap_b32 v29, v31
  s_nop 0
  v_fma_f32 v1, v12, v28, v30
  v_fma_f32 v2, v12, v29, v31
  v_fma_f32 v34, -v13, v29, v1
  v_fma_f32 v35, v13, v28, v2
  s_waitcnt lgkmcnt(8)
  v_mfma_f32_32x32x16_bf16 v[160:175], v[88:91], v[72:75], v[160:175]
  ds_read_b64_tr_b16 v[64:65], v26 offset:8192
  ds_read_b64_tr_b16 v[66:67], v26 offset:9216
  s_lshl_b32 s55, s60, 2
  s_lshr_b32 s56, s52, 1
  s_add_u32 s55, s55, s56
  s_mul_i32 s55, s55, 640
  s_add_u32 s55, s55, s62
  s_lshl_b32 s55, s55, 3
  s_add_u32 s55, s55, 524288
  buffer_store_dwordx2 v[34:35], v33, s[36:39], s55 offen
  v_mfma_f32_32x32x16_bf16 v[224:239], v[88:91], v[76:79], v[224:239]
  ds_read_b64_tr_b16 v[68:69], v27 offset:8192
  ds_read_b64_tr_b16 v[70:71], v27 offset:9216
  s_waitcnt lgkmcnt(10)
  v_mfma_f32_32x32x16_bf16 v[176:191], v[92:95], v[72:75], v[176:191]
  v_mfma_f32_32x32x16_bf16 v[240:255], v[92:95], v[76:79], v[240:255]
  s_waitcnt lgkmcnt(7)
  v_mfma_f32_32x32x16_bf16 v[128:143], v[56:59], v[48:51], v[128:143]
  ds_read_b128 v[72:75], v23 offset:0
  s_waitcnt lgkmcnt(7)
  v_mfma_f32_32x32x16_bf16 v[192:207], v[56:59], v[52:55], v[192:207]
  ds_read_b64_tr_b16 v[80:81], v24 offset:12288
  ds_read_b64_tr_b16 v[82:83], v24 offset:13312
  s_waitcnt lgkmcnt(7)
  v_mfma_f32_32x32x16_bf16 v[144:159], v[60:63], v[48:51], v[144:159]
  ds_read_b128 v[76:79], v23 offset:4096
  v_mfma_f32_32x32x16_bf16 v[208:223], v[60:63], v[52:55], v[208:223]
  ds_read_b64_tr_b16 v[84:85], v25 offset:12288
  ds_read_b64_tr_b16 v[86:87], v25 offset:13312
  s_waitcnt lgkmcnt(8)
  v_mfma_f32_32x32x16_bf16 v[160:175], v[64:67], v[48:51], v[160:175]
  ds_read_b64_tr_b16 v[88:89], v26 offset:12288
  ds_read_b64_tr_b16 v[90:91], v26 offset:13312
  v_mfma_f32_32x32x16_bf16 v[224:239], v[64:67], v[52:55], v[224:239]
  ds_read_b64_tr_b16 v[92:93], v27 offset:12288
  ds_read_b64_tr_b16 v[94:95], v27 offset:13312
  s_waitcnt lgkmcnt(10)
  v_mfma_f32_32x32x16_bf16 v[176:191], v[68:71], v[48:51], v[176:191]
  s_cmp_lg_u32 s73, 1
  s_cbranch_scc1 .Lk1t8
  v_lshrrev_b32 v3, 3, v0
  v_lshlrev_b32 v3, 6, v3
  v_and_or_b32 v3, v0, 7, v3
  v_lshlrev_b32 v3, 7, v3
  s_and_b32 s55, s2, 7
  s_lshl_b32 s55, s55, 10
  v_add_u32 v3, s55, v3
  s_lshr_b32 s56, s2, 3
  s_mov_b32 s88, s64
  s_mov_b32 s89, s65
  s_mov_b32 s90, 5242880
  s_mov_b32 s55, 64
  s_cmp_ge_u32 s56, 16
  s_cbranch_scc1 .Lk1t8
  s_mov_b32 s91, 0x00020000
  s_add_u32 s55, s55, s56
  s_lshl_b32 s55, s55, 16
  v_add_u32 v3, s55, v3
  buffer_load_dword v43, v3, s[88:91], 0 offen
.Lk1t8:
  v_mfma_f32_32x32x16_bf16 v[240:255], v[68:71], v[52:55], v[240:255]
  s_waitcnt lgkmcnt(7)
  v_mfma_f32_32x32x16_bf16 v[128:143], v[80:83], v[72:75], v[128:143]
  s_waitcnt lgkmcnt(6)
  v_mfma_f32_32x32x16_bf16 v[192:207], v[80:83], v[76:79], v[192:207]
  v_add_u32 v20, 0x10000, v20
  v_add_u32 v21, 0x10000, v21
  v_add_u32 v22, 0x10000, v22
  v_add_u32 v23, 0x10000, v23
  v_add_u32 v24, 0xfffe8000, v24
  v_add_u32 v25, 0xfffe8000, v25
  v_add_u32 v26, 0xfffe8000, v26
  v_add_u32 v27, 0xfffe8000, v27
  s_waitcnt lgkmcnt(0)
  s_waitcnt vmcnt(0)
  s_barrier
  ds_read_b128 v[48:51], v20 offset:0
  s_add_u32 m0, s58, 65536
  s_mov_b32 s57, 0
  buffer_load_dwordx4 v8, s[64:67], s57 offen offset:0 lds
  v_mfma_f32_32x32x16_bf16 v[144:159], v[84:87], v[72:75], v[144:159]
  ds_read_b64_tr_b16 v[56:57], v24 offset:0
  ds_read_b64_tr_b16 v[58:59], v24 offset:1024
  buffer_load_dwordx4 v9, s[64:67], s57 offen offset:1024 lds
  v_mfma_f32_32x32x16_bf16 v[208:223], v[84:87], v[76:79], v[208:223]
  ds_read_b128 v[52:55], v20 offset:4096
  buffer_load_dwordx4 v10, s[64:67], s57 offen offset:2048 lds
  v_mfma_f32_32x32x16_bf16 v[160:175], v[88:91], v[72:75], v[160:175]
  ds_read_b64_tr_b16 v[60:61], v25 offset:0
  ds_read_b64_tr_b16 v[62:63], v25 offset:1024
  buffer_load_dwordx4 v11, s[64:67], s57 offen offset:3072 lds
  v_mfma_f32_32x32x16_bf16 v[224:239], v[88:91], v[76:79], v[224:239]
  ds_read_b64_tr_b16 v[64:65], v26 offset:0
  ds_read_b64_tr_b16 v[66:67], v26 offset:1024
  v_mfma_f32_32x32x16_bf16 v[176:191], v[92:95], v[72:75], v[176:191]
  ds_read_b64_tr_b16 v[68:69], v27 offset:0
  ds_read_b64_tr_b16 v[70:71], v27 offset:1024
  s_add_u32 m0, s58, 98304
  s_add_u32 s57, s92, 128
  buffer_load_dwordx4 v36, s[32:35], s57 offen offset:0 lds
  v_mfma_f32_32x32x16_bf16 v[240:255], v[92:95], v[76:79], v[240:255]
  s_waitcnt lgkmcnt(7)
  v_mfma_f32_32x32x16_bf16 v[128:143], v[56:59], v[48:51], v[128:143]
  ds_read_b128 v[72:75], v21 offset:0
  v_and_b32 v30, 31, v0
  v_lshlrev_b32 v30, 3, v30
  s_lshl_b32 s55, s60, 2
  s_lshr_b32 s56, s52, 1
  s_add_u32 s55, s55, s56
  s_mul_i32 s55, s55, 640
  s_add_u32 s55, s55, s62
  s_lshl_b32 s55, s55, 3
  s_add_u32 s55, s55, 524288
  s_sub_u32 s55, s55, 15360
  s_cmp_ge_u32 s52, 6
  s_cselect_b32 s55, s55, 0x7ff00000
  v_add_u32 v31, s55, v30
  buffer_load_dwordx2 v[4:5], v31, s[36:39], 0 offen
  s_waitcnt lgkmcnt(7)
  v_mfma_f32_32x32x16_bf16 v[192:207], v[56:59], v[52:55], v[192:207]
  ds_read_b64_tr_b16 v[80:81], v24 offset:4096
  ds_read_b64_tr_b16 v[82:83], v24 offset:5120
  buffer_load_dwordx4 v37, s[32:35], s57 offen offset:1024 lds
  s_lshl_b32 s55, s60, 2
  s_lshr_b32 s56, s52, 1
  s_add_u32 s55, s55, s56
  s_mul_i32 s55, s55, 640
  s_add_u32 s55, s55, s62
  s_lshl_b32 s55, s55, 3
  s_add_u32 s55, s55, 524288
  s_sub_u32 s55, s55, 10240
  s_cmp_ge_u32 s52, 4
  s_cselect_b32 s55, s55, 0x7ff00000
  v_add_u32 v31, s55, v30
  buffer_load_dwordx2 v[6:7], v31, s[36:39], 0 offen
  s_lshl_b32 s55, s60, 2
  s_lshr_b32 s56, s52, 1
  s_add_u32 s55, s55, s56
  s_mul_i32 s55, s55, 640
  s_add_u32 s55, s55, s62
  s_lshl_b32 s55, s55, 3
  s_add_u32 s55, s55, 524288
  s_sub_u32 s55, s55, 5120
  s_cmp_ge_u32 s52, 2
  s_cselect_b32 s55, s55, 0x7ff00000
  v_add_u32 v31, s55, v30
  buffer_load_dwordx2 v[14:15], v31, s[36:39], 0 offen
  s_waitcnt lgkmcnt(7)
  v_mfma_f32_32x32x16_bf16 v[144:159], v[60:63], v[48:51], v[144:159]
  ds_read_b128 v[76:79], v21 offset:4096
  v_mov_b32 v16, v12
  v_mov_b32 v17, v13
  v_mul_f32 v1, v17, v17
  v_mul_f32 v17, v16, v17
  v_mfma_f32_32x32x16_bf16 v[208:223], v[60:63], v[52:55], v[208:223]
  ds_read_b64_tr_b16 v[84:85], v25 offset:4096
  ds_read_b64_tr_b16 v[86:87], v25 offset:5120
  v_fma_f32 v16, v16, v16, -v1
  v_add_f32 v17, v17, v17
  v_mov_b32 v18, v16
  v_mov_b32 v19, v17
  s_waitcnt lgkmcnt(8)
  v_mfma_f32_32x32x16_bf16 v[160:175], v[64:67], v[48:51], v[160:175]
  ds_read_b64_tr_b16 v[88:89], v26 offset:4096
  ds_read_b64_tr_b16 v[90:91], v26 offset:5120
  buffer_load_dwordx4 v38, s[32:35], s57 offen offset:2048 lds
  v_mul_f32 v1, v19, v19
  v_mul_f32 v19, v18, v19
  v_fma_f32 v18, v18, v18, -v1
  v_add_f32 v19, v19, v19
  v_mfma_f32_32x32x16_bf16 v[224:239], v[64:67], v[52:55], v[224:239]
  ds_read_b64_tr_b16 v[92:93], v27 offset:4096
  ds_read_b64_tr_b16 v[94:95], v27 offset:5120
  s_lshl_b32 s55, s53, 3
  v_lshl_add_u32 v42, v0, 2, s55
  v_cmp_gt_u32 vcc, 2, v0
  v_mov_b32 v41, 252
  s_nop 0
  v_cndmask_b32 v42, v41, v42, vcc
  buffer_load_dword v41, v42, s[28:31], 0 offen sc0 sc1
  s_waitcnt lgkmcnt(10)
  v_mfma_f32_32x32x16_bf16 v[176:191], v[68:71], v[48:51], v[176:191]
  s_sub_u32 s55, 15, s54
  s_sub_u32 s63, 7, s52
  s_cmp_lt_u32 s52, 4
  s_cselect_b32 s72, s55, s54
  s_cselect_b32 s63, s52, s63
  s_sub_u32 s75, s55, s72
  s_lshl_b32 s78, s72, 2
  s_add_u32 s78, s78, s63
  s_sub_u32 s79, s72, 1
  s_lshl_b32 s77, s73, 13
  s_add_u32 s77, s77, 65536
  s_lshl_b32 s91, s53, 20
  s_lshl_b32 s76, s73, 14
  s_add_u32 s76, s76, s91
  s_add_u32 s76, s76, 32768
  v_mfma_f32_32x32x16_bf16 v[240:255], v[68:71], v[52:55], v[240:255]
  buffer_load_dwordx4 v39, s[32:35], s57 offen offset:3072 lds
  s_add_u32 s69, s91, 1032192
  s_and_b32 s55, s58, 4096
  s_add_u32 s91, s91, s55
  s_lshr_b32 s55, s73, 1
  s_lshl_b32 s55, s55, 14
  s_add_u32 s91, s91, s55
  s_lshl_b32 s88, s53, 9
  s_add_u32 s88, s88, 48234496
  s_mov_b32 s101, 1
  s_mov_b32 s100, 0
  s_lshl_b32 s89, s78, 8
  s_add_u32 s89, s89, s53
  s_add_u32 s89, s89, 48283648
  s_waitcnt lgkmcnt(7)
  v_mfma_f32_32x32x16_bf16 v[128:143], v[80:83], v[72:75], v[128:143]
  ds_read_b128 v[48:51], v22 offset:0
  s_lshl_b32 s90, s54, 8
  s_and_b32 s55, s2, 31
  s_add_u32 s90, s90, s55
  s_add_u32 s90, s90, 48263168
  s_cmp_lt_u32 s2, 160
  s_cselect_b32 s55, 4, 0
  s_cmp_eq_u32 s52, s55
  s_cselect_b32 s90, s90, 0
  s_min_u32 s55, s75, 2
  s_cmp_gt_u32 s75, 3
  s_cselect_b32 s55, 3, s55
  s_cmp_eq_u32 s52, 7
  s_cselect_b32 s90, s55, s90
  s_mov_b32 s4, s70
  s_mov_b32 s5, s71
  s_mov_b32 s6, 10485760
  s_mov_b32 s7, 0x00020000
  s_mov_b32 s8, s80
  s_mov_b32 s9, s81
  s_mov_b32 s10, 2621440
  s_mov_b32 s11, 0x00020000
  s_mov_b32 s12, s86
  s_mov_b32 s13, s87
  s_mov_b32 s14, 1280
  s_mov_b32 s15, 0x00020000
  s_waitcnt lgkmcnt(7)
  v_mfma_f32_32x32x16_bf16 v[192:207], v[80:83], v[76:79], v[192:207]
  ds_read_b64_tr_b16 v[56:57], v24 offset:8192
  ds_read_b64_tr_b16 v[58:59], v24 offset:9216
  s_bfe_u32 s48, s2, 0x30003
  s_lshr_b32 s49, s52, 2
  s_mul_i32 s41, s52, 2560
  s_and_b32 s44, s2, 3
  s_xor_b32 s44, s44, 0
  s_and_b32 s55, s2, 4
  s_lshr_b32 s56, s2, 6
  s_add_u32 s55, s55, s56
  s_lshl_b32 s45, s55, 3
  s_add_u32 s45, s45, s48
  s_lshl_b32 s55, s55, 2
  s_add_u32 s47, s55, s73
  s_add_u32 s46, s47, 32
  s_cmp_eq_u32 s44, 3
  s_cselect_b32 s47, s46, s47
  s_cselect_b32 s26, 22, 12
  s_cmp_eq_u32 s44, 1
  s_cselect_b32 s42, s46, s47
  s_cselect_b32 s26, 0, s26
  s_cselect_b32 s24, 24, 0
  s_cselect_b32 s25, 32, 24
  s_lshl_b32 s42, s42, 1
  s_add_u32 s42, s42, s49
  s_waitcnt lgkmcnt(7)
  v_mfma_f32_32x32x16_bf16 v[144:159], v[84:87], v[72:75], v[144:159]
  ds_read_b128 v[52:55], v22 offset:4096
  s_mul_i32 s55, s48, 655360
  s_add_u32 s55, s55, 67108864
  s_mul_i32 s56, s26, 20480
  s_add_u32 s23, s55, s56
  s_mul_i32 s56, s24, 20480
  s_add_u32 s22, s55, s56
  s_lshl_b32 s21, s46, 5
  s_add_u32 s21, s21, s26
  s_lshl_b32 s21, s21, 13
  s_add_u32 s21, s21, 50331648
  s_lshl_b32 s20, s47, 5
  s_add_u32 s20, s20, s24
  s_lshl_b32 s20, s20, 13
  s_add_u32 s20, s20, 50331648
  s_mul_i32 s55, s47, 81920
  s_add_u32 s55, s55, 42991616
  s_mul_i32 s56, s48, 204800
  s_add_u32 s56, s56, 73400320
  s_cmp_ge_u32 s44, 2
  s_cselect_b32 s20, s55, s20
  s_cselect_b32 s22, s56, s22
  s_cselect_b32 s25, 0, s25
  v_mfma_f32_32x32x16_bf16 v[208:223], v[84:87], v[76:79], v[208:223]
  ds_read_b64_tr_b16 v[60:61], v25 offset:8192
  ds_read_b64_tr_b16 v[62:63], v25 offset:9216
  s_lshl_b32 s47, s47, 8
  s_add_u32 s47, s47, 48283648
  s_lshl_b32 s46, s46, 8
  s_add_u32 s46, s46, 48283648
  s_andn2_b32 s47, s47, 0x3ff
  s_mul_i32 s43, s45, 3
  s_add_u32 s43, s43, s44
  s_lshl_b32 s43, s43, 3
  s_add_u32 s43, s43, s52
  s_mul_i32 s43, s43, 5120
  s_add_u32 s43, s43, 100663296
  s_waitcnt lgkmcnt(8)
  v_mfma_f32_32x32x16_bf16 v[160:175], v[88:91], v[72:75], v[160:175]
  ds_read_b64_tr_b16 v[64:65], v26 offset:8192
  ds_read_b64_tr_b16 v[66:67], v26 offset:9216
  s_lshl_b32 s45, s45, 6
  s_add_u32 s45, s45, s52
  s_lshl_b32 s45, s45, 2
  s_add_u32 s45, s45, 48267264
  s_and_b32 s40, s54, 1
  s_lshl_b32 s40, s40, 16
  s_xor_b32 s27, s40, 0x10000
  s_add_u32 s50, s27, s41
  s_add_u32 s51, s40, s41
  v_mfma_f32_32x32x16_bf16 v[224:239], v[88:91], v[76:79], v[224:239]
  ds_read_b64_tr_b16 v[68:69], v27 offset:8192
  ds_read_b64_tr_b16 v[70:71], v27 offset:9216
  s_waitcnt lgkmcnt(10)
  v_mfma_f32_32x32x16_bf16 v[176:191], v[92:95], v[72:75], v[176:191]
  s_waitcnt vmcnt(3)
  v_mfma_f32_32x32x16_bf16 v[240:255], v[92:95], v[76:79], v[240:255]
  v_fma_f32 v1, v16, v4, v6
  v_fma_f32 v2, v16, v5, v7
  v_fma_f32 v30, -v17, v5, v1
  v_fma_f32 v31, v17, v4, v2
  s_waitcnt lgkmcnt(7)
  v_mfma_f32_32x32x16_bf16 v[128:143], v[56:59], v[48:51], v[128:143]
  ds_read_b128 v[76:79], v23 offset:4096
  v_fma_f32 v1, v16, v30, v14
  v_fma_f32 v2, v16, v31, v15
  v_fma_f32 v6, -v17, v31, v1
  v_fma_f32 v7, v17, v30, v2
  s_waitcnt lgkmcnt(7)
  v_mfma_f32_32x32x16_bf16 v[192:207], v[56:59], v[52:55], v[192:207]
  ds_read_b64_tr_b16 v[80:81], v24 offset:12288
  ds_read_b64_tr_b16 v[82:83], v24 offset:13312
  v_fma_f32 v1, v16, v6, v34
  v_fma_f32 v2, v16, v7, v35
  v_fma_f32 v34, -v17, v7, v1
  v_fma_f32 v35, v17, v6, v2
  s_waitcnt lgkmcnt(7)
  v_mfma_f32_32x32x16_bf16 v[144:159], v[60:63], v[48:51], v[144:159]
  ds_read_b64_tr_b16 v[84:85], v25 offset:12288
  ds_read_b64_tr_b16 v[86:87], v25 offset:13312
  s_mul_i32 s55, s60, 640
  s_add_u32 s55, s55, s62
  s_lshl_b32 s55, s55, 3
  s_cmp_ge_u32 s52, 6
  s_cselect_b32 s56, 0, 0x7ff00000
  v_or_b32 v33, s56, v33
  buffer_store_dwordx2 v[34:35], v33, s[36:39], s55 offen sc0 sc1
  s_bitcmp1_b32 s52, 1
  s_cselect_b64 vcc, -1, 0
  v_cndmask_b32 v4, 1.0, v16, vcc
  v_cndmask_b32 v5, 0, v17, vcc
  s_bitcmp1_b32 s52, 2
  s_cselect_b64 vcc, -1, 0
  v_cndmask_b32 v30, 1.0, v18, vcc
  v_cndmask_b32 v31, 0, v19, vcc
  v_mfma_f32_32x32x16_bf16 v[208:223], v[60:63], v[52:55], v[208:223]
  ds_read_b64_tr_b16 v[88:89], v26 offset:12288
  ds_read_b64_tr_b16 v[90:91], v26 offset:13312
  v_mul_f32 v1, v4, v30
  v_fma_f32 v1, -v5, v31, v1
  v_mul_f32 v2, v4, v31
  v_fma_f32 v5, v5, v30, v2
  s_waitcnt lgkmcnt(9)
  v_mfma_f32_32x32x16_bf16 v[160:175], v[64:67], v[48:51], v[160:175]
  ds_read_b64_tr_b16 v[92:93], v27 offset:12288
  ds_read_b64_tr_b16 v[94:95], v27 offset:13312
  v_mov_b32 v4, v1
  v_mul_f32 v1, v19, v19
  v_mul_f32 v19, v18, v19
  v_fma_f32 v18, v18, v18, -v1
  v_mfma_f32_32x32x16_bf16 v[224:239], v[64:67], v[52:55], v[224:239]
  ds_read_b128 v[72:75], v23 offset:0
  v_add_f32 v19, v19, v19
  v_mov_b32 v16, v18
  v_mov_b32 v17, v19
  v_mul_f32 v1, v17, v17
  s_waitcnt lgkmcnt(10)
  v_mfma_f32_32x32x16_bf16 v[176:191], v[68:71], v[48:51], v[176:191]
  v_mul_f32 v17, v16, v17
  v_fma_f32 v16, v16, v16, -v1
  v_add_f32 v17, v17, v17
  v_cmp_gt_u32 vcc, 32, v0
  s_nop 1
  v_cndmask_b32 v12, v12, 1.0, vcc
  v_cndmask_b32 v13, v13, 0, vcc
  v_mfma_f32_32x32x16_bf16 v[240:255], v[68:71], v[52:55], v[240:255]
  s_waitcnt vmcnt(2)
.Ldc9c:
  v_readlane_b32 s55, v41, 2
  v_readlane_b32 s56, v41, 0
  v_readlane_b32 s94, v41, 1
  s_bitcmp0_b32 s55, 31
  s_cbranch_scc1 .Ldc9s
.Ldc9k:
  s_xor_b32 s56, s56, s100
  s_xor_b32 s94, s94, s100
  s_or_b32 s94, s94, s56
  s_and_b32 s94, s94, 0x7f7f7f7f
  s_mov_b32 s94, 1
  s_mov_b32 s80, s16
  s_mov_b32 s81, s17
  s_mov_b32 s83, 0x00020000
  s_mov_b32 s84, s16
  s_mov_b32 s85, s17
  s_mov_b32 s87, 0x00020000
  s_cmp_lt_u32 s54, 2
  s_cselect_b32 s82, s18, 0
  s_cselect_b32 s86, 0, s18
  s_waitcnt lgkmcnt(7)
  v_mfma_f32_32x32x16_bf16 v[192:207], v[80:83], v[76:79], v[192:207]
  s_waitcnt lgkmcnt(5)
  v_mfma_f32_32x32x16_bf16 v[208:223], v[84:87], v[76:79], v[208:223]
  s_add_u32 s55, s74, 0xfffe8000
  v_add_u32 v20, s55, v20
  v_add_u32 v21, s55, v21
  v_add_u32 v22, s55, v22
  v_add_u32 v23, s55, v23
  v_add_u32 v24, 0x10000, v24
  v_add_u32 v25, 0x10000, v25
  v_add_u32 v26, 0x10000, v26
  v_add_u32 v27, 0x10000, v27
  s_waitcnt lgkmcnt(0)
  s_barrier
  ds_read_b128 v[48:51], v20 offset:0
  s_add_u32 m0, s58, 131072
  s_add_u32 s57, s92, 256
  buffer_load_dwordx4 v36, s[32:35], s57 offen offset:0 lds
  v_mfma_f32_32x32x16_bf16 v[224:239], v[88:91], v[76:79], v[224:239]
  ds_read_b64_tr_b16 v[52:53], v24 offset:0
  ds_read_b64_tr_b16 v[54:55], v24 offset:1024
  buffer_load_dwordx4 v37, s[32:35], s57 offen offset:1024 lds
  v_mfma_f32_32x32x16_bf16 v[240:255], v[92:95], v[76:79], v[240:255]
  ds_read_b64_tr_b16 v[56:57], v25 offset:0
  ds_read_b64_tr_b16 v[58:59], v25 offset:1024
  buffer_load_dwordx4 v38, s[32:35], s57 offen offset:2048 lds
  v_mfma_f32_32x32x16_bf16 v[128:143], v[80:83], v[72:75], v[128:143]
  ds_read_b64_tr_b16 v[60:61], v26 offset:0
  ds_read_b64_tr_b16 v[62:63], v26 offset:1024
  v_cvt_pk_bf16_f32 v192, v192, v193
  v_cvt_pk_bf16_f32 v193, v194, v195
  v_cvt_pk_bf16_f32 v194, v196, v197
  v_cvt_pk_bf16_f32 v195, v198, v199
  v_cvt_pk_bf16_f32 v196, v200, v201
  v_cvt_pk_bf16_f32 v197, v202, v203
  v_cvt_pk_bf16_f32 v198, v204, v205
  v_cvt_pk_bf16_f32 v199, v206, v207
  buffer_load_dwordx4 v39, s[32:35], s57 offen offset:3072 lds
  v_mfma_f32_32x32x16_bf16 v[144:159], v[84:87], v[72:75], v[144:159]
  ds_read_b64_tr_b16 v[64:65], v27 offset:0
  ds_read_b64_tr_b16 v[66:67], v27 offset:1024
  v_cvt_pk_bf16_f32 v208, v208, v209
  v_cvt_pk_bf16_f32 v209, v210, v211
  v_cvt_pk_bf16_f32 v210, v212, v213
  v_cvt_pk_bf16_f32 v211, v214, v215
  v_cvt_pk_bf16_f32 v212, v216, v217
  v_cvt_pk_bf16_f32 v213, v218, v219
  v_cvt_pk_bf16_f32 v214, v220, v221
  v_cvt_pk_bf16_f32 v215, v222, v223
  s_add_u32 m0, s58, 0
  s_mov_b32 s57, 1048576
  buffer_load_dwordx4 v8, s[64:67], s57 offen offset:0 lds
  v_mfma_f32_32x32x16_bf16 v[160:175], v[88:91], v[72:75], v[160:175]
  v_cvt_pk_bf16_f32 v224, v224, v225
  v_cvt_pk_bf16_f32 v225, v226, v227
  v_cvt_pk_bf16_f32 v226, v228, v229
  v_cvt_pk_bf16_f32 v227, v230, v231
  v_cvt_pk_bf16_f32 v228, v232, v233
  v_cvt_pk_bf16_f32 v229, v234, v235
  v_cvt_pk_bf16_f32 v230, v236, v237
  v_cvt_pk_bf16_f32 v231, v238, v239
  buffer_load_dwordx4 v9, s[64:67], s57 offen offset:1024 lds
  v_mfma_f32_32x32x16_bf16 v[176:191], v[92:95], v[72:75], v[176:191]
  v_cvt_pk_bf16_f32 v240, v240, v241
  v_cvt_pk_bf16_f32 v241, v242, v243
  v_cvt_pk_bf16_f32 v242, v244, v245
  v_cvt_pk_bf16_f32 v243, v246, v247
  v_cvt_pk_bf16_f32 v244, v248, v249
  v_cvt_pk_bf16_f32 v245, v250, v251
  v_cvt_pk_bf16_f32 v246, v252, v253
  v_cvt_pk_bf16_f32 v247, v254, v255
  buffer_load_dwordx4 v10, s[64:67], s57 offen offset:2048 lds
  v_cvt_pk_bf16_f32 v200, v128, v129
  v_cvt_pk_bf16_f32 v201, v130, v131
  v_cvt_pk_bf16_f32 v202, v132, v133
  v_cvt_pk_bf16_f32 v203, v134, v135
  v_cvt_pk_bf16_f32 v204, v136, v137
  v_cvt_pk_bf16_f32 v205, v138, v139
  v_cvt_pk_bf16_f32 v206, v140, v141
  v_cvt_pk_bf16_f32 v207, v142, v143
  s_waitcnt lgkmcnt(6)
  v_mfma_f32_32x32x16_bf16 v[128:143], v[52:55], v[48:51], 0
  ds_read_b128 v[72:75], v21 offset:0
  ds_read_b64_tr_b16 v[76:77], v24 offset:4096
  ds_read_b64_tr_b16 v[78:79], v24 offset:5120
  buffer_load_dwordx4 v11, s[64:67], s57 offen offset:3072 lds
  v_lshl_add_u32 v42, v0, 2, 4
  v_subrev_u32 v42, s3, v42
  v_med3_i32 v42, v42, 0, 4
  v_lshlrev_b32 v42, 2, v42
  v_cvt_pk_bf16_f32 v216, v144, v145
  v_cvt_pk_bf16_f32 v217, v146, v147
  v_cvt_pk_bf16_f32 v218, v148, v149
  v_cvt_pk_bf16_f32 v219, v150, v151
  v_cvt_pk_bf16_f32 v220, v152, v153
  v_cvt_pk_bf16_f32 v221, v154, v155
  v_cvt_pk_bf16_f32 v222, v156, v157
  v_cvt_pk_bf16_f32 v223, v158, v159
  s_waitcnt lgkmcnt(7)
  v_mfma_f32_32x32x16_bf16 v[144:159], v[56:59], v[48:51], 0
  ds_read_b64_tr_b16 v[80:81], v25 offset:4096
  ds_read_b64_tr_b16 v[82:83], v25 offset:5120
  v_mov_b32 v33, 0x01010101
  v_lshrrev_b32 v33, v42, v33
  v_lshrrev_b32 v42, v42, v33
  v_min_u32 v33, 3, v0
  v_cvt_pk_bf16_f32 v232, v160, v161
  v_cvt_pk_bf16_f32 v233, v162, v163
  v_cvt_pk_bf16_f32 v234, v164, v165
  v_cvt_pk_bf16_f32 v235, v166, v167
  v_cvt_pk_bf16_f32 v236, v168, v169
  v_cvt_pk_bf16_f32 v237, v170, v171
  v_cvt_pk_bf16_f32 v238, v172, v173
  v_cvt_pk_bf16_f32 v239, v174, v175
  s_waitcnt lgkmcnt(7)
  v_mfma_f32_32x32x16_bf16 v[160:175], v[60:63], v[48:51], 0
  ds_read_b64_tr_b16 v[84:85], v26 offset:4096
  ds_read_b64_tr_b16 v[86:87], v26 offset:5120
  s_lshl_b32 s55, s61, 10
  s_add_u32 s55, s55, 6307840
  v_lshl_add_u32 v33, v33, 8, s55
  v_cvt_pk_bf16_f32 v248, v176, v177
  v_cvt_pk_bf16_f32 v249, v178, v179
  v_cvt_pk_bf16_f32 v250, v180, v181
  v_cvt_pk_bf16_f32 v251, v182, v183
  v_cvt_pk_bf16_f32 v252, v184, v185
  v_cvt_pk_bf16_f32 v253, v186, v187
  v_cvt_pk_bf16_f32 v254, v188, v189
  v_cvt_pk_bf16_f32 v255, v190, v191
  s_waitcnt lgkmcnt(7)
  v_mfma_f32_32x32x16_bf16 v[176:191], v[64:67], v[48:51], 0
  ds_read_b64_tr_b16 v[88:89], v27 offset:4096
  ds_read_b64_tr_b16 v[90:91], v27 offset:5120
  s_waitcnt lgkmcnt(6)
  v_mfma_f32_32x32x16_bf16 v[128:143], v[76:79], v[72:75], v[128:143]
  ds_read_b128 v[48:51], v22 offset:0
  ds_read_b64_tr_b16 v[52:53], v24 offset:8192
  ds_read_b64_tr_b16 v[54:55], v24 offset:9216
  s_add_u32 s55, s59, 16384
  s_cmp_lg_u32 s94, 0
  s_cbranch_scc1 .Lkv10g
  buffer_store_dwordx4 v[192:195], v32, s[80:83], s55 offen offset:0
.Lkv10r:
  s_waitcnt lgkmcnt(7)
  v_mfma_f32_32x32x16_bf16 v[144:159], v[80:83], v[72:75], v[144:159]
  ds_read_b64_tr_b16 v[56:57], v25 offset:8192
  ds_read_b64_tr_b16 v[58:59], v25 offset:9216
  s_add_u32 s55, s59, 16384
  s_cmp_lg_u32 s94, 0
  s_cbranch_scc1 .Lkv11g
  buffer_store_dwordx4 v[192:195], v32, s[84:87], s55 offen offset:0
.Lkv11r:
  s_waitcnt lgkmcnt(7)
  v_mfma_f32_32x32x16_bf16 v[160:175], v[84:87], v[72:75], v[160:175]
  ds_read_b64_tr_b16 v[60:61], v26 offset:8192
  ds_read_b64_tr_b16 v[62:63], v26 offset:9216
  s_waitcnt lgkmcnt(7)
  v_mfma_f32_32x32x16_bf16 v[176:191], v[88:91], v[72:75], v[176:191]
  ds_read_b64_tr_b16 v[64:65], v27 offset:8192
  ds_read_b64_tr_b16 v[66:67], v27 offset:9216
  s_waitcnt lgkmcnt(6)
  v_mfma_f32_32x32x16_bf16 v[128:143], v[52:55], v[48:51], v[128:143]
  ds_read_b128 v[72:75], v23 offset:0
  ds_read_b64_tr_b16 v[76:77], v24 offset:12288
  ds_read_b64_tr_b16 v[78:79], v24 offset:13312
  s_add_u32 s55, s59, 16384
  s_cmp_lg_u32 s94, 0
  s_cbranch_scc1 .Lkv12g
  buffer_store_dwordx4 v[196:199], v32, s[80:83], s55 offen offset:1024
.Lkv12r:
  s_waitcnt lgkmcnt(7)
  v_mfma_f32_32x32x16_bf16 v[144:159], v[56:59], v[48:51], v[144:159]
  ds_read_b64_tr_b16 v[80:81], v25 offset:12288
  ds_read_b64_tr_b16 v[82:83], v25 offset:13312
  s_waitcnt lgkmcnt(7)
  v_mfma_f32_32x32x16_bf16 v[160:175], v[60:63], v[48:51], v[160:175]
  ds_read_b64_tr_b16 v[84:85], v26 offset:12288
  ds_read_b64_tr_b16 v[86:87], v26 offset:13312
  s_waitcnt lgkmcnt(7)
  v_mfma_f32_32x32x16_bf16 v[176:191], v[64:67], v[48:51], v[176:191]
  ds_read_b64_tr_b16 v[88:89], v27 offset:12288
  ds_read_b64_tr_b16 v[90:91], v27 offset:13312
  s_waitcnt lgkmcnt(6)
  v_mfma_f32_32x32x16_bf16 v[128:143], v[76:79], v[72:75], v[128:143]
  v_add_u32 v20, 0x10000, v20
  v_add_u32 v21, 0x10000, v21
  v_add_u32 v22, 0x10000, v22
  v_add_u32 v23, 0x10000, v23
  s_waitcnt lgkmcnt(0)
  s_waitcnt vmcnt(11)
  s_barrier
  s_lshl_b32 s55, s61, 2
  s_lshr_b32 s56, s60, 2
  s_add_u32 s55, s55, s56
  s_lshl_b32 s55, s55, 8
  s_and_b32 s56, s60, 3
  s_add_u32 s55, s55, s56
  s_add_u32 s55, s55, 6307840
  s_cmp_lg_u32 s52, 0
  s_cbranch_scc1 .Lfs13
  v_mov_b32 v43, 1
  s_mov_b64 exec, 1
  buffer_store_byte v43, off, s[36:39], s55 sc0 sc1
  s_mov_b64 exec, -1
.Lfs13:
  ds_read_b128 v[48:51], v20 offset:0
  ds_read_b64_tr_b16 v[52:53], v24 offset:16384
  ds_read_b64_tr_b16 v[54:55], v24 offset:17408
  s_add_u32 s55, s59, 0
  s_cmp_lg_u32 s94, 0
  s_cbranch_scc1 .Lkv14g
  buffer_store_dwordx4 v[200:203], v32, s[80:83], s55 offen offset:0
.Lkv14r:
  v_mfma_f32_32x32x16_bf16 v[144:159], v[80:83], v[72:75], v[144:159]
  ds_read_b64_tr_b16 v[56:57], v25 offset:16384
  ds_read_b64_tr_b16 v[58:59], v25 offset:17408
  ds_read_b64_tr_b16 v[60:61], v26 offset:16384
  ds_read_b64_tr_b16 v[62:63], v26 offset:17408
  v_mfma_f32_32x32x16_bf16 v[160:175], v[84:87], v[72:75], v[160:175]
  ds_read_b64_tr_b16 v[64:65], v27 offset:16384
  ds_read_b64_tr_b16 v[66:67], v27 offset:17408
  s_add_u32 m0, s58, 32768
  s_add_u32 s57, s92, 384
  buffer_load_dwordx4 v36, s[32:35], s57 offen offset:0 lds
  v_mfma_f32_32x32x16_bf16 v[176:191], v[88:91], v[72:75], v[176:191]
  s_waitcnt lgkmcnt(6)
  v_mfma_f32_32x32x16_bf16 v[128:143], v[52:55], v[48:51], v[128:143]
  ds_read_b128 v[72:75], v21 offset:0
  ds_read_b64_tr_b16 v[76:77], v24 offset:20480
  ds_read_b64_tr_b16 v[78:79], v24 offset:21504
  s_add_u32 s55, s59, 0
  s_cmp_lg_u32 s94, 0
  s_cbranch_scc1 .Lkv15g
  buffer_store_dwordx4 v[204:207], v32, s[80:83], s55 offen offset:1024
.Lkv15r:
  s_add_u32 s55, s59, 16384
  s_cmp_lg_u32 s94, 0
  s_cbranch_scc1 .Lkv16g
  buffer_store_dwordx4 v[196:199], v32, s[84:87], s55 offen offset:1024
.Lkv16r:
  s_waitcnt lgkmcnt(7)
  v_mfma_f32_32x32x16_bf16 v[144:159], v[56:59], v[48:51], v[144:159]
  ds_read_b64_tr_b16 v[80:81], v25 offset:20480
  ds_read_b64_tr_b16 v[82:83], v25 offset:21504
  buffer_load_dwordx4 v37, s[32:35], s57 offen offset:1024 lds
  s_waitcnt lgkmcnt(7)
  v_mfma_f32_32x32x16_bf16 v[160:175], v[60:63], v[48:51], v[160:175]
  ds_read_b64_tr_b16 v[84:85], v26 offset:20480
  ds_read_b64_tr_b16 v[86:87], v26 offset:21504
  s_waitcnt lgkmcnt(7)
  v_mfma_f32_32x32x16_bf16 v[176:191], v[64:67], v[48:51], v[176:191]
  ds_read_b64_tr_b16 v[88:89], v27 offset:20480
  ds_read_b64_tr_b16 v[90:91], v27 offset:21504
  s_waitcnt lgkmcnt(6)
  v_mfma_f32_32x32x16_bf16 v[128:143], v[76:79], v[72:75], v[128:143]
  ds_read_b128 v[48:51], v22 offset:0
  ds_read_b64_tr_b16 v[52:53], v24 offset:24576
  ds_read_b64_tr_b16 v[54:55], v24 offset:25600
  buffer_load_dwordx4 v38, s[32:35], s57 offen offset:2048 lds
  s_add_u32 s55, s59, 16384
  s_cmp_lg_u32 s94, 0
  s_cbranch_scc1 .Lkv17g
  buffer_store_dwordx4 v[208:211], v32, s[80:83], s55 offen offset:2048
.Lkv17r:
  s_waitcnt lgkmcnt(7)
  v_mfma_f32_32x32x16_bf16 v[144:159], v[80:83], v[72:75], v[144:159]
  ds_read_b64_tr_b16 v[56:57], v25 offset:24576
  ds_read_b64_tr_b16 v[58:59], v25 offset:25600
  s_waitcnt lgkmcnt(7)
  v_mfma_f32_32x32x16_bf16 v[160:175], v[84:87], v[72:75], v[160:175]
  ds_read_b64_tr_b16 v[60:61], v26 offset:24576
  ds_read_b64_tr_b16 v[62:63], v26 offset:25600
  s_waitcnt lgkmcnt(7)
  v_mfma_f32_32x32x16_bf16 v[176:191], v[88:91], v[72:75], v[176:191]
  ds_read_b64_tr_b16 v[64:65], v27 offset:24576
  ds_read_b64_tr_b16 v[66:67], v27 offset:25600
  buffer_load_dwordx4 v39, s[32:35], s57 offen offset:3072 lds
  s_waitcnt lgkmcnt(6)
  v_mfma_f32_32x32x16_bf16 v[128:143], v[52:55], v[48:51], v[128:143]
  ds_read_b128 v[72:75], v23 offset:0
  ds_read_b64_tr_b16 v[76:77], v24 offset:28672
  ds_read_b64_tr_b16 v[78:79], v24 offset:29696
  s_add_u32 s55, s59, 16384
  s_cmp_lg_u32 s94, 0
  s_cbranch_scc1 .Lkv18g
  buffer_store_dwordx4 v[212:215], v32, s[80:83], s55 offen offset:3072
.Lkv18r:
  s_waitcnt lgkmcnt(7)
  v_mfma_f32_32x32x16_bf16 v[144:159], v[56:59], v[48:51], v[144:159]
  ds_read_b64_tr_b16 v[80:81], v25 offset:28672
  ds_read_b64_tr_b16 v[82:83], v25 offset:29696
  s_waitcnt lgkmcnt(7)
  v_mfma_f32_32x32x16_bf16 v[160:175], v[60:63], v[48:51], v[160:175]
  ds_read_b64_tr_b16 v[84:85], v26 offset:28672
  ds_read_b64_tr_b16 v[86:87], v26 offset:29696
  s_waitcnt lgkmcnt(7)
  v_mfma_f32_32x32x16_bf16 v[176:191], v[64:67], v[48:51], v[176:191]
  ds_read_b64_tr_b16 v[88:89], v27 offset:28672
  ds_read_b64_tr_b16 v[90:91], v27 offset:29696
  s_add_u32 s55, s59, 0
  s_cmp_lg_u32 s94, 0
  s_cbranch_scc1 .Lkv19g
  buffer_store_dwordx4 v[200:203], v32, s[84:87], s55 offen offset:0
.Lkv19r:
  s_waitcnt lgkmcnt(6)
  v_mfma_f32_32x32x16_bf16 v[128:143], v[76:79], v[72:75], v[128:143]
  v_add_u32 v20, 0x8000, v20
  v_add_u32 v21, 0x8000, v21
  v_add_u32 v22, 0x8000, v22
  v_add_u32 v23, 0x8000, v23
  v_add_u32 v24, 0xffff0000, v24
  v_add_u32 v25, 0xffff0000, v25
  v_add_u32 v26, 0xffff0000, v26
  v_add_u32 v27, 0xffff0000, v27
  s_waitcnt lgkmcnt(0)
  s_waitcnt vmcnt(13)
  s_barrier
  ds_read_b128 v[48:51], v20 offset:0
  ds_read_b64_tr_b16 v[52:53], v24 offset:0
  ds_read_b64_tr_b16 v[54:55], v24 offset:1024
  s_add_u32 m0, s58, 65536
  s_add_u32 s57, s92, 512
  buffer_load_dwordx4 v36, s[32:35], s57 offen offset:0 lds
  s_add_u32 s55, s59, 0
  s_cmp_lg_u32 s94, 0
  s_cbranch_scc1 .Lkv20g
  buffer_store_dwordx4 v[216:219], v32, s[80:83], s55 offen offset:2048
.Lkv20r:
  buffer_load_dword v41, v33, s[36:39], 0 offen sc0 sc1
  v_mfma_f32_32x32x16_bf16 v[144:159], v[80:83], v[72:75], v[144:159]
  ds_read_b64_tr_b16 v[56:57], v25 offset:0
  ds_read_b64_tr_b16 v[58:59], v25 offset:1024
  ds_read_b64_tr_b16 v[60:61], v26 offset:0
  ds_read_b64_tr_b16 v[62:63], v26 offset:1024
  buffer_load_dwordx4 v37, s[32:35], s57 offen offset:1024 lds
  v_and_b32 v34, 31, v0
  v_lshrrev_b32 v35, 5, v0
  v_mul_u32_u24 v35, 5120, v35
  v_lshl_add_u32 v34, v34, 3, v35
  v_mfma_f32_32x32x16_bf16 v[160:175], v[84:87], v[72:75], v[160:175]
  ds_read_b64_tr_b16 v[64:65], v27 offset:0
  ds_read_b64_tr_b16 v[66:67], v27 offset:1024
  buffer_load_dwordx4 v38, s[32:35], s57 offen offset:2048 lds
  s_mul_i32 s55, s60, 640
  s_add_u32 s55, s55, s62
  s_lshl_b32 s55, s55, 3
  s_sub_u32 s55, s55, 81920
  v_add_u32 v34, s55, v34
  v_mfma_f32_32x32x16_bf16 v[176:191], v[88:91], v[72:75], v[176:191]
  buffer_load_dwordx4 v39, s[32:35], s57 offen offset:3072 lds
  s_waitcnt lgkmcnt(6)
  v_mfma_f32_32x32x16_bf16 v[128:143], v[52:55], v[48:51], v[128:143]
  ds_read_b128 v[72:75], v21 offset:0
  ds_read_b64_tr_b16 v[76:77], v24 offset:4096
  ds_read_b64_tr_b16 v[78:79], v24 offset:5120
  s_add_u32 m0, s58, 98304
  s_mov_b32 s57, 2097152
  buffer_load_dwordx4 v8, s[64:67], s57 offen offset:0 lds
  s_add_u32 s55, s59, 0
  s_cmp_lg_u32 s94, 0
  s_cbranch_scc1 .Lkv21g
  buffer_store_dwordx4 v[220:223], v32, s[80:83], s55 offen offset:3072
.Lkv21r:
  s_waitcnt lgkmcnt(7)
  v_mfma_f32_32x32x16_bf16 v[144:159], v[56:59], v[48:51], v[144:159]
  ds_read_b64_tr_b16 v[80:81], v25 offset:4096
  ds_read_b64_tr_b16 v[82:83], v25 offset:5120
  buffer_load_dwordx4 v9, s[64:67], s57 offen offset:1024 lds
  s_waitcnt lgkmcnt(7)
  v_mfma_f32_32x32x16_bf16 v[160:175], v[60:63], v[48:51], v[160:175]
  ds_read_b64_tr_b16 v[84:85], v26 offset:4096
  ds_read_b64_tr_b16 v[86:87], v26 offset:5120
  buffer_load_dwordx4 v10, s[64:67], s57 offen offset:2048 lds
  s_waitcnt lgkmcnt(7)
  v_mfma_f32_32x32x16_bf16 v[176:191], v[64:67], v[48:51], v[176:191]
  ds_read_b64_tr_b16 v[88:89], v27 offset:4096
  ds_read_b64_tr_b16 v[90:91], v27 offset:5120
  buffer_load_dwordx4 v11, s[64:67], s57 offen offset:3072 lds
  s_waitcnt lgkmcnt(6)
  v_mfma_f32_32x32x16_bf16 v[128:143], v[76:79], v[72:75], v[128:143]
  ds_read_b128 v[48:51], v22 offset:0
  ds_read_b64_tr_b16 v[52:53], v24 offset:8192
  ds_read_b64_tr_b16 v[54:55], v24 offset:9216
  s_add_u32 s55, s59, 20480
  s_cmp_lg_u32 s94, 0
  s_cbranch_scc1 .Lkv22g
  buffer_store_dwordx4 v[224:227], v32, s[80:83], s55 offen offset:0
.Lkv22r:
  s_waitcnt lgkmcnt(7)
  v_mfma_f32_32x32x16_bf16 v[144:159], v[80:83], v[72:75], v[144:159]
  ds_read_b64_tr_b16 v[56:57], v25 offset:8192
  ds_read_b64_tr_b16 v[58:59], v25 offset:9216
  s_waitcnt lgkmcnt(7)
  v_mfma_f32_32x32x16_bf16 v[160:175], v[84:87], v[72:75], v[160:175]
  ds_read_b64_tr_b16 v[60:61], v26 offset:8192
  ds_read_b64_tr_b16 v[62:63], v26 offset:9216
  s_add_u32 s55, s59, 0
  s_cmp_lg_u32 s94, 0
  s_cbranch_scc1 .Lkv23g
  buffer_store_dwordx4 v[204:207], v32, s[84:87], s55 offen offset:1024
.Lkv23r:
  s_waitcnt lgkmcnt(7)
  v_mfma_f32_32x32x16_bf16 v[176:191], v[88:91], v[72:75], v[176:191]
  ds_read_b64_tr_b16 v[64:65], v27 offset:8192
  ds_read_b64_tr_b16 v[66:67], v27 offset:9216
  s_waitcnt lgkmcnt(6)
  v_mfma_f32_32x32x16_bf16 v[128:143], v[52:55], v[48:51], v[128:143]
  ds_read_b128 v[72:75], v23 offset:0
  ds_read_b64_tr_b16 v[76:77], v24 offset:12288
  ds_read_b64_tr_b16 v[78:79], v24 offset:13312
  s_add_u32 s55, s59, 20480
  s_cmp_lg_u32 s94, 0
  s_cbranch_scc1 .Lkv24g
  buffer_store_dwordx4 v[228:231], v32, s[80:83], s55 offen offset:1024
.Lkv24r:
  s_waitcnt lgkmcnt(7)
  v_mfma_f32_32x32x16_bf16 v[144:159], v[56:59], v[48:51], v[144:159]
  ds_read_b64_tr_b16 v[80:81], v25 offset:12288
  ds_read_b64_tr_b16 v[82:83], v25 offset:13312
  s_waitcnt lgkmcnt(7)
  v_mfma_f32_32x32x16_bf16 v[160:175], v[60:63], v[48:51], v[160:175]
  ds_read_b64_tr_b16 v[84:85], v26 offset:12288
  ds_read_b64_tr_b16 v[86:87], v26 offset:13312
  s_waitcnt lgkmcnt(7)
  v_mfma_f32_32x32x16_bf16 v[176:191], v[64:67], v[48:51], v[176:191]
  ds_read_b64_tr_b16 v[88:89], v27 offset:12288
  ds_read_b64_tr_b16 v[90:91], v27 offset:13312
  s_waitcnt lgkmcnt(6)
  v_mfma_f32_32x32x16_bf16 v[128:143], v[76:79], v[72:75], v[128:143]
  v_add_u32 v20, 0xfffe8000, v20
  v_add_u32 v21, 0xfffe8000, v21
  v_add_u32 v22, 0xfffe8000, v22
  v_add_u32 v23, 0xfffe8000, v23
  s_waitcnt lgkmcnt(0)
  s_waitcnt vmcnt(16)
  s_barrier
  ds_read_b128 v[48:51], v20 offset:0
  ds_read_b64_tr_b16 v[52:53], v24 offset:16384
  ds_read_b64_tr_b16 v[54:55], v24 offset:17408
  s_add_u32 s55, s59, 4096
  s_cmp_lg_u32 s94, 0
  s_cbranch_scc1 .Lkv25g
  buffer_store_dwordx4 v[232:235], v32, s[80:83], s55 offen offset:0
.Lkv25r:
  s_waitcnt vmcnt(12)
.Lpl26c:
  v_and_b32 v1, v41, v42
  v_cmp_ne_u32 vcc, v1, v42
  s_nop 0
  s_cbranch_vccnz .Lpl26s
.Lpl26k:
  buffer_load_dwordx2 v[192:193], v34, s[36:39], 0 offen
  v_mfma_f32_32x32x16_bf16 v[144:159], v[80:83], v[72:75], v[144:159]
  ds_read_b64_tr_b16 v[56:57], v25 offset:16384
  ds_read_b64_tr_b16 v[58:59], v25 offset:17408
  ds_read_b64_tr_b16 v[60:61], v26 offset:16384
  ds_read_b64_tr_b16 v[62:63], v26 offset:17408
  v_add_u32 v35, 10240, v34
  buffer_load_dwordx2 v[194:195], v35, s[36:39], 0 offen
  v_add_u32 v34, 10240, v35
  v_mfma_f32_32x32x16_bf16 v[160:175], v[84:87], v[72:75], v[160:175]
  ds_read_b64_tr_b16 v[64:65], v27 offset:16384
  ds_read_b64_tr_b16 v[66:67], v27 offset:17408
  s_add_u32 m0, s58, 131072
  s_add_u32 s57, s92, 640
  buffer_load_dwordx4 v36, s[32:35], s57 offen offset:0 lds
  buffer_load_dwordx2 v[196:197], v34, s[36:39], 0 offen
  v_add_u32 v35, 10240, v34
  buffer_load_dwordx2 v[198:199], v35, s[36:39], 0 offen
  v_mfma_f32_32x32x16_bf16 v[176:191], v[88:91], v[72:75], v[176:191]
  v_add_u32 v34, 10240, v35
  buffer_load_dwordx2 v[200:201], v34, s[36:39], 0 offen
  v_add_u32 v35, 10240, v34
  s_waitcnt lgkmcnt(6)
  v_mfma_f32_32x32x16_bf16 v[128:143], v[52:55], v[48:51], v[128:143]
  ds_read_b128 v[72:75], v21 offset:0
  ds_read_b64_tr_b16 v[76:77], v24 offset:20480
  ds_read_b64_tr_b16 v[78:79], v24 offset:21504
  s_add_u32 s55, s59, 4096
  s_cmp_lg_u32 s94, 0
  s_cbranch_scc1 .Lkv27g
  buffer_store_dwordx4 v[236:239], v32, s[80:83], s55 offen offset:1024
.Lkv27r:
  buffer_load_dwordx2 v[202:203], v35, s[36:39], 0 offen
  s_waitcnt lgkmcnt(7)
  v_mfma_f32_32x32x16_bf16 v[144:159], v[56:59], v[48:51], v[144:159]
  ds_read_b64_tr_b16 v[80:81], v25 offset:20480
  ds_read_b64_tr_b16 v[82:83], v25 offset:21504
  buffer_load_dwordx4 v37, s[32:35], s57 offen offset:1024 lds
  s_add_u32 s55, s59, 16384
  s_cmp_lg_u32 s94, 0
  s_cbranch_scc1 .Lkv28g
  buffer_store_dwordx4 v[208:211], v32, s[84:87], s55 offen offset:2048
.Lkv28r:
  v_add_u32 v34, 10240, v35
  buffer_load_dwordx2 v[204:205], v34, s[36:39], 0 offen
  s_waitcnt lgkmcnt(7)
  v_mfma_f32_32x32x16_bf16 v[160:175], v[60:63], v[48:51], v[160:175]
  ds_read_b64_tr_b16 v[84:85], v26 offset:20480
  ds_read_b64_tr_b16 v[86:87], v26 offset:21504
  v_add_u32 v35, 10240, v34
  buffer_load_dwordx2 v[206:207], v35, s[36:39], 0 offen
  s_waitcnt lgkmcnt(7)
  v_mfma_f32_32x32x16_bf16 v[176:191], v[64:67], v[48:51], v[176:191]
  ds_read_b64_tr_b16 v[88:89], v27 offset:20480
  ds_read_b64_tr_b16 v[90:91], v27 offset:21504
  s_waitcnt lgkmcnt(6)
  v_mfma_f32_32x32x16_bf16 v[128:143], v[76:79], v[72:75], v[128:143]
  ds_read_b128 v[48:51], v22 offset:0
  ds_read_b64_tr_b16 v[52:53], v24 offset:24576
  ds_read_b64_tr_b16 v[54:55], v24 offset:25600
  buffer_load_dwordx4 v38, s[32:35], s57 offen offset:2048 lds
  s_add_u32 s55, s59, 20480
  s_cmp_lg_u32 s94, 0
  s_cbranch_scc1 .Lkv29g
  buffer_store_dwordx4 v[240:243], v32, s[80:83], s55 offen offset:2048
.Lkv29r:
  s_waitcnt lgkmcnt(7)
  v_mfma_f32_32x32x16_bf16 v[144:159], v[80:83], v[72:75], v[144:159]
  ds_read_b64_tr_b16 v[56:57], v25 offset:24576
  ds_read_b64_tr_b16 v[58:59], v25 offset:25600
  s_waitcnt lgkmcnt(7)
  v_mfma_f32_32x32x16_bf16 v[160:175], v[84:87], v[72:75], v[160:175]
  ds_read_b64_tr_b16 v[60:61], v26 offset:24576
  ds_read_b64_tr_b16 v[62:63], v26 offset:25600
  s_waitcnt lgkmcnt(7)
  v_mfma_f32_32x32x16_bf16 v[176:191], v[88:91], v[72:75], v[176:191]
  ds_read_b64_tr_b16 v[64:65], v27 offset:24576
  ds_read_b64_tr_b16 v[66:67], v27 offset:25600
  buffer_load_dwordx4 v39, s[32:35], s57 offen offset:3072 lds
  s_waitcnt lgkmcnt(6)
  v_mfma_f32_32x32x16_bf16 v[128:143], v[52:55], v[48:51], v[128:143]
  ds_read_b128 v[72:75], v23 offset:0
  ds_read_b64_tr_b16 v[76:77], v24 offset:28672
  ds_read_b64_tr_b16 v[78:79], v24 offset:29696
  s_add_u32 s55, s59, 20480
  s_cmp_lg_u32 s94, 0
  s_cbranch_scc1 .Lkv30g
  buffer_store_dwordx4 v[244:247], v32, s[80:83], s55 offen offset:3072
.Lkv30r:
  s_waitcnt lgkmcnt(7)
  v_mfma_f32_32x32x16_bf16 v[144:159], v[56:59], v[48:51], v[144:159]
  ds_read_b64_tr_b16 v[80:81], v25 offset:28672
  ds_read_b64_tr_b16 v[82:83], v25 offset:29696
  s_waitcnt lgkmcnt(7)
  v_mfma_f32_32x32x16_bf16 v[160:175], v[60:63], v[48:51], v[160:175]
  ds_read_b64_tr_b16 v[84:85], v26 offset:28672
  ds_read_b64_tr_b16 v[86:87], v26 offset:29696
  s_waitcnt lgkmcnt(7)
  v_mfma_f32_32x32x16_bf16 v[176:191], v[64:67], v[48:51], v[176:191]
  ds_read_b64_tr_b16 v[88:89], v27 offset:28672
  ds_read_b64_tr_b16 v[90:91], v27 offset:29696
  s_waitcnt lgkmcnt(6)
  v_mfma_f32_32x32x16_bf16 v[128:143], v[76:79], v[72:75], v[128:143]
  v_add_u32 v20, 0x8000, v20
  v_add_u32 v21, 0x8000, v21
  v_add_u32 v22, 0x8000, v22
  v_add_u32 v23, 0x8000, v23
  v_add_u32 v24, 0x18000, v24
  v_add_u32 v25, 0x18000, v25
  v_add_u32 v26, 0x18000, v26
  v_add_u32 v27, 0x18000, v27
  s_waitcnt lgkmcnt(0)
  s_waitcnt vmcnt(20)
  s_barrier
  ds_read_b128 v[48:51], v20 offset:0
  ds_read_b64_tr_b16 v[52:53], v24 offset:0
  ds_read_b64_tr_b16 v[54:55], v24 offset:1024
  s_add_u32 m0, s58, 0
  s_add_u32 s57, s92, 768
  buffer_load_dwordx4 v36, s[32:35], s57 offen offset:0 lds
  s_add_u32 s55, s59, 4096
  s_cmp_lg_u32 s94, 0
  s_cbranch_scc1 .Lkv31g
  buffer_store_dwordx4 v[248:251], v32, s[80:83], s55 offen offset:2048
.Lkv31r:
  s_add_u32 s55, s59, 16384
  s_cmp_lg_u32 s94, 0
  s_cbranch_scc1 .Lkv32g
  buffer_store_dwordx4 v[212:215], v32, s[84:87], s55 offen offset:3072
.Lkv32r:
  v_mfma_f32_32x32x16_bf16 v[144:159], v[80:83], v[72:75], v[144:159]
  ds_read_b64_tr_b16 v[56:57], v25 offset:0
  ds_read_b64_tr_b16 v[58:59], v25 offset:1024
  ds_read_b64_tr_b16 v[60:61], v26 offset:0
  ds_read_b64_tr_b16 v[62:63], v26 offset:1024
  buffer_load_dwordx4 v37, s[32:35], s57 offen offset:1024 lds
  s_waitcnt vmcnt(8)
  v_fma_f32 v1, v16, v192, v194
  v_fma_f32 v2, v16, v193, v195
  v_fma_f32 v34, -v17, v193, v1
  v_mfma_f32_32x32x16_bf16 v[160:175], v[84:87], v[72:75], v[160:175]
  ds_read_b64_tr_b16 v[64:65], v27 offset:0
  ds_read_b64_tr_b16 v[66:67], v27 offset:1024
  buffer_load_dwordx4 v38, s[32:35], s57 offen offset:2048 lds
  v_fma_f32 v35, v17, v192, v2
  v_fma_f32 v1, v16, v34, v196
  v_fma_f32 v2, v16, v35, v197
  v_fma_f32 v30, -v17, v35, v1
  v_mfma_f32_32x32x16_bf16 v[176:191], v[88:91], v[72:75], v[176:191]
  buffer_load_dwordx4 v39, s[32:35], s57 offen offset:3072 lds
  v_fma_f32 v31, v17, v34, v2
  v_fma_f32 v1, v16, v30, v198
  v_fma_f32 v2, v16, v31, v199
  v_fma_f32 v34, -v17, v31, v1
  s_waitcnt lgkmcnt(6)
  v_mfma_f32_32x32x16_bf16 v[128:143], v[52:55], v[48:51], v[128:143]
  ds_read_b128 v[72:75], v21 offset:0
  ds_read_b64_tr_b16 v[76:77], v24 offset:4096
  ds_read_b64_tr_b16 v[78:79], v24 offset:5120
  s_add_u32 m0, s58, 32768
  s_mov_b32 s57, 3145728
  buffer_load_dwordx4 v8, s[64:67], s57 offen offset:0 lds
  s_add_u32 s55, s59, 4096
  s_cmp_lg_u32 s94, 0
  s_cbranch_scc1 .Lkv33g
  buffer_store_dwordx4 v[252:255], v32, s[80:83], s55 offen offset:3072
.Lkv33r:
  v_fma_f32 v35, v17, v30, v2
  v_fma_f32 v1, v16, v34, v200
  s_waitcnt lgkmcnt(7)
  v_mfma_f32_32x32x16_bf16 v[144:159], v[56:59], v[48:51], v[144:159]
  ds_read_b64_tr_b16 v[80:81], v25 offset:4096
  ds_read_b64_tr_b16 v[82:83], v25 offset:5120
  buffer_load_dwordx4 v9, s[64:67], s57 offen offset:1024 lds
  v_fma_f32 v2, v16, v35, v201
  v_fma_f32 v30, -v17, v35, v1
  v_fma_f32 v31, v17, v34, v2
  v_fma_f32 v1, v16, v30, v202
  s_waitcnt lgkmcnt(7)
  v_mfma_f32_32x32x16_bf16 v[160:175], v[60:63], v[48:51], v[160:175]
  ds_read_b64_tr_b16 v[84:85], v26 offset:4096
  ds_read_b64_tr_b16 v[86:87], v26 offset:5120
  buffer_load_dwordx4 v10, s[64:67], s57 offen offset:2048 lds
  v_fma_f32 v2, v16, v31, v203
  v_fma_f32 v34, -v17, v31, v1
  v_fma_f32 v35, v17, v30, v2
  v_fma_f32 v1, v16, v34, v204
  s_waitcnt lgkmcnt(7)
  v_mfma_f32_32x32x16_bf16 v[176:191], v[64:67], v[48:51], v[176:191]
  ds_read_b64_tr_b16 v[88:89], v27 offset:4096
  ds_read_b64_tr_b16 v[90:91], v27 offset:5120
  buffer_load_dwordx4 v11, s[64:67], s57 offen offset:3072 lds
  v_fma_f32 v2, v16, v35, v205
  v_fma_f32 v30, -v17, v35, v1
  v_fma_f32 v31, v17, v34, v2
  v_fma_f32 v1, v16, v30, v206
  s_waitcnt lgkmcnt(6)
  v_mfma_f32_32x32x16_bf16 v[128:143], v[76:79], v[72:75], v[128:143]
  ds_read_b128 v[48:51], v22 offset:0
  ds_read_b64_tr_b16 v[52:53], v24 offset:8192
  ds_read_b64_tr_b16 v[54:55], v24 offset:9216
  s_add_u32 s55, s59, 0
  s_cmp_lg_u32 s94, 0
  s_cbranch_scc1 .Lkv34g
  buffer_store_dwordx4 v[216:219], v32, s[84:87], s55 offen offset:2048
.Lkv34r:
  v_fma_f32 v2, v16, v31, v207
  v_fma_f32 v34, -v17, v31, v1
  s_waitcnt lgkmcnt(7)
  v_mfma_f32_32x32x16_bf16 v[144:159], v[80:83], v[72:75], v[144:159]
  ds_read_b64_tr_b16 v[56:57], v25 offset:8192
  ds_read_b64_tr_b16 v[58:59], v25 offset:9216
  v_fma_f32 v35, v17, v30, v2
  v_mov_b32 v30, v34
  v_mov_b32 v31, v35
  s_nop 0
  v_permlane32_swap_b32 v34, v30
  s_waitcnt lgkmcnt(7)
  v_mfma_f32_32x32x16_bf16 v[160:175], v[84:87], v[72:75], v[160:175]
  ds_read_b64_tr_b16 v[60:61], v26 offset:8192
  ds_read_b64_tr_b16 v[62:63], v26 offset:9216
  v_permlane32_swap_b32 v35, v31
  s_nop 0
  v_fma_f32 v1, v18, v34, v30
  v_fma_f32 v2, v18, v35, v31
  s_waitcnt lgkmcnt(7)
  v_mfma_f32_32x32x16_bf16 v[176:191], v[88:91], v[72:75], v[176:191]
  ds_read_b64_tr_b16 v[64:65], v27 offset:8192
  ds_read_b64_tr_b16 v[66:67], v27 offset:9216
  v_fma_f32 v16, -v19, v35, v1
  v_fma_f32 v17, v19, v34, v2
  v_fma_f32 v1, v4, v16, v6
  v_fma_f32 v2, v4, v17, v7
  s_waitcnt lgkmcnt(6)
  v_mfma_f32_32x32x16_bf16 v[128:143], v[52:55], v[48:51], v[128:143]
  ds_read_b128 v[72:75], v23 offset:0
  ds_read_b64_tr_b16 v[76:77], v24 offset:12288
  ds_read_b64_tr_b16 v[78:79], v24 offset:13312
  v_fma_f32 v18, -v5, v17, v1
  v_fma_f32 v19, v5, v16, v2
  v_fma_f32 v1, v12, v18, v28
  v_fma_f32 v2, v12, v19, v29
  s_waitcnt lgkmcnt(7)
  v_mfma_f32_32x32x16_bf16 v[144:159], v[56:59], v[48:51], v[144:159]
  ds_read_b64_tr_b16 v[80:81], v25 offset:12288
  ds_read_b64_tr_b16 v[82:83], v25 offset:13312
  v_fma_f32 v30, -v13, v19, v1
  v_fma_f32 v31, v13, v18, v2
  v_fma_f32 v1, v44, v30, v96
  v_fma_f32 v2, v44, v31, v112
  s_waitcnt lgkmcnt(7)
  v_mfma_f32_32x32x16_bf16 v[160:175], v[60:63], v[48:51], v[160:175]
  ds_read_b64_tr_b16 v[84:85], v26 offset:12288
  ds_read_b64_tr_b16 v[86:87], v26 offset:13312
  v_fma_f32 v96, -v45, v31, v1
  v_fma_f32 v112, v45, v30, v2
  v_fma_f32 v1, v44, v96, v97
  v_fma_f32 v2, v44, v112, v113
  s_waitcnt lgkmcnt(7)
  v_mfma_f32_32x32x16_bf16 v[176:191], v[64:67], v[48:51], v[176:191]
  ds_read_b64_tr_b16 v[88:89], v27 offset:12288
  ds_read_b64_tr_b16 v[90:91], v27 offset:13312
  v_fma_f32 v97, -v45, v112, v1
  v_fma_f32 v113, v45, v96, v2
  v_fma_f32 v1, v44, v97, v98
  v_fma_f32 v2, v44, v113, v114
  s_waitcnt lgkmcnt(6)
  v_mfma_f32_32x32x16_bf16 v[128:143], v[76:79], v[72:75], v[128:143]
  v_add_u32 v20, 0x10000, v20
  v_add_u32 v21, 0x10000, v21
  v_add_u32 v22, 0x10000, v22
  v_add_u32 v23, 0x10000, v23
  s_waitcnt lgkmcnt(0)
  s_waitcnt vmcnt(13)
  s_barrier
  ds_read_b128 v[48:51], v20 offset:0
  ds_read_b64_tr_b16 v[52:53], v24 offset:16384
  ds_read_b64_tr_b16 v[54:55], v24 offset:17408
  s_add_u32 m0, s58, 65536
  s_add_u32 s57, s92, 896
  buffer_load_dwordx4 v36, s[32:35], s57 offen offset:0 lds
  s_add_u32 s55, s59, 0
  s_cmp_lg_u32 s94, 0
  s_cbranch_scc1 .Lkv35g
  buffer_store_dwordx4 v[220:223], v32, s[84:87], s55 offen offset:3072
.Lkv35r:
  v_fma_f32 v98, -v45, v113, v1
  v_fma_f32 v114, v45, v97, v2
  v_mfma_f32_32x32x16_bf16 v[144:159], v[80:83], v[72:75], v[144:159]
  ds_read_b64_tr_b16 v[56:57], v25 offset:16384
  ds_read_b64_tr_b16 v[58:59], v25 offset:17408
  ds_read_b64_tr_b16 v[60:61], v26 offset:16384
  ds_read_b64_tr_b16 v[62:63], v26 offset:17408
  buffer_load_dwordx4 v37, s[32:35], s57 offen offset:1024 lds
  v_fma_f32 v1, v44, v98, v99
  v_fma_f32 v2, v44, v114, v115
  v_fma_f32 v99, -v45, v114, v1
  v_fma_f32 v115, v45, v98, v2
  v_mfma_f32_32x32x16_bf16 v[160:175], v[84:87], v[72:75], v[160:175]
  ds_read_b64_tr_b16 v[64:65], v27 offset:16384
  ds_read_b64_tr_b16 v[66:67], v27 offset:17408
  buffer_load_dwordx4 v38, s[32:35], s57 offen offset:2048 lds
  v_fma_f32 v1, v44, v99, v100
  v_fma_f32 v2, v44, v115, v116
  v_fma_f32 v100, -v45, v115, v1
  v_fma_f32 v116, v45, v99, v2
  v_mfma_f32_32x32x16_bf16 v[176:191], v[88:91], v[72:75], v[176:191]
  buffer_load_dwordx4 v39, s[32:35], s57 offen offset:3072 lds
  v_fma_f32 v1, v44, v100, v101
  v_fma_f32 v2, v44, v116, v117
  v_fma_f32 v101, -v45, v116, v1
  v_fma_f32 v117, v45, v100, v2
  s_waitcnt lgkmcnt(6)
  v_mfma_f32_32x32x16_bf16 v[128:143], v[52:55], v[48:51], v[128:143]
  ds_read_b128 v[72:75], v21 offset:0
  ds_read_b64_tr_b16 v[76:77], v24 offset:20480
  ds_read_b64_tr_b16 v[78:79], v24 offset:21504
  s_add_u32 m0, s58, 81920
  s_add_u32 s57, s93, 896
  buffer_load_dwordx4 v36, s[32:35], s57 offen offset:0 lds
  v_fma_f32 v1, v44, v101, v102
  v_fma_f32 v2, v44, v117, v118
  v_fma_f32 v102, -v45, v117, v1
  v_fma_f32 v118, v45, v101, v2
  s_waitcnt lgkmcnt(7)
  v_mfma_f32_32x32x16_bf16 v[144:159], v[56:59], v[48:51], v[144:159]
  ds_read_b64_tr_b16 v[80:81], v25 offset:20480
  ds_read_b64_tr_b16 v[82:83], v25 offset:21504
  buffer_load_dwordx4 v37, s[32:35], s57 offen offset:1024 lds
  v_fma_f32 v1, v44, v102, v103
  v_fma_f32 v2, v44, v118, v119
  v_fma_f32 v103, -v45, v118, v1
  v_fma_f32 v119, v45, v102, v2
  s_waitcnt lgkmcnt(7)
  v_mfma_f32_32x32x16_bf16 v[160:175], v[60:63], v[48:51], v[160:175]
  ds_read_b64_tr_b16 v[84:85], v26 offset:20480
  ds_read_b64_tr_b16 v[86:87], v26 offset:21504
  buffer_load_dwordx4 v38, s[32:35], s57 offen offset:2048 lds
  v_fma_f32 v1, v44, v103, v104
  v_fma_f32 v2, v44, v119, v120
  v_fma_f32 v104, -v45, v119, v1
  v_fma_f32 v120, v45, v103, v2
  s_waitcnt lgkmcnt(7)
  v_mfma_f32_32x32x16_bf16 v[176:191], v[64:67], v[48:51], v[176:191]
  ds_read_b64_tr_b16 v[88:89], v27 offset:20480
  ds_read_b64_tr_b16 v[90:91], v27 offset:21504
  buffer_load_dwordx4 v39, s[32:35], s57 offen offset:3072 lds
  v_fma_f32 v1, v44, v104, v105
  v_fma_f32 v2, v44, v120, v121
  v_fma_f32 v105, -v45, v120, v1
  v_fma_f32 v121, v45, v104, v2
  s_waitcnt lgkmcnt(6)
  v_mfma_f32_32x32x16_bf16 v[128:143], v[76:79], v[72:75], v[128:143]
  ds_read_b128 v[48:51], v22 offset:0
  ds_read_b64_tr_b16 v[52:53], v24 offset:24576
  ds_read_b64_tr_b16 v[54:55], v24 offset:25600
  s_add_u32 s55, s59, 20480
  s_cmp_lg_u32 s94, 0
  s_cbranch_scc1 .Lkv36g
  buffer_store_dwordx4 v[224:227], v32, s[84:87], s55 offen offset:0
.Lkv36r:
  v_fma_f32 v1, v44, v105, v106
  v_fma_f32 v2, v44, v121, v122
  s_waitcnt lgkmcnt(7)
  v_mfma_f32_32x32x16_bf16 v[144:159], v[80:83], v[72:75], v[144:159]
  ds_read_b64_tr_b16 v[56:57], v25 offset:24576
  ds_read_b64_tr_b16 v[58:59], v25 offset:25600
  v_fma_f32 v106, -v45, v121, v1
  v_fma_f32 v122, v45, v105, v2
  v_fma_f32 v1, v44, v106, v107
  v_fma_f32 v2, v44, v122, v123
  s_waitcnt lgkmcnt(7)
  v_mfma_f32_32x32x16_bf16 v[160:175], v[84:87], v[72:75], v[160:175]
  ds_read_b64_tr_b16 v[60:61], v26 offset:24576
  ds_read_b64_tr_b16 v[62:63], v26 offset:25600
  v_fma_f32 v107, -v45, v122, v1
  v_fma_f32 v123, v45, v106, v2
  v_fma_f32 v1, v44, v107, v108
  v_fma_f32 v2, v44, v123, v124
  s_waitcnt lgkmcnt(7)
  v_mfma_f32_32x32x16_bf16 v[176:191], v[88:91], v[72:75], v[176:191]
  ds_read_b64_tr_b16 v[64:65], v27 offset:24576
  ds_read_b64_tr_b16 v[66:67], v27 offset:25600
  v_fma_f32 v108, -v45, v123, v1
  v_fma_f32 v124, v45, v107, v2
  v_fma_f32 v1, v44, v108, v109
  v_fma_f32 v2, v44, v124, v125
  s_waitcnt lgkmcnt(6)
  v_mfma_f32_32x32x16_bf16 v[128:143], v[52:55], v[48:51], v[128:143]
  ds_read_b128 v[72:75], v23 offset:0
  ds_read_b64_tr_b16 v[76:77], v24 offset:28672
  ds_read_b64_tr_b16 v[78:79], v24 offset:29696
  v_fma_f32 v109, -v45, v124, v1
  v_fma_f32 v125, v45, v108, v2
  v_fma_f32 v1, v44, v109, v110
  v_fma_f32 v2, v44, v125, v126
  s_waitcnt lgkmcnt(7)
  v_mfma_f32_32x32x16_bf16 v[144:159], v[56:59], v[48:51], v[144:159]
  ds_read_b64_tr_b16 v[80:81], v25 offset:28672
  ds_read_b64_tr_b16 v[82:83], v25 offset:29696
  v_fma_f32 v110, -v45, v125, v1
  v_fma_f32 v126, v45, v109, v2
  v_fma_f32 v1, v44, v110, v111
  v_fma_f32 v2, v44, v126, v127
  s_waitcnt lgkmcnt(7)
  v_mfma_f32_32x32x16_bf16 v[160:175], v[60:63], v[48:51], v[160:175]
  ds_read_b64_tr_b16 v[84:85], v26 offset:28672
  ds_read_b64_tr_b16 v[86:87], v26 offset:29696
  v_fma_f32 v111, -v45, v126, v1
  v_fma_f32 v127, v45, v110, v2
  v_mul_f32 v28, v46, v96
  v_mul_f32 v29, v46, v112
  s_waitcnt lgkmcnt(7)
  v_mfma_f32_32x32x16_bf16 v[176:191], v[64:67], v[48:51], v[176:191]
  ds_read_b64_tr_b16 v[88:89], v27 offset:28672
  ds_read_b64_tr_b16 v[90:91], v27 offset:29696
  v_fma_f32 v28, -v47, v112, v28
  v_fma_f32 v29, -v47, v96, -v29
  v_mul_f32 v30, v46, v97
  v_mul_f32 v31, v46, v113
  s_waitcnt lgkmcnt(6)
  v_mfma_f32_32x32x16_bf16 v[128:143], v[76:79], v[72:75], v[128:143]
  v_add_u32 v20, 0xfffe0000, v20
  v_add_u32 v21, 0xfffe0000, v21
  v_add_u32 v22, 0xfffe0000, v22
  v_add_u32 v23, 0xfffe0000, v23
  v_add_u32 v24, 0xffff0000, v24
  v_add_u32 v25, 0xffff0000, v25
  v_add_u32 v26, 0xffff0000, v26
  v_add_u32 v27, 0xffff0000, v27
  s_waitcnt lgkmcnt(0)
  s_waitcnt vmcnt(11)
  s_barrier
  s_lshl_b32 s55, s53, 1
  s_lshr_b32 s56, s54, 2
  s_add_u32 s55, s55, s56
  s_lshl_b32 s55, s55, 8
  s_and_b32 s56, s54, 3
  s_add_u32 s55, s55, s56
  s_add_u32 s100, s55, 48234496
  s_cmp_lg_u32 s52, 1
  s_cbranch_scc1 .Lfs37
  v_mov_b32 v43, 1
  s_mov_b64 exec, 1
  buffer_store_byte v43, off, s[80:83], s100 sc0 sc1
  s_mov_b64 exec, -1
.Lfs37:
  ds_read_b128 v[48:51], v20 offset:0
  ds_read_b64_tr_b16 v[52:53], v24 offset:0
  ds_read_b64_tr_b16 v[54:55], v24 offset:1024
  s_add_u32 m0, s58, 98304
  s_add_u32 s57, s92, 1024
  buffer_load_dwordx4 v36, s[32:35], s57 offen offset:0 lds
  s_add_u32 s55, s59, 20480
  s_cmp_lg_u32 s94, 0
  s_cbranch_scc1 .Lkv38g
  buffer_store_dwordx4 v[228:231], v32, s[84:87], s55 offen offset:1024
.Lkv38r:
  v_fma_f32 v30, -v47, v113, v30
  v_fma_f32 v31, -v47, v97, -v31
  v_mfma_f32_32x32x16_bf16 v[144:159], v[80:83], v[72:75], v[144:159]
  ds_read_b64_tr_b16 v[56:57], v25 offset:0
  ds_read_b64_tr_b16 v[58:59], v25 offset:1024
  ds_read_b64_tr_b16 v[60:61], v26 offset:0
  ds_read_b64_tr_b16 v[62:63], v26 offset:1024
  buffer_load_dwordx4 v37, s[32:35], s57 offen offset:1024 lds
  v_cvt_pk_bf16_f32 v96, v28, v30
  v_cvt_pk_bf16_f32 v112, v29, v31
  v_mul_f32 v28, v46, v98
  v_mul_f32 v29, v46, v114
  v_mfma_f32_32x32x16_bf16 v[160:175], v[84:87], v[72:75], v[160:175]
  ds_read_b64_tr_b16 v[64:65], v27 offset:0
  ds_read_b64_tr_b16 v[66:67], v27 offset:1024
  buffer_load_dwordx4 v38, s[32:35], s57 offen offset:2048 lds
  v_fma_f32 v28, -v47, v114, v28
  v_fma_f32 v29, -v47, v98, -v29
  v_mul_f32 v30, v46, v99
  v_mul_f32 v31, v46, v115
  v_mfma_f32_32x32x16_bf16 v[176:191], v[88:91], v[72:75], v[176:191]
  buffer_load_dwordx4 v39, s[32:35], s57 offen offset:3072 lds
  v_fma_f32 v30, -v47, v115, v30
  v_fma_f32 v31, -v47, v99, -v31
  v_cvt_pk_bf16_f32 v97, v28, v30
  v_cvt_pk_bf16_f32 v113, v29, v31
  s_waitcnt lgkmcnt(6)
  v_mfma_f32_32x32x16_bf16 v[128:143], v[52:55], v[48:51], v[128:143]
  ds_read_b128 v[72:75], v21 offset:0
  ds_read_b64_tr_b16 v[76:77], v24 offset:4096
  ds_read_b64_tr_b16 v[78:79], v24 offset:5120
  s_add_u32 m0, s58, 114688
  s_add_u32 s57, s93, 1024
  buffer_load_dwordx4 v36, s[32:35], s57 offen offset:0 lds
  v_mul_f32 v28, v46, v100
  v_mul_f32 v29, v46, v116
  v_fma_f32 v28, -v47, v116, v28
  v_fma_f32 v29, -v47, v100, -v29
  s_waitcnt lgkmcnt(7)
  v_mfma_f32_32x32x16_bf16 v[144:159], v[56:59], v[48:51], v[144:159]
  ds_read_b64_tr_b16 v[80:81], v25 offset:4096
  ds_read_b64_tr_b16 v[82:83], v25 offset:5120
  buffer_load_dwordx4 v37, s[32:35], s57 offen offset:1024 lds
  v_mul_f32 v30, v46, v101
  v_mul_f32 v31, v46, v117
  v_fma_f32 v30, -v47, v117, v30
  v_fma_f32 v31, -v47, v101, -v31
  s_waitcnt lgkmcnt(7)
  v_mfma_f32_32x32x16_bf16 v[160:175], v[60:63], v[48:51], v[160:175]
  ds_read_b64_tr_b16 v[84:85], v26 offset:4096
  ds_read_b64_tr_b16 v[86:87], v26 offset:5120
  buffer_load_dwordx4 v38, s[32:35], s57 offen offset:2048 lds
  v_cvt_pk_bf16_f32 v98, v28, v30
  v_cvt_pk_bf16_f32 v114, v29, v31
  v_mul_f32 v28, v46, v102
  v_mul_f32 v29, v46, v118
  s_waitcnt lgkmcnt(7)
  v_mfma_f32_32x32x16_bf16 v[176:191], v[64:67], v[48:51], v[176:191]
  ds_read_b64_tr_b16 v[88:89], v27 offset:4096
  ds_read_b64_tr_b16 v[90:91], v27 offset:5120
  buffer_load_dwordx4 v39, s[32:35], s57 offen offset:3072 lds
  v_fma_f32 v28, -v47, v118, v28
  v_fma_f32 v29, -v47, v102, -v29
  v_mul_f32 v30, v46, v103
  v_mul_f32 v31, v46, v119
  s_waitcnt lgkmcnt(6)
  v_mfma_f32_32x32x16_bf16 v[128:143], v[76:79], v[72:75], v[128:143]
  ds_read_b128 v[48:51], v22 offset:0
  ds_read_b64_tr_b16 v[52:53], v24 offset:8192
  ds_read_b64_tr_b16 v[54:55], v24 offset:9216
  s_add_u32 m0, s58, 131072
  s_mov_b32 s57, 4194304
  buffer_load_dwordx4 v8, s[64:67], s57 offen offset:0 lds
  s_add_u32 s55, s59, 4096
  s_cmp_lg_u32 s94, 0
  s_cbranch_scc1 .Lkv39g
  buffer_store_dwordx4 v[232:235], v32, s[84:87], s55 offen offset:0
.Lkv39r:
  v_fma_f32 v30, -v47, v119, v30
  v_fma_f32 v31, -v47, v103, -v31
  s_waitcnt lgkmcnt(7)
  v_mfma_f32_32x32x16_bf16 v[144:159], v[80:83], v[72:75], v[144:159]
  ds_read_b64_tr_b16 v[56:57], v25 offset:8192
  ds_read_b64_tr_b16 v[58:59], v25 offset:9216
  buffer_load_dwordx4 v9, s[64:67], s57 offen offset:1024 lds
  v_cvt_pk_bf16_f32 v99, v28, v30
  v_cvt_pk_bf16_f32 v115, v29, v31
  v_mul_f32 v28, v46, v104
  v_mul_f32 v29, v46, v120
  s_waitcnt lgkmcnt(7)
  v_mfma_f32_32x32x16_bf16 v[160:175], v[84:87], v[72:75], v[160:175]
  ds_read_b64_tr_b16 v[60:61], v26 offset:8192
  ds_read_b64_tr_b16 v[62:63], v26 offset:9216
  buffer_load_dwordx4 v10, s[64:67], s57 offen offset:2048 lds
  v_fma_f32 v28, -v47, v120, v28
  v_fma_f32 v29, -v47, v104, -v29
  v_mul_f32 v30, v46, v105
  v_mul_f32 v31, v46, v121
  s_waitcnt lgkmcnt(7)
  v_mfma_f32_32x32x16_bf16 v[176:191], v[88:91], v[72:75], v[176:191]
  ds_read_b64_tr_b16 v[64:65], v27 offset:8192
  ds_read_b64_tr_b16 v[66:67], v27 offset:9216
  buffer_load_dwordx4 v11, s[64:67], s57 offen offset:3072 lds
  v_fma_f32 v30, -v47, v121, v30
  v_fma_f32 v31, -v47, v105, -v31
  v_cvt_pk_bf16_f32 v100, v28, v30
  v_cvt_pk_bf16_f32 v116, v29, v31
  s_waitcnt lgkmcnt(6)
  v_mfma_f32_32x32x16_bf16 v[128:143], v[52:55], v[48:51], v[128:143]
  ds_read_b128 v[72:75], v23 offset:0
  ds_read_b64_tr_b16 v[76:77], v24 offset:12288
  ds_read_b64_tr_b16 v[78:79], v24 offset:13312
  s_add_u32 m0, s58, 147456
  s_mov_b32 s57, 4718592
  buffer_load_dwordx4 v8, s[64:67], s57 offen offset:0 lds
  v_mul_f32 v28, v46, v106
  v_mul_f32 v29, v46, v122
  v_fma_f32 v28, -v47, v122, v28
  v_fma_f32 v29, -v47, v106, -v29
  s_waitcnt lgkmcnt(7)
  v_mfma_f32_32x32x16_bf16 v[144:159], v[56:59], v[48:51], v[144:159]
  ds_read_b64_tr_b16 v[80:81], v25 offset:12288
  ds_read_b64_tr_b16 v[82:83], v25 offset:13312
  buffer_load_dwordx4 v9, s[64:67], s57 offen offset:1024 lds
  v_mul_f32 v30, v46, v107
  v_mul_f32 v31, v46, v123
  v_fma_f32 v30, -v47, v123, v30
  v_fma_f32 v31, -v47, v107, -v31
  s_waitcnt lgkmcnt(7)
  v_mfma_f32_32x32x16_bf16 v[160:175], v[60:63], v[48:51], v[160:175]
  ds_read_b64_tr_b16 v[84:85], v26 offset:12288
  ds_read_b64_tr_b16 v[86:87], v26 offset:13312
  buffer_load_dwordx4 v10, s[64:67], s57 offen offset:2048 lds
  v_cvt_pk_bf16_f32 v101, v28, v30
  v_cvt_pk_bf16_f32 v117, v29, v31
  v_mul_f32 v28, v46, v108
  v_mul_f32 v29, v46, v124
  s_waitcnt lgkmcnt(7)
  v_mfma_f32_32x32x16_bf16 v[176:191], v[64:67], v[48:51], v[176:191]
  ds_read_b64_tr_b16 v[88:89], v27 offset:12288
  ds_read_b64_tr_b16 v[90:91], v27 offset:13312
  buffer_load_dwordx4 v11, s[64:67], s57 offen offset:3072 lds
  v_fma_f32 v28, -v47, v124, v28
  v_fma_f32 v29, -v47, v108, -v29
  v_mul_f32 v30, v46, v109
  v_mul_f32 v31, v46, v125
  s_waitcnt lgkmcnt(6)
  v_mfma_f32_32x32x16_bf16 v[128:143], v[76:79], v[72:75], v[128:143]
  v_add_u32 v20, 0x10000, v20
  v_add_u32 v21, 0x10000, v21
  v_add_u32 v22, 0x10000, v22
  v_add_u32 v23, 0x10000, v23
  s_waitcnt lgkmcnt(0)
  s_waitcnt vmcnt(19)
  s_barrier
  ds_read_b128 v[48:51], v20 offset:0
  ds_read_b64_tr_b16 v[52:53], v24 offset:16384
  ds_read_b64_tr_b16 v[54:55], v24 offset:17408
  s_add_u32 m0, s58, 0
  s_add_u32 s57, s92, 1152
  buffer_load_dwordx4 v36, s[32:35], s57 offen offset:0 lds
  s_add_u32 s55, s59, 4096
  s_cmp_lg_u32 s94, 0
  s_cbranch_scc1 .Lkv40g
  buffer_store_dwordx4 v[236:239], v32, s[84:87], s55 offen offset:1024
.Lkv40r:
  v_fma_f32 v30, -v47, v125, v30
  v_fma_f32 v31, -v47, v109, -v31
  v_mfma_f32_32x32x16_bf16 v[144:159], v[80:83], v[72:75], v[144:159]
  ds_read_b64_tr_b16 v[56:57], v25 offset:16384
  ds_read_b64_tr_b16 v[58:59], v25 offset:17408
  ds_read_b64_tr_b16 v[60:61], v26 offset:16384
  ds_read_b64_tr_b16 v[62:63], v26 offset:17408
  buffer_load_dwordx4 v37, s[32:35], s57 offen offset:1024 lds
  v_cvt_pk_bf16_f32 v102, v28, v30
  v_cvt_pk_bf16_f32 v118, v29, v31
  v_mul_f32 v28, v46, v110
  v_mul_f32 v29, v46, v126
  v_mfma_f32_32x32x16_bf16 v[160:175], v[84:87], v[72:75], v[160:175]
  ds_read_b64_tr_b16 v[64:65], v27 offset:16384
  ds_read_b64_tr_b16 v[66:67], v27 offset:17408
  buffer_load_dwordx4 v38, s[32:35], s57 offen offset:2048 lds
  v_fma_f32 v28, -v47, v126, v28
  v_fma_f32 v29, -v47, v110, -v29
  v_mul_f32 v30, v46, v111
  v_mul_f32 v31, v46, v127
  v_mfma_f32_32x32x16_bf16 v[176:191], v[88:91], v[72:75], v[176:191]
  buffer_load_dwordx4 v39, s[32:35], s57 offen offset:3072 lds
  v_fma_f32 v30, -v47, v127, v30
  v_fma_f32 v31, -v47, v111, -v31
  v_cvt_pk_bf16_f32 v103, v28, v30
  v_cvt_pk_bf16_f32 v119, v29, v31
  s_waitcnt lgkmcnt(6)
  v_mfma_f32_32x32x16_bf16 v[128:143], v[52:55], v[48:51], v[128:143]
  ds_read_b128 v[72:75], v21 offset:0
  ds_read_b64_tr_b16 v[76:77], v24 offset:20480
  ds_read_b64_tr_b16 v[78:79], v24 offset:21504
  s_add_u32 m0, s58, 16384
  s_add_u32 s57, s93, 1152
  buffer_load_dwordx4 v36, s[32:35], s57 offen offset:0 lds
  v_and_b32 v28, 31, v0
  v_lshlrev_b32 v28, 6, v28
  v_and_b32 v30, 32, v0
  s_lshl_b32 s55, s52, 12
  s_add_u32 s55, s55, 131072
  v_add3_u32 v28, v28, v30, s55
  s_waitcnt lgkmcnt(7)
  v_mfma_f32_32x32x16_bf16 v[144:159], v[56:59], v[48:51], v[144:159]
  ds_read_b64_tr_b16 v[80:81], v25 offset:20480
  ds_read_b64_tr_b16 v[82:83], v25 offset:21504
  buffer_load_dwordx4 v37, s[32:35], s57 offen offset:1024 lds
  v_lshlrev_b32 v1, 4, v0
  v_and_b32 v1, 32, v1
  v_xor_b32 v28, v28, v1
  v_lshlrev_b32 v1, 2, v0
  s_waitcnt lgkmcnt(7)
  v_mfma_f32_32x32x16_bf16 v[160:175], v[60:63], v[48:51], v[160:175]
  ds_read_b64_tr_b16 v[84:85], v26 offset:20480
  ds_read_b64_tr_b16 v[86:87], v26 offset:21504
  buffer_load_dwordx4 v38, s[32:35], s57 offen offset:2048 lds
  v_and_b32 v1, 16, v1
  v_xor_b32 v28, v28, v1
  v_xor_b32 v30, 16, v28
  s_waitcnt lgkmcnt(7)
  v_mfma_f32_32x32x16_bf16 v[176:191], v[64:67], v[48:51], v[176:191]
  ds_read_b64_tr_b16 v[88:89], v27 offset:20480
  ds_read_b64_tr_b16 v[90:91], v27 offset:21504
  buffer_load_dwordx4 v39, s[32:35], s57 offen offset:3072 lds
  s_waitcnt lgkmcnt(6)
  v_mfma_f32_32x32x16_bf16 v[128:143], v[76:79], v[72:75], v[128:143]
  ds_read_b128 v[48:51], v22 offset:0
  ds_read_b64_tr_b16 v[52:53], v24 offset:24576
  ds_read_b64_tr_b16 v[54:55], v24 offset:25600
  s_add_u32 s55, s59, 20480
  s_cmp_lg_u32 s94, 0
  s_cbranch_scc1 .Lkv41g
  buffer_store_dwordx4 v[240:243], v32, s[84:87], s55 offen offset:2048
.Lkv41r:
  s_waitcnt lgkmcnt(7)
  v_mfma_f32_32x32x16_bf16 v[144:159], v[80:83], v[72:75], v[144:159]
  ds_read_b64_tr_b16 v[56:57], v25 offset:24576
  ds_read_b64_tr_b16 v[58:59], v25 offset:25600
  s_waitcnt lgkmcnt(7)
  v_mfma_f32_32x32x16_bf16 v[160:175], v[84:87], v[72:75], v[160:175]
  ds_read_b64_tr_b16 v[60:61], v26 offset:24576
  ds_read_b64_tr_b16 v[62:63], v26 offset:25600
  s_waitcnt lgkmcnt(7)
  v_mfma_f32_32x32x16_bf16 v[176:191], v[88:91], v[72:75], v[176:191]
  ds_read_b64_tr_b16 v[64:65], v27 offset:24576
  ds_read_b64_tr_b16 v[66:67], v27 offset:25600
  s_waitcnt lgkmcnt(6)
  v_mfma_f32_32x32x16_bf16 v[128:143], v[52:55], v[48:51], v[128:143]
  ds_read_b128 v[72:75], v23 offset:0
  ds_read_b64_tr_b16 v[76:77], v24 offset:28672
  ds_read_b64_tr_b16 v[78:79], v24 offset:29696
  s_waitcnt lgkmcnt(7)
  v_mfma_f32_32x32x16_bf16 v[144:159], v[56:59], v[48:51], v[144:159]
  ds_read_b64_tr_b16 v[80:81], v25 offset:28672
  ds_read_b64_tr_b16 v[82:83], v25 offset:29696
  s_waitcnt lgkmcnt(7)
  v_mfma_f32_32x32x16_bf16 v[160:175], v[60:63], v[48:51], v[160:175]
  ds_read_b64_tr_b16 v[84:85], v26 offset:28672
  ds_read_b64_tr_b16 v[86:87], v26 offset:29696
  s_waitcnt lgkmcnt(7)
  v_mfma_f32_32x32x16_bf16 v[176:191], v[64:67], v[48:51], v[176:191]
  ds_read_b64_tr_b16 v[88:89], v27 offset:28672
  ds_read_b64_tr_b16 v[90:91], v27 offset:29696
  s_waitcnt lgkmcnt(6)
  v_mfma_f32_32x32x16_bf16 v[128:143], v[76:79], v[72:75], v[128:143]
  v_add_u32 v20, 0x8000, v20
  v_add_u32 v21, 0x8000, v21
  v_add_u32 v22, 0x8000, v22
  v_add_u32 v23, 0x8000, v23
  v_add_u32 v24, 0x18000, v24
  v_add_u32 v25, 0x18000, v25
  v_add_u32 v26, 0x18000, v26
  v_add_u32 v27, 0x18000, v27
  s_waitcnt lgkmcnt(0)
  s_waitcnt vmcnt(10)
  s_barrier
  ds_read_b128 v[48:51], v20 offset:0
  ds_read_b64_tr_b16 v[52:53], v24 offset:0
  ds_read_b64_tr_b16 v[54:55], v24 offset:1024
  s_add_u32 s55, s59, 20480
  s_cmp_lg_u32 s94, 0
  s_cbranch_scc1 .Lkv42g
  buffer_store_dwordx4 v[244:247], v32, s[84:87], s55 offen offset:3072
.Lkv42r:
  v_mfma_f32_32x32x16_bf16 v[144:159], v[80:83], v[72:75], v[144:159]
  ds_read_b64_tr_b16 v[56:57], v25 offset:0
  ds_read_b64_tr_b16 v[58:59], v25 offset:1024
  ds_read_b64_tr_b16 v[60:61], v26 offset:0
  ds_read_b64_tr_b16 v[62:63], v26 offset:1024
  v_mfma_f32_32x32x16_bf16 v[160:175], v[84:87], v[72:75], v[160:175]
  ds_read_b64_tr_b16 v[64:65], v27 offset:0
  ds_read_b64_tr_b16 v[66:67], v27 offset:1024
  v_mfma_f32_32x32x16_bf16 v[176:191], v[88:91], v[72:75], v[176:191]
  s_waitcnt lgkmcnt(6)
  v_mfma_f32_32x32x16_bf16 v[128:143], v[52:55], v[48:51], v[128:143]
  ds_read_b128 v[72:75], v21 offset:0
  ds_read_b64_tr_b16 v[76:77], v24 offset:4096
  ds_read_b64_tr_b16 v[78:79], v24 offset:5120
  s_waitcnt lgkmcnt(7)
  v_mfma_f32_32x32x16_bf16 v[144:159], v[56:59], v[48:51], v[144:159]
  ds_read_b64_tr_b16 v[80:81], v25 offset:4096
  ds_read_b64_tr_b16 v[82:83], v25 offset:5120
  s_waitcnt lgkmcnt(7)
  v_mfma_f32_32x32x16_bf16 v[160:175], v[60:63], v[48:51], v[160:175]
  ds_read_b64_tr_b16 v[84:85], v26 offset:4096
  ds_read_b64_tr_b16 v[86:87], v26 offset:5120
  s_waitcnt lgkmcnt(7)
  v_mfma_f32_32x32x16_bf16 v[176:191], v[64:67], v[48:51], v[176:191]
  ds_read_b64_tr_b16 v[88:89], v27 offset:4096
  ds_read_b64_tr_b16 v[90:91], v27 offset:5120
  s_waitcnt lgkmcnt(6)
  v_mfma_f32_32x32x16_bf16 v[128:143], v[76:79], v[72:75], v[128:143]
  ds_read_b128 v[48:51], v22 offset:0
  ds_read_b64_tr_b16 v[52:53], v24 offset:8192
  ds_read_b64_tr_b16 v[54:55], v24 offset:9216
  s_add_u32 s55, s59, 4096
  s_cmp_lg_u32 s94, 0
  s_cbranch_scc1 .Lkv43g
  buffer_store_dwordx4 v[248:251], v32, s[84:87], s55 offen offset:2048
.Lkv43r:
  s_waitcnt lgkmcnt(7)
  v_mfma_f32_32x32x16_bf16 v[144:159], v[80:83], v[72:75], v[144:159]
  ds_read_b64_tr_b16 v[56:57], v25 offset:8192
  ds_read_b64_tr_b16 v[58:59], v25 offset:9216
  s_waitcnt lgkmcnt(7)
  v_mfma_f32_32x32x16_bf16 v[160:175], v[84:87], v[72:75], v[160:175]
  ds_read_b64_tr_b16 v[60:61], v26 offset:8192
  ds_read_b64_tr_b16 v[62:63], v26 offset:9216
  s_waitcnt lgkmcnt(7)
  v_mfma_f32_32x32x16_bf16 v[176:191], v[88:91], v[72:75], v[176:191]
  ds_read_b64_tr_b16 v[64:65], v27 offset:8192
  ds_read_b64_tr_b16 v[66:67], v27 offset:9216
  s_waitcnt lgkmcnt(6)
  v_mfma_f32_32x32x16_bf16 v[128:143], v[52:55], v[48:51], v[128:143]
  ds_read_b128 v[72:75], v23 offset:0
  ds_read_b64_tr_b16 v[76:77], v24 offset:12288
  ds_read_b64_tr_b16 v[78:79], v24 offset:13312
  s_waitcnt lgkmcnt(7)
  v_mfma_f32_32x32x16_bf16 v[144:159], v[56:59], v[48:51], v[144:159]
  ds_read_b64_tr_b16 v[80:81], v25 offset:12288
  ds_read_b64_tr_b16 v[82:83], v25 offset:13312
  s_waitcnt lgkmcnt(7)
  v_mfma_f32_32x32x16_bf16 v[160:175], v[60:63], v[48:51], v[160:175]
  ds_read_b64_tr_b16 v[84:85], v26 offset:12288
  ds_read_b64_tr_b16 v[86:87], v26 offset:13312
  s_waitcnt lgkmcnt(7)
  v_mfma_f32_32x32x16_bf16 v[176:191], v[64:67], v[48:51], v[176:191]
  ds_read_b64_tr_b16 v[88:89], v27 offset:12288
  ds_read_b64_tr_b16 v[90:91], v27 offset:13312
  s_waitcnt lgkmcnt(6)
  v_mfma_f32_32x32x16_bf16 v[128:143], v[76:79], v[72:75], v[128:143]
  v_add_u32 v20, 0xfffe8000, v20
  v_add_u32 v21, 0xfffe8000, v21
  v_add_u32 v22, 0xfffe8000, v22
  v_add_u32 v23, 0xfffe8000, v23
  s_waitcnt lgkmcnt(0)
  s_waitcnt vmcnt(3)
  s_barrier
  ds_read_b128 v[48:51], v20 offset:0
  ds_read_b64_tr_b16 v[52:53], v24 offset:16384
  ds_read_b64_tr_b16 v[54:55], v24 offset:17408
  s_add_u32 s55, s59, 4096
  s_cmp_lg_u32 s94, 0
  s_cbranch_scc1 .Lkv44g
  buffer_store_dwordx4 v[252:255], v32, s[84:87], s55 offen offset:3072
.Lkv44r:
  v_mfma_f32_32x32x16_bf16 v[144:159], v[80:83], v[72:75], v[144:159]
  ds_read_b64_tr_b16 v[56:57], v25 offset:16384
  ds_read_b64_tr_b16 v[58:59], v25 offset:17408
  ds_read_b64_tr_b16 v[60:61], v26 offset:16384
  ds_read_b64_tr_b16 v[62:63], v26 offset:17408
  v_mfma_f32_32x32x16_bf16 v[160:175], v[84:87], v[72:75], v[160:175]
  ds_read_b64_tr_b16 v[64:65], v27 offset:16384
  ds_read_b64_tr_b16 v[66:67], v27 offset:17408
  v_mfma_f32_32x32x16_bf16 v[176:191], v[88:91], v[72:75], v[176:191]
  s_waitcnt lgkmcnt(6)
  v_mfma_f32_32x32x16_bf16 v[128:143], v[52:55], v[48:51], v[128:143]
  ds_read_b128 v[72:75], v21 offset:0
  ds_read_b64_tr_b16 v[76:77], v24 offset:20480
  ds_read_b64_tr_b16 v[78:79], v24 offset:21504
  s_waitcnt lgkmcnt(7)
  v_mfma_f32_32x32x16_bf16 v[144:159], v[56:59], v[48:51], v[144:159]
  ds_read_b64_tr_b16 v[80:81], v25 offset:20480
  ds_read_b64_tr_b16 v[82:83], v25 offset:21504
  s_waitcnt lgkmcnt(7)
  v_mfma_f32_32x32x16_bf16 v[160:175], v[60:63], v[48:51], v[160:175]
  ds_read_b64_tr_b16 v[84:85], v26 offset:20480
  ds_read_b64_tr_b16 v[86:87], v26 offset:21504
  s_waitcnt lgkmcnt(7)
  v_mfma_f32_32x32x16_bf16 v[176:191], v[64:67], v[48:51], v[176:191]
  ds_read_b64_tr_b16 v[88:89], v27 offset:20480
  ds_read_b64_tr_b16 v[90:91], v27 offset:21504
  s_waitcnt lgkmcnt(6)
  v_mfma_f32_32x32x16_bf16 v[128:143], v[76:79], v[72:75], v[128:143]
  ds_read_b128 v[48:51], v22 offset:0
  ds_read_b64_tr_b16 v[52:53], v24 offset:24576
  ds_read_b64_tr_b16 v[54:55], v24 offset:25600
  s_waitcnt lgkmcnt(7)
  v_mfma_f32_32x32x16_bf16 v[144:159], v[80:83], v[72:75], v[144:159]
  ds_read_b64_tr_b16 v[56:57], v25 offset:24576
  ds_read_b64_tr_b16 v[58:59], v25 offset:25600
  s_waitcnt lgkmcnt(7)
  v_mfma_f32_32x32x16_bf16 v[160:175], v[84:87], v[72:75], v[160:175]
  ds_read_b64_tr_b16 v[60:61], v26 offset:24576
  ds_read_b64_tr_b16 v[62:63], v26 offset:25600
  s_waitcnt lgkmcnt(7)
  v_mfma_f32_32x32x16_bf16 v[176:191], v[88:91], v[72:75], v[176:191]
  ds_read_b64_tr_b16 v[64:65], v27 offset:24576
  ds_read_b64_tr_b16 v[66:67], v27 offset:25600
  s_waitcnt lgkmcnt(6)
  v_mfma_f32_32x32x16_bf16 v[128:143], v[52:55], v[48:51], v[128:143]
  ds_read_b128 v[72:75], v23 offset:0
  ds_read_b64_tr_b16 v[76:77], v24 offset:28672
  ds_read_b64_tr_b16 v[78:79], v24 offset:29696
  s_waitcnt lgkmcnt(7)
  v_mfma_f32_32x32x16_bf16 v[144:159], v[56:59], v[48:51], v[144:159]
  ds_read_b64_tr_b16 v[80:81], v25 offset:28672
  ds_read_b64_tr_b16 v[82:83], v25 offset:29696
  s_waitcnt lgkmcnt(7)
  v_mfma_f32_32x32x16_bf16 v[160:175], v[60:63], v[48:51], v[160:175]
  ds_read_b64_tr_b16 v[84:85], v26 offset:28672
  ds_read_b64_tr_b16 v[86:87], v26 offset:29696
  s_waitcnt lgkmcnt(7)
  v_mfma_f32_32x32x16_bf16 v[176:191], v[64:67], v[48:51], v[176:191]
  ds_read_b64_tr_b16 v[88:89], v27 offset:28672
  ds_read_b64_tr_b16 v[90:91], v27 offset:29696
  s_waitcnt lgkmcnt(6)
  v_mfma_f32_32x32x16_bf16 v[128:143], v[76:79], v[72:75], v[128:143]
  s_waitcnt lgkmcnt(0)
  s_barrier
  ds_write_b128 v28, v[96:99] offset:0
  ds_write_b128 v30, v[100:103] offset:0
  ds_write_b128 v28, v[112:115] offset:2048
  ds_write_b128 v30, v[116:119] offset:2048
  v_mov_b32 v123, v33
  v_add_u32 v1, 16384, v32
  v_mov_b32 v2, v32
  ds_read_b128 v[192:195], v1 offset:16384
  ds_read_b128 v[196:199], v1 offset:17408
  ds_read_b128 v[200:203], v1 offset:18432
  v_mfma_f32_32x32x16_bf16 v[144:159], v[80:83], v[72:75], v[144:159]
  ds_read_b128 v[204:207], v1 offset:19456
  ds_read_b128 v[208:211], v1 offset:20480
  ds_read_b128 v[212:215], v1 offset:21504
  v_mfma_f32_32x32x16_bf16 v[160:175], v[84:87], v[72:75], v[160:175]
  ds_read_b128 v[216:219], v1 offset:22528
  ds_read_b128 v[220:223], v1 offset:23552
  v_mfma_f32_32x32x16_bf16 v[176:191], v[88:91], v[72:75], v[176:191]
  v_and_b32 v3, 31, v0
  v_lshrrev_b32 v5, 5, v0
  v_lshlrev_b32 v5, 2, v5
  v_sub_u32 v3, v3, v5
  v_mov_b32 v4, 0
  v_mov_b32 v5, 0
  v_mov_b64 v[48:49], 0
  v_mov_b64 v[50:51], 0
  v_mov_b64 v[52:53], 0
  v_mov_b64 v[54:55], 0
  v_mov_b64 v[56:57], 0
  v_mov_b64 v[58:59], 0
  v_mov_b64 v[60:61], 0
  v_mov_b64 v[62:63], 0
  s_mov_b32 s56, 0x3e0293ee
  s_mov_b32 s57, 0x3e0293ee
  v_mov_b64 v[104:105], 0
  v_mov_b64 v[106:107], 0
  v_pk_mul_f32 v[128:129], v[128:129], s[56:57]
  v_pk_mul_f32 v[130:131], v[130:131], s[56:57]
  v_pk_mul_f32 v[132:133], v[132:133], s[56:57]
  v_pk_mul_f32 v[134:135], v[134:135], s[56:57]
  v_pk_mul_f32 v[136:137], v[136:137], s[56:57]
  v_pk_mul_f32 v[138:139], v[138:139], s[56:57]
  v_pk_mul_f32 v[140:141], v[140:141], s[56:57]
  v_pk_mul_f32 v[142:143], v[142:143], s[56:57]
  v_cvt_pk_bf16_f32 v16, v128, v129
  v_cvt_pk_bf16_f32 v17, v130, v131
  v_cvt_pk_bf16_f32 v18, v132, v133
  v_cvt_pk_bf16_f32 v19, v134, v135
  v_cvt_pk_bf16_f32 v20, v136, v137
  v_cvt_pk_bf16_f32 v21, v138, v139
  v_cvt_pk_bf16_f32 v22, v140, v141
  v_cvt_pk_bf16_f32 v23, v142, v143
  s_waitcnt lgkmcnt(7)
  v_mfma_f32_32x32x16_bf16 v[64:79], v[192:195], v[16:19], v[48:63]
  s_waitcnt lgkmcnt(6)
  v_mfma_f32_32x32x16_bf16 v[64:79], v[196:199], v[20:23], v[64:79]
  ds_read_b128 v[192:195], v1 offset:24576
  ds_read_b128 v[196:199], v1 offset:25600
  v_mfma_f32_32x32x16_bf16 v[128:143], v[104:107], v[104:107], 0
  v_pk_mul_f32 v[144:145], v[144:145], s[56:57]
  v_pk_mul_f32 v[146:147], v[146:147], s[56:57]
  v_pk_mul_f32 v[148:149], v[148:149], s[56:57]
  v_pk_mul_f32 v[150:151], v[150:151], s[56:57]
  v_pk_mul_f32 v[152:153], v[152:153], s[56:57]
  v_pk_mul_f32 v[154:155], v[154:155], s[56:57]
  v_pk_mul_f32 v[156:157], v[156:157], s[56:57]
  v_pk_mul_f32 v[158:159], v[158:159], s[56:57]
  v_cvt_pk_bf16_f32 v24, v144, v145
  v_cvt_pk_bf16_f32 v25, v146, v147
  v_cvt_pk_bf16_f32 v26, v148, v149
  v_cvt_pk_bf16_f32 v27, v150, v151
  v_cvt_pk_bf16_f32 v28, v152, v153
  v_cvt_pk_bf16_f32 v29, v154, v155
  v_cvt_pk_bf16_f32 v30, v156, v157
  v_cvt_pk_bf16_f32 v31, v158, v159
  s_waitcnt lgkmcnt(7)
  v_mfma_f32_32x32x16_bf16 v[64:79], v[200:203], v[24:27], v[64:79]
  s_waitcnt lgkmcnt(6)
  v_mfma_f32_32x32x16_bf16 v[64:79], v[204:207], v[28:31], v[64:79]
  ds_read_b128 v[200:203], v1 offset:26624
  ds_read_b128 v[204:207], v1 offset:27648
  v_mfma_f32_32x32x16_bf16 v[144:159], v[104:107], v[104:107], 0
  v_pk_mul_f32 v[160:161], v[160:161], s[56:57]
  v_pk_mul_f32 v[162:163], v[162:163], s[56:57]
  v_pk_mul_f32 v[164:165], v[164:165], s[56:57]
  v_pk_mul_f32 v[166:167], v[166:167], s[56:57]
  v_pk_mul_f32 v[168:169], v[168:169], s[56:57]
  v_pk_mul_f32 v[170:171], v[170:171], s[56:57]
  v_pk_mul_f32 v[172:173], v[172:173], s[56:57]
  v_pk_mul_f32 v[174:175], v[174:175], s[56:57]
  v_cvt_pk_bf16_f32 v32, v160, v161
  v_cvt_pk_bf16_f32 v33, v162, v163
  v_cvt_pk_bf16_f32 v34, v164, v165
  v_cvt_pk_bf16_f32 v35, v166, v167
  v_cvt_pk_bf16_f32 v36, v168, v169
  v_cvt_pk_bf16_f32 v37, v170, v171
  v_cvt_pk_bf16_f32 v38, v172, v173
  v_cvt_pk_bf16_f32 v39, v174, v175
  s_waitcnt lgkmcnt(7)
  v_mfma_f32_32x32x16_bf16 v[64:79], v[208:211], v[32:35], v[64:79]
  s_waitcnt lgkmcnt(6)
  v_mfma_f32_32x32x16_bf16 v[64:79], v[212:215], v[36:39], v[64:79]
  ds_read_b128 v[208:211], v1 offset:28672
  ds_read_b128 v[212:215], v1 offset:29696
  v_mfma_f32_32x32x16_bf16 v[160:175], v[104:107], v[104:107], 0
  v_pk_mul_f32 v[176:177], v[176:177], s[56:57]
  v_pk_mul_f32 v[178:179], v[178:179], s[56:57]
  v_pk_mul_f32 v[180:181], v[180:181], s[56:57]
  v_pk_mul_f32 v[182:183], v[182:183], s[56:57]
  v_pk_mul_f32 v[184:185], v[184:185], s[56:57]
  v_pk_mul_f32 v[186:187], v[186:187], s[56:57]
  v_pk_mul_f32 v[188:189], v[188:189], s[56:57]
  v_pk_mul_f32 v[190:191], v[190:191], s[56:57]
  v_cvt_pk_bf16_f32 v40, v176, v177
  v_cvt_pk_bf16_f32 v41, v178, v179
  v_cvt_pk_bf16_f32 v42, v180, v181
  v_cvt_pk_bf16_f32 v43, v182, v183
  v_cvt_pk_bf16_f32 v44, v184, v185
  v_cvt_pk_bf16_f32 v45, v186, v187
  v_cvt_pk_bf16_f32 v46, v188, v189
  v_cvt_pk_bf16_f32 v47, v190, v191
  s_waitcnt lgkmcnt(7)
  v_mfma_f32_32x32x16_bf16 v[64:79], v[216:219], v[40:43], v[64:79]
  s_waitcnt lgkmcnt(6)
  v_mfma_f32_32x32x16_bf16 v[64:79], v[220:223], v[44:47], v[64:79]
  ds_read_b128 v[216:219], v1 offset:30720
  ds_read_b128 v[220:223], v1 offset:31744
  v_mfma_f32_32x32x16_bf16 v[176:191], v[104:107], v[104:107], 0
  s_nop 8
  v_max3_f32 v12, v64, v65, v66
  v_max3_f32 v13, v67, v68, v69
  v_max3_f32 v12, v12, v70, v71
  v_max3_f32 v13, v13, v72, v73
  v_max3_f32 v12, v12, v74, v75
  v_max3_f32 v13, v13, v76, v77
  v_max3_f32 v12, v12, v78, v79
  v_max_f32 v12, v12, v13
  v_mov_b32 v13, v12
  s_nop 1
  v_permlane32_swap_b32 v13, v12
  s_nop 1
  v_max_f32 v13, v12, v13
  v_sub_f32 v12, 0, v13
  v_sub_f32 v13, 0, v13
  v_pk_add_f32 v[64:65], v[64:65], v[12:13]
  v_pk_add_f32 v[66:67], v[66:67], v[12:13]
  v_pk_add_f32 v[68:69], v[68:69], v[12:13]
  v_pk_add_f32 v[70:71], v[70:71], v[12:13]
  v_pk_add_f32 v[72:73], v[72:73], v[12:13]
  v_pk_add_f32 v[74:75], v[74:75], v[12:13]
  v_pk_add_f32 v[76:77], v[76:77], v[12:13]
  v_pk_add_f32 v[78:79], v[78:79], v[12:13]
  v_mov_b64 v[48:49], v[12:13]
  v_mov_b64 v[50:51], v[12:13]
  v_mov_b64 v[52:53], v[12:13]
  v_mov_b64 v[54:55], v[12:13]
  v_mov_b64 v[56:57], v[12:13]
  v_mov_b64 v[58:59], v[12:13]
  v_mov_b64 v[60:61], v[12:13]
  v_mov_b64 v[62:63], v[12:13]
  v_exp_f32 v6, v64
  v_exp_f32 v7, v65
  v_add_f32 v4, v4, v6
  v_exp_f32 v8, v66
  v_add_f32 v5, v5, v7
  v_cvt_pk_bf16_f32 v96, v6, v7
  v_exp_f32 v9, v67
  v_add_f32 v4, v4, v8
  v_exp_f32 v10, v68
  v_add_f32 v5, v5, v9
  v_cvt_pk_bf16_f32 v97, v8, v9
  v_exp_f32 v11, v69
  v_add_f32 v4, v4, v10
  s_waitcnt vmcnt(0) lgkmcnt(0)
  s_barrier
  s_cmp_lt_u32 s90, 16
  s_cbranch_scc1 .Lp145
  v_mov_b32 v12, 1
  s_mov_b64 exec, 1
  buffer_store_byte v12, off, s[16:19], s90 sc0 sc1
  s_mov_b64 exec, -1
  s_mov_b32 s90, 0
.Lp145:
  s_cmp_lg_u32 s52, 1
  s_cbranch_scc1 .Lfs47
  v_mov_b32 v12, 1
  s_mov_b64 exec, 1
  buffer_store_byte v12, off, s[84:87], s100 sc0 sc1
  s_mov_b64 exec, -1
.Lfs47:
  v_add_u32 v1, 49152, v1
  s_branch .Lk2l_l0
.Lk2l_loop:
  s_setprio 0
  s_waitcnt lgkmcnt(7)
  v_mfma_f32_32x32x16_bf16 v[64:79], v[192:195], v[16:19], v[48:63]
  ds_read_b128 v[224:227], v1 offset:57344
  v_exp_f32 v6, v86
  v_add_f32 v5, v5, v11
  v_cvt_pk_bf16_f32 v106, v10, v11
  s_waitcnt lgkmcnt(7)
  v_mfma_f32_32x32x16_bf16 v[64:79], v[196:199], v[20:23], v[64:79]
  ds_read_b128 v[232:235], v1 offset:59392
  v_exp_f32 v7, v87
  v_add_f32 v4, v4, v6
  s_waitcnt lgkmcnt(7)
  v_mfma_f32_32x32x16_bf16 v[64:79], v[200:203], v[24:27], v[64:79]
  ds_read_b128 v[240:243], v1 offset:61440
  v_exp_f32 v8, v88
  v_add_f32 v5, v5, v7
  v_cvt_pk_bf16_f32 v107, v6, v7
  s_waitcnt lgkmcnt(7)
  v_mfma_f32_32x32x16_bf16 v[64:79], v[204:207], v[28:31], v[64:79]
  ds_read_b128 v[248:251], v1 offset:63488
  v_exp_f32 v9, v89
  v_add_f32 v4, v4, v8
  s_waitcnt lgkmcnt(7)
  v_mfma_f32_32x32x16_bf16 v[64:79], v[208:211], v[32:35], v[64:79]
  ds_read_b128 v[228:231], v1 offset:58368
  v_exp_f32 v10, v90
  v_add_f32 v5, v5, v9
  v_cvt_pk_bf16_f32 v108, v8, v9
  s_waitcnt lgkmcnt(7)
  v_mfma_f32_32x32x16_bf16 v[64:79], v[212:215], v[36:39], v[64:79]
  ds_read_b128 v[236:239], v1 offset:60416
  v_exp_f32 v11, v91
  v_add_f32 v4, v4, v10
  s_waitcnt lgkmcnt(7)
  v_mfma_f32_32x32x16_bf16 v[64:79], v[216:219], v[40:43], v[64:79]
  ds_read_b128 v[244:247], v1 offset:62464
  v_exp_f32 v6, v92
  v_add_f32 v5, v5, v11
  v_cvt_pk_bf16_f32 v109, v10, v11
  s_waitcnt lgkmcnt(7)
  v_mfma_f32_32x32x16_bf16 v[64:79], v[220:223], v[44:47], v[64:79]
  ds_read_b128 v[252:255], v1 offset:64512
  v_exp_f32 v7, v93
  v_add_f32 v4, v4, v6
  s_waitcnt lgkmcnt(7)
  v_mfma_f32_32x32x16_bf16 v[128:143], v[224:227], v[104:107], v[128:143]
  ds_read_b128 v[192:195], v1 offset:24576
  ds_read_b128 v[196:199], v1 offset:25600
  v_exp_f32 v8, v94
  v_add_f32 v5, v5, v7
  v_cvt_pk_bf16_f32 v110, v6, v7
  s_waitcnt lgkmcnt(8)
  v_mfma_f32_32x32x16_bf16 v[144:159], v[232:235], v[104:107], v[144:159]
  ds_read_b128 v[200:203], v1 offset:26624
  ds_read_b128 v[204:207], v1 offset:27648
  v_exp_f32 v9, v95
  v_add_f32 v4, v4, v8
  s_waitcnt lgkmcnt(9)
  v_mfma_f32_32x32x16_bf16 v[160:175], v[240:243], v[104:107], v[160:175]
  ds_read_b128 v[208:211], v1 offset:28672
  ds_read_b128 v[212:215], v1 offset:29696
  v_add_f32 v5, v5, v9
  v_cvt_pk_bf16_f32 v111, v8, v9
  v_exp_f32 v6, v64
  s_waitcnt lgkmcnt(10)
  v_mfma_f32_32x32x16_bf16 v[176:191], v[248:251], v[104:107], v[176:191]
  ds_read_b128 v[216:219], v1 offset:30720
  ds_read_b128 v[220:223], v1 offset:31744
  v_exp_f32 v7, v65
  v_add_f32 v4, v4, v6
  s_waitcnt lgkmcnt(11)
  v_mfma_f32_32x32x16_bf16 v[128:143], v[228:231], v[108:111], v[128:143]
  v_exp_f32 v8, v66
  v_add_f32 v5, v5, v7
  v_cvt_pk_bf16_f32 v96, v6, v7
  s_waitcnt lgkmcnt(10)
  v_mfma_f32_32x32x16_bf16 v[144:159], v[236:239], v[108:111], v[144:159]
  v_exp_f32 v9, v67
  v_add_f32 v4, v4, v8
  s_waitcnt lgkmcnt(9)
  v_mfma_f32_32x32x16_bf16 v[160:175], v[244:247], v[108:111], v[160:175]
  v_exp_f32 v10, v68
  v_add_f32 v5, v5, v9
  v_cvt_pk_bf16_f32 v97, v8, v9
  s_waitcnt lgkmcnt(0)
  s_barrier
  v_xor_b32 v1, 0x10000, v1
  v_mfma_f32_32x32x16_bf16 v[176:191], v[252:255], v[108:111], v[176:191]
  v_exp_f32 v11, v69
  v_add_f32 v4, v4, v10
.Lk2l_l0:
  s_setprio 3
  v_mfma_f32_32x32x16_bf16 v[80:95], v[192:195], v[16:19], v[48:63]
  ds_read_b128 v[224:227], v1 offset:32768
  v_exp_f32 v6, v70
  v_add_f32 v5, v5, v11
  v_cvt_pk_bf16_f32 v98, v10, v11
  v_mfma_f32_32x32x16_bf16 v[80:95], v[196:199], v[20:23], v[80:95]
  ds_read_b128 v[232:235], v1 offset:34816
  v_exp_f32 v7, v71
  v_add_f32 v4, v4, v6
  v_mfma_f32_32x32x16_bf16 v[80:95], v[200:203], v[24:27], v[80:95]
  ds_read_b128 v[240:243], v1 offset:36864
  v_exp_f32 v8, v72
  v_add_f32 v5, v5, v7
  v_cvt_pk_bf16_f32 v99, v6, v7
  v_mfma_f32_32x32x16_bf16 v[80:95], v[204:207], v[28:31], v[80:95]
  ds_read_b128 v[248:251], v1 offset:38912
  v_exp_f32 v9, v73
  v_add_f32 v4, v4, v8
  v_mfma_f32_32x32x16_bf16 v[80:95], v[208:211], v[32:35], v[80:95]
  ds_read_b128 v[228:231], v1 offset:33792
  v_exp_f32 v10, v74
  v_add_f32 v5, v5, v9
  v_cvt_pk_bf16_f32 v100, v8, v9
  v_mfma_f32_32x32x16_bf16 v[80:95], v[212:215], v[36:39], v[80:95]
  ds_read_b128 v[236:239], v1 offset:35840
  v_exp_f32 v11, v75
  v_add_f32 v4, v4, v10
  v_mfma_f32_32x32x16_bf16 v[80:95], v[216:219], v[40:43], v[80:95]
  ds_read_b128 v[244:247], v1 offset:37888
  v_exp_f32 v6, v76
  v_add_f32 v5, v5, v11
  v_cvt_pk_bf16_f32 v101, v10, v11
  v_mfma_f32_32x32x16_bf16 v[80:95], v[220:223], v[44:47], v[80:95]
  ds_read_b128 v[252:255], v1 offset:39936
  v_exp_f32 v7, v77
  v_add_f32 v4, v4, v6
  s_waitcnt lgkmcnt(7)
  v_mfma_f32_32x32x16_bf16 v[128:143], v[224:227], v[96:99], v[128:143]
  ds_read_b128 v[192:195], v1 offset:0
  v_exp_f32 v8, v78
  v_add_f32 v5, v5, v7
  v_cvt_pk_bf16_f32 v102, v6, v7
  s_waitcnt lgkmcnt(7)
  v_mfma_f32_32x32x16_bf16 v[144:159], v[232:235], v[96:99], v[144:159]
  ds_read_b128 v[196:199], v1 offset:1024
  v_exp_f32 v9, v79
  v_add_f32 v4, v4, v8
  s_waitcnt lgkmcnt(7)
  v_mfma_f32_32x32x16_bf16 v[160:175], v[240:243], v[96:99], v[160:175]
  ds_read_b128 v[200:203], v1 offset:2048
  v_add_f32 v5, v5, v9
  v_cvt_pk_bf16_f32 v103, v8, v9
  v_exp_f32 v6, v80
  s_waitcnt lgkmcnt(7)
  v_mfma_f32_32x32x16_bf16 v[176:191], v[248:251], v[96:99], v[176:191]
  ds_read_b128 v[204:207], v1 offset:3072
  v_exp_f32 v7, v81
  v_add_f32 v4, v4, v6
  s_waitcnt lgkmcnt(7)
  v_mfma_f32_32x32x16_bf16 v[128:143], v[228:231], v[100:103], v[128:143]
  ds_read_b128 v[208:211], v1 offset:4096
  v_exp_f32 v8, v82
  v_add_f32 v5, v5, v7
  v_cvt_pk_bf16_f32 v104, v6, v7
  s_waitcnt lgkmcnt(7)
  v_mfma_f32_32x32x16_bf16 v[144:159], v[236:239], v[100:103], v[144:159]
  ds_read_b128 v[212:215], v1 offset:5120
  v_exp_f32 v9, v83
  v_add_f32 v4, v4, v8
  s_waitcnt lgkmcnt(7)
  v_mfma_f32_32x32x16_bf16 v[160:175], v[244:247], v[100:103], v[160:175]
  ds_read_b128 v[216:219], v1 offset:6144
  v_exp_f32 v10, v84
  v_add_f32 v5, v5, v9
  v_cvt_pk_bf16_f32 v105, v8, v9
  s_waitcnt lgkmcnt(7)
  v_mfma_f32_32x32x16_bf16 v[176:191], v[252:255], v[100:103], v[176:191]
  ds_read_b128 v[220:223], v1 offset:7168
  v_exp_f32 v11, v85
  v_add_f32 v4, v4, v10
  s_setprio 2
  s_waitcnt lgkmcnt(7)
  v_mfma_f32_32x32x16_bf16 v[64:79], v[192:195], v[16:19], v[48:63]
  ds_read_b128 v[224:227], v1 offset:40960
  v_exp_f32 v6, v86
  v_add_f32 v5, v5, v11
  v_cvt_pk_bf16_f32 v106, v10, v11
  s_waitcnt lgkmcnt(7)
  v_mfma_f32_32x32x16_bf16 v[64:79], v[196:199], v[20:23], v[64:79]
  ds_read_b128 v[232:235], v1 offset:43008
  v_exp_f32 v7, v87
  v_add_f32 v4, v4, v6
  s_waitcnt lgkmcnt(7)
  v_mfma_f32_32x32x16_bf16 v[64:79], v[200:203], v[24:27], v[64:79]
  ds_read_b128 v[240:243], v1 offset:45056
  v_exp_f32 v8, v88
  v_add_f32 v5, v5, v7
  v_cvt_pk_bf16_f32 v107, v6, v7
  s_waitcnt lgkmcnt(7)
  v_mfma_f32_32x32x16_bf16 v[64:79], v[204:207], v[28:31], v[64:79]
  ds_read_b128 v[248:251], v1 offset:47104
  v_exp_f32 v9, v89
  v_add_f32 v4, v4, v8
  s_waitcnt lgkmcnt(7)
  v_mfma_f32_32x32x16_bf16 v[64:79], v[208:211], v[32:35], v[64:79]
  ds_read_b128 v[228:231], v1 offset:41984
  v_exp_f32 v10, v90
  v_add_f32 v5, v5, v9
  v_cvt_pk_bf16_f32 v108, v8, v9
  s_waitcnt lgkmcnt(7)
  v_mfma_f32_32x32x16_bf16 v[64:79], v[212:215], v[36:39], v[64:79]
  ds_read_b128 v[236:239], v1 offset:44032
  v_exp_f32 v11, v91
  v_add_f32 v4, v4, v10
  s_waitcnt lgkmcnt(7)
  v_mfma_f32_32x32x16_bf16 v[64:79], v[216:219], v[40:43], v[64:79]
  ds_read_b128 v[244:247], v1 offset:46080
  v_exp_f32 v6, v92
  v_add_f32 v5, v5, v11
  v_cvt_pk_bf16_f32 v109, v10, v11
  s_waitcnt lgkmcnt(7)
  v_mfma_f32_32x32x16_bf16 v[64:79], v[220:223], v[44:47], v[64:79]
  ds_read_b128 v[252:255], v1 offset:48128
  v_exp_f32 v7, v93
  v_add_f32 v4, v4, v6
  s_waitcnt lgkmcnt(7)
  v_mfma_f32_32x32x16_bf16 v[128:143], v[224:227], v[104:107], v[128:143]
  ds_read_b128 v[192:195], v1 offset:8192
  v_exp_f32 v8, v94
  v_add_f32 v5, v5, v7
  v_cvt_pk_bf16_f32 v110, v6, v7
  s_waitcnt lgkmcnt(7)
  v_mfma_f32_32x32x16_bf16 v[144:159], v[232:235], v[104:107], v[144:159]
  ds_read_b128 v[196:199], v1 offset:9216
  v_exp_f32 v9, v95
  v_add_f32 v4, v4, v8
  s_waitcnt lgkmcnt(7)
  v_mfma_f32_32x32x16_bf16 v[160:175], v[240:243], v[104:107], v[160:175]
  ds_read_b128 v[200:203], v1 offset:10240
  v_add_f32 v5, v5, v9
  v_cvt_pk_bf16_f32 v111, v8, v9
  v_exp_f32 v6, v64
  s_waitcnt lgkmcnt(7)
  v_mfma_f32_32x32x16_bf16 v[176:191], v[248:251], v[104:107], v[176:191]
  ds_read_b128 v[204:207], v1 offset:11264
  v_exp_f32 v7, v65
  v_add_f32 v4, v4, v6
  s_waitcnt lgkmcnt(7)
  v_mfma_f32_32x32x16_bf16 v[128:143], v[228:231], v[108:111], v[128:143]
  ds_read_b128 v[208:211], v1 offset:12288
  v_exp_f32 v8, v66
  v_add_f32 v5, v5, v7
  v_cvt_pk_bf16_f32 v96, v6, v7
  s_waitcnt lgkmcnt(7)
  v_mfma_f32_32x32x16_bf16 v[144:159], v[236:239], v[108:111], v[144:159]
  ds_read_b128 v[212:215], v1 offset:13312
  v_exp_f32 v9, v67
  v_add_f32 v4, v4, v8
  s_waitcnt lgkmcnt(7)
  v_mfma_f32_32x32x16_bf16 v[160:175], v[244:247], v[108:111], v[160:175]
  ds_read_b128 v[216:219], v1 offset:14336
  v_exp_f32 v10, v68
  v_add_f32 v5, v5, v9
  v_cvt_pk_bf16_f32 v97, v8, v9
  s_waitcnt lgkmcnt(7)
  v_mfma_f32_32x32x16_bf16 v[176:191], v[252:255], v[108:111], v[176:191]
  ds_read_b128 v[220:223], v1 offset:15360
  v_exp_f32 v11, v69
  v_add_f32 v4, v4, v10
  s_setprio 1
  s_waitcnt lgkmcnt(7)
  v_mfma_f32_32x32x16_bf16 v[80:95], v[192:195], v[16:19], v[48:63]
  ds_read_b128 v[224:227], v1 offset:49152
  v_exp_f32 v6, v70
  v_add_f32 v5, v5, v11
  v_cvt_pk_bf16_f32 v98, v10, v11
  s_waitcnt lgkmcnt(7)
  v_mfma_f32_32x32x16_bf16 v[80:95], v[196:199], v[20:23], v[80:95]
  ds_read_b128 v[232:235], v1 offset:51200
  v_exp_f32 v7, v71
  v_add_f32 v4, v4, v6
  s_waitcnt lgkmcnt(7)
  v_mfma_f32_32x32x16_bf16 v[80:95], v[200:203], v[24:27], v[80:95]
  ds_read_b128 v[240:243], v1 offset:53248
  v_exp_f32 v8, v72
  v_add_f32 v5, v5, v7
  v_cvt_pk_bf16_f32 v99, v6, v7
  s_waitcnt lgkmcnt(7)
  v_mfma_f32_32x32x16_bf16 v[80:95], v[204:207], v[28:31], v[80:95]
  ds_read_b128 v[248:251], v1 offset:55296
  v_exp_f32 v9, v73
  v_add_f32 v4, v4, v8
  s_waitcnt lgkmcnt(7)
  v_mfma_f32_32x32x16_bf16 v[80:95], v[208:211], v[32:35], v[80:95]
  ds_read_b128 v[228:231], v1 offset:50176
  v_exp_f32 v10, v74
  v_add_f32 v5, v5, v9
  v_cvt_pk_bf16_f32 v100, v8, v9
  s_waitcnt lgkmcnt(7)
  v_mfma_f32_32x32x16_bf16 v[80:95], v[212:215], v[36:39], v[80:95]
  ds_read_b128 v[236:239], v1 offset:52224
  v_exp_f32 v11, v75
  v_add_f32 v4, v4, v10
  s_waitcnt lgkmcnt(7)
  v_mfma_f32_32x32x16_bf16 v[80:95], v[216:219], v[40:43], v[80:95]
  ds_read_b128 v[244:247], v1 offset:54272
  v_exp_f32 v6, v76
  v_add_f32 v5, v5, v11
  v_cvt_pk_bf16_f32 v101, v10, v11
  s_waitcnt lgkmcnt(7)
  v_mfma_f32_32x32x16_bf16 v[80:95], v[220:223], v[44:47], v[80:95]
  ds_read_b128 v[252:255], v1 offset:56320
  v_exp_f32 v7, v77
  v_add_f32 v4, v4, v6
  s_waitcnt lgkmcnt(7)
  v_mfma_f32_32x32x16_bf16 v[128:143], v[224:227], v[96:99], v[128:143]
  ds_read_b128 v[192:195], v1 offset:16384
  v_exp_f32 v8, v78
  v_add_f32 v5, v5, v7
  v_cvt_pk_bf16_f32 v102, v6, v7
  s_waitcnt lgkmcnt(7)
  v_mfma_f32_32x32x16_bf16 v[144:159], v[232:235], v[96:99], v[144:159]
  ds_read_b128 v[196:199], v1 offset:17408
  v_exp_f32 v9, v79
  v_add_f32 v4, v4, v8
  s_waitcnt lgkmcnt(7)
  v_mfma_f32_32x32x16_bf16 v[160:175], v[240:243], v[96:99], v[160:175]
  ds_read_b128 v[200:203], v1 offset:18432
  v_add_f32 v5, v5, v9
  v_cvt_pk_bf16_f32 v103, v8, v9
  v_exp_f32 v6, v80
  s_waitcnt lgkmcnt(7)
  v_mfma_f32_32x32x16_bf16 v[176:191], v[248:251], v[96:99], v[176:191]
  ds_read_b128 v[204:207], v1 offset:19456
  v_exp_f32 v7, v81
  v_add_f32 v4, v4, v6
  s_waitcnt lgkmcnt(7)
  v_mfma_f32_32x32x16_bf16 v[128:143], v[228:231], v[100:103], v[128:143]
  ds_read_b128 v[208:211], v1 offset:20480
  v_exp_f32 v8, v82
  v_add_f32 v5, v5, v7
  v_cvt_pk_bf16_f32 v104, v6, v7
  s_waitcnt lgkmcnt(7)
  v_mfma_f32_32x32x16_bf16 v[144:159], v[236:239], v[100:103], v[144:159]
  ds_read_b128 v[212:215], v1 offset:21504
  v_exp_f32 v9, v83
  v_add_f32 v4, v4, v8
  s_waitcnt lgkmcnt(7)
  v_mfma_f32_32x32x16_bf16 v[160:175], v[244:247], v[100:103], v[160:175]
  ds_read_b128 v[216:219], v1 offset:22528
  v_exp_f32 v10, v84
  v_add_f32 v5, v5, v9
  v_cvt_pk_bf16_f32 v105, v8, v9
  s_waitcnt lgkmcnt(7)
  v_mfma_f32_32x32x16_bf16 v[176:191], v[252:255], v[100:103], v[176:191]
  ds_read_b128 v[220:223], v1 offset:23552
  v_exp_f32 v11, v85
  v_add_f32 v4, v4, v10
  s_sub_u32 s79, s79, 1
  s_cbranch_scc0 .Lk2l_loop
  s_cmp_lg_u32 s63, 0
  s_cbranch_scc1 .Lk2l_m0
  v_mov_b32 v12, 0xf149f2ca
  v_cmp_gt_i32 vcc, 0, v3
  s_nop 1
  v_cndmask_b32 v48, v48, v12, vcc
  v_cmp_gt_i32 vcc, 1, v3
  s_nop 1
  v_cndmask_b32 v49, v49, v12, vcc
  v_cmp_gt_i32 vcc, 2, v3
  s_nop 1
  v_cndmask_b32 v50, v50, v12, vcc
  v_cmp_gt_i32 vcc, 3, v3
  s_nop 1
  v_cndmask_b32 v51, v51, v12, vcc
  v_cmp_gt_i32 vcc, 8, v3
  s_nop 1
  v_cndmask_b32 v52, v52, v12, vcc
  v_cmp_gt_i32 vcc, 9, v3
  s_nop 1
  v_cndmask_b32 v53, v53, v12, vcc
  v_cmp_gt_i32 vcc, 10, v3
  s_nop 1
  v_cndmask_b32 v54, v54, v12, vcc
  v_cmp_gt_i32 vcc, 11, v3
  s_nop 1
  v_cndmask_b32 v55, v55, v12, vcc
  v_cmp_gt_i32 vcc, 16, v3
  s_nop 1
  v_cndmask_b32 v56, v56, v12, vcc
  v_cmp_gt_i32 vcc, 17, v3
  s_nop 1
  v_cndmask_b32 v57, v57, v12, vcc
  v_cmp_gt_i32 vcc, 18, v3
  s_nop 1
  v_cndmask_b32 v58, v58, v12, vcc
  v_cmp_gt_i32 vcc, 19, v3
  s_nop 1
  v_cndmask_b32 v59, v59, v12, vcc
  v_cmp_gt_i32 vcc, 24, v3
  s_nop 1
  v_cndmask_b32 v60, v60, v12, vcc
  v_cmp_gt_i32 vcc, 25, v3
  s_nop 1
  v_cndmask_b32 v61, v61, v12, vcc
  v_cmp_gt_i32 vcc, 26, v3
  s_nop 1
  v_cndmask_b32 v62, v62, v12, vcc
  v_cmp_gt_i32 vcc, 27, v3
  s_nop 1
  v_cndmask_b32 v63, v63, v12, vcc
.Lk2l_m0:
  s_mov_b32 s28, s16
  s_mov_b32 s29, s17
  s_mov_b32 s31, 0x00020000
  s_setprio 0
  s_waitcnt lgkmcnt(7)
  v_mfma_f32_32x32x16_bf16 v[64:79], v[192:195], v[16:19], v[48:63]
  ds_read_b128 v[224:227], v1 offset:57344
  v_exp_f32 v6, v86
  v_add_f32 v5, v5, v11
  v_cvt_pk_bf16_f32 v106, v10, v11
  s_waitcnt lgkmcnt(7)
  v_mfma_f32_32x32x16_bf16 v[64:79], v[196:199], v[20:23], v[64:79]
  ds_read_b128 v[232:235], v1 offset:59392
  v_exp_f32 v7, v87
  v_add_f32 v4, v4, v6
  s_waitcnt lgkmcnt(7)
  v_mfma_f32_32x32x16_bf16 v[64:79], v[200:203], v[24:27], v[64:79]
  ds_read_b128 v[240:243], v1 offset:61440
  v_exp_f32 v8, v88
  v_add_f32 v5, v5, v7
  v_cvt_pk_bf16_f32 v107, v6, v7
  s_waitcnt lgkmcnt(7)
  v_mfma_f32_32x32x16_bf16 v[64:79], v[204:207], v[28:31], v[64:79]
  ds_read_b128 v[248:251], v1 offset:63488
  v_exp_f32 v9, v89
  v_add_f32 v4, v4, v8
  s_waitcnt lgkmcnt(7)
  v_mfma_f32_32x32x16_bf16 v[64:79], v[208:211], v[32:35], v[64:79]
  ds_read_b128 v[228:231], v1 offset:58368
  v_exp_f32 v10, v90
  v_add_f32 v5, v5, v9
  v_cvt_pk_bf16_f32 v108, v8, v9
  s_waitcnt lgkmcnt(7)
  v_mfma_f32_32x32x16_bf16 v[64:79], v[212:215], v[36:39], v[64:79]
  ds_read_b128 v[236:239], v1 offset:60416
  v_exp_f32 v11, v91
  v_add_f32 v4, v4, v10
  s_waitcnt lgkmcnt(7)
  v_mfma_f32_32x32x16_bf16 v[64:79], v[216:219], v[40:43], v[64:79]
  ds_read_b128 v[244:247], v1 offset:62464
  v_exp_f32 v6, v92
  v_add_f32 v5, v5, v11
  v_cvt_pk_bf16_f32 v109, v10, v11
  s_waitcnt lgkmcnt(7)
  v_mfma_f32_32x32x16_bf16 v[64:79], v[220:223], v[44:47], v[64:79]
  ds_read_b128 v[252:255], v1 offset:64512
  v_exp_f32 v7, v93
  v_add_f32 v4, v4, v6
  s_waitcnt lgkmcnt(7)
  v_mfma_f32_32x32x16_bf16 v[128:143], v[224:227], v[104:107], v[128:143]
  ds_read_b128 v[192:195], v1 offset:24576
  ds_read_b128 v[196:199], v1 offset:25600
  v_exp_f32 v8, v94
  v_add_f32 v5, v5, v7
  v_cvt_pk_bf16_f32 v110, v6, v7
  s_waitcnt lgkmcnt(8)
  v_mfma_f32_32x32x16_bf16 v[144:159], v[232:235], v[104:107], v[144:159]
  ds_read_b128 v[200:203], v1 offset:26624
  ds_read_b128 v[204:207], v1 offset:27648
  v_exp_f32 v9, v95
  v_add_f32 v4, v4, v8
  s_waitcnt lgkmcnt(9)
  v_mfma_f32_32x32x16_bf16 v[160:175], v[240:243], v[104:107], v[160:175]
  ds_read_b128 v[208:211], v1 offset:28672
  ds_read_b128 v[212:215], v1 offset:29696
  v_add_f32 v5, v5, v9
  v_cvt_pk_bf16_f32 v111, v8, v9
  v_exp_f32 v6, v64
  s_waitcnt lgkmcnt(10)
  v_mfma_f32_32x32x16_bf16 v[176:191], v[248:251], v[104:107], v[176:191]
  ds_read_b128 v[216:219], v1 offset:30720
  ds_read_b128 v[220:223], v1 offset:31744
  v_exp_f32 v7, v65
  v_add_f32 v4, v4, v6
  s_waitcnt lgkmcnt(11)
  v_mfma_f32_32x32x16_bf16 v[128:143], v[228:231], v[108:111], v[128:143]
  v_exp_f32 v8, v66
  v_add_f32 v5, v5, v7
  v_cvt_pk_bf16_f32 v96, v6, v7
  s_waitcnt lgkmcnt(10)
  v_mfma_f32_32x32x16_bf16 v[144:159], v[236:239], v[108:111], v[144:159]
  v_exp_f32 v9, v67
  v_add_f32 v4, v4, v8
  s_waitcnt lgkmcnt(9)
  v_mfma_f32_32x32x16_bf16 v[160:175], v[244:247], v[108:111], v[160:175]
  v_exp_f32 v10, v68
  v_add_f32 v5, v5, v9
  v_cvt_pk_bf16_f32 v97, v8, v9
  s_waitcnt lgkmcnt(0)
  s_barrier
  v_xor_b32 v1, 0x10000, v1
  v_mfma_f32_32x32x16_bf16 v[176:191], v[252:255], v[108:111], v[176:191]
  v_exp_f32 v11, v69
  v_add_f32 v4, v4, v10
.Lk2l_te:
  s_lshl_b32 s55, s63, 13
  v_add_u32 v14, s55, v1
  s_cmp_eq_u32 s63, 0
  s_cbranch_scc1 .Lk2l_f0
  s_cmp_lg_u32 s63, 1
  s_cbranch_scc1 .Lk2l_m1
  v_mov_b32 v12, 0xf149f2ca
  v_cmp_gt_i32 vcc, 0, v3
  s_nop 1
  v_cndmask_b32 v48, v48, v12, vcc
  v_cmp_gt_i32 vcc, 1, v3
  s_nop 1
  v_cndmask_b32 v49, v49, v12, vcc
  v_cmp_gt_i32 vcc, 2, v3
  s_nop 1
  v_cndmask_b32 v50, v50, v12, vcc
  v_cmp_gt_i32 vcc, 3, v3
  s_nop 1
  v_cndmask_b32 v51, v51, v12, vcc
  v_cmp_gt_i32 vcc, 8, v3
  s_nop 1
  v_cndmask_b32 v52, v52, v12, vcc
  v_cmp_gt_i32 vcc, 9, v3
  s_nop 1
  v_cndmask_b32 v53, v53, v12, vcc
  v_cmp_gt_i32 vcc, 10, v3
  s_nop 1
  v_cndmask_b32 v54, v54, v12, vcc
  v_cmp_gt_i32 vcc, 11, v3
  s_nop 1
  v_cndmask_b32 v55, v55, v12, vcc
  v_cmp_gt_i32 vcc, 16, v3
  s_nop 1
  v_cndmask_b32 v56, v56, v12, vcc
  v_cmp_gt_i32 vcc, 17, v3
  s_nop 1
  v_cndmask_b32 v57, v57, v12, vcc
  v_cmp_gt_i32 vcc, 18, v3
  s_nop 1
  v_cndmask_b32 v58, v58, v12, vcc
  v_cmp_gt_i32 vcc, 19, v3
  s_nop 1
  v_cndmask_b32 v59, v59, v12, vcc
  v_cmp_gt_i32 vcc, 24, v3
  s_nop 1
  v_cndmask_b32 v60, v60, v12, vcc
  v_cmp_gt_i32 vcc, 25, v3
  s_nop 1
  v_cndmask_b32 v61, v61, v12, vcc
  v_cmp_gt_i32 vcc, 26, v3
  s_nop 1
  v_cndmask_b32 v62, v62, v12, vcc
  v_cmp_gt_i32 vcc, 27, v3
  s_nop 1
  v_cndmask_b32 v63, v63, v12, vcc
.Lk2l_m1:
  s_setprio 3
  s_nop 0
  v_mfma_f32_32x32x16_bf16 v[80:95], v[192:195], v[16:19], v[48:63]
  ds_read_b128 v[224:227], v1 offset:32768
  v_exp_f32 v6, v70
  v_add_f32 v5, v5, v11
  v_cvt_pk_bf16_f32 v98, v10, v11
  v_mfma_f32_32x32x16_bf16 v[80:95], v[196:199], v[20:23], v[80:95]
  ds_read_b128 v[232:235], v1 offset:34816
  v_exp_f32 v7, v71
  v_add_f32 v4, v4, v6
  v_mfma_f32_32x32x16_bf16 v[80:95], v[200:203], v[24:27], v[80:95]
  ds_read_b128 v[240:243], v1 offset:36864
  v_exp_f32 v8, v72
  v_add_f32 v5, v5, v7
  v_cvt_pk_bf16_f32 v99, v6, v7
  v_mfma_f32_32x32x16_bf16 v[80:95], v[204:207], v[28:31], v[80:95]
  ds_read_b128 v[248:251], v1 offset:38912
  v_exp_f32 v9, v73
  v_add_f32 v4, v4, v8
  v_mfma_f32_32x32x16_bf16 v[80:95], v[208:211], v[32:35], v[80:95]
  ds_read_b128 v[228:231], v1 offset:33792
  v_exp_f32 v10, v74
  v_add_f32 v5, v5, v9
  v_cvt_pk_bf16_f32 v100, v8, v9
  v_mfma_f32_32x32x16_bf16 v[80:95], v[212:215], v[36:39], v[80:95]
  ds_read_b128 v[236:239], v1 offset:35840
  v_exp_f32 v11, v75
  v_add_f32 v4, v4, v10
  v_mfma_f32_32x32x16_bf16 v[80:95], v[216:219], v[40:43], v[80:95]
  ds_read_b128 v[244:247], v1 offset:37888
  v_exp_f32 v6, v76
  v_add_f32 v5, v5, v11
  v_cvt_pk_bf16_f32 v101, v10, v11
  v_mfma_f32_32x32x16_bf16 v[80:95], v[220:223], v[44:47], v[80:95]
  ds_read_b128 v[252:255], v1 offset:39936
  v_exp_f32 v7, v77
  v_add_f32 v4, v4, v6
  s_waitcnt lgkmcnt(7)
  v_mfma_f32_32x32x16_bf16 v[128:143], v[224:227], v[96:99], v[128:143]
  ds_read_b128 v[192:195], v1 offset:0
  v_exp_f32 v8, v78
  v_add_f32 v5, v5, v7
  v_cvt_pk_bf16_f32 v102, v6, v7
  s_waitcnt lgkmcnt(7)
  v_mfma_f32_32x32x16_bf16 v[144:159], v[232:235], v[96:99], v[144:159]
  ds_read_b128 v[196:199], v1 offset:1024
  v_exp_f32 v9, v79
  v_add_f32 v4, v4, v8
  s_waitcnt lgkmcnt(7)
  v_mfma_f32_32x32x16_bf16 v[160:175], v[240:243], v[96:99], v[160:175]
  ds_read_b128 v[200:203], v1 offset:2048
  v_add_f32 v5, v5, v9
  v_cvt_pk_bf16_f32 v103, v8, v9
  v_exp_f32 v6, v80
  s_waitcnt lgkmcnt(7)
  v_mfma_f32_32x32x16_bf16 v[176:191], v[248:251], v[96:99], v[176:191]
  ds_read_b128 v[204:207], v1 offset:3072
  v_exp_f32 v7, v81
  v_add_f32 v4, v4, v6
  s_waitcnt lgkmcnt(7)
  v_mfma_f32_32x32x16_bf16 v[128:143], v[228:231], v[100:103], v[128:143]
  ds_read_b128 v[208:211], v1 offset:4096
  v_exp_f32 v8, v82
  v_add_f32 v5, v5, v7
  v_cvt_pk_bf16_f32 v104, v6, v7
  s_waitcnt lgkmcnt(7)
  v_mfma_f32_32x32x16_bf16 v[144:159], v[236:239], v[100:103], v[144:159]
  ds_read_b128 v[212:215], v1 offset:5120
  v_exp_f32 v9, v83
  v_add_f32 v4, v4, v8
  s_waitcnt lgkmcnt(7)
  v_mfma_f32_32x32x16_bf16 v[160:175], v[244:247], v[100:103], v[160:175]
  ds_read_b128 v[216:219], v1 offset:6144
  v_exp_f32 v10, v84
  v_add_f32 v5, v5, v9
  v_cvt_pk_bf16_f32 v105, v8, v9
  s_waitcnt lgkmcnt(7)
  v_mfma_f32_32x32x16_bf16 v[176:191], v[252:255], v[100:103], v[176:191]
  ds_read_b128 v[220:223], v1 offset:7168
  v_exp_f32 v11, v85
  v_add_f32 v4, v4, v10
  s_cmp_eq_u32 s63, 1
  s_cbranch_scc1 .Lk2l_f1
  s_cmp_lg_u32 s63, 2
  s_cbranch_scc1 .Lk2l_m2
  v_mov_b32 v12, 0xf149f2ca
  v_cmp_gt_i32 vcc, 0, v3
  s_nop 1
  v_cndmask_b32 v48, v48, v12, vcc
  v_cmp_gt_i32 vcc, 1, v3
  s_nop 1
  v_cndmask_b32 v49, v49, v12, vcc
  v_cmp_gt_i32 vcc, 2, v3
  s_nop 1
  v_cndmask_b32 v50, v50, v12, vcc
  v_cmp_gt_i32 vcc, 3, v3
  s_nop 1
  v_cndmask_b32 v51, v51, v12, vcc
  v_cmp_gt_i32 vcc, 8, v3
  s_nop 1
  v_cndmask_b32 v52, v52, v12, vcc
  v_cmp_gt_i32 vcc, 9, v3
  s_nop 1
  v_cndmask_b32 v53, v53, v12, vcc
  v_cmp_gt_i32 vcc, 10, v3
  s_nop 1
  v_cndmask_b32 v54, v54, v12, vcc
  v_cmp_gt_i32 vcc, 11, v3
  s_nop 1
  v_cndmask_b32 v55, v55, v12, vcc
  v_cmp_gt_i32 vcc, 16, v3
  s_nop 1
  v_cndmask_b32 v56, v56, v12, vcc
  v_cmp_gt_i32 vcc, 17, v3
  s_nop 1
  v_cndmask_b32 v57, v57, v12, vcc
  v_cmp_gt_i32 vcc, 18, v3
  s_nop 1
  v_cndmask_b32 v58, v58, v12, vcc
  v_cmp_gt_i32 vcc, 19, v3
  s_nop 1
  v_cndmask_b32 v59, v59, v12, vcc
  v_cmp_gt_i32 vcc, 24, v3
  s_nop 1
  v_cndmask_b32 v60, v60, v12, vcc
  v_cmp_gt_i32 vcc, 25, v3
  s_nop 1
  v_cndmask_b32 v61, v61, v12, vcc
  v_cmp_gt_i32 vcc, 26, v3
  s_nop 1
  v_cndmask_b32 v62, v62, v12, vcc
  v_cmp_gt_i32 vcc, 27, v3
  s_nop 1
  v_cndmask_b32 v63, v63, v12, vcc
.Lk2l_m2:
  s_setprio 2
  s_waitcnt lgkmcnt(7)
  v_mfma_f32_32x32x16_bf16 v[64:79], v[192:195], v[16:19], v[48:63]
  ds_read_b128 v[224:227], v1 offset:40960
  v_exp_f32 v6, v86
  v_add_f32 v5, v5, v11
  v_cvt_pk_bf16_f32 v106, v10, v11
  s_waitcnt lgkmcnt(7)
  v_mfma_f32_32x32x16_bf16 v[64:79], v[196:199], v[20:23], v[64:79]
  ds_read_b128 v[232:235], v1 offset:43008
  v_exp_f32 v7, v87
  v_add_f32 v4, v4, v6
  s_waitcnt lgkmcnt(7)
  v_mfma_f32_32x32x16_bf16 v[64:79], v[200:203], v[24:27], v[64:79]
  ds_read_b128 v[240:243], v1 offset:45056
  v_exp_f32 v8, v88
  v_add_f32 v5, v5, v7
  v_cvt_pk_bf16_f32 v107, v6, v7
  s_waitcnt lgkmcnt(7)
  v_mfma_f32_32x32x16_bf16 v[64:79], v[204:207], v[28:31], v[64:79]
  ds_read_b128 v[248:251], v1 offset:47104
  v_exp_f32 v9, v89
  v_add_f32 v4, v4, v8
  s_waitcnt lgkmcnt(7)
  v_mfma_f32_32x32x16_bf16 v[64:79], v[208:211], v[32:35], v[64:79]
  ds_read_b128 v[228:231], v1 offset:41984
  v_exp_f32 v10, v90
  v_add_f32 v5, v5, v9
  v_cvt_pk_bf16_f32 v108, v8, v9
  s_waitcnt lgkmcnt(7)
  v_mfma_f32_32x32x16_bf16 v[64:79], v[212:215], v[36:39], v[64:79]
  ds_read_b128 v[236:239], v1 offset:44032
  v_exp_f32 v11, v91
  v_add_f32 v4, v4, v10
  s_waitcnt lgkmcnt(7)
  v_mfma_f32_32x32x16_bf16 v[64:79], v[216:219], v[40:43], v[64:79]
  ds_read_b128 v[244:247], v1 offset:46080
  v_exp_f32 v6, v92
  v_add_f32 v5, v5, v11
  v_cvt_pk_bf16_f32 v109, v10, v11
  s_waitcnt lgkmcnt(7)
  v_mfma_f32_32x32x16_bf16 v[64:79], v[220:223], v[44:47], v[64:79]
  ds_read_b128 v[252:255], v1 offset:48128
  v_exp_f32 v7, v93
  v_add_f32 v4, v4, v6
  s_waitcnt lgkmcnt(7)
  v_mfma_f32_32x32x16_bf16 v[128:143], v[224:227], v[104:107], v[128:143]
  ds_read_b128 v[192:195], v1 offset:8192
  v_exp_f32 v8, v94
  v_add_f32 v5, v5, v7
  v_cvt_pk_bf16_f32 v110, v6, v7
  s_waitcnt lgkmcnt(7)
  v_mfma_f32_32x32x16_bf16 v[144:159], v[232:235], v[104:107], v[144:159]
  ds_read_b128 v[196:199], v1 offset:9216
  v_exp_f32 v9, v95
  v_add_f32 v4, v4, v8
  s_waitcnt lgkmcnt(7)
  v_mfma_f32_32x32x16_bf16 v[160:175], v[240:243], v[104:107], v[160:175]
  ds_read_b128 v[200:203], v1 offset:10240
  v_add_f32 v5, v5, v9
  v_cvt_pk_bf16_f32 v111, v8, v9
  v_exp_f32 v6, v64
  s_waitcnt lgkmcnt(7)
  v_mfma_f32_32x32x16_bf16 v[176:191], v[248:251], v[104:107], v[176:191]
  ds_read_b128 v[204:207], v1 offset:11264
  v_exp_f32 v7, v65
  v_add_f32 v4, v4, v6
  s_waitcnt lgkmcnt(7)
  v_mfma_f32_32x32x16_bf16 v[128:143], v[228:231], v[108:111], v[128:143]
  ds_read_b128 v[208:211], v1 offset:12288
  v_exp_f32 v8, v66
  v_add_f32 v5, v5, v7
  v_cvt_pk_bf16_f32 v96, v6, v7
  s_waitcnt lgkmcnt(7)
  v_mfma_f32_32x32x16_bf16 v[144:159], v[236:239], v[108:111], v[144:159]
  ds_read_b128 v[212:215], v1 offset:13312
  v_exp_f32 v9, v67
  v_add_f32 v4, v4, v8
  s_waitcnt lgkmcnt(7)
  v_mfma_f32_32x32x16_bf16 v[160:175], v[244:247], v[108:111], v[160:175]
  ds_read_b128 v[216:219], v1 offset:14336
  v_exp_f32 v10, v68
  v_add_f32 v5, v5, v9
  v_cvt_pk_bf16_f32 v97, v8, v9
  s_waitcnt lgkmcnt(7)
  v_mfma_f32_32x32x16_bf16 v[176:191], v[252:255], v[108:111], v[176:191]
  ds_read_b128 v[220:223], v1 offset:15360
  v_exp_f32 v11, v69
  v_add_f32 v4, v4, v10
  s_cmp_eq_u32 s63, 2
  s_cbranch_scc1 .Lk2l_f0
  s_cmp_lg_u32 s63, 3
  s_cbranch_scc1 .Lk2l_m3
  v_mov_b32 v12, 0xf149f2ca
  v_cmp_gt_i32 vcc, 0, v3
  s_nop 1
  v_cndmask_b32 v48, v48, v12, vcc
  v_cmp_gt_i32 vcc, 1, v3
  s_nop 1
  v_cndmask_b32 v49, v49, v12, vcc
  v_cmp_gt_i32 vcc, 2, v3
  s_nop 1
  v_cndmask_b32 v50, v50, v12, vcc
  v_cmp_gt_i32 vcc, 3, v3
  s_nop 1
  v_cndmask_b32 v51, v51, v12, vcc
  v_cmp_gt_i32 vcc, 8, v3
  s_nop 1
  v_cndmask_b32 v52, v52, v12, vcc
  v_cmp_gt_i32 vcc, 9, v3
  s_nop 1
  v_cndmask_b32 v53, v53, v12, vcc
  v_cmp_gt_i32 vcc, 10, v3
  s_nop 1
  v_cndmask_b32 v54, v54, v12, vcc
  v_cmp_gt_i32 vcc, 11, v3
  s_nop 1
  v_cndmask_b32 v55, v55, v12, vcc
  v_cmp_gt_i32 vcc, 16, v3
  s_nop 1
  v_cndmask_b32 v56, v56, v12, vcc
  v_cmp_gt_i32 vcc, 17, v3
  s_nop 1
  v_cndmask_b32 v57, v57, v12, vcc
  v_cmp_gt_i32 vcc, 18, v3
  s_nop 1
  v_cndmask_b32 v58, v58, v12, vcc
  v_cmp_gt_i32 vcc, 19, v3
  s_nop 1
  v_cndmask_b32 v59, v59, v12, vcc
  v_cmp_gt_i32 vcc, 24, v3
  s_nop 1
  v_cndmask_b32 v60, v60, v12, vcc
  v_cmp_gt_i32 vcc, 25, v3
  s_nop 1
  v_cndmask_b32 v61, v61, v12, vcc
  v_cmp_gt_i32 vcc, 26, v3
  s_nop 1
  v_cndmask_b32 v62, v62, v12, vcc
  v_cmp_gt_i32 vcc, 27, v3
  s_nop 1
  v_cndmask_b32 v63, v63, v12, vcc
.Lk2l_m3:
  s_setprio 1
  s_waitcnt lgkmcnt(7)
  v_mfma_f32_32x32x16_bf16 v[80:95], v[192:195], v[16:19], v[48:63]
  ds_read_b128 v[224:227], v1 offset:49152
  v_exp_f32 v6, v70
  v_add_f32 v5, v5, v11
  v_cvt_pk_bf16_f32 v98, v10, v11
  s_waitcnt lgkmcnt(7)
  v_mfma_f32_32x32x16_bf16 v[80:95], v[196:199], v[20:23], v[80:95]
  ds_read_b128 v[232:235], v1 offset:51200
  v_exp_f32 v7, v71
  v_add_f32 v4, v4, v6
  s_waitcnt lgkmcnt(7)
  v_mfma_f32_32x32x16_bf16 v[80:95], v[200:203], v[24:27], v[80:95]
  ds_read_b128 v[240:243], v1 offset:53248
  v_exp_f32 v8, v72
  v_add_f32 v5, v5, v7
  v_cvt_pk_bf16_f32 v99, v6, v7
  s_waitcnt lgkmcnt(7)
  v_mfma_f32_32x32x16_bf16 v[80:95], v[204:207], v[28:31], v[80:95]
  ds_read_b128 v[248:251], v1 offset:55296
  v_exp_f32 v9, v73
  v_add_f32 v4, v4, v8
  s_waitcnt lgkmcnt(7)
  v_mfma_f32_32x32x16_bf16 v[80:95], v[208:211], v[32:35], v[80:95]
  ds_read_b128 v[228:231], v1 offset:50176
  v_exp_f32 v10, v74
  v_add_f32 v5, v5, v9
  v_cvt_pk_bf16_f32 v100, v8, v9
  s_waitcnt lgkmcnt(7)
  v_mfma_f32_32x32x16_bf16 v[80:95], v[212:215], v[36:39], v[80:95]
  ds_read_b128 v[236:239], v1 offset:52224
  v_exp_f32 v11, v75
  v_add_f32 v4, v4, v10
  s_waitcnt lgkmcnt(7)
  v_mfma_f32_32x32x16_bf16 v[80:95], v[216:219], v[40:43], v[80:95]
  ds_read_b128 v[244:247], v1 offset:54272
  v_exp_f32 v6, v76
  v_add_f32 v5, v5, v11
  v_cvt_pk_bf16_f32 v101, v10, v11
  s_waitcnt lgkmcnt(7)
  v_mfma_f32_32x32x16_bf16 v[80:95], v[220:223], v[44:47], v[80:95]
  ds_read_b128 v[252:255], v1 offset:56320
  v_exp_f32 v7, v77
  v_add_f32 v4, v4, v6
  s_waitcnt lgkmcnt(7)
  v_mfma_f32_32x32x16_bf16 v[128:143], v[224:227], v[96:99], v[128:143]
  v_exp_f32 v8, v78
  v_add_f32 v5, v5, v7
  v_cvt_pk_bf16_f32 v102, v6, v7
  s_waitcnt lgkmcnt(6)
  v_mfma_f32_32x32x16_bf16 v[144:159], v[232:235], v[96:99], v[144:159]
  v_exp_f32 v9, v79
  v_add_f32 v4, v4, v8
  s_waitcnt lgkmcnt(5)
  v_mfma_f32_32x32x16_bf16 v[160:175], v[240:243], v[96:99], v[160:175]
  v_add_f32 v5, v5, v9
  v_cvt_pk_bf16_f32 v103, v8, v9
  v_exp_f32 v6, v80
  s_waitcnt lgkmcnt(4)
  v_mfma_f32_32x32x16_bf16 v[176:191], v[248:251], v[96:99], v[176:191]
  v_exp_f32 v7, v81
  v_add_f32 v4, v4, v6
  s_waitcnt lgkmcnt(3)
  v_mfma_f32_32x32x16_bf16 v[128:143], v[228:231], v[100:103], v[128:143]
  v_exp_f32 v8, v82
  v_add_f32 v5, v5, v7
  v_cvt_pk_bf16_f32 v104, v6, v7
  s_waitcnt lgkmcnt(2)
  v_mfma_f32_32x32x16_bf16 v[144:159], v[236:239], v[100:103], v[144:159]
  v_exp_f32 v9, v83
  v_add_f32 v4, v4, v8
  s_waitcnt lgkmcnt(1)
  v_mfma_f32_32x32x16_bf16 v[160:175], v[244:247], v[100:103], v[160:175]
  v_exp_f32 v10, v84
  v_add_f32 v5, v5, v9
  v_cvt_pk_bf16_f32 v105, v8, v9
  s_waitcnt lgkmcnt(0)
  v_mfma_f32_32x32x16_bf16 v[176:191], v[252:255], v[100:103], v[176:191]
  v_exp_f32 v11, v85
  v_add_f32 v4, v4, v10
.Lk2l_f1:
  v_mov_b32 v115, 163776
  ds_read_b32 v119, v115
  ds_read_b128 v[224:227], v14 offset:32768
  ds_read_b128 v[232:235], v14 offset:34816
  ds_read_b128 v[240:243], v14 offset:36864
  ds_read_b128 v[248:251], v14 offset:38912
  ds_read_b128 v[228:231], v14 offset:33792
  ds_read_b128 v[236:239], v14 offset:35840
  ds_read_b128 v[244:247], v14 offset:37888
  ds_read_b128 v[252:255], v14 offset:39936
  v_exp_f32 v6, v86
  v_add_f32 v5, v5, v11
  v_cvt_pk_bf16_f32 v106, v10, v11
  v_exp_f32 v7, v87
  v_add_f32 v4, v4, v6
  v_exp_f32 v8, v88
  v_add_f32 v5, v5, v7
  v_cvt_pk_bf16_f32 v107, v6, v7
  v_exp_f32 v9, v89
  v_add_f32 v4, v4, v8
  v_exp_f32 v10, v90
  v_add_f32 v5, v5, v9
  v_cvt_pk_bf16_f32 v108, v8, v9
  v_exp_f32 v11, v91
  v_add_f32 v4, v4, v10
  v_exp_f32 v6, v92
  v_add_f32 v5, v5, v11
  v_cvt_pk_bf16_f32 v109, v10, v11
  v_exp_f32 v7, v93
  v_add_f32 v4, v4, v6
  v_exp_f32 v8, v94
  v_add_f32 v5, v5, v7
  v_cvt_pk_bf16_f32 v110, v6, v7
  v_exp_f32 v9, v95
  v_add_f32 v4, v4, v8
  v_add_f32 v5, v5, v9
  v_cvt_pk_bf16_f32 v111, v8, v9
  s_waitcnt lgkmcnt(8)
  v_readfirstlane_b32 s55, v119
  s_nop 0
  s_cmp_lg_u32 s55, 1
  s_cselect_b32 s68, 1, 0
  s_cselect_b32 s30, 0, s18
  s_waitcnt lgkmcnt(7)
  v_mfma_f32_32x32x16_bf16 v[128:143], v[224:227], v[104:107], v[128:143]
  s_mul_i32 s55, s49, 4352
  v_and_b32 v3, 0x300, v2
  v_add3_u32 v1, v3, v2, s55
  v_xor_b32 v3, 256, v1
  s_add_u32 s56, s20, 0
  buffer_load_dwordx4 v[192:195], v1, s[28:31], s56 offen offset:0
  v_mov_b32 v64, 0
  v_mov_b32 v65, 0
  v_mov_b32 v66, 0
  v_mov_b32 v67, 0
  s_waitcnt lgkmcnt(6)
  v_mfma_f32_32x32x16_bf16 v[144:159], v[232:235], v[104:107], v[144:159]
  buffer_load_dwordx4 v[196:199], v3, s[28:31], s56 offen offset:0
  buffer_load_dwordx4 v[200:203], v1, s[28:31], s56 offen offset:2048
  v_mov_b32 v68, 0
  v_mov_b32 v69, 0
  v_mov_b32 v70, 0
  v_mov_b32 v71, 0
  s_waitcnt lgkmcnt(5)
  v_mfma_f32_32x32x16_bf16 v[160:175], v[240:243], v[104:107], v[160:175]
  buffer_load_dwordx4 v[204:207], v3, s[28:31], s56 offen offset:2048
  s_add_u32 s56, s20, 8192
  buffer_load_dwordx4 v[208:211], v1, s[28:31], s56 offen offset:0
  v_mov_b32 v72, 0
  v_mov_b32 v73, 0
  v_mov_b32 v74, 0
  v_mov_b32 v75, 0
  s_waitcnt lgkmcnt(4)
  v_mfma_f32_32x32x16_bf16 v[176:191], v[248:251], v[104:107], v[176:191]
  buffer_load_dwordx4 v[212:215], v3, s[28:31], s56 offen offset:0
  buffer_load_dwordx4 v[216:219], v1, s[28:31], s56 offen offset:2048
  v_mov_b32 v76, 0
  v_mov_b32 v77, 0
  v_mov_b32 v78, 0
  v_mov_b32 v79, 0
  s_waitcnt lgkmcnt(3)
  v_mfma_f32_32x32x16_bf16 v[128:143], v[228:231], v[108:111], v[128:143]
  buffer_load_dwordx4 v[220:223], v3, s[28:31], s56 offen offset:2048
  s_add_u32 s56, s20, 16384
  buffer_load_dwordx4 v[48:51], v1, s[28:31], s56 offen offset:0
  v_mov_b32 v80, 0
  v_mov_b32 v81, 0
  v_mov_b32 v82, 0
  v_mov_b32 v83, 0
  s_waitcnt lgkmcnt(2)
  v_mfma_f32_32x32x16_bf16 v[144:159], v[236:239], v[108:111], v[144:159]
  buffer_load_dwordx4 v[52:55], v3, s[28:31], s56 offen offset:0
  buffer_load_dwordx4 v[56:59], v1, s[28:31], s56 offen offset:2048
  v_mov_b32 v84, 0
  v_mov_b32 v85, 0
  v_mov_b32 v86, 0
  v_mov_b32 v87, 0
  s_waitcnt lgkmcnt(1)
  v_mfma_f32_32x32x16_bf16 v[160:175], v[244:247], v[108:111], v[160:175]
  buffer_load_dwordx4 v[60:63], v3, s[28:31], s56 offen offset:2048
  v_mov_b32 v88, 0
  v_mov_b32 v89, 0
  v_mov_b32 v90, 0
  v_mov_b32 v91, 0
  s_waitcnt lgkmcnt(0)
  v_mfma_f32_32x32x16_bf16 v[176:191], v[252:255], v[108:111], v[176:191]
  v_mov_b32 v92, 0
  v_mov_b32 v93, 0
  v_mov_b32 v94, 0
  v_mov_b32 v95, 0
  s_branch .Lk2l_done
.Lk2l_f0:
  v_mov_b32 v115, 163776
  ds_read_b32 v119, v115
  ds_read_b128 v[224:227], v14 offset:32768
  ds_read_b128 v[232:235], v14 offset:34816
  ds_read_b128 v[240:243], v14 offset:36864
  ds_read_b128 v[248:251], v14 offset:38912
  ds_read_b128 v[228:231], v14 offset:33792
  ds_read_b128 v[236:239], v14 offset:35840
  ds_read_b128 v[244:247], v14 offset:37888
  ds_read_b128 v[252:255], v14 offset:39936
  v_exp_f32 v6, v70
  v_add_f32 v5, v5, v11
  v_cvt_pk_bf16_f32 v98, v10, v11
  v_exp_f32 v7, v71
  v_add_f32 v4, v4, v6
  v_exp_f32 v8, v72
  v_add_f32 v5, v5, v7
  v_cvt_pk_bf16_f32 v99, v6, v7
  v_exp_f32 v9, v73
  v_add_f32 v4, v4, v8
  v_exp_f32 v10, v74
  v_add_f32 v5, v5, v9
  v_cvt_pk_bf16_f32 v100, v8, v9
  v_exp_f32 v11, v75
  v_add_f32 v4, v4, v10
  v_exp_f32 v6, v76
  v_add_f32 v5, v5, v11
  v_cvt_pk_bf16_f32 v101, v10, v11
  v_exp_f32 v7, v77
  v_add_f32 v4, v4, v6
  v_exp_f32 v8, v78
  v_add_f32 v5, v5, v7
  v_cvt_pk_bf16_f32 v102, v6, v7
  v_exp_f32 v9, v79
  v_add_f32 v4, v4, v8
  v_add_f32 v5, v5, v9
  v_cvt_pk_bf16_f32 v103, v8, v9
  s_waitcnt lgkmcnt(8)
  v_readfirstlane_b32 s55, v119
  s_nop 0
  s_cmp_lg_u32 s55, 1
  s_cselect_b32 s68, 1, 0
  s_cselect_b32 s30, 0, s18
  s_waitcnt lgkmcnt(7)
  v_mfma_f32_32x32x16_bf16 v[128:143], v[224:227], v[96:99], v[128:143]
  s_mul_i32 s55, s49, 4352
  v_and_b32 v3, 0x300, v2
  v_add3_u32 v1, v3, v2, s55
  v_xor_b32 v3, 256, v1
  s_add_u32 s56, s20, 0
  buffer_load_dwordx4 v[192:195], v1, s[28:31], s56 offen offset:0
  v_mov_b32 v64, 0
  v_mov_b32 v65, 0
  v_mov_b32 v66, 0
  v_mov_b32 v67, 0
  s_waitcnt lgkmcnt(6)
  v_mfma_f32_32x32x16_bf16 v[144:159], v[232:235], v[96:99], v[144:159]
  buffer_load_dwordx4 v[196:199], v3, s[28:31], s56 offen offset:0
  buffer_load_dwordx4 v[200:203], v1, s[28:31], s56 offen offset:2048
  v_mov_b32 v68, 0
  v_mov_b32 v69, 0
  v_mov_b32 v70, 0
  v_mov_b32 v71, 0
  s_waitcnt lgkmcnt(5)
  v_mfma_f32_32x32x16_bf16 v[160:175], v[240:243], v[96:99], v[160:175]
  buffer_load_dwordx4 v[204:207], v3, s[28:31], s56 offen offset:2048
  s_add_u32 s56, s20, 8192
  buffer_load_dwordx4 v[208:211], v1, s[28:31], s56 offen offset:0
  v_mov_b32 v72, 0
  v_mov_b32 v73, 0
  v_mov_b32 v74, 0
  v_mov_b32 v75, 0
  s_waitcnt lgkmcnt(4)
  v_mfma_f32_32x32x16_bf16 v[176:191], v[248:251], v[96:99], v[176:191]
  buffer_load_dwordx4 v[212:215], v3, s[28:31], s56 offen offset:0
  buffer_load_dwordx4 v[216:219], v1, s[28:31], s56 offen offset:2048
  v_mov_b32 v76, 0
  v_mov_b32 v77, 0
  v_mov_b32 v78, 0
  v_mov_b32 v79, 0
  s_waitcnt lgkmcnt(3)
  v_mfma_f32_32x32x16_bf16 v[128:143], v[228:231], v[100:103], v[128:143]
  buffer_load_dwordx4 v[220:223], v3, s[28:31], s56 offen offset:2048
  s_add_u32 s56, s20, 16384
  buffer_load_dwordx4 v[48:51], v1, s[28:31], s56 offen offset:0
  v_mov_b32 v80, 0
  v_mov_b32 v81, 0
  v_mov_b32 v82, 0
  v_mov_b32 v83, 0
  s_waitcnt lgkmcnt(2)
  v_mfma_f32_32x32x16_bf16 v[144:159], v[236:239], v[100:103], v[144:159]
  buffer_load_dwordx4 v[52:55], v3, s[28:31], s56 offen offset:0
  buffer_load_dwordx4 v[56:59], v1, s[28:31], s56 offen offset:2048
  v_mov_b32 v84, 0
  v_mov_b32 v85, 0
  v_mov_b32 v86, 0
  v_mov_b32 v87, 0
  s_waitcnt lgkmcnt(1)
  v_mfma_f32_32x32x16_bf16 v[160:175], v[244:247], v[100:103], v[160:175]
  buffer_load_dwordx4 v[60:63], v3, s[28:31], s56 offen offset:2048
  v_mov_b32 v88, 0
  v_mov_b32 v89, 0
  v_mov_b32 v90, 0
  v_mov_b32 v91, 0
  s_waitcnt lgkmcnt(0)
  v_mfma_f32_32x32x16_bf16 v[176:191], v[252:255], v[100:103], v[176:191]
  v_mov_b32 v92, 0
  v_mov_b32 v93, 0
  v_mov_b32 v94, 0
  v_mov_b32 v95, 0
.Lk2l_done:
  s_setprio 0
  v_add_f32 v4, v4, v5
  v_mov_b32 v12, v4
  s_nop 1
  v_permlane32_swap_b32 v12, v4
  v_mov_b32 v13, 0x4e800000
  v_add_f32 v4, v4, v12
  v_cmp_nlt_f32 vcc, v4, v13
  s_nop 0
  s_cbranch_vccnz .Lk2_safe
  v_mov_b32 v96, 0
  v_mov_b32 v97, 0
  v_mov_b32 v98, 0
  v_mov_b32 v99, 0
  v_mov_b32 v100, 0
  v_mov_b32 v101, 0
  v_mov_b32 v102, 0
  v_mov_b32 v103, 0
  v_rcp_f32 v4, v4
  s_lshl_b32 s55, s78, 5
  s_add_u32 s55, s55, s53
  s_lshl_b32 s55, s55, 13
  s_add_u32 s55, s55, 50331648
  s_add_u32 s56, s55, 4096
  v_mov_b32 v5, v4
  v_pk_mul_f32 v[128:129], v[128:129], v[4:5]
  v_pk_mul_f32 v[130:131], v[130:131], v[4:5]
  v_pk_mul_f32 v[132:133], v[132:133], v[4:5]
  v_pk_mul_f32 v[134:135], v[134:135], v[4:5]
  v_pk_mul_f32 v[136:137], v[136:137], v[4:5]
  v_pk_mul_f32 v[138:139], v[138:139], v[4:5]
  v_pk_mul_f32 v[140:141], v[140:141], v[4:5]
  v_pk_mul_f32 v[142:143], v[142:143], v[4:5]
  v_cvt_pk_bf16_f32 v128, v128, v129
  v_cvt_pk_bf16_f32 v129, v130, v131
  v_cvt_pk_bf16_f32 v130, v132, v133
  v_cvt_pk_bf16_f32 v131, v134, v135
  v_cvt_pk_bf16_f32 v132, v136, v137
  v_cvt_pk_bf16_f32 v133, v138, v139
  v_cvt_pk_bf16_f32 v134, v140, v141
  v_cvt_pk_bf16_f32 v135, v142, v143
  buffer_store_dwordx4 v[128:131], v2, s[16:19], s55 offen offset:0 sc1
  buffer_store_dwordx4 v[132:135], v2, s[16:19], s55 offen offset:1024 sc1
  v_pk_mul_f32 v[144:145], v[144:145], v[4:5]
  v_pk_mul_f32 v[146:147], v[146:147], v[4:5]
  v_pk_mul_f32 v[148:149], v[148:149], v[4:5]
  v_pk_mul_f32 v[150:151], v[150:151], v[4:5]
  v_pk_mul_f32 v[152:153], v[152:153], v[4:5]
  v_pk_mul_f32 v[154:155], v[154:155], v[4:5]
  v_pk_mul_f32 v[156:157], v[156:157], v[4:5]
  v_pk_mul_f32 v[158:159], v[158:159], v[4:5]
  v_cvt_pk_bf16_f32 v144, v144, v145
  v_cvt_pk_bf16_f32 v145, v146, v147
  v_cvt_pk_bf16_f32 v146, v148, v149
  v_cvt_pk_bf16_f32 v147, v150, v151
  v_cvt_pk_bf16_f32 v148, v152, v153
  v_cvt_pk_bf16_f32 v149, v154, v155
  v_cvt_pk_bf16_f32 v150, v156, v157
  v_cvt_pk_bf16_f32 v151, v158, v159
  buffer_store_dwordx4 v[144:147], v2, s[16:19], s55 offen offset:2048 sc1
  buffer_store_dwordx4 v[148:151], v2, s[16:19], s55 offen offset:3072 sc1
  v_pk_mul_f32 v[160:161], v[160:161], v[4:5]
  v_pk_mul_f32 v[162:163], v[162:163], v[4:5]
  v_pk_mul_f32 v[164:165], v[164:165], v[4:5]
  v_pk_mul_f32 v[166:167], v[166:167], v[4:5]
  v_pk_mul_f32 v[168:169], v[168:169], v[4:5]
  v_pk_mul_f32 v[170:171], v[170:171], v[4:5]
  v_pk_mul_f32 v[172:173], v[172:173], v[4:5]
  v_pk_mul_f32 v[174:175], v[174:175], v[4:5]
  v_cvt_pk_bf16_f32 v160, v160, v161
  v_cvt_pk_bf16_f32 v161, v162, v163
  v_cvt_pk_bf16_f32 v162, v164, v165
  v_cvt_pk_bf16_f32 v163, v166, v167
  v_cvt_pk_bf16_f32 v164, v168, v169
  v_cvt_pk_bf16_f32 v165, v170, v171
  v_cvt_pk_bf16_f32 v166, v172, v173
  v_cvt_pk_bf16_f32 v167, v174, v175
  buffer_store_dwordx4 v[160:163], v2, s[16:19], s56 offen offset:0 sc1
  buffer_store_dwordx4 v[164:167], v2, s[16:19], s56 offen offset:1024 sc1
  v_pk_mul_f32 v[176:177], v[176:177], v[4:5]
  v_pk_mul_f32 v[178:179], v[178:179], v[4:5]
  v_pk_mul_f32 v[180:181], v[180:181], v[4:5]
  v_pk_mul_f32 v[182:183], v[182:183], v[4:5]
  v_pk_mul_f32 v[184:185], v[184:185], v[4:5]
  v_pk_mul_f32 v[186:187], v[186:187], v[4:5]
  v_pk_mul_f32 v[188:189], v[188:189], v[4:5]
  v_pk_mul_f32 v[190:191], v[190:191], v[4:5]
  v_cvt_pk_bf16_f32 v176, v176, v177
  v_cvt_pk_bf16_f32 v177, v178, v179
  v_cvt_pk_bf16_f32 v178, v180, v181
  v_cvt_pk_bf16_f32 v179, v182, v183
  v_cvt_pk_bf16_f32 v180, v184, v185
  v_cvt_pk_bf16_f32 v181, v186, v187
  v_cvt_pk_bf16_f32 v182, v188, v189
  v_cvt_pk_bf16_f32 v183, v190, v191
  buffer_store_dwordx4 v[176:179], v2, s[16:19], s56 offen offset:2048 sc1
  buffer_store_dwordx4 v[180:183], v2, s[16:19], s56 offen offset:3072 sc1
  s_cmp_eq_u32 s68, 0
  s_cbranch_scc1 .Lp3
.Lk2l_x:
  s_waitcnt vmcnt(0)
  s_cmp_eq_u32 s89, 0
  s_cbranch_scc1 .Lcf48
  v_mov_b32 v12, 1
  s_mov_b64 exec, 1
  buffer_store_byte v12, off, s[16:19], s89 sc0 sc1
  s_mov_b64 exec, -1
  s_mov_b32 s89, 0
.Lcf48:
.Lrs50:
  v_mov_b32 v115, 163776
  ds_read_b32 v119, v115
  s_waitcnt lgkmcnt(0)
  v_readfirstlane_b32 s55, v119
  s_nop 0
  s_cmp_lg_u32 s55, 1
  s_cselect_b32 s68, 1, 0
  s_cbranch_scc0 .Lrs50k
  s_sleep 2
  s_sub_u32 s95, s95, 1
  s_cselect_b32 s95, 0, s95
  s_cbranch_scc0 .Lrs50
.Lrs50k:
  s_mul_i32 s55, s49, 4352
  v_and_b32 v3, 0x300, v2
  v_add3_u32 v1, v3, v2, s55
  v_xor_b32 v3, 256, v1
  s_add_u32 s56, s20, 0
  buffer_load_dwordx4 v[192:195], v1, s[16:19], s56 offen offset:0
  buffer_load_dwordx4 v[196:199], v3, s[16:19], s56 offen offset:0
  buffer_load_dwordx4 v[200:203], v1, s[16:19], s56 offen offset:2048
  buffer_load_dwordx4 v[204:207], v3, s[16:19], s56 offen offset:2048
  s_add_u32 s56, s20, 8192
  buffer_load_dwordx4 v[208:211], v1, s[16:19], s56 offen offset:0
  buffer_load_dwordx4 v[212:215], v3, s[16:19], s56 offen offset:0
  buffer_load_dwordx4 v[216:219], v1, s[16:19], s56 offen offset:2048
  buffer_load_dwordx4 v[220:223], v3, s[16:19], s56 offen offset:2048
  s_add_u32 s56, s20, 16384
  buffer_load_dwordx4 v[48:51], v1, s[16:19], s56 offen offset:0
  buffer_load_dwordx4 v[52:55], v3, s[16:19], s56 offen offset:0
  buffer_load_dwordx4 v[56:59], v1, s[16:19], s56 offen offset:2048
  buffer_load_dwordx4 v[60:63], v3, s[16:19], s56 offen offset:2048
  s_waitcnt vmcnt(0)
  s_branch .Lp3
.Lk1_s0_2:
  buffer_load_dwordx4 v15, s[20:23], s57 offen offset:3072 lds
  s_sub_u32 s55, 0xfffe8000, s63
  v_add_u32 v20, s55, v20
  v_add_u32 v21, s55, v21
  v_add_u32 v22, s55, v22
  v_add_u32 v23, s55, v23
  v_add_u32 v24, 0xffff8000, v24
  v_add_u32 v25, 0xffff8000, v25
  v_add_u32 v26, 0xffff8000, v26
  v_add_u32 v27, 0xffff8000, v27
  s_waitcnt lgkmcnt(0)
  s_waitcnt vmcnt(4)
  s_barrier
  ds_read_b128 v[48:51], v20 offset:0
  ds_read_b64_tr_b16 v[56:57], v24 offset:0
  ds_read_b64_tr_b16 v[58:59], v24 offset:1024
  s_add_u32 m0, s58, 131072
  s_cmp_lt_u32 s2, 160
  s_cselect_b32 s26, s69, 0
  s_mov_b32 s57, 256
  buffer_load_dwordx4 v16, s[24:27], s57 offen offset:0 lds
  ds_read_b128 v[52:55], v20 offset:4096
  ds_read_b64_tr_b16 v[60:61], v25 offset:0
  ds_read_b64_tr_b16 v[62:63], v25 offset:1024
  buffer_load_dwordx4 v17, s[24:27], s57 offen offset:1024 lds
  ds_read_b64_tr_b16 v[64:65], v26 offset:0
  ds_read_b64_tr_b16 v[66:67], v26 offset:1024
  ds_read_b64_tr_b16 v[68:69], v27 offset:0
  ds_read_b64_tr_b16 v[70:71], v27 offset:1024
  buffer_load_dwordx4 v18, s[24:27], s57 offen offset:2048 lds
  buffer_load_dwordx4 v19, s[24:27], s57 offen offset:3072 lds
  s_branch .Lk1_s0_2r
.Lk1_s0_4:
  buffer_load_dwordx4 v15, s[20:23], s57 offen offset:3072 lds
  s_cmp_ge_u32 s2, 200
  s_cbranch_scc1 .Lk1_ro0_1sl
  s_load_dwordx4 s[40:43], s[0:1], 40
  s_sub_u32 s60, s2, 160
  v_and_b32 v2, 15, v0
  v_mul_u32_u24 v2, 1280, v2
  v_lshrrev_b32 v3, 4, v0
  v_lshl_add_u32 v2, v3, 4, v2
  s_lshl_b32 s60, s60, 3
  s_add_u32 s60, s60, s52
  s_mul_i32 s55, s60, 0xcccd
  s_lshr_b32 s55, s55, 21
  s_mul_i32 s56, s55, 40
  s_sub_u32 s56, s60, s56
  s_cmp_ge_u32 s56, 20
  s_waitcnt lgkmcnt(0)
  s_cselect_b32 s44, s42, s40
  s_cselect_b32 s45, s43, s41
  s_cselect_b32 s57, 20, 0
  s_mov_b32 s46, 819200
  s_mov_b32 s47, 0x00020000
  s_sub_u32 s56, s56, s57
  s_lshl_b32 s56, s56, 6
  s_mul_i32 s55, s55, 102400
  s_add_u32 s55, s55, s56
  buffer_load_dwordx4 v[96:99], v2, s[44:47], s55 offen
  s_add_u32 s55, s55, 20480
  buffer_load_dwordx4 v[100:103], v2, s[44:47], s55 offen
  s_add_u32 s55, s55, 20480
  buffer_load_dwordx4 v[104:107], v2, s[44:47], s55 offen
  s_add_u32 s55, s55, 20480
  buffer_load_dwordx4 v[108:111], v2, s[44:47], s55 offen
  s_add_u32 s55, s55, 20480
  buffer_load_dwordx4 v[112:115], v2, s[44:47], s55 offen
.Lk1_ro0_1sl:
  s_sub_u32 s55, 0xfffe8000, s63
  v_add_u32 v20, s55, v20
  v_add_u32 v21, s55, v21
  v_add_u32 v22, s55, v22
  v_add_u32 v23, s55, v23
  v_add_u32 v24, 0xffff8000, v24
  v_add_u32 v25, 0xffff8000, v25
  v_add_u32 v26, 0xffff8000, v26
  v_add_u32 v27, 0xffff8000, v27
  s_waitcnt lgkmcnt(0)
  s_waitcnt vmcnt(4)
  s_barrier
  ds_read_b128 v[48:51], v20 offset:0
  ds_read_b64_tr_b16 v[56:57], v24 offset:0
  ds_read_b64_tr_b16 v[58:59], v24 offset:1024
  s_add_u32 m0, s58, 98304
  s_cmp_lt_u32 s2, 160
  s_cselect_b32 s26, s69, 0
  s_mov_b32 s57, 512
  buffer_load_dwordx4 v16, s[24:27], s57 offen offset:0 lds
  ds_read_b128 v[52:55], v20 offset:4096
  ds_read_b64_tr_b16 v[60:61], v25 offset:0
  ds_read_b64_tr_b16 v[62:63], v25 offset:1024
  buffer_load_dwordx4 v17, s[24:27], s57 offen offset:1024 lds
  ds_read_b64_tr_b16 v[64:65], v26 offset:0
  ds_read_b64_tr_b16 v[66:67], v26 offset:1024
  ds_read_b64_tr_b16 v[68:69], v27 offset:0
  ds_read_b64_tr_b16 v[70:71], v27 offset:1024
  buffer_load_dwordx4 v18, s[24:27], s57 offen offset:2048 lds
  buffer_load_dwordx4 v19, s[24:27], s57 offen offset:3072 lds
  s_branch .Lk1_s0_4r
.Lk1_s0_6:
  buffer_load_dwordx4 v15, s[20:23], s57 offen offset:3072 lds
  s_cmp_ge_u32 s2, 200
  s_cbranch_scc1 .Lk1_ro0_2s
  s_mul_i32 s55, s60, 5120
  s_add_u32 s55, s55, 73400320
  s_add_u32 s56, s55, 4096
  s_waitcnt vmcnt(0)
  buffer_store_dwordx4 v[96:99], v32, s[16:19], s55 offen offset:0 sc1
  buffer_store_dwordx4 v[100:103], v32, s[16:19], s55 offen offset:1024 sc1
  buffer_store_dwordx4 v[104:107], v32, s[16:19], s55 offen offset:2048 sc1
  buffer_store_dwordx4 v[108:111], v32, s[16:19], s55 offen offset:3072 sc1
  buffer_store_dwordx4 v[112:115], v32, s[16:19], s56 offen offset:0 sc1
.Lk1_ro0_2s:
  s_sub_u32 s55, 0x10000, s63
  v_add_u32 v20, s55, v20
  v_add_u32 v21, s55, v21
  v_add_u32 v22, s55, v22
  v_add_u32 v23, s55, v23
  v_add_u32 v24, 0xffff8000, v24
  v_add_u32 v25, 0xffff8000, v25
  v_add_u32 v26, 0xffff8000, v26
  v_add_u32 v27, 0xffff8000, v27
  s_waitcnt lgkmcnt(0)
  s_waitcnt vmcnt(4)
  s_barrier
  ds_read_b128 v[48:51], v20 offset:0
  ds_read_b64_tr_b16 v[56:57], v24 offset:0
  ds_read_b64_tr_b16 v[58:59], v24 offset:1024
  s_add_u32 m0, s58, 65536
  s_mov_b32 s26, s69
  s_mov_b32 s57, 768
  buffer_load_dwordx4 v16, s[24:27], s57 offen offset:0 lds
  ds_read_b128 v[52:55], v20 offset:4096
  ds_read_b64_tr_b16 v[60:61], v25 offset:0
  ds_read_b64_tr_b16 v[62:63], v25 offset:1024
  buffer_load_dwordx4 v17, s[24:27], s57 offen offset:1024 lds
  ds_read_b64_tr_b16 v[64:65], v26 offset:0
  ds_read_b64_tr_b16 v[66:67], v26 offset:1024
  ds_read_b64_tr_b16 v[68:69], v27 offset:0
  ds_read_b64_tr_b16 v[70:71], v27 offset:1024
  buffer_load_dwordx4 v18, s[24:27], s57 offen offset:2048 lds
  buffer_load_dwordx4 v19, s[24:27], s57 offen offset:3072 lds
  s_branch .Lk1_s0_6r
.Lk1_s0_8:
  buffer_load_dwordx4 v15, s[20:23], s57 offen offset:3072 lds
  s_cmp_lt_u32 s2, 176
  s_cbranch_scc1 .Lk1_ro0_3
  v_lshrrev_b32 v2, 5, v0
  v_bfe_u32 v3, v0, 4, 1
  v_lshlrev_b32 v2, 4, v2
  v_lshl_add_u32 v2, v3, 2, v2
  v_bfe_u32 v3, v0, 2, 2
  v_add_u32 v2, v2, v3
  v_lshlrev_b32 v2, 8, v2
  s_lshr_b32 s55, s52, 1
  v_xor_b32 v3, s55, v3
  v_lshl_add_u32 v2, v3, 6, v2
  v_and_b32 v3, 3, v0
  v_lshl_add_u32 v2, v3, 3, v2
  s_and_b32 s55, s52, 1
  s_lshl_b32 s55, s55, 5
  v_add_u32 v2, s55, v2
  v_add_u32 v3, 65536, v2
  v_add_u32 v2, 32768, v2
  ds_read_b64_tr_b16 v[96:97], v2 offset:0
  ds_read_b64_tr_b16 v[98:99], v2 offset:2048
  ds_read_b64_tr_b16 v[100:101], v2 offset:8192
  ds_read_b64_tr_b16 v[102:103], v2 offset:10240
  ds_read_b64_tr_b16 v[104:105], v2 offset:16384
  ds_read_b64_tr_b16 v[106:107], v2 offset:18432
  ds_read_b64_tr_b16 v[108:109], v2 offset:24576
  ds_read_b64_tr_b16 v[110:111], v2 offset:26624
  ds_read_b64_tr_b16 v[112:113], v3 offset:0
  ds_read_b64_tr_b16 v[114:115], v3 offset:2048
  ds_read_b64_tr_b16 v[116:117], v3 offset:8192
  ds_read_b64_tr_b16 v[118:119], v3 offset:10240
  ds_read_b64_tr_b16 v[120:121], v3 offset:16384
  ds_read_b64_tr_b16 v[122:123], v3 offset:18432
  ds_read_b64_tr_b16 v[124:125], v3 offset:24576
  ds_read_b64_tr_b16 v[126:127], v3 offset:26624
  s_lshl_b32 s55, s77, 3
  s_add_u32 s55, s55, s52
  s_mul_i32 s56, s55, 0xcccd
  s_lshr_b32 s56, s56, 18
  s_mul_i32 s57, s56, 5
  s_sub_u32 s57, s55, s57
  s_lshl_b32 s56, s56, 7
  s_lshl_b32 s55, s76, 2
  s_add_u32 s56, s56, s55
  s_mul_i32 s56, s56, 5
  s_add_u32 s56, s56, s57
  s_lshl_b32 s56, s56, 10
  s_add_u32 s56, s56, 67108864
  s_waitcnt lgkmcnt(8)
  buffer_store_dwordx4 v[96:99], v32, s[16:19], s56 offen sc1
  s_add_u32 s56, s56, 5120
  buffer_store_dwordx4 v[100:103], v32, s[16:19], s56 offen sc1
  s_add_u32 s56, s56, 5120
  buffer_store_dwordx4 v[104:107], v32, s[16:19], s56 offen sc1
  s_add_u32 s56, s56, 5120
  buffer_store_dwordx4 v[108:111], v32, s[16:19], s56 offen sc1
  s_lshl_b32 s55, s79, 3
  s_add_u32 s55, s55, s52
  s_mul_i32 s56, s55, 0xcccd
  s_lshr_b32 s56, s56, 18
  s_mul_i32 s57, s56, 5
  s_sub_u32 s57, s55, s57
  s_lshl_b32 s56, s56, 7
  s_lshl_b32 s55, s78, 2
  s_add_u32 s56, s56, s55
  s_mul_i32 s56, s56, 5
  s_add_u32 s56, s56, s57
  s_lshl_b32 s56, s56, 10
  s_add_u32 s56, s56, 67108864
  s_waitcnt lgkmcnt(0)
  buffer_store_dwordx4 v[112:115], v32, s[16:19], s56 offen sc1
  s_add_u32 s56, s56, 5120
  buffer_store_dwordx4 v[116:119], v32, s[16:19], s56 offen sc1
  s_add_u32 s56, s56, 5120
  buffer_store_dwordx4 v[120:123], v32, s[16:19], s56 offen sc1
  s_add_u32 s56, s56, 5120
  buffer_store_dwordx4 v[124:127], v32, s[16:19], s56 offen sc1
.Lk1_ro0_3:
  s_sub_u32 s55, 0x10000, s63
  v_add_u32 v20, s55, v20
  v_add_u32 v21, s55, v21
  v_add_u32 v22, s55, v22
  v_add_u32 v23, s55, v23
  v_add_u32 v24, 0x20000, v24
  v_add_u32 v25, 0x20000, v25
  v_add_u32 v26, 0x20000, v26
  v_add_u32 v27, 0x20000, v27
  s_waitcnt lgkmcnt(0)
  s_waitcnt vmcnt(4)
  s_barrier
  ds_read_b128 v[48:51], v20 offset:0
  ds_read_b64_tr_b16 v[56:57], v24 offset:0
  ds_read_b64_tr_b16 v[58:59], v24 offset:1024
  s_add_u32 m0, s58, 32768
  s_cmp_lt_u32 s2, 160
  s_cselect_b32 s26, s69, 0
  s_mov_b32 s57, 1024
  buffer_load_dwordx4 v16, s[24:27], s57 offen offset:0 lds
  ds_read_b128 v[52:55], v20 offset:4096
  ds_read_b64_tr_b16 v[60:61], v25 offset:0
  ds_read_b64_tr_b16 v[62:63], v25 offset:1024
  buffer_load_dwordx4 v17, s[24:27], s57 offen offset:1024 lds
  ds_read_b64_tr_b16 v[64:65], v26 offset:0
  ds_read_b64_tr_b16 v[66:67], v26 offset:1024
  ds_read_b64_tr_b16 v[68:69], v27 offset:0
  ds_read_b64_tr_b16 v[70:71], v27 offset:1024
  buffer_load_dwordx4 v18, s[24:27], s57 offen offset:2048 lds
  buffer_load_dwordx4 v19, s[24:27], s57 offen offset:3072 lds
  s_branch .Lk1_s0_8r
.Lk1_s0_10:
  buffer_load_dwordx4 v7, s[4:7], s57 offen offset:3072 lds
  s_sub_u32 s55, 0x10000, s63
  v_add_u32 v20, s55, v20
  v_add_u32 v21, s55, v21
  v_add_u32 v22, s55, v22
  v_add_u32 v23, s55, v23
  v_add_u32 v24, 0xffff8000, v24
  v_add_u32 v25, 0xffff8000, v25
  v_add_u32 v26, 0xffff8000, v26
  v_add_u32 v27, 0xffff8000, v27
  s_waitcnt lgkmcnt(0)
  s_waitcnt vmcnt(4)
  s_barrier
  ds_read_b128 v[48:51], v20 offset:0
  ds_read_b64_tr_b16 v[56:57], v24 offset:0
  ds_read_b64_tr_b16 v[58:59], v24 offset:1024
  s_add_u32 m0, s58, 0
  s_mov_b32 s57, 3670016
  buffer_load_dwordx4 v8, s[8:11], s57 offen offset:0 lds
  ds_read_b128 v[52:55], v20 offset:4096
  ds_read_b64_tr_b16 v[60:61], v25 offset:0
  ds_read_b64_tr_b16 v[62:63], v25 offset:1024
  buffer_load_dwordx4 v9, s[8:11], s57 offen offset:1024 lds
  ds_read_b64_tr_b16 v[64:65], v26 offset:0
  ds_read_b64_tr_b16 v[66:67], v26 offset:1024
  ds_read_b64_tr_b16 v[68:69], v27 offset:0
  ds_read_b64_tr_b16 v[70:71], v27 offset:1024
  buffer_load_dwordx4 v10, s[8:11], s57 offen offset:2048 lds
  buffer_load_dwordx4 v11, s[8:11], s57 offen offset:3072 lds
  s_branch .Lk1_s0_10r
.Ldc9s:
  s_sub_u32 s95, s95, 1
  s_cselect_b32 s95, 0, s95
  s_cbranch_scc1 .Ldc9k
  s_sleep 1
  buffer_load_dword v41, v42, s[28:31], 0 offen sc0 sc1
  s_waitcnt vmcnt(0)
  s_branch .Ldc9c
.Lkv10g:
  buffer_store_dwordx4 v[192:195], v32, s[80:83], s55 offen offset:0 sc1
  s_branch .Lkv10r
.Lkv11g:
  buffer_store_dwordx4 v[192:195], v32, s[84:87], s55 offen offset:0 sc1
  s_branch .Lkv11r
.Lkv12g:
  buffer_store_dwordx4 v[196:199], v32, s[80:83], s55 offen offset:1024 sc1
  s_branch .Lkv12r
.Lkv14g:
  buffer_store_dwordx4 v[200:203], v32, s[80:83], s55 offen offset:0 sc1
  s_branch .Lkv14r
.Lkv15g:
  buffer_store_dwordx4 v[204:207], v32, s[80:83], s55 offen offset:1024 sc1
  s_branch .Lkv15r
.Lkv16g:
  buffer_store_dwordx4 v[196:199], v32, s[84:87], s55 offen offset:1024 sc1
  s_branch .Lkv16r
.Lkv17g:
  buffer_store_dwordx4 v[208:211], v32, s[80:83], s55 offen offset:2048 sc1
  s_branch .Lkv17r
.Lkv18g:
  buffer_store_dwordx4 v[212:215], v32, s[80:83], s55 offen offset:3072 sc1
  s_branch .Lkv18r
.Lkv19g:
  buffer_store_dwordx4 v[200:203], v32, s[84:87], s55 offen offset:0 sc1
  s_branch .Lkv19r
.Lkv20g:
  buffer_store_dwordx4 v[216:219], v32, s[80:83], s55 offen offset:2048 sc1
  s_branch .Lkv20r
.Lkv21g:
  buffer_store_dwordx4 v[220:223], v32, s[80:83], s55 offen offset:3072 sc1
  s_branch .Lkv21r
.Lkv22g:
  buffer_store_dwordx4 v[224:227], v32, s[80:83], s55 offen offset:0 sc1
  s_branch .Lkv22r
.Lkv23g:
  buffer_store_dwordx4 v[204:207], v32, s[84:87], s55 offen offset:1024 sc1
  s_branch .Lkv23r
.Lkv24g:
  buffer_store_dwordx4 v[228:231], v32, s[80:83], s55 offen offset:1024 sc1
  s_branch .Lkv24r
.Lkv25g:
  buffer_store_dwordx4 v[232:235], v32, s[80:83], s55 offen offset:0 sc1
  s_branch .Lkv25r
.Lpl26s:
  s_sub_u32 s95, s95, 1
  s_cselect_b32 s95, 0, s95
  s_cbranch_scc1 .Lpl26k
  s_sleep 4
  buffer_load_dword v41, v33, s[36:39], 0 offen sc0 sc1
  s_waitcnt vmcnt(0)
  s_branch .Lpl26c
.Lkv27g:
  buffer_store_dwordx4 v[236:239], v32, s[80:83], s55 offen offset:1024 sc1
  s_branch .Lkv27r
.Lkv28g:
  buffer_store_dwordx4 v[208:211], v32, s[84:87], s55 offen offset:2048 sc1
  s_branch .Lkv28r
.Lkv29g:
  buffer_store_dwordx4 v[240:243], v32, s[80:83], s55 offen offset:2048 sc1
  s_branch .Lkv29r
.Lkv30g:
  buffer_store_dwordx4 v[244:247], v32, s[80:83], s55 offen offset:3072 sc1
  s_branch .Lkv30r
.Lkv31g:
  buffer_store_dwordx4 v[248:251], v32, s[80:83], s55 offen offset:2048 sc1
  s_branch .Lkv31r
.Lkv32g:
  buffer_store_dwordx4 v[212:215], v32, s[84:87], s55 offen offset:3072 sc1
  s_branch .Lkv32r
.Lkv33g:
  buffer_store_dwordx4 v[252:255], v32, s[80:83], s55 offen offset:3072 sc1
  s_branch .Lkv33r
.Lkv34g:
  buffer_store_dwordx4 v[216:219], v32, s[84:87], s55 offen offset:2048 sc1
  s_branch .Lkv34r
.Lkv35g:
  buffer_store_dwordx4 v[220:223], v32, s[84:87], s55 offen offset:3072 sc1
  s_branch .Lkv35r
.Lkv36g:
  buffer_store_dwordx4 v[224:227], v32, s[84:87], s55 offen offset:0 sc1
  s_branch .Lkv36r
.Lkv38g:
  buffer_store_dwordx4 v[228:231], v32, s[84:87], s55 offen offset:1024 sc1
  s_branch .Lkv38r
.Lkv39g:
  buffer_store_dwordx4 v[232:235], v32, s[84:87], s55 offen offset:0 sc1
  s_branch .Lkv39r
.Lkv40g:
  buffer_store_dwordx4 v[236:239], v32, s[84:87], s55 offen offset:1024 sc1
  s_branch .Lkv40r
.Lkv41g:
  buffer_store_dwordx4 v[240:243], v32, s[84:87], s55 offen offset:2048 sc1
  s_branch .Lkv41r
.Lkv42g:
  buffer_store_dwordx4 v[244:247], v32, s[84:87], s55 offen offset:3072 sc1
  s_branch .Lkv42r
.Lkv43g:
  buffer_store_dwordx4 v[248:251], v32, s[84:87], s55 offen offset:2048 sc1
  s_branch .Lkv43r
.Lkv44g:
  buffer_store_dwordx4 v[252:255], v32, s[84:87], s55 offen offset:3072 sc1
  s_branch .Lkv44r
.Lm1:
  s_waitcnt vmcnt(15)
  s_barrier
  ds_read_b128 v[48:51], v20 offset:0
  ds_read_b64_tr_b16 v[56:57], v24 offset:0
  ds_read_b64_tr_b16 v[58:59], v24 offset:1024
  ds_read_b128 v[52:55], v20 offset:4096
  ds_read_b64_tr_b16 v[60:61], v25 offset:0
  ds_read_b64_tr_b16 v[62:63], v25 offset:1024
  ds_read_b64_tr_b16 v[64:65], v26 offset:0
  ds_read_b64_tr_b16 v[66:67], v26 offset:1024
  ds_read_b64_tr_b16 v[68:69], v27 offset:0
  ds_read_b64_tr_b16 v[70:71], v27 offset:1024
  s_waitcnt lgkmcnt(7)
  v_mfma_f32_32x32x16_bf16 v[128:143], v[48:51], v[56:59], 0
  ds_read_b128 v[72:75], v21 offset:0
  s_waitcnt lgkmcnt(7)
  v_mfma_f32_32x32x16_bf16 v[192:207], v[52:55], v[56:59], 0
  ds_read_b64_tr_b16 v[80:81], v24 offset:4096
  ds_read_b64_tr_b16 v[82:83], v24 offset:5120
  s_waitcnt lgkmcnt(7)
  v_mfma_f32_32x32x16_bf16 v[144:159], v[48:51], v[60:63], 0
  ds_read_b128 v[76:79], v21 offset:4096
  v_mfma_f32_32x32x16_bf16 v[208:223], v[52:55], v[60:63], 0
  ds_read_b64_tr_b16 v[84:85], v25 offset:4096
  ds_read_b64_tr_b16 v[86:87], v25 offset:5120
  s_waitcnt lgkmcnt(8)
  v_mfma_f32_32x32x16_bf16 v[160:175], v[48:51], v[64:67], 0
  ds_read_b64_tr_b16 v[88:89], v26 offset:4096
  ds_read_b64_tr_b16 v[90:91], v26 offset:5120
  v_mfma_f32_32x32x16_bf16 v[224:239], v[52:55], v[64:67], 0
  ds_read_b64_tr_b16 v[92:93], v27 offset:4096
  ds_read_b64_tr_b16 v[94:95], v27 offset:5120
  s_waitcnt lgkmcnt(10)
  v_mfma_f32_32x32x16_bf16 v[176:191], v[48:51], v[68:71], 0
  v_mfma_f32_32x32x16_bf16 v[240:255], v[52:55], v[68:71], 0
  s_waitcnt lgkmcnt(7)
  v_mfma_f32_32x32x16_bf16 v[128:143], v[72:75], v[80:83], v[128:143]
  ds_read_b128 v[48:51], v22 offset:0
  s_waitcnt lgkmcnt(7)
  v_mfma_f32_32x32x16_bf16 v[192:207], v[76:79], v[80:83], v[192:207]
  ds_read_b64_tr_b16 v[56:57], v24 offset:8192
  ds_read_b64_tr_b16 v[58:59], v24 offset:9216
  s_waitcnt lgkmcnt(7)
  v_mfma_f32_32x32x16_bf16 v[144:159], v[72:75], v[84:87], v[144:159]
  ds_read_b128 v[52:55], v22 offset:4096
  v_mfma_f32_32x32x16_bf16 v[208:223], v[76:79], v[84:87], v[208:223]
  ds_read_b64_tr_b16 v[60:61], v25 offset:8192
  ds_read_b64_tr_b16 v[62:63], v25 offset:9216
  s_waitcnt lgkmcnt(8)
  v_mfma_f32_32x32x16_bf16 v[160:175], v[72:75], v[88:91], v[160:175]
  ds_read_b64_tr_b16 v[64:65], v26 offset:8192
  ds_read_b64_tr_b16 v[66:67], v26 offset:9216
  v_mfma_f32_32x32x16_bf16 v[224:239], v[76:79], v[88:91], v[224:239]
  ds_read_b64_tr_b16 v[68:69], v27 offset:8192
  ds_read_b64_tr_b16 v[70:71], v27 offset:9216
  s_waitcnt lgkmcnt(10)
  v_mfma_f32_32x32x16_bf16 v[176:191], v[72:75], v[92:95], v[176:191]
  v_mfma_f32_32x32x16_bf16 v[240:255], v[76:79], v[92:95], v[240:255]
  s_waitcnt lgkmcnt(7)
  v_mfma_f32_32x32x16_bf16 v[128:143], v[48:51], v[56:59], v[128:143]
  ds_read_b128 v[72:75], v23 offset:0
  s_waitcnt lgkmcnt(7)
  v_mfma_f32_32x32x16_bf16 v[192:207], v[52:55], v[56:59], v[192:207]
  ds_read_b64_tr_b16 v[80:81], v24 offset:12288
  ds_read_b64_tr_b16 v[82:83], v24 offset:13312
  s_waitcnt lgkmcnt(7)
  v_mfma_f32_32x32x16_bf16 v[144:159], v[48:51], v[60:63], v[144:159]
  ds_read_b128 v[76:79], v23 offset:4096
  v_mfma_f32_32x32x16_bf16 v[208:223], v[52:55], v[60:63], v[208:223]
  ds_read_b64_tr_b16 v[84:85], v25 offset:12288
  ds_read_b64_tr_b16 v[86:87], v25 offset:13312
  s_waitcnt lgkmcnt(8)
  v_mfma_f32_32x32x16_bf16 v[160:175], v[48:51], v[64:67], v[160:175]
  ds_read_b64_tr_b16 v[88:89], v26 offset:12288
  ds_read_b64_tr_b16 v[90:91], v26 offset:13312
  v_mfma_f32_32x32x16_bf16 v[224:239], v[52:55], v[64:67], v[224:239]
  ds_read_b64_tr_b16 v[92:93], v27 offset:12288
  ds_read_b64_tr_b16 v[94:95], v27 offset:13312
  s_waitcnt lgkmcnt(10)
  v_mfma_f32_32x32x16_bf16 v[176:191], v[48:51], v[68:71], v[176:191]
  v_mfma_f32_32x32x16_bf16 v[240:255], v[52:55], v[68:71], v[240:255]
  s_waitcnt lgkmcnt(7)
  v_mfma_f32_32x32x16_bf16 v[128:143], v[72:75], v[80:83], v[128:143]
  s_waitcnt lgkmcnt(6)
  v_mfma_f32_32x32x16_bf16 v[192:207], v[76:79], v[80:83], v[192:207]
  v_add_u32 v20, 0x10000, v20
  v_add_u32 v21, 0x10000, v21
  v_add_u32 v22, 0x10000, v22
  v_add_u32 v23, 0x10000, v23
  v_add_u32 v24, 0x10000, v24
  v_add_u32 v25, 0x10000, v25
  v_add_u32 v26, 0x10000, v26
  v_add_u32 v27, 0x10000, v27
  s_waitcnt lgkmcnt(0)
  s_waitcnt vmcnt(4)
  s_barrier
  ds_read_b128 v[48:51], v20 offset:0
  s_add_u32 m0, s58, 16384
  s_cmp_lt_u32 s2, 160
  s_cselect_b32 s26, s69, 0
  s_add_u32 s57, s75, 0
  buffer_load_dwordx4 v16, s[24:27], s57 offen offset:0 lds
  v_mfma_f32_32x32x16_bf16 v[144:159], v[72:75], v[84:87], v[144:159]
  ds_read_b64_tr_b16 v[56:57], v24 offset:0
  ds_read_b64_tr_b16 v[58:59], v24 offset:1024
  buffer_load_dwordx4 v17, s[24:27], s57 offen offset:1024 lds
  v_mfma_f32_32x32x16_bf16 v[208:223], v[76:79], v[84:87], v[208:223]
  ds_read_b128 v[52:55], v20 offset:4096
  buffer_load_dwordx4 v18, s[24:27], s57 offen offset:2048 lds
  v_mfma_f32_32x32x16_bf16 v[160:175], v[72:75], v[88:91], v[160:175]
  ds_read_b64_tr_b16 v[60:61], v25 offset:0
  ds_read_b64_tr_b16 v[62:63], v25 offset:1024
  buffer_load_dwordx4 v19, s[24:27], s57 offen offset:3072 lds
  v_mfma_f32_32x32x16_bf16 v[224:239], v[76:79], v[88:91], v[224:239]
  ds_read_b64_tr_b16 v[64:65], v26 offset:0
  ds_read_b64_tr_b16 v[66:67], v26 offset:1024
  s_add_u32 m0, s58, 49152
  s_mov_b32 s57, 131328
  buffer_load_dwordx4 v4, s[4:7], s57 offen offset:0 lds
  v_mfma_f32_32x32x16_bf16 v[176:191], v[72:75], v[92:95], v[176:191]
  ds_read_b64_tr_b16 v[68:69], v27 offset:0
  ds_read_b64_tr_b16 v[70:71], v27 offset:1024
  v_mfma_f32_32x32x16_bf16 v[240:255], v[76:79], v[92:95], v[240:255]
  s_waitcnt lgkmcnt(7)
  v_mfma_f32_32x32x16_bf16 v[128:143], v[48:51], v[56:59], v[128:143]
  ds_read_b128 v[72:75], v21 offset:0
  buffer_load_dwordx4 v5, s[4:7], s57 offen offset:1024 lds
  s_waitcnt lgkmcnt(7)
  v_mfma_f32_32x32x16_bf16 v[192:207], v[52:55], v[56:59], v[192:207]
  ds_read_b64_tr_b16 v[80:81], v24 offset:4096
  ds_read_b64_tr_b16 v[82:83], v24 offset:5120
  s_waitcnt lgkmcnt(7)
  v_mfma_f32_32x32x16_bf16 v[144:159], v[48:51], v[60:63], v[144:159]
  ds_read_b128 v[76:79], v21 offset:4096
  v_mfma_f32_32x32x16_bf16 v[208:223], v[52:55], v[60:63], v[208:223]
  ds_read_b64_tr_b16 v[84:85], v25 offset:4096
  ds_read_b64_tr_b16 v[86:87], v25 offset:5120
  buffer_load_dwordx4 v6, s[4:7], s57 offen offset:2048 lds
  s_waitcnt lgkmcnt(8)
  v_mfma_f32_32x32x16_bf16 v[160:175], v[48:51], v[64:67], v[160:175]
  ds_read_b64_tr_b16 v[88:89], v26 offset:4096
  ds_read_b64_tr_b16 v[90:91], v26 offset:5120
  v_mfma_f32_32x32x16_bf16 v[224:239], v[52:55], v[64:67], v[224:239]
  ds_read_b64_tr_b16 v[92:93], v27 offset:4096
  ds_read_b64_tr_b16 v[94:95], v27 offset:5120
  s_waitcnt lgkmcnt(10)
  v_mfma_f32_32x32x16_bf16 v[176:191], v[48:51], v[68:71], v[176:191]
  buffer_load_dwordx4 v7, s[4:7], s57 offen offset:3072 lds
  v_mfma_f32_32x32x16_bf16 v[240:255], v[52:55], v[68:71], v[240:255]
  s_waitcnt lgkmcnt(7)
  v_mfma_f32_32x32x16_bf16 v[128:143], v[72:75], v[80:83], v[128:143]
  ds_read_b128 v[48:51], v22 offset:0
  s_waitcnt lgkmcnt(7)
  v_mfma_f32_32x32x16_bf16 v[192:207], v[76:79], v[80:83], v[192:207]
  ds_read_b64_tr_b16 v[56:57], v24 offset:8192
  ds_read_b64_tr_b16 v[58:59], v24 offset:9216
  s_waitcnt lgkmcnt(7)
  v_mfma_f32_32x32x16_bf16 v[144:159], v[72:75], v[84:87], v[144:159]
  ds_read_b128 v[52:55], v22 offset:4096
  v_mfma_f32_32x32x16_bf16 v[208:223], v[76:79], v[84:87], v[208:223]
  ds_read_b64_tr_b16 v[60:61], v25 offset:8192
  ds_read_b64_tr_b16 v[62:63], v25 offset:9216
  s_waitcnt lgkmcnt(8)
  v_mfma_f32_32x32x16_bf16 v[160:175], v[72:75], v[88:91], v[160:175]
  ds_read_b64_tr_b16 v[64:65], v26 offset:8192
  ds_read_b64_tr_b16 v[66:67], v26 offset:9216
  v_mfma_f32_32x32x16_bf16 v[224:239], v[76:79], v[88:91], v[224:239]
  ds_read_b64_tr_b16 v[68:69], v27 offset:8192
  ds_read_b64_tr_b16 v[70:71], v27 offset:9216
  s_waitcnt lgkmcnt(10)
  v_mfma_f32_32x32x16_bf16 v[176:191], v[72:75], v[92:95], v[176:191]
  v_mfma_f32_32x32x16_bf16 v[240:255], v[76:79], v[92:95], v[240:255]
  s_waitcnt lgkmcnt(7)
  v_mfma_f32_32x32x16_bf16 v[128:143], v[48:51], v[56:59], v[128:143]
  ds_read_b128 v[72:75], v23 offset:0
  s_waitcnt lgkmcnt(7)
  v_mfma_f32_32x32x16_bf16 v[192:207], v[52:55], v[56:59], v[192:207]
  ds_read_b64_tr_b16 v[80:81], v24 offset:12288
  ds_read_b64_tr_b16 v[82:83], v24 offset:13312
  s_waitcnt lgkmcnt(7)
  v_mfma_f32_32x32x16_bf16 v[144:159], v[48:51], v[60:63], v[144:159]
  ds_read_b128 v[76:79], v23 offset:4096
  v_mfma_f32_32x32x16_bf16 v[208:223], v[52:55], v[60:63], v[208:223]
  ds_read_b64_tr_b16 v[84:85], v25 offset:12288
  ds_read_b64_tr_b16 v[86:87], v25 offset:13312
  s_waitcnt lgkmcnt(8)
  v_mfma_f32_32x32x16_bf16 v[160:175], v[48:51], v[64:67], v[160:175]
  ds_read_b64_tr_b16 v[88:89], v26 offset:12288
  ds_read_b64_tr_b16 v[90:91], v26 offset:13312
  v_mfma_f32_32x32x16_bf16 v[224:239], v[52:55], v[64:67], v[224:239]
  ds_read_b64_tr_b16 v[92:93], v27 offset:12288
  ds_read_b64_tr_b16 v[94:95], v27 offset:13312
  s_waitcnt lgkmcnt(10)
  v_mfma_f32_32x32x16_bf16 v[176:191], v[48:51], v[68:71], v[176:191]
  v_mfma_f32_32x32x16_bf16 v[240:255], v[52:55], v[68:71], v[240:255]
  s_waitcnt lgkmcnt(7)
  v_mfma_f32_32x32x16_bf16 v[128:143], v[72:75], v[80:83], v[128:143]
  s_waitcnt lgkmcnt(6)
  v_mfma_f32_32x32x16_bf16 v[192:207], v[76:79], v[80:83], v[192:207]
  s_add_u32 s55, s63, 0x10000
  v_add_u32 v20, s55, v20
  v_add_u32 v21, s55, v21
  v_add_u32 v22, s55, v22
  v_add_u32 v23, s55, v23
  s_add_u32 s55, s72, 0xfffe0000
  v_add_u32 v28, s55, v20
  v_add_u32 v29, s55, v21
  v_add_u32 v30, s55, v22
  v_add_u32 v31, s55, v23
  s_waitcnt lgkmcnt(0)
  s_waitcnt vmcnt(4)
  s_barrier
  s_and_b32 s55, s100, 0x7f
  s_or_b32 s55, s55, 0x80
  s_movk_i32 s56, 255
  s_cmp_lg_u32 s101, 2047
  s_cbranch_scc1 .Lfs51
  v_mov_b32 v41, s55
  s_mov_b64 exec, 1
  buffer_store_byte v41, off, s[28:31], s56 sc0 sc1
  s_mov_b64 exec, -1
.Lfs51:
  ds_read_b128 v[48:51], v20 offset:0
  s_add_u32 m0, s58, 81920
  s_mov_b32 s57, 1048576
  buffer_load_dwordx4 v8, s[12:15], s57 offen offset:0 lds
  v_mfma_f32_32x32x16_bf16 v[144:159], v[72:75], v[84:87], v[144:159]
  ds_read_b128 v[52:55], v28 offset:0
  buffer_load_dwordx4 v9, s[12:15], s57 offen offset:1024 lds
  v_mfma_f32_32x32x16_bf16 v[208:223], v[76:79], v[84:87], v[208:223]
  ds_read_b128 v[56:59], v28 offset:8192
  buffer_load_dwordx4 v10, s[12:15], s57 offen offset:2048 lds
  v_mfma_f32_32x32x16_bf16 v[160:175], v[72:75], v[88:91], v[160:175]
  ds_read_b128 v[60:63], v21 offset:0
  buffer_load_dwordx4 v11, s[12:15], s57 offen offset:3072 lds
  v_mfma_f32_32x32x16_bf16 v[224:239], v[76:79], v[88:91], v[224:239]
  ds_read_b128 v[64:67], v29 offset:0
  s_add_u32 m0, s58, 114688
  s_cmp_lt_u32 s2, 160
  s_cselect_b32 s22, s68, 0
  s_add_u32 s57, s75, 256
  buffer_load_dwordx4 v12, s[20:23], s57 offen offset:0 lds
  v_mfma_f32_32x32x16_bf16 v[176:191], v[72:75], v[92:95], v[176:191]
  ds_read_b128 v[68:71], v29 offset:8192
  s_cmp_lg_u32 s73, 1
  s_cbranch_scc1 .Lk1t52
  v_lshrrev_b32 v3, 3, v0
  v_lshlrev_b32 v3, 6, v3
  v_and_or_b32 v3, v0, 7, v3
  v_lshlrev_b32 v3, 7, v3
  s_and_b32 s55, s2, 7
  s_lshl_b32 s55, s55, 10
  v_add_u32 v3, s55, v3
  s_lshr_b32 s56, s2, 3
  s_mov_b32 s88, s8
  s_mov_b32 s89, s9
  s_mov_b32 s90, 4194304
  s_mov_b32 s55, 32
  s_cmp_ge_u32 s56, 16
  s_cselect_b32 s88, s12, s88
  s_cselect_b32 s89, s13, s89
  s_cselect_b32 s90, 4194304, s90
  s_cselect_b32 s55, 16, s55
  s_mov_b32 s91, 0x00020000
  s_add_u32 s55, s55, s56
  s_lshl_b32 s55, s55, 16
  v_add_u32 v3, s55, v3
  buffer_load_dword v43, v3, s[88:91], 0 offen
.Lk1t52:
  buffer_load_dwordx4 v13, s[20:23], s57 offen offset:1024 lds
  v_mfma_f32_32x32x16_bf16 v[240:255], v[76:79], v[92:95], v[240:255]
  buffer_load_dwordx4 v14, s[20:23], s57 offen offset:2048 lds
  s_cmp_ge_u32 s2, 160
  s_cbranch_scc1 .Lk1_s1_2
  s_waitcnt lgkmcnt(4)
  v_mfma_f32_32x32x16_bf16 v[96:111], v[48:51], v[52:55], 0
  ds_read_b128 v[72:75], v22 offset:0
  ds_read_b128 v[76:79], v30 offset:0
  buffer_load_dwordx4 v15, s[20:23], s57 offen offset:3072 lds
  s_waitcnt lgkmcnt(5)
  v_mfma_f32_32x32x16_bf16 v[112:127], v[48:51], v[56:59], 0
  ds_read_b128 v[80:83], v30 offset:8192
  s_waitcnt lgkmcnt(4)
  v_mfma_f32_32x32x16_bf16 v[96:111], v[60:63], v[64:67], v[96:111]
  ds_read_b128 v[84:87], v23 offset:0
  ds_read_b128 v[88:91], v31 offset:0
  s_waitcnt lgkmcnt(5)
  v_mfma_f32_32x32x16_bf16 v[112:127], v[60:63], v[68:71], v[112:127]
  ds_read_b128 v[92:95], v31 offset:8192
  s_waitcnt lgkmcnt(4)
  v_mfma_f32_32x32x16_bf16 v[96:111], v[72:75], v[76:79], v[96:111]
  ds_read_b128 v[48:51], v20 offset:16384
  ds_read_b128 v[52:55], v28 offset:16384
  s_waitcnt lgkmcnt(5)
  v_mfma_f32_32x32x16_bf16 v[112:127], v[72:75], v[80:83], v[112:127]
  ds_read_b128 v[56:59], v28 offset:24576
  s_waitcnt lgkmcnt(4)
  v_mfma_f32_32x32x16_bf16 v[96:111], v[84:87], v[88:91], v[96:111]
  ds_read_b128 v[60:63], v21 offset:16384
  ds_read_b128 v[64:67], v29 offset:16384
  s_waitcnt lgkmcnt(5)
  v_mfma_f32_32x32x16_bf16 v[112:127], v[84:87], v[92:95], v[112:127]
  ds_read_b128 v[68:71], v29 offset:24576
  s_waitcnt lgkmcnt(4)
  v_mfma_f32_32x32x16_bf16 v[96:111], v[48:51], v[52:55], v[96:111]
  ds_read_b128 v[72:75], v22 offset:16384
  ds_read_b128 v[76:79], v30 offset:16384
  s_waitcnt lgkmcnt(5)
  v_mfma_f32_32x32x16_bf16 v[112:127], v[48:51], v[56:59], v[112:127]
  ds_read_b128 v[80:83], v30 offset:24576
  s_waitcnt lgkmcnt(4)
  v_mfma_f32_32x32x16_bf16 v[96:111], v[60:63], v[64:67], v[96:111]
  ds_read_b128 v[84:87], v23 offset:16384
  ds_read_b128 v[88:91], v31 offset:16384
  s_waitcnt lgkmcnt(5)
  v_mfma_f32_32x32x16_bf16 v[112:127], v[60:63], v[68:71], v[112:127]
  ds_read_b128 v[92:95], v31 offset:24576
  s_waitcnt lgkmcnt(4)
  v_mfma_f32_32x32x16_bf16 v[96:111], v[72:75], v[76:79], v[96:111]
  s_sub_u32 s55, 0xfffe8000, s63
  v_add_u32 v20, s55, v20
  v_add_u32 v21, s55, v21
  v_add_u32 v22, s55, v22
  v_add_u32 v23, s55, v23
  v_add_u32 v24, 0xffff8000, v24
  v_add_u32 v25, 0xffff8000, v25
  v_add_u32 v26, 0xffff8000, v26
  v_add_u32 v27, 0xffff8000, v27
  s_waitcnt lgkmcnt(0)
  s_waitcnt vmcnt(4)
  s_barrier
  ds_read_b128 v[48:51], v20 offset:0
  ds_read_b64_tr_b16 v[56:57], v24 offset:0
  ds_read_b64_tr_b16 v[58:59], v24 offset:1024
  s_add_u32 m0, s58, 147456
  s_cmp_lt_u32 s2, 160
  s_cselect_b32 s26, s69, 0
  s_add_u32 s57, s75, 256
  buffer_load_dwordx4 v16, s[24:27], s57 offen offset:0 lds
  v_mfma_f32_32x32x16_bf16 v[112:127], v[72:75], v[80:83], v[112:127]
  ds_read_b128 v[52:55], v20 offset:4096
  ds_read_b64_tr_b16 v[60:61], v25 offset:0
  ds_read_b64_tr_b16 v[62:63], v25 offset:1024
  buffer_load_dwordx4 v17, s[24:27], s57 offen offset:1024 lds
  v_mfma_f32_32x32x16_bf16 v[96:111], v[84:87], v[88:91], v[96:111]
  ds_read_b64_tr_b16 v[64:65], v26 offset:0
  ds_read_b64_tr_b16 v[66:67], v26 offset:1024
  ds_read_b64_tr_b16 v[68:69], v27 offset:0
  ds_read_b64_tr_b16 v[70:71], v27 offset:1024
  buffer_load_dwordx4 v18, s[24:27], s57 offen offset:2048 lds
  v_mfma_f32_32x32x16_bf16 v[112:127], v[84:87], v[92:95], v[112:127]
  buffer_load_dwordx4 v19, s[24:27], s57 offen offset:3072 lds
.Lk1_s1_2r:
  s_waitcnt lgkmcnt(7)
  v_mfma_f32_32x32x16_bf16 v[128:143], v[48:51], v[56:59], v[128:143]
  ds_read_b128 v[72:75], v21 offset:0
  s_add_u32 m0, s58, 16384
  s_mov_b32 s57, 131456
  buffer_load_dwordx4 v4, s[4:7], s57 offen offset:0 lds
  s_waitcnt lgkmcnt(7)
  v_mfma_f32_32x32x16_bf16 v[192:207], v[52:55], v[56:59], v[192:207]
  ds_read_b64_tr_b16 v[80:81], v24 offset:4096
  ds_read_b64_tr_b16 v[82:83], v24 offset:5120
  s_waitcnt lgkmcnt(7)
  v_mfma_f32_32x32x16_bf16 v[144:159], v[48:51], v[60:63], v[144:159]
  ds_read_b128 v[76:79], v21 offset:4096
  v_mfma_f32_32x32x16_bf16 v[208:223], v[52:55], v[60:63], v[208:223]
  ds_read_b64_tr_b16 v[84:85], v25 offset:4096
  ds_read_b64_tr_b16 v[86:87], v25 offset:5120
  buffer_load_dwordx4 v5, s[4:7], s57 offen offset:1024 lds
  s_waitcnt lgkmcnt(8)
  v_mfma_f32_32x32x16_bf16 v[160:175], v[48:51], v[64:67], v[160:175]
  ds_read_b64_tr_b16 v[88:89], v26 offset:4096
  ds_read_b64_tr_b16 v[90:91], v26 offset:5120
  v_mfma_f32_32x32x16_bf16 v[224:239], v[52:55], v[64:67], v[224:239]
  ds_read_b64_tr_b16 v[92:93], v27 offset:4096
  ds_read_b64_tr_b16 v[94:95], v27 offset:5120
  s_waitcnt lgkmcnt(10)
  v_mfma_f32_32x32x16_bf16 v[176:191], v[48:51], v[68:71], v[176:191]
  buffer_load_dwordx4 v6, s[4:7], s57 offen offset:2048 lds
  v_mfma_f32_32x32x16_bf16 v[240:255], v[52:55], v[68:71], v[240:255]
  s_waitcnt lgkmcnt(7)
  v_mfma_f32_32x32x16_bf16 v[128:143], v[72:75], v[80:83], v[128:143]
  ds_read_b128 v[48:51], v22 offset:0
  s_cmp_lg_u32 s73, 2
  s_cbranch_scc1 .Lk1t53
  v_lshrrev_b32 v3, 3, v0
  v_lshlrev_b32 v3, 6, v3
  v_and_or_b32 v3, v0, 7, v3
  v_lshlrev_b32 v3, 7, v3
  s_and_b32 s55, s2, 7
  s_lshl_b32 s55, s55, 10
  v_add_u32 v3, s55, v3
  s_lshr_b32 s56, s2, 3
  s_mov_b32 s88, s8
  s_mov_b32 s89, s9
  s_mov_b32 s90, 4194304
  s_mov_b32 s55, 48
  s_cmp_ge_u32 s56, 16
  s_cselect_b32 s88, s12, s88
  s_cselect_b32 s89, s13, s89
  s_cselect_b32 s90, 4194304, s90
  s_cselect_b32 s55, 32, s55
  s_mov_b32 s91, 0x00020000
  s_add_u32 s55, s55, s56
  s_lshl_b32 s55, s55, 16
  v_add_u32 v3, s55, v3
  buffer_load_dword v43, v3, s[88:91], 0 offen
.Lk1t53:
  s_waitcnt lgkmcnt(7)
  v_mfma_f32_32x32x16_bf16 v[192:207], v[76:79], v[80:83], v[192:207]
  ds_read_b64_tr_b16 v[56:57], v24 offset:8192
  ds_read_b64_tr_b16 v[58:59], v24 offset:9216
  buffer_load_dwordx4 v7, s[4:7], s57 offen offset:3072 lds
  s_waitcnt lgkmcnt(7)
  v_mfma_f32_32x32x16_bf16 v[144:159], v[72:75], v[84:87], v[144:159]
  ds_read_b128 v[52:55], v22 offset:4096
  v_mfma_f32_32x32x16_bf16 v[208:223], v[76:79], v[84:87], v[208:223]
  ds_read_b64_tr_b16 v[60:61], v25 offset:8192
  ds_read_b64_tr_b16 v[62:63], v25 offset:9216
  s_waitcnt lgkmcnt(8)
  v_mfma_f32_32x32x16_bf16 v[160:175], v[72:75], v[88:91], v[160:175]
  ds_read_b64_tr_b16 v[64:65], v26 offset:8192
  ds_read_b64_tr_b16 v[66:67], v26 offset:9216
  v_mfma_f32_32x32x16_bf16 v[224:239], v[76:79], v[88:91], v[224:239]
  ds_read_b64_tr_b16 v[68:69], v27 offset:8192
  ds_read_b64_tr_b16 v[70:71], v27 offset:9216
  s_waitcnt lgkmcnt(10)
  v_mfma_f32_32x32x16_bf16 v[176:191], v[72:75], v[92:95], v[176:191]
  v_mfma_f32_32x32x16_bf16 v[240:255], v[76:79], v[92:95], v[240:255]
  s_waitcnt lgkmcnt(7)
  v_mfma_f32_32x32x16_bf16 v[128:143], v[48:51], v[56:59], v[128:143]
  ds_read_b128 v[72:75], v23 offset:0
  s_waitcnt lgkmcnt(7)
  v_mfma_f32_32x32x16_bf16 v[192:207], v[52:55], v[56:59], v[192:207]
  ds_read_b64_tr_b16 v[80:81], v24 offset:12288
  ds_read_b64_tr_b16 v[82:83], v24 offset:13312
  s_waitcnt lgkmcnt(7)
  v_mfma_f32_32x32x16_bf16 v[144:159], v[48:51], v[60:63], v[144:159]
  ds_read_b128 v[76:79], v23 offset:4096
  v_mfma_f32_32x32x16_bf16 v[208:223], v[52:55], v[60:63], v[208:223]
  ds_read_b64_tr_b16 v[84:85], v25 offset:12288
  ds_read_b64_tr_b16 v[86:87], v25 offset:13312
  s_waitcnt lgkmcnt(8)
  v_mfma_f32_32x32x16_bf16 v[160:175], v[48:51], v[64:67], v[160:175]
  ds_read_b64_tr_b16 v[88:89], v26 offset:12288
  ds_read_b64_tr_b16 v[90:91], v26 offset:13312
  v_mfma_f32_32x32x16_bf16 v[224:239], v[52:55], v[64:67], v[224:239]
  ds_read_b64_tr_b16 v[92:93], v27 offset:12288
  ds_read_b64_tr_b16 v[94:95], v27 offset:13312
  s_waitcnt lgkmcnt(10)
  v_mfma_f32_32x32x16_bf16 v[176:191], v[48:51], v[68:71], v[176:191]
  v_mfma_f32_32x32x16_bf16 v[240:255], v[52:55], v[68:71], v[240:255]
  s_waitcnt lgkmcnt(7)
  v_mfma_f32_32x32x16_bf16 v[128:143], v[72:75], v[80:83], v[128:143]
  s_waitcnt lgkmcnt(6)
  v_mfma_f32_32x32x16_bf16 v[192:207], v[76:79], v[80:83], v[192:207]
  s_add_u32 s55, s63, 0x10000
  v_add_u32 v20, s55, v20
  v_add_u32 v21, s55, v21
  v_add_u32 v22, s55, v22
  v_add_u32 v23, s55, v23
  s_add_u32 s55, s72, 0x8000
  v_add_u32 v28, s55, v20
  v_add_u32 v29, s55, v21
  v_add_u32 v30, s55, v22
  v_add_u32 v31, s55, v23
  s_waitcnt lgkmcnt(0)
  s_waitcnt vmcnt(4)
  s_barrier
  ds_read_b128 v[48:51], v20 offset:0
  s_add_u32 m0, s58, 49152
  s_mov_b32 s57, 1572864
  buffer_load_dwordx4 v8, s[12:15], s57 offen offset:0 lds
  v_mfma_f32_32x32x16_bf16 v[144:159], v[72:75], v[84:87], v[144:159]
  ds_read_b128 v[52:55], v28 offset:0
  buffer_load_dwordx4 v9, s[12:15], s57 offen offset:1024 lds
  v_mfma_f32_32x32x16_bf16 v[208:223], v[76:79], v[84:87], v[208:223]
  ds_read_b128 v[56:59], v28 offset:8192
  buffer_load_dwordx4 v10, s[12:15], s57 offen offset:2048 lds
  v_mfma_f32_32x32x16_bf16 v[160:175], v[72:75], v[88:91], v[160:175]
  ds_read_b128 v[60:63], v21 offset:0
  buffer_load_dwordx4 v11, s[12:15], s57 offen offset:3072 lds
  v_mfma_f32_32x32x16_bf16 v[224:239], v[76:79], v[88:91], v[224:239]
  ds_read_b128 v[64:67], v29 offset:0
  s_add_u32 m0, s58, 81920
  s_cmp_lt_u32 s2, 160
  s_cselect_b32 s22, s68, 0
  s_add_u32 s57, s75, 512
  buffer_load_dwordx4 v12, s[20:23], s57 offen offset:0 lds
  v_mfma_f32_32x32x16_bf16 v[176:191], v[72:75], v[92:95], v[176:191]
  ds_read_b128 v[68:71], v29 offset:8192
  buffer_load_dwordx4 v13, s[20:23], s57 offen offset:1024 lds
  v_mfma_f32_32x32x16_bf16 v[240:255], v[76:79], v[92:95], v[240:255]
  buffer_load_dwordx4 v14, s[20:23], s57 offen offset:2048 lds
  s_cmp_ge_u32 s2, 160
  s_cbranch_scc1 .Lk1_s1_4
  s_waitcnt lgkmcnt(4)
  v_mfma_f32_32x32x16_bf16 v[96:111], v[48:51], v[52:55], v[96:111]
  ds_read_b128 v[72:75], v22 offset:0
  ds_read_b128 v[76:79], v30 offset:0
  buffer_load_dwordx4 v15, s[20:23], s57 offen offset:3072 lds
  s_waitcnt lgkmcnt(5)
  v_mfma_f32_32x32x16_bf16 v[112:127], v[48:51], v[56:59], v[112:127]
  ds_read_b128 v[80:83], v30 offset:8192
  s_waitcnt lgkmcnt(4)
  v_mfma_f32_32x32x16_bf16 v[96:111], v[60:63], v[64:67], v[96:111]
  ds_read_b128 v[84:87], v23 offset:0
  ds_read_b128 v[88:91], v31 offset:0
  s_waitcnt lgkmcnt(5)
  v_mfma_f32_32x32x16_bf16 v[112:127], v[60:63], v[68:71], v[112:127]
  ds_read_b128 v[92:95], v31 offset:8192
  s_waitcnt lgkmcnt(4)
  v_mfma_f32_32x32x16_bf16 v[96:111], v[72:75], v[76:79], v[96:111]
  ds_read_b128 v[48:51], v20 offset:16384
  ds_read_b128 v[52:55], v28 offset:16384
  s_waitcnt lgkmcnt(5)
  v_mfma_f32_32x32x16_bf16 v[112:127], v[72:75], v[80:83], v[112:127]
  ds_read_b128 v[56:59], v28 offset:24576
  s_waitcnt lgkmcnt(4)
  v_mfma_f32_32x32x16_bf16 v[96:111], v[84:87], v[88:91], v[96:111]
  ds_read_b128 v[60:63], v21 offset:16384
  ds_read_b128 v[64:67], v29 offset:16384
  s_waitcnt lgkmcnt(5)
  v_mfma_f32_32x32x16_bf16 v[112:127], v[84:87], v[92:95], v[112:127]
  ds_read_b128 v[68:71], v29 offset:24576
  s_waitcnt lgkmcnt(4)
  v_mfma_f32_32x32x16_bf16 v[96:111], v[48:51], v[52:55], v[96:111]
  ds_read_b128 v[72:75], v22 offset:16384
  ds_read_b128 v[76:79], v30 offset:16384
  s_waitcnt lgkmcnt(5)
  v_mfma_f32_32x32x16_bf16 v[112:127], v[48:51], v[56:59], v[112:127]
  ds_read_b128 v[80:83], v30 offset:24576
  s_waitcnt lgkmcnt(4)
  v_mfma_f32_32x32x16_bf16 v[96:111], v[60:63], v[64:67], v[96:111]
  ds_read_b128 v[84:87], v23 offset:16384
  ds_read_b128 v[88:91], v31 offset:16384
  s_waitcnt lgkmcnt(5)
  v_mfma_f32_32x32x16_bf16 v[112:127], v[60:63], v[68:71], v[112:127]
  ds_read_b128 v[92:95], v31 offset:24576
  s_waitcnt lgkmcnt(4)
  v_mfma_f32_32x32x16_bf16 v[96:111], v[72:75], v[76:79], v[96:111]
  s_sub_u32 s55, 0xfffe8000, s63
  v_add_u32 v20, s55, v20
  v_add_u32 v21, s55, v21
  v_add_u32 v22, s55, v22
  v_add_u32 v23, s55, v23
  v_add_u32 v24, 0xffff8000, v24
  v_add_u32 v25, 0xffff8000, v25
  v_add_u32 v26, 0xffff8000, v26
  v_add_u32 v27, 0xffff8000, v27
  s_waitcnt lgkmcnt(0)
  s_waitcnt vmcnt(4)
  s_barrier
  ds_read_b128 v[48:51], v20 offset:0
  ds_read_b64_tr_b16 v[56:57], v24 offset:0
  ds_read_b64_tr_b16 v[58:59], v24 offset:1024
  s_add_u32 m0, s58, 114688
  s_cmp_lt_u32 s2, 160
  s_cselect_b32 s26, s69, 0
  s_add_u32 s57, s75, 512
  buffer_load_dwordx4 v16, s[24:27], s57 offen offset:0 lds
  v_mfma_f32_32x32x16_bf16 v[112:127], v[72:75], v[80:83], v[112:127]
  ds_read_b128 v[52:55], v20 offset:4096
  ds_read_b64_tr_b16 v[60:61], v25 offset:0
  ds_read_b64_tr_b16 v[62:63], v25 offset:1024
  buffer_load_dwordx4 v17, s[24:27], s57 offen offset:1024 lds
  v_mfma_f32_32x32x16_bf16 v[96:111], v[84:87], v[88:91], v[96:111]
  ds_read_b64_tr_b16 v[64:65], v26 offset:0
  ds_read_b64_tr_b16 v[66:67], v26 offset:1024
  ds_read_b64_tr_b16 v[68:69], v27 offset:0
  ds_read_b64_tr_b16 v[70:71], v27 offset:1024
  buffer_load_dwordx4 v18, s[24:27], s57 offen offset:2048 lds
  v_mfma_f32_32x32x16_bf16 v[112:127], v[84:87], v[92:95], v[112:127]
  buffer_load_dwordx4 v19, s[24:27], s57 offen offset:3072 lds
.Lk1_s1_4r:
  s_waitcnt lgkmcnt(7)
  v_mfma_f32_32x32x16_bf16 v[128:143], v[48:51], v[56:59], v[128:143]
  ds_read_b128 v[72:75], v21 offset:0
  s_add_u32 m0, s58, 147456
  s_mov_b32 s57, 131584
  buffer_load_dwordx4 v4, s[4:7], s57 offen offset:0 lds
  s_waitcnt lgkmcnt(7)
  v_mfma_f32_32x32x16_bf16 v[192:207], v[52:55], v[56:59], v[192:207]
  ds_read_b64_tr_b16 v[80:81], v24 offset:4096
  ds_read_b64_tr_b16 v[82:83], v24 offset:5120
  s_waitcnt lgkmcnt(7)
  v_mfma_f32_32x32x16_bf16 v[144:159], v[48:51], v[60:63], v[144:159]
  ds_read_b128 v[76:79], v21 offset:4096
  v_mfma_f32_32x32x16_bf16 v[208:223], v[52:55], v[60:63], v[208:223]
  ds_read_b64_tr_b16 v[84:85], v25 offset:4096
  ds_read_b64_tr_b16 v[86:87], v25 offset:5120
  buffer_load_dwordx4 v5, s[4:7], s57 offen offset:1024 lds
  s_waitcnt lgkmcnt(8)
  v_mfma_f32_32x32x16_bf16 v[160:175], v[48:51], v[64:67], v[160:175]
  ds_read_b64_tr_b16 v[88:89], v26 offset:4096
  ds_read_b64_tr_b16 v[90:91], v26 offset:5120
  v_mfma_f32_32x32x16_bf16 v[224:239], v[52:55], v[64:67], v[224:239]
  ds_read_b64_tr_b16 v[92:93], v27 offset:4096
  ds_read_b64_tr_b16 v[94:95], v27 offset:5120
  s_waitcnt lgkmcnt(10)
  v_mfma_f32_32x32x16_bf16 v[176:191], v[48:51], v[68:71], v[176:191]
  buffer_load_dwordx4 v6, s[4:7], s57 offen offset:2048 lds
  v_mfma_f32_32x32x16_bf16 v[240:255], v[52:55], v[68:71], v[240:255]
  s_waitcnt lgkmcnt(7)
  v_mfma_f32_32x32x16_bf16 v[128:143], v[72:75], v[80:83], v[128:143]
  ds_read_b128 v[48:51], v22 offset:0
  s_waitcnt lgkmcnt(7)
  v_mfma_f32_32x32x16_bf16 v[192:207], v[76:79], v[80:83], v[192:207]
  ds_read_b64_tr_b16 v[56:57], v24 offset:8192
  ds_read_b64_tr_b16 v[58:59], v24 offset:9216
  buffer_load_dwordx4 v7, s[4:7], s57 offen offset:3072 lds
  s_waitcnt lgkmcnt(7)
  v_mfma_f32_32x32x16_bf16 v[144:159], v[72:75], v[84:87], v[144:159]
  ds_read_b128 v[52:55], v22 offset:4096
  v_mfma_f32_32x32x16_bf16 v[208:223], v[76:79], v[84:87], v[208:223]
  ds_read_b64_tr_b16 v[60:61], v25 offset:8192
  ds_read_b64_tr_b16 v[62:63], v25 offset:9216
  s_waitcnt lgkmcnt(8)
  v_mfma_f32_32x32x16_bf16 v[160:175], v[72:75], v[88:91], v[160:175]
  ds_read_b64_tr_b16 v[64:65], v26 offset:8192
  ds_read_b64_tr_b16 v[66:67], v26 offset:9216
  v_mfma_f32_32x32x16_bf16 v[224:239], v[76:79], v[88:91], v[224:239]
  ds_read_b64_tr_b16 v[68:69], v27 offset:8192
  ds_read_b64_tr_b16 v[70:71], v27 offset:9216
  s_waitcnt lgkmcnt(10)
  v_mfma_f32_32x32x16_bf16 v[176:191], v[72:75], v[92:95], v[176:191]
  v_mfma_f32_32x32x16_bf16 v[240:255], v[76:79], v[92:95], v[240:255]
  s_waitcnt lgkmcnt(7)
  v_mfma_f32_32x32x16_bf16 v[128:143], v[48:51], v[56:59], v[128:143]
  ds_read_b128 v[72:75], v23 offset:0
  s_waitcnt lgkmcnt(7)
  v_mfma_f32_32x32x16_bf16 v[192:207], v[52:55], v[56:59], v[192:207]
  ds_read_b64_tr_b16 v[80:81], v24 offset:12288
  ds_read_b64_tr_b16 v[82:83], v24 offset:13312
  s_waitcnt lgkmcnt(7)
  v_mfma_f32_32x32x16_bf16 v[144:159], v[48:51], v[60:63], v[144:159]
  ds_read_b128 v[76:79], v23 offset:4096
  v_mfma_f32_32x32x16_bf16 v[208:223], v[52:55], v[60:63], v[208:223]
  ds_read_b64_tr_b16 v[84:85], v25 offset:12288
  ds_read_b64_tr_b16 v[86:87], v25 offset:13312
  s_waitcnt lgkmcnt(8)
  v_mfma_f32_32x32x16_bf16 v[160:175], v[48:51], v[64:67], v[160:175]
  ds_read_b64_tr_b16 v[88:89], v26 offset:12288
  ds_read_b64_tr_b16 v[90:91], v26 offset:13312
  s_cmp_lg_u32 s73, 0
  s_cbranch_scc1 .Lk1t54
  v_lshlrev_b32 v3, 7, v0
  s_mov_b32 s88, s32
  s_mov_b32 s89, s33
  s_mov_b32 s90, 2621440
  s_mov_b32 s55, 0
  s_mov_b32 s91, 0x00020000
  s_add_u32 s55, s55, s2
  s_lshl_b32 s55, s55, 13
  v_add_u32 v3, s55, v3
  buffer_load_dword v43, v3, s[88:91], 0 offen
.Lk1t54:
  v_mfma_f32_32x32x16_bf16 v[224:239], v[52:55], v[64:67], v[224:239]
  ds_read_b64_tr_b16 v[92:93], v27 offset:12288
  ds_read_b64_tr_b16 v[94:95], v27 offset:13312
  s_waitcnt lgkmcnt(10)
  v_mfma_f32_32x32x16_bf16 v[176:191], v[48:51], v[68:71], v[176:191]
  v_mfma_f32_32x32x16_bf16 v[240:255], v[52:55], v[68:71], v[240:255]
  s_waitcnt lgkmcnt(7)
  v_mfma_f32_32x32x16_bf16 v[128:143], v[72:75], v[80:83], v[128:143]
  s_waitcnt lgkmcnt(6)
  v_mfma_f32_32x32x16_bf16 v[192:207], v[76:79], v[80:83], v[192:207]
  s_add_u32 s55, s63, 0x10000
  v_add_u32 v20, s55, v20
  v_add_u32 v21, s55, v21
  v_add_u32 v22, s55, v22
  v_add_u32 v23, s55, v23
  s_add_u32 s55, s72, 0x8000
  v_add_u32 v28, s55, v20
  v_add_u32 v29, s55, v21
  v_add_u32 v30, s55, v22
  v_add_u32 v31, s55, v23
  s_waitcnt lgkmcnt(0)
  s_waitcnt vmcnt(4)
  s_barrier
  ds_read_b128 v[48:51], v20 offset:0
  s_add_u32 m0, s58, 16384
  s_mov_b32 s57, 2097152
  buffer_load_dwordx4 v8, s[12:15], s57 offen offset:0 lds
  v_mfma_f32_32x32x16_bf16 v[144:159], v[72:75], v[84:87], v[144:159]
  ds_read_b128 v[52:55], v28 offset:0
  buffer_load_dwordx4 v9, s[12:15], s57 offen offset:1024 lds
  v_mfma_f32_32x32x16_bf16 v[208:223], v[76:79], v[84:87], v[208:223]
  ds_read_b128 v[56:59], v28 offset:8192
  buffer_load_dwordx4 v10, s[12:15], s57 offen offset:2048 lds
  v_mfma_f32_32x32x16_bf16 v[160:175], v[72:75], v[88:91], v[160:175]
  ds_read_b128 v[60:63], v21 offset:0
  buffer_load_dwordx4 v11, s[12:15], s57 offen offset:3072 lds
  v_mfma_f32_32x32x16_bf16 v[224:239], v[76:79], v[88:91], v[224:239]
  ds_read_b128 v[64:67], v29 offset:0
  s_add_u32 m0, s58, 49152
  s_mov_b32 s22, s68
  s_add_u32 s57, s75, 768
  buffer_load_dwordx4 v12, s[20:23], s57 offen offset:0 lds
  v_mfma_f32_32x32x16_bf16 v[176:191], v[72:75], v[92:95], v[176:191]
  ds_read_b128 v[68:71], v29 offset:8192
  buffer_load_dwordx4 v13, s[20:23], s57 offen offset:1024 lds
  v_mfma_f32_32x32x16_bf16 v[240:255], v[76:79], v[92:95], v[240:255]
  buffer_load_dwordx4 v14, s[20:23], s57 offen offset:2048 lds
  s_cmp_ge_u32 s2, 160
  s_cbranch_scc1 .Lk1_s1_6
  s_waitcnt lgkmcnt(4)
  v_mfma_f32_32x32x16_bf16 v[96:111], v[48:51], v[52:55], v[96:111]
  ds_read_b128 v[72:75], v22 offset:0
  ds_read_b128 v[76:79], v30 offset:0
  buffer_load_dwordx4 v15, s[20:23], s57 offen offset:3072 lds
  s_waitcnt lgkmcnt(5)
  v_mfma_f32_32x32x16_bf16 v[112:127], v[48:51], v[56:59], v[112:127]
  ds_read_b128 v[80:83], v30 offset:8192
  s_waitcnt lgkmcnt(4)
  v_mfma_f32_32x32x16_bf16 v[96:111], v[60:63], v[64:67], v[96:111]
  ds_read_b128 v[84:87], v23 offset:0
  ds_read_b128 v[88:91], v31 offset:0
  s_waitcnt lgkmcnt(5)
  v_mfma_f32_32x32x16_bf16 v[112:127], v[60:63], v[68:71], v[112:127]
  ds_read_b128 v[92:95], v31 offset:8192
  s_waitcnt lgkmcnt(4)
  v_mfma_f32_32x32x16_bf16 v[96:111], v[72:75], v[76:79], v[96:111]
  ds_read_b128 v[48:51], v20 offset:16384
  ds_read_b128 v[52:55], v28 offset:16384
  s_waitcnt lgkmcnt(5)
  v_mfma_f32_32x32x16_bf16 v[112:127], v[72:75], v[80:83], v[112:127]
  ds_read_b128 v[56:59], v28 offset:24576
  s_waitcnt lgkmcnt(4)
  v_mfma_f32_32x32x16_bf16 v[96:111], v[84:87], v[88:91], v[96:111]
  ds_read_b128 v[60:63], v21 offset:16384
  ds_read_b128 v[64:67], v29 offset:16384
  s_waitcnt lgkmcnt(5)
  v_mfma_f32_32x32x16_bf16 v[112:127], v[84:87], v[92:95], v[112:127]
  ds_read_b128 v[68:71], v29 offset:24576
  s_waitcnt lgkmcnt(4)
  v_mfma_f32_32x32x16_bf16 v[96:111], v[48:51], v[52:55], v[96:111]
  ds_read_b128 v[72:75], v22 offset:16384
  ds_read_b128 v[76:79], v30 offset:16384
  s_waitcnt lgkmcnt(5)
  v_mfma_f32_32x32x16_bf16 v[112:127], v[48:51], v[56:59], v[112:127]
  ds_read_b128 v[80:83], v30 offset:24576
  s_waitcnt lgkmcnt(4)
  v_mfma_f32_32x32x16_bf16 v[96:111], v[60:63], v[64:67], v[96:111]
  ds_read_b128 v[84:87], v23 offset:16384
  ds_read_b128 v[88:91], v31 offset:16384
  s_waitcnt lgkmcnt(5)
  v_mfma_f32_32x32x16_bf16 v[112:127], v[60:63], v[68:71], v[112:127]
  ds_read_b128 v[92:95], v31 offset:24576
  s_waitcnt lgkmcnt(4)
  v_mfma_f32_32x32x16_bf16 v[96:111], v[72:75], v[76:79], v[96:111]
  s_sub_u32 s55, 0x10000, s63
  v_add_u32 v20, s55, v20
  v_add_u32 v21, s55, v21
  v_add_u32 v22, s55, v22
  v_add_u32 v23, s55, v23
  v_add_u32 v24, 0xffff8000, v24
  v_add_u32 v25, 0xffff8000, v25
  v_add_u32 v26, 0xffff8000, v26
  v_add_u32 v27, 0xffff8000, v27
  s_waitcnt lgkmcnt(0)
  s_waitcnt vmcnt(4)
  s_barrier
  ds_read_b128 v[48:51], v20 offset:0
  ds_read_b64_tr_b16 v[56:57], v24 offset:0
  ds_read_b64_tr_b16 v[58:59], v24 offset:1024
  s_add_u32 m0, s58, 81920
  s_mov_b32 s26, s69
  s_add_u32 s57, s75, 768
  buffer_load_dwordx4 v16, s[24:27], s57 offen offset:0 lds
  v_mfma_f32_32x32x16_bf16 v[112:127], v[72:75], v[80:83], v[112:127]
  ds_read_b128 v[52:55], v20 offset:4096
  ds_read_b64_tr_b16 v[60:61], v25 offset:0
  ds_read_b64_tr_b16 v[62:63], v25 offset:1024
  buffer_load_dwordx4 v17, s[24:27], s57 offen offset:1024 lds
  v_mfma_f32_32x32x16_bf16 v[96:111], v[84:87], v[88:91], v[96:111]
  ds_read_b64_tr_b16 v[64:65], v26 offset:0
  ds_read_b64_tr_b16 v[66:67], v26 offset:1024
  ds_read_b64_tr_b16 v[68:69], v27 offset:0
  ds_read_b64_tr_b16 v[70:71], v27 offset:1024
  buffer_load_dwordx4 v18, s[24:27], s57 offen offset:2048 lds
  v_mfma_f32_32x32x16_bf16 v[112:127], v[84:87], v[92:95], v[112:127]
  buffer_load_dwordx4 v19, s[24:27], s57 offen offset:3072 lds
.Lk1_s1_6r:
  s_waitcnt lgkmcnt(7)
  v_mfma_f32_32x32x16_bf16 v[128:143], v[48:51], v[56:59], v[128:143]
  ds_read_b128 v[72:75], v21 offset:0
  s_add_u32 m0, s58, 114688
  s_mov_b32 s57, 131712
  buffer_load_dwordx4 v4, s[4:7], s57 offen offset:0 lds
  s_waitcnt lgkmcnt(7)
  v_mfma_f32_32x32x16_bf16 v[192:207], v[52:55], v[56:59], v[192:207]
  ds_read_b64_tr_b16 v[80:81], v24 offset:4096
  ds_read_b64_tr_b16 v[82:83], v24 offset:5120
  s_waitcnt lgkmcnt(7)
  v_mfma_f32_32x32x16_bf16 v[144:159], v[48:51], v[60:63], v[144:159]
  ds_read_b128 v[76:79], v21 offset:4096
  v_mfma_f32_32x32x16_bf16 v[208:223], v[52:55], v[60:63], v[208:223]
  ds_read_b64_tr_b16 v[84:85], v25 offset:4096
  ds_read_b64_tr_b16 v[86:87], v25 offset:5120
  buffer_load_dwordx4 v5, s[4:7], s57 offen offset:1024 lds
  s_waitcnt lgkmcnt(8)
  v_mfma_f32_32x32x16_bf16 v[160:175], v[48:51], v[64:67], v[160:175]
  ds_read_b64_tr_b16 v[88:89], v26 offset:4096
  ds_read_b64_tr_b16 v[90:91], v26 offset:5120
  v_mfma_f32_32x32x16_bf16 v[224:239], v[52:55], v[64:67], v[224:239]
  ds_read_b64_tr_b16 v[92:93], v27 offset:4096
  ds_read_b64_tr_b16 v[94:95], v27 offset:5120
  s_waitcnt lgkmcnt(10)
  v_mfma_f32_32x32x16_bf16 v[176:191], v[48:51], v[68:71], v[176:191]
  buffer_load_dwordx4 v6, s[4:7], s57 offen offset:2048 lds
  v_mfma_f32_32x32x16_bf16 v[240:255], v[52:55], v[68:71], v[240:255]
  s_waitcnt lgkmcnt(7)
  v_mfma_f32_32x32x16_bf16 v[128:143], v[72:75], v[80:83], v[128:143]
  ds_read_b128 v[48:51], v22 offset:0
  s_waitcnt lgkmcnt(7)
  v_mfma_f32_32x32x16_bf16 v[192:207], v[76:79], v[80:83], v[192:207]
  ds_read_b64_tr_b16 v[56:57], v24 offset:8192
  ds_read_b64_tr_b16 v[58:59], v24 offset:9216
  buffer_load_dwordx4 v7, s[4:7], s57 offen offset:3072 lds
  s_waitcnt lgkmcnt(7)
  v_mfma_f32_32x32x16_bf16 v[144:159], v[72:75], v[84:87], v[144:159]
  ds_read_b128 v[52:55], v22 offset:4096
  v_mfma_f32_32x32x16_bf16 v[208:223], v[76:79], v[84:87], v[208:223]
  ds_read_b64_tr_b16 v[60:61], v25 offset:8192
  ds_read_b64_tr_b16 v[62:63], v25 offset:9216
  s_waitcnt lgkmcnt(8)
  v_mfma_f32_32x32x16_bf16 v[160:175], v[72:75], v[88:91], v[160:175]
  ds_read_b64_tr_b16 v[64:65], v26 offset:8192
  ds_read_b64_tr_b16 v[66:67], v26 offset:9216
  v_mfma_f32_32x32x16_bf16 v[224:239], v[76:79], v[88:91], v[224:239]
  ds_read_b64_tr_b16 v[68:69], v27 offset:8192
  ds_read_b64_tr_b16 v[70:71], v27 offset:9216
  s_waitcnt lgkmcnt(10)
  v_mfma_f32_32x32x16_bf16 v[176:191], v[72:75], v[92:95], v[176:191]
  v_mfma_f32_32x32x16_bf16 v[240:255], v[76:79], v[92:95], v[240:255]
  s_waitcnt lgkmcnt(7)
  v_mfma_f32_32x32x16_bf16 v[128:143], v[48:51], v[56:59], v[128:143]
  ds_read_b128 v[72:75], v23 offset:0
  s_waitcnt lgkmcnt(7)
  v_mfma_f32_32x32x16_bf16 v[192:207], v[52:55], v[56:59], v[192:207]
  ds_read_b64_tr_b16 v[80:81], v24 offset:12288
  ds_read_b64_tr_b16 v[82:83], v24 offset:13312
  s_waitcnt lgkmcnt(7)
  v_mfma_f32_32x32x16_bf16 v[144:159], v[48:51], v[60:63], v[144:159]
  ds_read_b128 v[76:79], v23 offset:4096
  v_mfma_f32_32x32x16_bf16 v[208:223], v[52:55], v[60:63], v[208:223]
  ds_read_b64_tr_b16 v[84:85], v25 offset:12288
  ds_read_b64_tr_b16 v[86:87], v25 offset:13312
  s_waitcnt lgkmcnt(8)
  v_mfma_f32_32x32x16_bf16 v[160:175], v[48:51], v[64:67], v[160:175]
  ds_read_b64_tr_b16 v[88:89], v26 offset:12288
  ds_read_b64_tr_b16 v[90:91], v26 offset:13312
  v_mfma_f32_32x32x16_bf16 v[224:239], v[52:55], v[64:67], v[224:239]
  ds_read_b64_tr_b16 v[92:93], v27 offset:12288
  ds_read_b64_tr_b16 v[94:95], v27 offset:13312
  s_waitcnt lgkmcnt(10)
  v_mfma_f32_32x32x16_bf16 v[176:191], v[48:51], v[68:71], v[176:191]
  v_mfma_f32_32x32x16_bf16 v[240:255], v[52:55], v[68:71], v[240:255]
  s_waitcnt lgkmcnt(7)
  v_mfma_f32_32x32x16_bf16 v[128:143], v[72:75], v[80:83], v[128:143]
  s_waitcnt lgkmcnt(6)
  v_mfma_f32_32x32x16_bf16 v[192:207], v[76:79], v[80:83], v[192:207]
  s_add_u32 s55, s63, 0xfffe8000
  v_add_u32 v20, s55, v20
  v_add_u32 v21, s55, v21
  v_add_u32 v22, s55, v22
  v_add_u32 v23, s55, v23
  s_add_u32 s55, s72, 0x8000
  v_add_u32 v28, s55, v20
  v_add_u32 v29, s55, v21
  v_add_u32 v30, s55, v22
  v_add_u32 v31, s55, v23
  s_waitcnt lgkmcnt(0)
  s_waitcnt vmcnt(4)
  s_barrier
  ds_read_b128 v[48:51], v20 offset:0
  s_add_u32 m0, s58, 147456
  s_mov_b32 s57, 2621440
  buffer_load_dwordx4 v8, s[12:15], s57 offen offset:0 lds
  v_mfma_f32_32x32x16_bf16 v[144:159], v[72:75], v[84:87], v[144:159]
  ds_read_b128 v[52:55], v28 offset:0
  buffer_load_dwordx4 v9, s[12:15], s57 offen offset:1024 lds
  v_mfma_f32_32x32x16_bf16 v[208:223], v[76:79], v[84:87], v[208:223]
  ds_read_b128 v[56:59], v28 offset:8192
  buffer_load_dwordx4 v10, s[12:15], s57 offen offset:2048 lds
  v_mfma_f32_32x32x16_bf16 v[160:175], v[72:75], v[88:91], v[160:175]
  ds_read_b128 v[60:63], v21 offset:0
  buffer_load_dwordx4 v11, s[12:15], s57 offen offset:3072 lds
  v_mfma_f32_32x32x16_bf16 v[224:239], v[76:79], v[88:91], v[224:239]
  ds_read_b128 v[64:67], v29 offset:0
  s_add_u32 m0, s58, 16384
  s_cmp_lt_u32 s2, 160
  s_cselect_b32 s22, s68, 0
  s_add_u32 s57, s75, 1024
  buffer_load_dwordx4 v12, s[20:23], s57 offen offset:0 lds
  v_mfma_f32_32x32x16_bf16 v[176:191], v[72:75], v[92:95], v[176:191]
  ds_read_b128 v[68:71], v29 offset:8192
  buffer_load_dwordx4 v13, s[20:23], s57 offen offset:1024 lds
  v_mfma_f32_32x32x16_bf16 v[240:255], v[76:79], v[92:95], v[240:255]
  buffer_load_dwordx4 v14, s[20:23], s57 offen offset:2048 lds
  s_cmp_ge_u32 s2, 160
  s_cbranch_scc1 .Lk1_s1_8
  s_waitcnt lgkmcnt(4)
  v_mfma_f32_32x32x16_bf16 v[96:111], v[48:51], v[52:55], v[96:111]
  ds_read_b128 v[72:75], v22 offset:0
  ds_read_b128 v[76:79], v30 offset:0
  buffer_load_dwordx4 v15, s[20:23], s57 offen offset:3072 lds
  s_waitcnt lgkmcnt(5)
  v_mfma_f32_32x32x16_bf16 v[112:127], v[48:51], v[56:59], v[112:127]
  ds_read_b128 v[80:83], v30 offset:8192
  s_waitcnt lgkmcnt(4)
  v_mfma_f32_32x32x16_bf16 v[96:111], v[60:63], v[64:67], v[96:111]
  ds_read_b128 v[84:87], v23 offset:0
  ds_read_b128 v[88:91], v31 offset:0
  s_waitcnt lgkmcnt(5)
  v_mfma_f32_32x32x16_bf16 v[112:127], v[60:63], v[68:71], v[112:127]
  ds_read_b128 v[92:95], v31 offset:8192
  s_waitcnt lgkmcnt(4)
  v_mfma_f32_32x32x16_bf16 v[96:111], v[72:75], v[76:79], v[96:111]
  ds_read_b128 v[48:51], v20 offset:16384
  ds_read_b128 v[52:55], v28 offset:16384
  s_waitcnt lgkmcnt(5)
  v_mfma_f32_32x32x16_bf16 v[112:127], v[72:75], v[80:83], v[112:127]
  ds_read_b128 v[56:59], v28 offset:24576
  s_waitcnt lgkmcnt(4)
  v_mfma_f32_32x32x16_bf16 v[96:111], v[84:87], v[88:91], v[96:111]
  ds_read_b128 v[60:63], v21 offset:16384
  ds_read_b128 v[64:67], v29 offset:16384
  s_waitcnt lgkmcnt(5)
  v_mfma_f32_32x32x16_bf16 v[112:127], v[84:87], v[92:95], v[112:127]
  ds_read_b128 v[68:71], v29 offset:24576
  s_waitcnt lgkmcnt(4)
  v_mfma_f32_32x32x16_bf16 v[96:111], v[48:51], v[52:55], v[96:111]
  ds_read_b128 v[72:75], v22 offset:16384
  ds_read_b128 v[76:79], v30 offset:16384
  s_waitcnt lgkmcnt(5)
  v_mfma_f32_32x32x16_bf16 v[112:127], v[48:51], v[56:59], v[112:127]
  ds_read_b128 v[80:83], v30 offset:24576
  s_waitcnt lgkmcnt(4)
  v_mfma_f32_32x32x16_bf16 v[96:111], v[60:63], v[64:67], v[96:111]
  ds_read_b128 v[84:87], v23 offset:16384
  ds_read_b128 v[88:91], v31 offset:16384
  s_waitcnt lgkmcnt(5)
  v_mfma_f32_32x32x16_bf16 v[112:127], v[60:63], v[68:71], v[112:127]
  ds_read_b128 v[92:95], v31 offset:24576
  s_waitcnt lgkmcnt(4)
  v_mfma_f32_32x32x16_bf16 v[96:111], v[72:75], v[76:79], v[96:111]
  s_sub_u32 s55, 0x10000, s63
  v_add_u32 v20, s55, v20
  v_add_u32 v21, s55, v21
  v_add_u32 v22, s55, v22
  v_add_u32 v23, s55, v23
  v_add_u32 v24, 0x20000, v24
  v_add_u32 v25, 0x20000, v25
  v_add_u32 v26, 0x20000, v26
  v_add_u32 v27, 0x20000, v27
  s_waitcnt lgkmcnt(0)
  s_waitcnt vmcnt(4)
  s_barrier
  ds_read_b128 v[48:51], v20 offset:0
  ds_read_b64_tr_b16 v[56:57], v24 offset:0
  ds_read_b64_tr_b16 v[58:59], v24 offset:1024
  s_add_u32 m0, s58, 49152
  s_cmp_lt_u32 s2, 160
  s_cselect_b32 s26, s69, 0
  s_add_u32 s57, s75, 1024
  buffer_load_dwordx4 v16, s[24:27], s57 offen offset:0 lds
  v_mfma_f32_32x32x16_bf16 v[112:127], v[72:75], v[80:83], v[112:127]
  ds_read_b128 v[52:55], v20 offset:4096
  ds_read_b64_tr_b16 v[60:61], v25 offset:0
  ds_read_b64_tr_b16 v[62:63], v25 offset:1024
  buffer_load_dwordx4 v17, s[24:27], s57 offen offset:1024 lds
  v_mfma_f32_32x32x16_bf16 v[96:111], v[84:87], v[88:91], v[96:111]
  ds_read_b64_tr_b16 v[64:65], v26 offset:0
  ds_read_b64_tr_b16 v[66:67], v26 offset:1024
  ds_read_b64_tr_b16 v[68:69], v27 offset:0
  ds_read_b64_tr_b16 v[70:71], v27 offset:1024
  buffer_load_dwordx4 v18, s[24:27], s57 offen offset:2048 lds
  v_mfma_f32_32x32x16_bf16 v[112:127], v[84:87], v[92:95], v[112:127]
  buffer_load_dwordx4 v19, s[24:27], s57 offen offset:3072 lds
.Lk1_s1_8r:
  s_waitcnt lgkmcnt(7)
  v_mfma_f32_32x32x16_bf16 v[128:143], v[48:51], v[56:59], v[128:143]
  ds_read_b128 v[72:75], v21 offset:0
  s_add_u32 m0, s58, 81920
  s_mov_b32 s57, 131840
  buffer_load_dwordx4 v4, s[4:7], s57 offen offset:0 lds
  v_lshlrev_b32 v33, 16, v33
  v_lshlrev_b32 v34, 16, v34
  v_lshlrev_b32 v35, 16, v35
  v_mul_f32 v35, 0x3fb8aa3b, v35
  s_waitcnt lgkmcnt(7)
  v_mfma_f32_32x32x16_bf16 v[192:207], v[52:55], v[56:59], v[192:207]
  ds_read_b64_tr_b16 v[80:81], v24 offset:4096
  ds_read_b64_tr_b16 v[82:83], v24 offset:5120
  v_exp_f32 v35, v35
  s_nop 0
  v_cvt_pk_bf16_f32 v35, v35, v35
  v_and_b32 v35, 0xffff0000, v35
  v_mul_f32 v1, v35, v33
  s_waitcnt lgkmcnt(7)
  v_mfma_f32_32x32x16_bf16 v[144:159], v[48:51], v[60:63], v[144:159]
  ds_read_b128 v[76:79], v21 offset:4096
  v_mul_f32 v2, v35, v34
  v_mul_f32 v1, 0x3fb8aa3b, v1
  v_exp_f32 v1, v1
  v_mul_f32 v2, 0x3e22f983, v2
  v_mfma_f32_32x32x16_bf16 v[208:223], v[52:55], v[60:63], v[208:223]
  ds_read_b64_tr_b16 v[84:85], v25 offset:4096
  ds_read_b64_tr_b16 v[86:87], v25 offset:5120
  buffer_load_dwordx4 v5, s[4:7], s57 offen offset:1024 lds
  v_cos_f32 v44, v2
  v_sin_f32 v45, v2
  v_mul_f32 v44, v44, v1
  v_mul_f32 v45, v45, v1
  s_waitcnt lgkmcnt(8)
  v_mfma_f32_32x32x16_bf16 v[160:175], v[48:51], v[64:67], v[160:175]
  ds_read_b64_tr_b16 v[88:89], v26 offset:4096
  ds_read_b64_tr_b16 v[90:91], v26 offset:5120
  v_add_f32 v1, -1.0, v44
  v_mul_f32 v2, v33, v33
  v_fmac_f32 v2, v34, v34
  v_rcp_f32 v2, v2
  v_mfma_f32_32x32x16_bf16 v[224:239], v[52:55], v[64:67], v[224:239]
  ds_read_b64_tr_b16 v[92:93], v27 offset:4096
  ds_read_b64_tr_b16 v[94:95], v27 offset:5120
  v_mul_f32 v46, v1, v33
  v_fmac_f32 v46, v45, v34
  v_mul_f32 v47, v45, v33
  v_fma_f32 v47, -v1, v34, v47
  s_waitcnt lgkmcnt(10)
  v_mfma_f32_32x32x16_bf16 v[176:191], v[48:51], v[68:71], v[176:191]
  buffer_load_dwordx4 v6, s[4:7], s57 offen offset:2048 lds
  v_add_f32 v2, v2, v2
  v_mul_f32 v46, v46, v2
  v_mul_f32 v47, v47, v2
  v_mov_b32 v12, v44
  v_mfma_f32_32x32x16_bf16 v[240:255], v[52:55], v[68:71], v[240:255]
  v_mov_b32 v13, v45
  v_mul_f32 v1, v13, v13
  v_mul_f32 v13, v12, v13
  v_fma_f32 v12, v12, v12, -v1
  s_waitcnt lgkmcnt(7)
  v_mfma_f32_32x32x16_bf16 v[128:143], v[72:75], v[80:83], v[128:143]
  ds_read_b128 v[48:51], v22 offset:0
  s_cmp_lg_u32 s73, 3
  s_cbranch_scc1 .Lk1t55
  v_lshrrev_b32 v3, 3, v0
  v_lshlrev_b32 v3, 6, v3
  v_and_or_b32 v3, v0, 7, v3
  v_lshlrev_b32 v3, 7, v3
  s_and_b32 s55, s2, 7
  s_lshl_b32 s55, s55, 10
  v_add_u32 v3, s55, v3
  s_lshr_b32 s56, s2, 3
  s_mov_b32 s88, s64
  s_mov_b32 s89, s65
  s_mov_b32 s90, 5242880
  s_mov_b32 s55, 0
  s_mov_b32 s91, 0x00020000
  s_add_u32 s55, s55, s56
  s_lshl_b32 s55, s55, 16
  v_add_u32 v3, s55, v3
  buffer_load_dword v43, v3, s[88:91], 0 offen
.Lk1t55:
  v_add_f32 v13, v13, v13
  v_mul_f32 v1, v13, v13
  v_mul_f32 v13, v12, v13
  v_fma_f32 v12, v12, v12, -v1
  s_waitcnt lgkmcnt(7)
  v_mfma_f32_32x32x16_bf16 v[192:207], v[76:79], v[80:83], v[192:207]
  ds_read_b64_tr_b16 v[56:57], v24 offset:8192
  ds_read_b64_tr_b16 v[58:59], v24 offset:9216
  buffer_load_dwordx4 v7, s[4:7], s57 offen offset:3072 lds
  v_add_f32 v13, v13, v13
  v_mul_f32 v1, v13, v13
  v_mul_f32 v13, v12, v13
  v_fma_f32 v12, v12, v12, -v1
  s_waitcnt lgkmcnt(7)
  v_mfma_f32_32x32x16_bf16 v[144:159], v[72:75], v[84:87], v[144:159]
  ds_read_b128 v[52:55], v22 offset:4096
  v_add_f32 v13, v13, v13
  v_mul_f32 v1, v13, v13
  v_mul_f32 v13, v12, v13
  v_fma_f32 v12, v12, v12, -v1
  v_mfma_f32_32x32x16_bf16 v[208:223], v[76:79], v[84:87], v[208:223]
  ds_read_b64_tr_b16 v[60:61], v25 offset:8192
  ds_read_b64_tr_b16 v[62:63], v25 offset:9216
  v_add_f32 v13, v13, v13
  s_waitcnt lgkmcnt(8)
  v_mfma_f32_32x32x16_bf16 v[160:175], v[72:75], v[88:91], v[160:175]
  ds_read_b64_tr_b16 v[64:65], v26 offset:8192
  ds_read_b64_tr_b16 v[66:67], v26 offset:9216
  v_mfma_f32_32x32x16_bf16 v[224:239], v[76:79], v[88:91], v[224:239]
  ds_read_b64_tr_b16 v[68:69], v27 offset:8192
  ds_read_b64_tr_b16 v[70:71], v27 offset:9216
  s_waitcnt lgkmcnt(10)
  v_mfma_f32_32x32x16_bf16 v[176:191], v[72:75], v[92:95], v[176:191]
  v_mfma_f32_32x32x16_bf16 v[240:255], v[76:79], v[92:95], v[240:255]
  s_waitcnt lgkmcnt(7)
  v_mfma_f32_32x32x16_bf16 v[128:143], v[48:51], v[56:59], v[128:143]
  ds_read_b128 v[72:75], v23 offset:0
  s_waitcnt lgkmcnt(7)
  v_mfma_f32_32x32x16_bf16 v[192:207], v[52:55], v[56:59], v[192:207]
  ds_read_b64_tr_b16 v[80:81], v24 offset:12288
  ds_read_b64_tr_b16 v[82:83], v24 offset:13312
  s_waitcnt lgkmcnt(7)
  v_mfma_f32_32x32x16_bf16 v[144:159], v[48:51], v[60:63], v[144:159]
  ds_read_b128 v[76:79], v23 offset:4096
  v_mfma_f32_32x32x16_bf16 v[208:223], v[52:55], v[60:63], v[208:223]
  ds_read_b64_tr_b16 v[84:85], v25 offset:12288
  ds_read_b64_tr_b16 v[86:87], v25 offset:13312
  s_waitcnt lgkmcnt(8)
  v_mfma_f32_32x32x16_bf16 v[160:175], v[48:51], v[64:67], v[160:175]
  ds_read_b64_tr_b16 v[88:89], v26 offset:12288
  ds_read_b64_tr_b16 v[90:91], v26 offset:13312
  v_mfma_f32_32x32x16_bf16 v[224:239], v[52:55], v[64:67], v[224:239]
  ds_read_b64_tr_b16 v[92:93], v27 offset:12288
  ds_read_b64_tr_b16 v[94:95], v27 offset:13312
  s_waitcnt lgkmcnt(10)
  v_mfma_f32_32x32x16_bf16 v[176:191], v[48:51], v[68:71], v[176:191]
  v_mfma_f32_32x32x16_bf16 v[240:255], v[52:55], v[68:71], v[240:255]
  s_waitcnt lgkmcnt(7)
  v_mfma_f32_32x32x16_bf16 v[128:143], v[72:75], v[80:83], v[128:143]
  s_waitcnt lgkmcnt(6)
  v_mfma_f32_32x32x16_bf16 v[192:207], v[76:79], v[80:83], v[192:207]
  s_add_u32 s55, s63, 0xfffe8000
  v_add_u32 v20, s55, v20
  v_add_u32 v21, s55, v21
  v_add_u32 v22, s55, v22
  v_add_u32 v23, s55, v23
  s_add_u32 s55, s72, 0x8000
  v_add_u32 v28, s55, v20
  v_add_u32 v29, s55, v21
  v_add_u32 v30, s55, v22
  v_add_u32 v31, s55, v23
  s_waitcnt lgkmcnt(0)
  s_waitcnt vmcnt(4)
  s_barrier
  ds_read_b128 v[48:51], v20 offset:0
  s_add_u32 m0, s58, 114688
  s_mov_b32 s57, 3145728
  buffer_load_dwordx4 v8, s[12:15], s57 offen offset:0 lds
  v_mfma_f32_32x32x16_bf16 v[144:159], v[72:75], v[84:87], v[144:159]
  ds_read_b128 v[52:55], v28 offset:0
  buffer_load_dwordx4 v9, s[12:15], s57 offen offset:1024 lds
  v_mfma_f32_32x32x16_bf16 v[208:223], v[76:79], v[84:87], v[208:223]
  ds_read_b128 v[56:59], v28 offset:8192
  buffer_load_dwordx4 v10, s[12:15], s57 offen offset:2048 lds
  v_mfma_f32_32x32x16_bf16 v[160:175], v[72:75], v[88:91], v[160:175]
  ds_read_b128 v[60:63], v21 offset:0
  buffer_load_dwordx4 v11, s[12:15], s57 offen offset:3072 lds
  v_mfma_f32_32x32x16_bf16 v[224:239], v[76:79], v[88:91], v[224:239]
  ds_read_b128 v[64:67], v29 offset:0
  s_add_u32 m0, s58, 147456
  s_mov_b32 s57, 131968
  buffer_load_dwordx4 v4, s[4:7], s57 offen offset:0 lds
  v_mfma_f32_32x32x16_bf16 v[176:191], v[72:75], v[92:95], v[176:191]
  ds_read_b128 v[68:71], v29 offset:8192
  buffer_load_dwordx4 v5, s[4:7], s57 offen offset:1024 lds
  v_mfma_f32_32x32x16_bf16 v[240:255], v[76:79], v[92:95], v[240:255]
  buffer_load_dwordx4 v6, s[4:7], s57 offen offset:2048 lds
  s_cmp_ge_u32 s2, 160
  s_cbranch_scc1 .Lk1_s1_10
  s_waitcnt lgkmcnt(4)
  v_mfma_f32_32x32x16_bf16 v[96:111], v[48:51], v[52:55], v[96:111]
  ds_read_b128 v[72:75], v22 offset:0
  ds_read_b128 v[76:79], v30 offset:0
  buffer_load_dwordx4 v7, s[4:7], s57 offen offset:3072 lds
  s_waitcnt lgkmcnt(5)
  v_mfma_f32_32x32x16_bf16 v[112:127], v[48:51], v[56:59], v[112:127]
  ds_read_b128 v[80:83], v30 offset:8192
  s_waitcnt lgkmcnt(4)
  v_mfma_f32_32x32x16_bf16 v[96:111], v[60:63], v[64:67], v[96:111]
  ds_read_b128 v[84:87], v23 offset:0
  ds_read_b128 v[88:91], v31 offset:0
  s_waitcnt lgkmcnt(5)
  v_mfma_f32_32x32x16_bf16 v[112:127], v[60:63], v[68:71], v[112:127]
  ds_read_b128 v[92:95], v31 offset:8192
  s_waitcnt lgkmcnt(4)
  v_mfma_f32_32x32x16_bf16 v[96:111], v[72:75], v[76:79], v[96:111]
  ds_read_b128 v[48:51], v20 offset:16384
  ds_read_b128 v[52:55], v28 offset:16384
  s_waitcnt lgkmcnt(5)
  v_mfma_f32_32x32x16_bf16 v[112:127], v[72:75], v[80:83], v[112:127]
  ds_read_b128 v[56:59], v28 offset:24576
  s_waitcnt lgkmcnt(4)
  v_mfma_f32_32x32x16_bf16 v[96:111], v[84:87], v[88:91], v[96:111]
  ds_read_b128 v[60:63], v21 offset:16384
  ds_read_b128 v[64:67], v29 offset:16384
  s_waitcnt lgkmcnt(5)
  v_mfma_f32_32x32x16_bf16 v[112:127], v[84:87], v[92:95], v[112:127]
  ds_read_b128 v[68:71], v29 offset:24576
  s_waitcnt lgkmcnt(4)
  v_mfma_f32_32x32x16_bf16 v[96:111], v[48:51], v[52:55], v[96:111]
  ds_read_b128 v[72:75], v22 offset:16384
  ds_read_b128 v[76:79], v30 offset:16384
  s_waitcnt lgkmcnt(5)
  v_mfma_f32_32x32x16_bf16 v[112:127], v[48:51], v[56:59], v[112:127]
  ds_read_b128 v[80:83], v30 offset:24576
  s_waitcnt lgkmcnt(4)
  v_mfma_f32_32x32x16_bf16 v[96:111], v[60:63], v[64:67], v[96:111]
  ds_read_b128 v[84:87], v23 offset:16384
  ds_read_b128 v[88:91], v31 offset:16384
  s_waitcnt lgkmcnt(5)
  v_mfma_f32_32x32x16_bf16 v[112:127], v[60:63], v[68:71], v[112:127]
  ds_read_b128 v[92:95], v31 offset:24576
  s_waitcnt lgkmcnt(4)
  v_mfma_f32_32x32x16_bf16 v[96:111], v[72:75], v[76:79], v[96:111]
  s_sub_u32 s55, 0x10000, s63
  v_add_u32 v20, s55, v20
  v_add_u32 v21, s55, v21
  v_add_u32 v22, s55, v22
  v_add_u32 v23, s55, v23
  v_add_u32 v24, 0xffff8000, v24
  v_add_u32 v25, 0xffff8000, v25
  v_add_u32 v26, 0xffff8000, v26
  v_add_u32 v27, 0xffff8000, v27
  s_waitcnt lgkmcnt(0)
  s_waitcnt vmcnt(4)
  s_barrier
  ds_read_b128 v[48:51], v20 offset:0
  ds_read_b64_tr_b16 v[56:57], v24 offset:0
  ds_read_b64_tr_b16 v[58:59], v24 offset:1024
  s_add_u32 m0, s58, 16384
  s_mov_b32 s57, 3670016
  buffer_load_dwordx4 v8, s[12:15], s57 offen offset:0 lds
  v_mfma_f32_32x32x16_bf16 v[112:127], v[72:75], v[80:83], v[112:127]
  ds_read_b128 v[52:55], v20 offset:4096
  ds_read_b64_tr_b16 v[60:61], v25 offset:0
  ds_read_b64_tr_b16 v[62:63], v25 offset:1024
  buffer_load_dwordx4 v9, s[12:15], s57 offen offset:1024 lds
  v_mfma_f32_32x32x16_bf16 v[96:111], v[84:87], v[88:91], v[96:111]
  ds_read_b64_tr_b16 v[64:65], v26 offset:0
  ds_read_b64_tr_b16 v[66:67], v26 offset:1024
  ds_read_b64_tr_b16 v[68:69], v27 offset:0
  ds_read_b64_tr_b16 v[70:71], v27 offset:1024
  buffer_load_dwordx4 v10, s[12:15], s57 offen offset:2048 lds
  v_mfma_f32_32x32x16_bf16 v[112:127], v[84:87], v[92:95], v[112:127]
  buffer_load_dwordx4 v11, s[12:15], s57 offen offset:3072 lds
.Lk1_s1_10r:
  s_waitcnt lgkmcnt(7)
  v_mfma_f32_32x32x16_bf16 v[128:143], v[48:51], v[56:59], v[128:143]
  ds_read_b128 v[72:75], v21 offset:0
  s_add_u32 m0, s58, 49152
  s_add_u32 s57, s93, 0
  buffer_load_dwordx4 v36, s[32:35], s57 offen offset:0 lds
  v_subrev_u32 v33, 32, v0
  v_lshlrev_b32 v33, 3, v33
  v_and_b32 v33, 0x7fffffff, v33
  v_fma_f32 v1, v44, v96, v97
  s_nop 0
  v_fma_f32 v2, v44, v112, v113
  v_fma_f32 v30, -v45, v112, v1
  s_waitcnt lgkmcnt(7)
  v_mfma_f32_32x32x16_bf16 v[192:207], v[52:55], v[56:59], v[192:207]
  ds_read_b64_tr_b16 v[80:81], v24 offset:4096
  ds_read_b64_tr_b16 v[82:83], v24 offset:5120
  v_fma_f32 v31, v45, v96, v2
  v_fma_f32 v1, v44, v30, v98
  v_fma_f32 v2, v44, v31, v114
  v_fma_f32 v28, -v45, v31, v1
  v_fma_f32 v29, v45, v30, v2
  v_fma_f32 v1, v44, v28, v99
  s_waitcnt lgkmcnt(7)
  v_mfma_f32_32x32x16_bf16 v[144:159], v[48:51], v[60:63], v[144:159]
  ds_read_b128 v[76:79], v21 offset:4096
  v_fma_f32 v2, v44, v29, v115
  v_fma_f32 v30, -v45, v29, v1
  v_fma_f32 v31, v45, v28, v2
  v_fma_f32 v1, v44, v30, v100
  v_fma_f32 v2, v44, v31, v116
  v_fma_f32 v28, -v45, v31, v1
  v_mfma_f32_32x32x16_bf16 v[208:223], v[52:55], v[60:63], v[208:223]
  ds_read_b64_tr_b16 v[84:85], v25 offset:4096
  ds_read_b64_tr_b16 v[86:87], v25 offset:5120
  buffer_load_dwordx4 v37, s[32:35], s57 offen offset:1024 lds
  v_fma_f32 v29, v45, v30, v2
  v_fma_f32 v1, v44, v28, v101
  v_fma_f32 v2, v44, v29, v117
  v_fma_f32 v30, -v45, v29, v1
  v_fma_f32 v31, v45, v28, v2
  v_fma_f32 v1, v44, v30, v102
  s_waitcnt lgkmcnt(8)
  v_mfma_f32_32x32x16_bf16 v[160:175], v[48:51], v[64:67], v[160:175]
  ds_read_b64_tr_b16 v[88:89], v26 offset:4096
  ds_read_b64_tr_b16 v[90:91], v26 offset:5120
  v_fma_f32 v2, v44, v31, v118
  v_fma_f32 v28, -v45, v31, v1
  v_fma_f32 v29, v45, v30, v2
  v_fma_f32 v1, v44, v28, v103
  v_fma_f32 v2, v44, v29, v119
  v_fma_f32 v30, -v45, v29, v1
  v_mfma_f32_32x32x16_bf16 v[224:239], v[52:55], v[64:67], v[224:239]
  ds_read_b64_tr_b16 v[92:93], v27 offset:4096
  ds_read_b64_tr_b16 v[94:95], v27 offset:5120
  v_fma_f32 v31, v45, v28, v2
  v_fma_f32 v1, v44, v30, v104
  v_fma_f32 v2, v44, v31, v120
  v_fma_f32 v28, -v45, v31, v1
  v_fma_f32 v29, v45, v30, v2
  v_fma_f32 v1, v44, v28, v105
  s_waitcnt lgkmcnt(10)
  v_mfma_f32_32x32x16_bf16 v[176:191], v[48:51], v[68:71], v[176:191]
  buffer_load_dwordx4 v38, s[32:35], s57 offen offset:2048 lds
  v_fma_f32 v2, v44, v29, v121
  v_fma_f32 v30, -v45, v29, v1
  v_fma_f32 v31, v45, v28, v2
  v_fma_f32 v1, v44, v30, v106
  v_fma_f32 v2, v44, v31, v122
  v_fma_f32 v28, -v45, v31, v1
  v_mfma_f32_32x32x16_bf16 v[240:255], v[52:55], v[68:71], v[240:255]
  v_fma_f32 v29, v45, v30, v2
  v_fma_f32 v1, v44, v28, v107
  v_fma_f32 v2, v44, v29, v123
  v_fma_f32 v30, -v45, v29, v1
  v_fma_f32 v31, v45, v28, v2
  v_fma_f32 v1, v44, v30, v108
  s_waitcnt lgkmcnt(7)
  v_mfma_f32_32x32x16_bf16 v[128:143], v[72:75], v[80:83], v[128:143]
  ds_read_b128 v[48:51], v22 offset:0
  v_fma_f32 v2, v44, v31, v124
  v_fma_f32 v28, -v45, v31, v1
  v_fma_f32 v29, v45, v30, v2
  v_fma_f32 v1, v44, v28, v109
  v_fma_f32 v2, v44, v29, v125
  v_fma_f32 v30, -v45, v29, v1
  s_waitcnt lgkmcnt(7)
  v_mfma_f32_32x32x16_bf16 v[192:207], v[76:79], v[80:83], v[192:207]
  ds_read_b64_tr_b16 v[56:57], v24 offset:8192
  ds_read_b64_tr_b16 v[58:59], v24 offset:9216
  buffer_load_dwordx4 v39, s[32:35], s57 offen offset:3072 lds
  v_fma_f32 v31, v45, v28, v2
  v_fma_f32 v1, v44, v30, v110
  v_fma_f32 v2, v44, v31, v126
  v_fma_f32 v28, -v45, v31, v1
  v_fma_f32 v29, v45, v30, v2
  v_fma_f32 v1, v44, v28, v111
  s_waitcnt lgkmcnt(7)
  v_mfma_f32_32x32x16_bf16 v[144:159], v[72:75], v[84:87], v[144:159]
  ds_read_b128 v[52:55], v22 offset:4096
  v_fma_f32 v2, v44, v29, v127
  v_fma_f32 v30, -v45, v29, v1
  v_fma_f32 v31, v45, v28, v2
  v_mov_b32 v28, 0
  v_mov_b32 v29, 0
  s_nop 0
  v_permlane32_swap_b32 v28, v30
  v_mfma_f32_32x32x16_bf16 v[208:223], v[76:79], v[84:87], v[208:223]
  ds_read_b64_tr_b16 v[60:61], v25 offset:8192
  ds_read_b64_tr_b16 v[62:63], v25 offset:9216
  v_permlane32_swap_b32 v29, v31
  s_nop 0
  v_fma_f32 v1, v12, v28, v30
  v_fma_f32 v2, v12, v29, v31
  v_fma_f32 v34, -v13, v29, v1
  v_fma_f32 v35, v13, v28, v2
  s_waitcnt lgkmcnt(8)
  v_mfma_f32_32x32x16_bf16 v[160:175], v[72:75], v[88:91], v[160:175]
  ds_read_b64_tr_b16 v[64:65], v26 offset:8192
  ds_read_b64_tr_b16 v[66:67], v26 offset:9216
  s_lshl_b32 s55, s60, 2
  s_lshr_b32 s56, s52, 1
  s_add_u32 s55, s55, s56
  s_mul_i32 s55, s55, 640
  s_add_u32 s55, s55, s62
  s_lshl_b32 s55, s55, 3
  s_add_u32 s55, s55, 524288
  buffer_store_dwordx2 v[34:35], v33, s[36:39], s55 offen
  v_mfma_f32_32x32x16_bf16 v[224:239], v[76:79], v[88:91], v[224:239]
  ds_read_b64_tr_b16 v[68:69], v27 offset:8192
  ds_read_b64_tr_b16 v[70:71], v27 offset:9216
  s_waitcnt lgkmcnt(10)
  v_mfma_f32_32x32x16_bf16 v[176:191], v[72:75], v[92:95], v[176:191]
  v_mfma_f32_32x32x16_bf16 v[240:255], v[76:79], v[92:95], v[240:255]
  s_waitcnt lgkmcnt(7)
  v_mfma_f32_32x32x16_bf16 v[128:143], v[48:51], v[56:59], v[128:143]
  ds_read_b128 v[72:75], v23 offset:0
  s_waitcnt lgkmcnt(7)
  v_mfma_f32_32x32x16_bf16 v[192:207], v[52:55], v[56:59], v[192:207]
  ds_read_b64_tr_b16 v[80:81], v24 offset:12288
  ds_read_b64_tr_b16 v[82:83], v24 offset:13312
  s_waitcnt lgkmcnt(7)
  v_mfma_f32_32x32x16_bf16 v[144:159], v[48:51], v[60:63], v[144:159]
  ds_read_b128 v[76:79], v23 offset:4096
  v_mfma_f32_32x32x16_bf16 v[208:223], v[52:55], v[60:63], v[208:223]
  ds_read_b64_tr_b16 v[84:85], v25 offset:12288
  ds_read_b64_tr_b16 v[86:87], v25 offset:13312
  s_waitcnt lgkmcnt(8)
  v_mfma_f32_32x32x16_bf16 v[160:175], v[48:51], v[64:67], v[160:175]
  ds_read_b64_tr_b16 v[88:89], v26 offset:12288
  ds_read_b64_tr_b16 v[90:91], v26 offset:13312
  v_mfma_f32_32x32x16_bf16 v[224:239], v[52:55], v[64:67], v[224:239]
  ds_read_b64_tr_b16 v[92:93], v27 offset:12288
  ds_read_b64_tr_b16 v[94:95], v27 offset:13312
  s_waitcnt lgkmcnt(10)
  v_mfma_f32_32x32x16_bf16 v[176:191], v[48:51], v[68:71], v[176:191]
  v_mfma_f32_32x32x16_bf16 v[240:255], v[52:55], v[68:71], v[240:255]
  s_waitcnt lgkmcnt(7)
  v_mfma_f32_32x32x16_bf16 v[128:143], v[72:75], v[80:83], v[128:143]
  s_waitcnt lgkmcnt(6)
  v_mfma_f32_32x32x16_bf16 v[192:207], v[76:79], v[80:83], v[192:207]
  v_add_u32 v20, 0x10000, v20
  v_add_u32 v21, 0x10000, v21
  v_add_u32 v22, 0x10000, v22
  v_add_u32 v23, 0x10000, v23
  v_add_u32 v24, 0xfffe8000, v24
  v_add_u32 v25, 0xfffe8000, v25
  v_add_u32 v26, 0xfffe8000, v26
  v_add_u32 v27, 0xfffe8000, v27
  s_waitcnt lgkmcnt(0)
  s_waitcnt vmcnt(0)
  s_barrier
  ds_read_b128 v[48:51], v20 offset:0
  s_add_u32 m0, s58, 81920
  s_mov_b32 s57, 524288
  buffer_load_dwordx4 v8, s[64:67], s57 offen offset:0 lds
  v_mfma_f32_32x32x16_bf16 v[144:159], v[72:75], v[84:87], v[144:159]
  ds_read_b64_tr_b16 v[56:57], v24 offset:0
  ds_read_b64_tr_b16 v[58:59], v24 offset:1024
  buffer_load_dwordx4 v9, s[64:67], s57 offen offset:1024 lds
  v_mfma_f32_32x32x16_bf16 v[208:223], v[76:79], v[84:87], v[208:223]
  ds_read_b128 v[52:55], v20 offset:4096
  buffer_load_dwordx4 v10, s[64:67], s57 offen offset:2048 lds
  v_mfma_f32_32x32x16_bf16 v[160:175], v[72:75], v[88:91], v[160:175]
  ds_read_b64_tr_b16 v[60:61], v25 offset:0
  ds_read_b64_tr_b16 v[62:63], v25 offset:1024
  buffer_load_dwordx4 v11, s[64:67], s57 offen offset:3072 lds
  v_mfma_f32_32x32x16_bf16 v[224:239], v[76:79], v[88:91], v[224:239]
  ds_read_b64_tr_b16 v[64:65], v26 offset:0
  ds_read_b64_tr_b16 v[66:67], v26 offset:1024
  s_add_u32 m0, s58, 114688
  s_add_u32 s57, s93, 128
  buffer_load_dwordx4 v36, s[32:35], s57 offen offset:0 lds
  v_mfma_f32_32x32x16_bf16 v[176:191], v[72:75], v[92:95], v[176:191]
  ds_read_b64_tr_b16 v[68:69], v27 offset:0
  ds_read_b64_tr_b16 v[70:71], v27 offset:1024
  v_mfma_f32_32x32x16_bf16 v[240:255], v[76:79], v[92:95], v[240:255]
  s_waitcnt lgkmcnt(7)
  v_mfma_f32_32x32x16_bf16 v[128:143], v[48:51], v[56:59], v[128:143]
  ds_read_b128 v[72:75], v21 offset:0
  buffer_load_dwordx4 v37, s[32:35], s57 offen offset:1024 lds
  v_and_b32 v30, 31, v0
  v_lshlrev_b32 v30, 3, v30
  s_lshl_b32 s55, s60, 2
  s_lshr_b32 s56, s52, 1
  s_add_u32 s55, s55, s56
  s_mul_i32 s55, s55, 640
  s_add_u32 s55, s55, s62
  s_lshl_b32 s55, s55, 3
  s_add_u32 s55, s55, 524288
  s_sub_u32 s55, s55, 15360
  s_cmp_ge_u32 s52, 6
  s_cselect_b32 s55, s55, 0x7ff00000
  v_add_u32 v31, s55, v30
  buffer_load_dwordx2 v[4:5], v31, s[36:39], 0 offen
  s_waitcnt lgkmcnt(7)
  v_mfma_f32_32x32x16_bf16 v[192:207], v[52:55], v[56:59], v[192:207]
  ds_read_b64_tr_b16 v[80:81], v24 offset:4096
  ds_read_b64_tr_b16 v[82:83], v24 offset:5120
  s_lshl_b32 s55, s60, 2
  s_lshr_b32 s56, s52, 1
  s_add_u32 s55, s55, s56
  s_mul_i32 s55, s55, 640
  s_add_u32 s55, s55, s62
  s_lshl_b32 s55, s55, 3
  s_add_u32 s55, s55, 524288
  s_sub_u32 s55, s55, 10240
  s_cmp_ge_u32 s52, 4
  s_cselect_b32 s55, s55, 0x7ff00000
  v_add_u32 v31, s55, v30
  buffer_load_dwordx2 v[6:7], v31, s[36:39], 0 offen
  s_lshl_b32 s55, s60, 2
  s_lshr_b32 s56, s52, 1
  s_add_u32 s55, s55, s56
  s_mul_i32 s55, s55, 640
  s_add_u32 s55, s55, s62
  s_lshl_b32 s55, s55, 3
  s_add_u32 s55, s55, 524288
  s_sub_u32 s55, s55, 5120
  s_cmp_ge_u32 s52, 2
  s_cselect_b32 s55, s55, 0x7ff00000
  v_add_u32 v31, s55, v30
  buffer_load_dwordx2 v[14:15], v31, s[36:39], 0 offen
  s_waitcnt lgkmcnt(7)
  v_mfma_f32_32x32x16_bf16 v[144:159], v[48:51], v[60:63], v[144:159]
  ds_read_b128 v[76:79], v21 offset:4096
  v_mov_b32 v16, v12
  v_mov_b32 v17, v13
  v_mul_f32 v1, v17, v17
  v_mul_f32 v17, v16, v17
  v_mfma_f32_32x32x16_bf16 v[208:223], v[52:55], v[60:63], v[208:223]
  ds_read_b64_tr_b16 v[84:85], v25 offset:4096
  ds_read_b64_tr_b16 v[86:87], v25 offset:5120
  buffer_load_dwordx4 v38, s[32:35], s57 offen offset:2048 lds
  v_fma_f32 v16, v16, v16, -v1
  v_add_f32 v17, v17, v17
  v_mov_b32 v18, v16
  v_mov_b32 v19, v17
  s_waitcnt lgkmcnt(8)
  v_mfma_f32_32x32x16_bf16 v[160:175], v[48:51], v[64:67], v[160:175]
  ds_read_b64_tr_b16 v[88:89], v26 offset:4096
  ds_read_b64_tr_b16 v[90:91], v26 offset:5120
  v_mul_f32 v1, v19, v19
  v_mul_f32 v19, v18, v19
  v_fma_f32 v18, v18, v18, -v1
  v_add_f32 v19, v19, v19
  v_mfma_f32_32x32x16_bf16 v[224:239], v[52:55], v[64:67], v[224:239]
  ds_read_b64_tr_b16 v[92:93], v27 offset:4096
  ds_read_b64_tr_b16 v[94:95], v27 offset:5120
  s_lshl_b32 s55, s53, 3
  v_lshl_add_u32 v42, v0, 2, s55
  v_cmp_gt_u32 vcc, 2, v0
  v_mov_b32 v41, 252
  s_nop 0
  v_cndmask_b32 v42, v41, v42, vcc
  buffer_load_dword v41, v42, s[28:31], 0 offen sc0 sc1
  s_waitcnt lgkmcnt(10)
  v_mfma_f32_32x32x16_bf16 v[176:191], v[48:51], v[68:71], v[176:191]
  buffer_load_dwordx4 v39, s[32:35], s57 offen offset:3072 lds
  s_sub_u32 s55, 15, s54
  s_sub_u32 s63, 7, s52
  s_cmp_lt_u32 s52, 4
  s_cselect_b32 s72, s55, s54
  s_cselect_b32 s63, s52, s63
  s_sub_u32 s75, s55, s72
  s_lshl_b32 s78, s72, 2
  s_add_u32 s78, s78, s63
  s_sub_u32 s79, s72, 1
  s_lshl_b32 s77, s73, 13
  s_add_u32 s77, s77, 65536
  s_lshl_b32 s91, s53, 20
  s_lshl_b32 s76, s73, 14
  s_add_u32 s76, s76, s91
  s_add_u32 s76, s76, 32768
  v_mfma_f32_32x32x16_bf16 v[240:255], v[52:55], v[68:71], v[240:255]
  s_add_u32 s69, s91, 1032192
  s_and_b32 s55, s58, 4096
  s_add_u32 s91, s91, s55
  s_lshr_b32 s55, s73, 1
  s_lshl_b32 s55, s55, 14
  s_add_u32 s91, s91, s55
  s_lshl_b32 s88, s53, 9
  s_add_u32 s88, s88, 48234496
  s_mov_b32 s101, 1
  s_mov_b32 s100, 0
  s_lshl_b32 s89, s78, 8
  s_add_u32 s89, s89, s53
  s_add_u32 s89, s89, 48283648
  s_waitcnt lgkmcnt(7)
  v_mfma_f32_32x32x16_bf16 v[128:143], v[72:75], v[80:83], v[128:143]
  ds_read_b128 v[48:51], v22 offset:0
  s_lshl_b32 s90, s54, 8
  s_and_b32 s55, s2, 31
  s_add_u32 s90, s90, s55
  s_add_u32 s90, s90, 48263168
  s_cmp_lt_u32 s2, 160
  s_cselect_b32 s55, 4, 0
  s_cmp_eq_u32 s52, s55
  s_cselect_b32 s90, s90, 0
  s_min_u32 s55, s75, 2
  s_cmp_gt_u32 s75, 3
  s_cselect_b32 s55, 3, s55
  s_cmp_eq_u32 s52, 7
  s_cselect_b32 s90, s55, s90
  s_mov_b32 s4, s70
  s_mov_b32 s5, s71
  s_mov_b32 s6, 10485760
  s_mov_b32 s7, 0x00020000
  s_mov_b32 s8, s80
  s_mov_b32 s9, s81
  s_mov_b32 s10, 2621440
  s_mov_b32 s11, 0x00020000
  s_mov_b32 s12, s86
  s_mov_b32 s13, s87
  s_mov_b32 s14, 1280
  s_mov_b32 s15, 0x00020000
  s_waitcnt lgkmcnt(7)
  v_mfma_f32_32x32x16_bf16 v[192:207], v[76:79], v[80:83], v[192:207]
  ds_read_b64_tr_b16 v[56:57], v24 offset:8192
  ds_read_b64_tr_b16 v[58:59], v24 offset:9216
  s_bfe_u32 s48, s2, 0x30003
  s_lshr_b32 s49, s52, 2
  s_mul_i32 s41, s52, 2560
  s_and_b32 s44, s2, 3
  s_xor_b32 s44, s44, 0
  s_and_b32 s55, s2, 4
  s_lshr_b32 s56, s2, 6
  s_add_u32 s55, s55, s56
  s_lshl_b32 s45, s55, 3
  s_add_u32 s45, s45, s48
  s_lshl_b32 s55, s55, 2
  s_add_u32 s47, s55, s73
  s_add_u32 s46, s47, 32
  s_cmp_eq_u32 s44, 3
  s_cselect_b32 s47, s46, s47
  s_cselect_b32 s26, 22, 12
  s_cmp_eq_u32 s44, 1
  s_cselect_b32 s42, s46, s47
  s_cselect_b32 s26, 0, s26
  s_cselect_b32 s24, 24, 0
  s_cselect_b32 s25, 32, 24
  s_lshl_b32 s42, s42, 1
  s_add_u32 s42, s42, s49
  s_waitcnt lgkmcnt(7)
  v_mfma_f32_32x32x16_bf16 v[144:159], v[72:75], v[84:87], v[144:159]
  ds_read_b128 v[52:55], v22 offset:4096
  s_mul_i32 s55, s48, 655360
  s_add_u32 s55, s55, 67108864
  s_mul_i32 s56, s26, 20480
  s_add_u32 s23, s55, s56
  s_mul_i32 s56, s24, 20480
  s_add_u32 s22, s55, s56
  s_lshl_b32 s21, s46, 5
  s_add_u32 s21, s21, s26
  s_lshl_b32 s21, s21, 13
  s_add_u32 s21, s21, 50331648
  s_lshl_b32 s20, s47, 5
  s_add_u32 s20, s20, s24
  s_lshl_b32 s20, s20, 13
  s_add_u32 s20, s20, 50331648
  s_mul_i32 s55, s47, 81920
  s_add_u32 s55, s55, 42991616
  s_mul_i32 s56, s48, 204800
  s_add_u32 s56, s56, 73400320
  s_cmp_ge_u32 s44, 2
  s_cselect_b32 s20, s55, s20
  s_cselect_b32 s22, s56, s22
  s_cselect_b32 s25, 0, s25
  v_mfma_f32_32x32x16_bf16 v[208:223], v[76:79], v[84:87], v[208:223]
  ds_read_b64_tr_b16 v[60:61], v25 offset:8192
  ds_read_b64_tr_b16 v[62:63], v25 offset:9216
  s_lshl_b32 s47, s47, 8
  s_add_u32 s47, s47, 48283648
  s_lshl_b32 s46, s46, 8
  s_add_u32 s46, s46, 48283648
  s_andn2_b32 s47, s47, 0x3ff
  s_mul_i32 s43, s45, 3
  s_add_u32 s43, s43, s44
  s_lshl_b32 s43, s43, 3
  s_add_u32 s43, s43, s52
  s_mul_i32 s43, s43, 5120
  s_add_u32 s43, s43, 100663296
  s_waitcnt lgkmcnt(8)
  v_mfma_f32_32x32x16_bf16 v[160:175], v[72:75], v[88:91], v[160:175]
  ds_read_b64_tr_b16 v[64:65], v26 offset:8192
  ds_read_b64_tr_b16 v[66:67], v26 offset:9216
  s_lshl_b32 s45, s45, 6
  s_add_u32 s45, s45, s52
  s_lshl_b32 s45, s45, 2
  s_add_u32 s45, s45, 48267264
  s_and_b32 s40, s54, 1
  s_lshl_b32 s40, s40, 16
  s_xor_b32 s27, s40, 0x10000
  s_add_u32 s50, s27, s41
  s_add_u32 s51, s40, s41
  v_mfma_f32_32x32x16_bf16 v[224:239], v[76:79], v[88:91], v[224:239]
  ds_read_b64_tr_b16 v[68:69], v27 offset:8192
  ds_read_b64_tr_b16 v[70:71], v27 offset:9216
  s_waitcnt lgkmcnt(10)
  v_mfma_f32_32x32x16_bf16 v[176:191], v[72:75], v[92:95], v[176:191]
  s_waitcnt vmcnt(3)
  v_mfma_f32_32x32x16_bf16 v[240:255], v[76:79], v[92:95], v[240:255]
  v_fma_f32 v1, v16, v4, v6
  v_fma_f32 v2, v16, v5, v7
  v_fma_f32 v30, -v17, v5, v1
  v_fma_f32 v31, v17, v4, v2
  s_waitcnt lgkmcnt(7)
  v_mfma_f32_32x32x16_bf16 v[128:143], v[48:51], v[56:59], v[128:143]
  ds_read_b128 v[76:79], v23 offset:4096
  v_fma_f32 v1, v16, v30, v14
  v_fma_f32 v2, v16, v31, v15
  v_fma_f32 v6, -v17, v31, v1
  v_fma_f32 v7, v17, v30, v2
  s_waitcnt lgkmcnt(7)
  v_mfma_f32_32x32x16_bf16 v[192:207], v[52:55], v[56:59], v[192:207]
  ds_read_b64_tr_b16 v[80:81], v24 offset:12288
  ds_read_b64_tr_b16 v[82:83], v24 offset:13312
  v_fma_f32 v1, v16, v6, v34
  v_fma_f32 v2, v16, v7, v35
  v_fma_f32 v34, -v17, v7, v1
  v_fma_f32 v35, v17, v6, v2
  s_waitcnt lgkmcnt(7)
  v_mfma_f32_32x32x16_bf16 v[144:159], v[48:51], v[60:63], v[144:159]
  ds_read_b64_tr_b16 v[84:85], v25 offset:12288
  ds_read_b64_tr_b16 v[86:87], v25 offset:13312
  s_mul_i32 s55, s60, 640
  s_add_u32 s55, s55, s62
  s_lshl_b32 s55, s55, 3
  s_cmp_ge_u32 s52, 6
  s_cselect_b32 s56, 0, 0x7ff00000
  v_or_b32 v33, s56, v33
  buffer_store_dwordx2 v[34:35], v33, s[36:39], s55 offen sc0 sc1
  s_bitcmp1_b32 s52, 1
  s_cselect_b64 vcc, -1, 0
  v_cndmask_b32 v4, 1.0, v16, vcc
  v_cndmask_b32 v5, 0, v17, vcc
  s_bitcmp1_b32 s52, 2
  s_cselect_b64 vcc, -1, 0
  v_cndmask_b32 v30, 1.0, v18, vcc
  v_cndmask_b32 v31, 0, v19, vcc
  v_mfma_f32_32x32x16_bf16 v[208:223], v[52:55], v[60:63], v[208:223]
  ds_read_b64_tr_b16 v[88:89], v26 offset:12288
  ds_read_b64_tr_b16 v[90:91], v26 offset:13312
  v_mul_f32 v1, v4, v30
  v_fma_f32 v1, -v5, v31, v1
  v_mul_f32 v2, v4, v31
  v_fma_f32 v5, v5, v30, v2
  s_waitcnt lgkmcnt(9)
  v_mfma_f32_32x32x16_bf16 v[160:175], v[48:51], v[64:67], v[160:175]
  ds_read_b64_tr_b16 v[92:93], v27 offset:12288
  ds_read_b64_tr_b16 v[94:95], v27 offset:13312
  v_mov_b32 v4, v1
  v_mul_f32 v1, v19, v19
  v_mul_f32 v19, v18, v19
  v_fma_f32 v18, v18, v18, -v1
  v_mfma_f32_32x32x16_bf16 v[224:239], v[52:55], v[64:67], v[224:239]
  ds_read_b128 v[72:75], v23 offset:0
  v_add_f32 v19, v19, v19
  v_mov_b32 v16, v18
  v_mov_b32 v17, v19
  v_mul_f32 v1, v17, v17
  s_waitcnt lgkmcnt(10)
  v_mfma_f32_32x32x16_bf16 v[176:191], v[48:51], v[68:71], v[176:191]
  v_mul_f32 v17, v16, v17
  v_fma_f32 v16, v16, v16, -v1
  v_add_f32 v17, v17, v17
  v_cmp_gt_u32 vcc, 32, v0
  s_nop 1
  v_cndmask_b32 v12, v12, 1.0, vcc
  v_cndmask_b32 v13, v13, 0, vcc
  v_mfma_f32_32x32x16_bf16 v[240:255], v[52:55], v[68:71], v[240:255]
  s_waitcnt vmcnt(2)
.Ldc56c:
  v_readlane_b32 s55, v41, 2
  v_readlane_b32 s56, v41, 0
  v_readlane_b32 s94, v41, 1
  s_bitcmp0_b32 s55, 31
  s_cbranch_scc1 .Ldc56s
.Ldc56k:
  s_xor_b32 s56, s56, s100
  s_xor_b32 s94, s94, s100
  s_or_b32 s94, s94, s56
  s_and_b32 s94, s94, 0x7f7f7f7f
  s_mov_b32 s94, 1
  s_mov_b32 s80, s16
  s_mov_b32 s81, s17
  s_mov_b32 s83, 0x00020000
  s_mov_b32 s84, s16
  s_mov_b32 s85, s17
  s_mov_b32 s87, 0x00020000
  s_cmp_lt_u32 s54, 2
  s_cselect_b32 s82, s18, 0
  s_cselect_b32 s86, 0, s18
  s_waitcnt lgkmcnt(7)
  v_mfma_f32_32x32x16_bf16 v[192:207], v[76:79], v[80:83], v[192:207]
  s_waitcnt lgkmcnt(5)
  v_mfma_f32_32x32x16_bf16 v[208:223], v[76:79], v[84:87], v[208:223]
  s_add_u32 s55, s74, 0xfffe8000
  v_add_u32 v20, s55, v20
  v_add_u32 v21, s55, v21
  v_add_u32 v22, s55, v22
  v_add_u32 v23, s55, v23
  v_add_u32 v24, 0xc000, v24
  v_add_u32 v25, 0xc000, v25
  v_add_u32 v26, 0xc000, v26
  v_add_u32 v27, 0xc000, v27
  s_waitcnt lgkmcnt(0)
  s_barrier
  ds_read_b128 v[48:51], v20 offset:0
  s_add_u32 m0, s58, 147456
  s_add_u32 s57, s93, 256
  buffer_load_dwordx4 v36, s[32:35], s57 offen offset:0 lds
  v_mfma_f32_32x32x16_bf16 v[224:239], v[76:79], v[88:91], v[224:239]
  ds_read_b64_tr_b16 v[52:53], v24 offset:0
  ds_read_b64_tr_b16 v[54:55], v24 offset:1024
  buffer_load_dwordx4 v37, s[32:35], s57 offen offset:1024 lds
  v_mfma_f32_32x32x16_bf16 v[240:255], v[76:79], v[92:95], v[240:255]
  ds_read_b64_tr_b16 v[56:57], v25 offset:0
  ds_read_b64_tr_b16 v[58:59], v25 offset:1024
  buffer_load_dwordx4 v38, s[32:35], s57 offen offset:2048 lds
  v_mfma_f32_32x32x16_bf16 v[128:143], v[72:75], v[80:83], v[128:143]
  ds_read_b64_tr_b16 v[60:61], v26 offset:0
  ds_read_b64_tr_b16 v[62:63], v26 offset:1024
  v_cvt_pk_bf16_f32 v192, v192, v193
  v_cvt_pk_bf16_f32 v193, v194, v195
  v_cvt_pk_bf16_f32 v194, v196, v197
  v_cvt_pk_bf16_f32 v195, v198, v199
  v_cvt_pk_bf16_f32 v196, v200, v201
  v_cvt_pk_bf16_f32 v197, v202, v203
  v_cvt_pk_bf16_f32 v198, v204, v205
  v_cvt_pk_bf16_f32 v199, v206, v207
  buffer_load_dwordx4 v39, s[32:35], s57 offen offset:3072 lds
  v_mfma_f32_32x32x16_bf16 v[144:159], v[72:75], v[84:87], v[144:159]
  ds_read_b64_tr_b16 v[64:65], v27 offset:0
  ds_read_b64_tr_b16 v[66:67], v27 offset:1024
  v_cvt_pk_bf16_f32 v208, v208, v209
  v_cvt_pk_bf16_f32 v209, v210, v211
  v_cvt_pk_bf16_f32 v210, v212, v213
  v_cvt_pk_bf16_f32 v211, v214, v215
  v_cvt_pk_bf16_f32 v212, v216, v217
  v_cvt_pk_bf16_f32 v213, v218, v219
  v_cvt_pk_bf16_f32 v214, v220, v221
  v_cvt_pk_bf16_f32 v215, v222, v223
  s_add_u32 m0, s58, 16384
  s_mov_b32 s57, 1572864
  buffer_load_dwordx4 v8, s[64:67], s57 offen offset:0 lds
  v_mfma_f32_32x32x16_bf16 v[160:175], v[72:75], v[88:91], v[160:175]
  v_cvt_pk_bf16_f32 v224, v224, v225
  v_cvt_pk_bf16_f32 v225, v226, v227
  v_cvt_pk_bf16_f32 v226, v228, v229
  v_cvt_pk_bf16_f32 v227, v230, v231
  v_cvt_pk_bf16_f32 v228, v232, v233
  v_cvt_pk_bf16_f32 v229, v234, v235
  v_cvt_pk_bf16_f32 v230, v236, v237
  v_cvt_pk_bf16_f32 v231, v238, v239
  buffer_load_dwordx4 v9, s[64:67], s57 offen offset:1024 lds
  v_mfma_f32_32x32x16_bf16 v[176:191], v[72:75], v[92:95], v[176:191]
  v_cvt_pk_bf16_f32 v240, v240, v241
  v_cvt_pk_bf16_f32 v241, v242, v243
  v_cvt_pk_bf16_f32 v242, v244, v245
  v_cvt_pk_bf16_f32 v243, v246, v247
  v_cvt_pk_bf16_f32 v244, v248, v249
  v_cvt_pk_bf16_f32 v245, v250, v251
  v_cvt_pk_bf16_f32 v246, v252, v253
  v_cvt_pk_bf16_f32 v247, v254, v255
  buffer_load_dwordx4 v10, s[64:67], s57 offen offset:2048 lds
  v_cvt_pk_bf16_f32 v200, v128, v129
  v_cvt_pk_bf16_f32 v201, v130, v131
  v_cvt_pk_bf16_f32 v202, v132, v133
  v_cvt_pk_bf16_f32 v203, v134, v135
  v_cvt_pk_bf16_f32 v204, v136, v137
  v_cvt_pk_bf16_f32 v205, v138, v139
  v_cvt_pk_bf16_f32 v206, v140, v141
  v_cvt_pk_bf16_f32 v207, v142, v143
  s_waitcnt lgkmcnt(6)
  v_mfma_f32_32x32x16_bf16 v[128:143], v[52:55], v[48:51], 0
  ds_read_b128 v[72:75], v21 offset:0
  ds_read_b64_tr_b16 v[76:77], v24 offset:4096
  ds_read_b64_tr_b16 v[78:79], v24 offset:5120
  buffer_load_dwordx4 v11, s[64:67], s57 offen offset:3072 lds
  v_lshl_add_u32 v42, v0, 2, 4
  v_subrev_u32 v42, s3, v42
  v_med3_i32 v42, v42, 0, 4
  v_lshlrev_b32 v42, 2, v42
  v_cvt_pk_bf16_f32 v216, v144, v145
  v_cvt_pk_bf16_f32 v217, v146, v147
  v_cvt_pk_bf16_f32 v218, v148, v149
  v_cvt_pk_bf16_f32 v219, v150, v151
  v_cvt_pk_bf16_f32 v220, v152, v153
  v_cvt_pk_bf16_f32 v221, v154, v155
  v_cvt_pk_bf16_f32 v222, v156, v157
  v_cvt_pk_bf16_f32 v223, v158, v159
  s_waitcnt lgkmcnt(7)
  v_mfma_f32_32x32x16_bf16 v[144:159], v[56:59], v[48:51], 0
  ds_read_b64_tr_b16 v[80:81], v25 offset:4096
  ds_read_b64_tr_b16 v[82:83], v25 offset:5120
  v_mov_b32 v33, 0x01010101
  v_lshrrev_b32 v33, v42, v33
  v_lshrrev_b32 v42, v42, v33
  v_min_u32 v33, 3, v0
  v_cvt_pk_bf16_f32 v232, v160, v161
  v_cvt_pk_bf16_f32 v233, v162, v163
  v_cvt_pk_bf16_f32 v234, v164, v165
  v_cvt_pk_bf16_f32 v235, v166, v167
  v_cvt_pk_bf16_f32 v236, v168, v169
  v_cvt_pk_bf16_f32 v237, v170, v171
  v_cvt_pk_bf16_f32 v238, v172, v173
  v_cvt_pk_bf16_f32 v239, v174, v175
  s_waitcnt lgkmcnt(7)
  v_mfma_f32_32x32x16_bf16 v[160:175], v[60:63], v[48:51], 0
  ds_read_b64_tr_b16 v[84:85], v26 offset:4096
  ds_read_b64_tr_b16 v[86:87], v26 offset:5120
  s_lshl_b32 s55, s61, 10
  s_add_u32 s55, s55, 6307840
  v_lshl_add_u32 v33, v33, 8, s55
  v_cvt_pk_bf16_f32 v248, v176, v177
  v_cvt_pk_bf16_f32 v249, v178, v179
  v_cvt_pk_bf16_f32 v250, v180, v181
  v_cvt_pk_bf16_f32 v251, v182, v183
  v_cvt_pk_bf16_f32 v252, v184, v185
  v_cvt_pk_bf16_f32 v253, v186, v187
  v_cvt_pk_bf16_f32 v254, v188, v189
  v_cvt_pk_bf16_f32 v255, v190, v191
  s_waitcnt lgkmcnt(7)
  v_mfma_f32_32x32x16_bf16 v[176:191], v[64:67], v[48:51], 0
  ds_read_b64_tr_b16 v[88:89], v27 offset:4096
  ds_read_b64_tr_b16 v[90:91], v27 offset:5120
  s_waitcnt lgkmcnt(6)
  v_mfma_f32_32x32x16_bf16 v[128:143], v[76:79], v[72:75], v[128:143]
  ds_read_b128 v[48:51], v22 offset:0
  ds_read_b64_tr_b16 v[52:53], v24 offset:8192
  ds_read_b64_tr_b16 v[54:55], v24 offset:9216
  s_waitcnt lgkmcnt(7)
  v_mfma_f32_32x32x16_bf16 v[144:159], v[80:83], v[72:75], v[144:159]
  ds_read_b64_tr_b16 v[56:57], v25 offset:8192
  ds_read_b64_tr_b16 v[58:59], v25 offset:9216
  s_waitcnt lgkmcnt(7)
  v_mfma_f32_32x32x16_bf16 v[160:175], v[84:87], v[72:75], v[160:175]
  ds_read_b64_tr_b16 v[60:61], v26 offset:8192
  ds_read_b64_tr_b16 v[62:63], v26 offset:9216
  s_add_u32 s55, s59, 16384
  s_cmp_lg_u32 s94, 0
  s_cbranch_scc1 .Lkv57g
  buffer_store_dwordx4 v[192:195], v32, s[80:83], s55 offen offset:0
.Lkv57r:
  s_waitcnt lgkmcnt(7)
  v_mfma_f32_32x32x16_bf16 v[176:191], v[88:91], v[72:75], v[176:191]
  ds_read_b64_tr_b16 v[64:65], v27 offset:8192
  ds_read_b64_tr_b16 v[66:67], v27 offset:9216
  s_waitcnt lgkmcnt(6)
  v_mfma_f32_32x32x16_bf16 v[128:143], v[52:55], v[48:51], v[128:143]
  ds_read_b128 v[72:75], v23 offset:0
  ds_read_b64_tr_b16 v[76:77], v24 offset:12288
  ds_read_b64_tr_b16 v[78:79], v24 offset:13312
  s_waitcnt lgkmcnt(7)
  v_mfma_f32_32x32x16_bf16 v[144:159], v[56:59], v[48:51], v[144:159]
  ds_read_b64_tr_b16 v[80:81], v25 offset:12288
  ds_read_b64_tr_b16 v[82:83], v25 offset:13312
  s_waitcnt lgkmcnt(7)
  v_mfma_f32_32x32x16_bf16 v[160:175], v[60:63], v[48:51], v[160:175]
  ds_read_b64_tr_b16 v[84:85], v26 offset:12288
  ds_read_b64_tr_b16 v[86:87], v26 offset:13312
  s_add_u32 s55, s59, 16384
  s_cmp_lg_u32 s94, 0
  s_cbranch_scc1 .Lkv58g
  buffer_store_dwordx4 v[196:199], v32, s[80:83], s55 offen offset:1024
.Lkv58r:
  s_add_u32 s55, s59, 16384
  s_cmp_lg_u32 s94, 0
  s_cbranch_scc1 .Lkv59g
  buffer_store_dwordx4 v[192:195], v32, s[84:87], s55 offen offset:0
.Lkv59r:
  s_waitcnt lgkmcnt(7)
  v_mfma_f32_32x32x16_bf16 v[176:191], v[64:67], v[48:51], v[176:191]
  ds_read_b64_tr_b16 v[88:89], v27 offset:12288
  ds_read_b64_tr_b16 v[90:91], v27 offset:13312
  s_waitcnt lgkmcnt(6)
  v_mfma_f32_32x32x16_bf16 v[128:143], v[76:79], v[72:75], v[128:143]
  v_add_u32 v20, 0x10000, v20
  v_add_u32 v21, 0x10000, v21
  v_add_u32 v22, 0x10000, v22
  v_add_u32 v23, 0x10000, v23
  s_waitcnt lgkmcnt(0)
  s_waitcnt vmcnt(11)
  s_barrier
  ds_read_b128 v[48:51], v20 offset:0
  ds_read_b64_tr_b16 v[52:53], v24 offset:16384
  ds_read_b64_tr_b16 v[54:55], v24 offset:17408
  v_mfma_f32_32x32x16_bf16 v[144:159], v[80:83], v[72:75], v[144:159]
  ds_read_b64_tr_b16 v[56:57], v25 offset:16384
  ds_read_b64_tr_b16 v[58:59], v25 offset:17408
  ds_read_b64_tr_b16 v[60:61], v26 offset:16384
  ds_read_b64_tr_b16 v[62:63], v26 offset:17408
  s_add_u32 m0, s58, 49152
  s_add_u32 s57, s93, 384
  buffer_load_dwordx4 v36, s[32:35], s57 offen offset:0 lds
  v_mfma_f32_32x32x16_bf16 v[160:175], v[84:87], v[72:75], v[160:175]
  ds_read_b64_tr_b16 v[64:65], v27 offset:16384
  ds_read_b64_tr_b16 v[66:67], v27 offset:17408
  s_add_u32 s55, s59, 0
  s_cmp_lg_u32 s94, 0
  s_cbranch_scc1 .Lkv60g
  buffer_store_dwordx4 v[200:203], v32, s[80:83], s55 offen offset:0
.Lkv60r:
  v_mfma_f32_32x32x16_bf16 v[176:191], v[88:91], v[72:75], v[176:191]
  s_waitcnt lgkmcnt(6)
  v_mfma_f32_32x32x16_bf16 v[128:143], v[52:55], v[48:51], v[128:143]
  ds_read_b128 v[72:75], v21 offset:0
  ds_read_b64_tr_b16 v[76:77], v24 offset:20480
  ds_read_b64_tr_b16 v[78:79], v24 offset:21504
  buffer_load_dwordx4 v37, s[32:35], s57 offen offset:1024 lds
  s_waitcnt lgkmcnt(7)
  v_mfma_f32_32x32x16_bf16 v[144:159], v[56:59], v[48:51], v[144:159]
  ds_read_b64_tr_b16 v[80:81], v25 offset:20480
  ds_read_b64_tr_b16 v[82:83], v25 offset:21504
  s_waitcnt lgkmcnt(7)
  v_mfma_f32_32x32x16_bf16 v[160:175], v[60:63], v[48:51], v[160:175]
  ds_read_b64_tr_b16 v[84:85], v26 offset:20480
  ds_read_b64_tr_b16 v[86:87], v26 offset:21504
  s_add_u32 s55, s59, 0
  s_cmp_lg_u32 s94, 0
  s_cbranch_scc1 .Lkv61g
  buffer_store_dwordx4 v[204:207], v32, s[80:83], s55 offen offset:1024
.Lkv61r:
  s_waitcnt lgkmcnt(7)
  v_mfma_f32_32x32x16_bf16 v[176:191], v[64:67], v[48:51], v[176:191]
  ds_read_b64_tr_b16 v[88:89], v27 offset:20480
  ds_read_b64_tr_b16 v[90:91], v27 offset:21504
  buffer_load_dwordx4 v38, s[32:35], s57 offen offset:2048 lds
  s_waitcnt lgkmcnt(6)
  v_mfma_f32_32x32x16_bf16 v[128:143], v[76:79], v[72:75], v[128:143]
  ds_read_b128 v[48:51], v22 offset:0
  ds_read_b64_tr_b16 v[52:53], v24 offset:24576
  ds_read_b64_tr_b16 v[54:55], v24 offset:25600
  s_waitcnt lgkmcnt(7)
  v_mfma_f32_32x32x16_bf16 v[144:159], v[80:83], v[72:75], v[144:159]
  ds_read_b64_tr_b16 v[56:57], v25 offset:24576
  ds_read_b64_tr_b16 v[58:59], v25 offset:25600
  s_add_u32 s55, s59, 16384
  s_cmp_lg_u32 s94, 0
  s_cbranch_scc1 .Lkv62g
  buffer_store_dwordx4 v[196:199], v32, s[84:87], s55 offen offset:1024
.Lkv62r:
  s_waitcnt lgkmcnt(7)
  v_mfma_f32_32x32x16_bf16 v[160:175], v[84:87], v[72:75], v[160:175]
  ds_read_b64_tr_b16 v[60:61], v26 offset:24576
  ds_read_b64_tr_b16 v[62:63], v26 offset:25600
  buffer_load_dwordx4 v39, s[32:35], s57 offen offset:3072 lds
  s_add_u32 s55, s59, 16384
  s_cmp_lg_u32 s94, 0
  s_cbranch_scc1 .Lkv63g
  buffer_store_dwordx4 v[208:211], v32, s[80:83], s55 offen offset:2048
.Lkv63r:
  s_waitcnt lgkmcnt(7)
  v_mfma_f32_32x32x16_bf16 v[176:191], v[88:91], v[72:75], v[176:191]
  ds_read_b64_tr_b16 v[64:65], v27 offset:24576
  ds_read_b64_tr_b16 v[66:67], v27 offset:25600
  s_waitcnt lgkmcnt(6)
  v_mfma_f32_32x32x16_bf16 v[128:143], v[52:55], v[48:51], v[128:143]
  ds_read_b128 v[72:75], v23 offset:0
  ds_read_b64_tr_b16 v[76:77], v24 offset:28672
  ds_read_b64_tr_b16 v[78:79], v24 offset:29696
  s_waitcnt lgkmcnt(7)
  v_mfma_f32_32x32x16_bf16 v[144:159], v[56:59], v[48:51], v[144:159]
  ds_read_b64_tr_b16 v[80:81], v25 offset:28672
  ds_read_b64_tr_b16 v[82:83], v25 offset:29696
  s_waitcnt lgkmcnt(7)
  v_mfma_f32_32x32x16_bf16 v[160:175], v[60:63], v[48:51], v[160:175]
  ds_read_b64_tr_b16 v[84:85], v26 offset:28672
  ds_read_b64_tr_b16 v[86:87], v26 offset:29696
  s_add_u32 s55, s59, 16384
  s_cmp_lg_u32 s94, 0
  s_cbranch_scc1 .Lkv64g
  buffer_store_dwordx4 v[212:215], v32, s[80:83], s55 offen offset:3072
.Lkv64r:
  s_waitcnt lgkmcnt(7)
  v_mfma_f32_32x32x16_bf16 v[176:191], v[64:67], v[48:51], v[176:191]
  ds_read_b64_tr_b16 v[88:89], v27 offset:28672
  ds_read_b64_tr_b16 v[90:91], v27 offset:29696
  s_waitcnt lgkmcnt(6)
  v_mfma_f32_32x32x16_bf16 v[128:143], v[76:79], v[72:75], v[128:143]
  v_add_u32 v20, 0x8000, v20
  v_add_u32 v21, 0x8000, v21
  v_add_u32 v22, 0x8000, v22
  v_add_u32 v23, 0x8000, v23
  v_add_u32 v24, 0xffff0000, v24
  v_add_u32 v25, 0xffff0000, v25
  v_add_u32 v26, 0xffff0000, v26
  v_add_u32 v27, 0xffff0000, v27
  s_waitcnt lgkmcnt(0)
  s_waitcnt vmcnt(12)
  s_barrier
  ds_read_b128 v[48:51], v20 offset:0
  ds_read_b64_tr_b16 v[52:53], v24 offset:0
  ds_read_b64_tr_b16 v[54:55], v24 offset:1024
  s_add_u32 m0, s58, 81920
  s_add_u32 s57, s93, 512
  buffer_load_dwordx4 v36, s[32:35], s57 offen offset:0 lds
  buffer_load_dword v41, v33, s[36:39], 0 offen sc0 sc1
  v_and_b32 v34, 31, v0
  v_lshrrev_b32 v35, 5, v0
  v_mfma_f32_32x32x16_bf16 v[144:159], v[80:83], v[72:75], v[144:159]
  ds_read_b64_tr_b16 v[56:57], v25 offset:0
  ds_read_b64_tr_b16 v[58:59], v25 offset:1024
  ds_read_b64_tr_b16 v[60:61], v26 offset:0
  ds_read_b64_tr_b16 v[62:63], v26 offset:1024
  buffer_load_dwordx4 v37, s[32:35], s57 offen offset:1024 lds
  v_mul_u32_u24 v35, 5120, v35
  v_lshl_add_u32 v34, v34, 3, v35
  s_mul_i32 s55, s60, 640
  s_add_u32 s55, s55, s62
  s_lshl_b32 s55, s55, 3
  s_sub_u32 s55, s55, 81920
  v_add_u32 v34, s55, v34
  v_mfma_f32_32x32x16_bf16 v[160:175], v[84:87], v[72:75], v[160:175]
  ds_read_b64_tr_b16 v[64:65], v27 offset:0
  ds_read_b64_tr_b16 v[66:67], v27 offset:1024
  buffer_load_dwordx4 v38, s[32:35], s57 offen offset:2048 lds
  s_add_u32 s55, s59, 0
  s_cmp_lg_u32 s94, 0
  s_cbranch_scc1 .Lkv65g
  buffer_store_dwordx4 v[216:219], v32, s[80:83], s55 offen offset:2048
.Lkv65r:
  v_mfma_f32_32x32x16_bf16 v[176:191], v[88:91], v[72:75], v[176:191]
  buffer_load_dwordx4 v39, s[32:35], s57 offen offset:3072 lds
  s_waitcnt lgkmcnt(6)
  v_mfma_f32_32x32x16_bf16 v[128:143], v[52:55], v[48:51], v[128:143]
  ds_read_b128 v[72:75], v21 offset:0
  ds_read_b64_tr_b16 v[76:77], v24 offset:4096
  ds_read_b64_tr_b16 v[78:79], v24 offset:5120
  s_add_u32 m0, s58, 114688
  s_mov_b32 s57, 2621440
  buffer_load_dwordx4 v8, s[64:67], s57 offen offset:0 lds
  s_add_u32 s55, s59, 0
  s_cmp_lg_u32 s94, 0
  s_cbranch_scc1 .Lkv66g
  buffer_store_dwordx4 v[200:203], v32, s[84:87], s55 offen offset:0
.Lkv66r:
  s_waitcnt lgkmcnt(7)
  v_mfma_f32_32x32x16_bf16 v[144:159], v[56:59], v[48:51], v[144:159]
  ds_read_b64_tr_b16 v[80:81], v25 offset:4096
  ds_read_b64_tr_b16 v[82:83], v25 offset:5120
  buffer_load_dwordx4 v9, s[64:67], s57 offen offset:1024 lds
  s_waitcnt lgkmcnt(7)
  v_mfma_f32_32x32x16_bf16 v[160:175], v[60:63], v[48:51], v[160:175]
  ds_read_b64_tr_b16 v[84:85], v26 offset:4096
  ds_read_b64_tr_b16 v[86:87], v26 offset:5120
  buffer_load_dwordx4 v10, s[64:67], s57 offen offset:2048 lds
  s_add_u32 s55, s59, 0
  s_cmp_lg_u32 s94, 0
  s_cbranch_scc1 .Lkv67g
  buffer_store_dwordx4 v[220:223], v32, s[80:83], s55 offen offset:3072
.Lkv67r:
  s_waitcnt lgkmcnt(7)
  v_mfma_f32_32x32x16_bf16 v[176:191], v[64:67], v[48:51], v[176:191]
  ds_read_b64_tr_b16 v[88:89], v27 offset:4096
  ds_read_b64_tr_b16 v[90:91], v27 offset:5120
  buffer_load_dwordx4 v11, s[64:67], s57 offen offset:3072 lds
  s_waitcnt lgkmcnt(6)
  v_mfma_f32_32x32x16_bf16 v[128:143], v[76:79], v[72:75], v[128:143]
  ds_read_b128 v[48:51], v22 offset:0
  ds_read_b64_tr_b16 v[52:53], v24 offset:8192
  ds_read_b64_tr_b16 v[54:55], v24 offset:9216
  s_waitcnt lgkmcnt(7)
  v_mfma_f32_32x32x16_bf16 v[144:159], v[80:83], v[72:75], v[144:159]
  ds_read_b64_tr_b16 v[56:57], v25 offset:8192
  ds_read_b64_tr_b16 v[58:59], v25 offset:9216
  s_waitcnt lgkmcnt(7)
  v_mfma_f32_32x32x16_bf16 v[160:175], v[84:87], v[72:75], v[160:175]
  ds_read_b64_tr_b16 v[60:61], v26 offset:8192
  ds_read_b64_tr_b16 v[62:63], v26 offset:9216
  s_add_u32 s55, s59, 20480
  s_cmp_lg_u32 s94, 0
  s_cbranch_scc1 .Lkv68g
  buffer_store_dwordx4 v[224:227], v32, s[80:83], s55 offen offset:0
.Lkv68r:
  s_waitcnt lgkmcnt(7)
  v_mfma_f32_32x32x16_bf16 v[176:191], v[88:91], v[72:75], v[176:191]
  ds_read_b64_tr_b16 v[64:65], v27 offset:8192
  ds_read_b64_tr_b16 v[66:67], v27 offset:9216
  s_waitcnt lgkmcnt(6)
  v_mfma_f32_32x32x16_bf16 v[128:143], v[52:55], v[48:51], v[128:143]
  ds_read_b128 v[72:75], v23 offset:0
  ds_read_b64_tr_b16 v[76:77], v24 offset:12288
  ds_read_b64_tr_b16 v[78:79], v24 offset:13312
  s_waitcnt lgkmcnt(7)
  v_mfma_f32_32x32x16_bf16 v[144:159], v[56:59], v[48:51], v[144:159]
  ds_read_b64_tr_b16 v[80:81], v25 offset:12288
  ds_read_b64_tr_b16 v[82:83], v25 offset:13312
  s_waitcnt lgkmcnt(7)
  v_mfma_f32_32x32x16_bf16 v[160:175], v[60:63], v[48:51], v[160:175]
  ds_read_b64_tr_b16 v[84:85], v26 offset:12288
  ds_read_b64_tr_b16 v[86:87], v26 offset:13312
  s_add_u32 s55, s59, 20480
  s_cmp_lg_u32 s94, 0
  s_cbranch_scc1 .Lkv69g
  buffer_store_dwordx4 v[228:231], v32, s[80:83], s55 offen offset:1024
.Lkv69r:
  s_waitcnt lgkmcnt(7)
  v_mfma_f32_32x32x16_bf16 v[176:191], v[64:67], v[48:51], v[176:191]
  ds_read_b64_tr_b16 v[88:89], v27 offset:12288
  ds_read_b64_tr_b16 v[90:91], v27 offset:13312
  s_add_u32 s55, s59, 0
  s_cmp_lg_u32 s94, 0
  s_cbranch_scc1 .Lkv70g
  buffer_store_dwordx4 v[204:207], v32, s[84:87], s55 offen offset:1024
.Lkv70r:
  s_waitcnt lgkmcnt(6)
  v_mfma_f32_32x32x16_bf16 v[128:143], v[76:79], v[72:75], v[128:143]
  v_add_u32 v20, 0xfffe8000, v20
  v_add_u32 v21, 0xfffe8000, v21
  v_add_u32 v22, 0xfffe8000, v22
  v_add_u32 v23, 0xfffe8000, v23
  s_waitcnt lgkmcnt(0)
  s_waitcnt vmcnt(17)
  s_barrier
  ds_read_b128 v[48:51], v20 offset:0
  ds_read_b64_tr_b16 v[52:53], v24 offset:16384
  ds_read_b64_tr_b16 v[54:55], v24 offset:17408
  s_waitcnt vmcnt(13)
.Lpl71c:
  v_and_b32 v1, v41, v42
  v_cmp_ne_u32 vcc, v1, v42
  s_nop 0
  s_cbranch_vccnz .Lpl71s
.Lpl71k:
  buffer_load_dwordx2 v[192:193], v34, s[36:39], 0 offen
  v_add_u32 v35, 10240, v34
  v_mfma_f32_32x32x16_bf16 v[144:159], v[80:83], v[72:75], v[144:159]
  ds_read_b64_tr_b16 v[56:57], v25 offset:16384
  ds_read_b64_tr_b16 v[58:59], v25 offset:17408
  ds_read_b64_tr_b16 v[60:61], v26 offset:16384
  ds_read_b64_tr_b16 v[62:63], v26 offset:17408
  s_add_u32 m0, s58, 147456
  s_add_u32 s57, s93, 640
  buffer_load_dwordx4 v36, s[32:35], s57 offen offset:0 lds
  buffer_load_dwordx2 v[194:195], v35, s[36:39], 0 offen
  v_add_u32 v34, 10240, v35
  buffer_load_dwordx2 v[196:197], v34, s[36:39], 0 offen
  v_mfma_f32_32x32x16_bf16 v[160:175], v[84:87], v[72:75], v[160:175]
  ds_read_b64_tr_b16 v[64:65], v27 offset:16384
  ds_read_b64_tr_b16 v[66:67], v27 offset:17408
  s_add_u32 s55, s59, 4096
  s_cmp_lg_u32 s94, 0
  s_cbranch_scc1 .Lkv72g
  buffer_store_dwordx4 v[232:235], v32, s[80:83], s55 offen offset:0
.Lkv72r:
  v_add_u32 v35, 10240, v34
  buffer_load_dwordx2 v[198:199], v35, s[36:39], 0 offen
  v_mfma_f32_32x32x16_bf16 v[176:191], v[88:91], v[72:75], v[176:191]
  v_add_u32 v34, 10240, v35
  buffer_load_dwordx2 v[200:201], v34, s[36:39], 0 offen
  v_add_u32 v35, 10240, v34
  s_waitcnt lgkmcnt(6)
  v_mfma_f32_32x32x16_bf16 v[128:143], v[52:55], v[48:51], v[128:143]
  ds_read_b128 v[72:75], v21 offset:0
  ds_read_b64_tr_b16 v[76:77], v24 offset:20480
  ds_read_b64_tr_b16 v[78:79], v24 offset:21504
  buffer_load_dwordx4 v37, s[32:35], s57 offen offset:1024 lds
  buffer_load_dwordx2 v[202:203], v35, s[36:39], 0 offen
  v_add_u32 v34, 10240, v35
  buffer_load_dwordx2 v[204:205], v34, s[36:39], 0 offen
  s_waitcnt lgkmcnt(7)
  v_mfma_f32_32x32x16_bf16 v[144:159], v[56:59], v[48:51], v[144:159]
  ds_read_b64_tr_b16 v[80:81], v25 offset:20480
  ds_read_b64_tr_b16 v[82:83], v25 offset:21504
  v_add_u32 v35, 10240, v34
  buffer_load_dwordx2 v[206:207], v35, s[36:39], 0 offen
  s_waitcnt lgkmcnt(7)
  v_mfma_f32_32x32x16_bf16 v[160:175], v[60:63], v[48:51], v[160:175]
  ds_read_b64_tr_b16 v[84:85], v26 offset:20480
  ds_read_b64_tr_b16 v[86:87], v26 offset:21504
  s_add_u32 s55, s59, 4096
  s_cmp_lg_u32 s94, 0
  s_cbranch_scc1 .Lkv73g
  buffer_store_dwordx4 v[236:239], v32, s[80:83], s55 offen offset:1024
.Lkv73r:
  s_waitcnt lgkmcnt(7)
  v_mfma_f32_32x32x16_bf16 v[176:191], v[64:67], v[48:51], v[176:191]
  ds_read_b64_tr_b16 v[88:89], v27 offset:20480
  ds_read_b64_tr_b16 v[90:91], v27 offset:21504
  buffer_load_dwordx4 v38, s[32:35], s57 offen offset:2048 lds
  s_waitcnt lgkmcnt(6)
  v_mfma_f32_32x32x16_bf16 v[128:143], v[76:79], v[72:75], v[128:143]
  ds_read_b128 v[48:51], v22 offset:0
  ds_read_b64_tr_b16 v[52:53], v24 offset:24576
  ds_read_b64_tr_b16 v[54:55], v24 offset:25600
  s_waitcnt lgkmcnt(7)
  v_mfma_f32_32x32x16_bf16 v[144:159], v[80:83], v[72:75], v[144:159]
  ds_read_b64_tr_b16 v[56:57], v25 offset:24576
  ds_read_b64_tr_b16 v[58:59], v25 offset:25600
  s_waitcnt lgkmcnt(7)
  v_mfma_f32_32x32x16_bf16 v[160:175], v[84:87], v[72:75], v[160:175]
  ds_read_b64_tr_b16 v[60:61], v26 offset:24576
  ds_read_b64_tr_b16 v[62:63], v26 offset:25600
  buffer_load_dwordx4 v39, s[32:35], s57 offen offset:3072 lds
  s_add_u32 s55, s59, 20480
  s_cmp_lg_u32 s94, 0
  s_cbranch_scc1 .Lkv74g
  buffer_store_dwordx4 v[240:243], v32, s[80:83], s55 offen offset:2048
.Lkv74r:
  s_add_u32 s55, s59, 16384
  s_cmp_lg_u32 s94, 0
  s_cbranch_scc1 .Lkv75g
  buffer_store_dwordx4 v[208:211], v32, s[84:87], s55 offen offset:2048
.Lkv75r:
  s_waitcnt lgkmcnt(7)
  v_mfma_f32_32x32x16_bf16 v[176:191], v[88:91], v[72:75], v[176:191]
  ds_read_b64_tr_b16 v[64:65], v27 offset:24576
  ds_read_b64_tr_b16 v[66:67], v27 offset:25600
  s_waitcnt lgkmcnt(6)
  v_mfma_f32_32x32x16_bf16 v[128:143], v[52:55], v[48:51], v[128:143]
  ds_read_b128 v[72:75], v23 offset:0
  ds_read_b64_tr_b16 v[76:77], v24 offset:28672
  ds_read_b64_tr_b16 v[78:79], v24 offset:29696
  s_waitcnt lgkmcnt(7)
  v_mfma_f32_32x32x16_bf16 v[144:159], v[56:59], v[48:51], v[144:159]
  ds_read_b64_tr_b16 v[80:81], v25 offset:28672
  ds_read_b64_tr_b16 v[82:83], v25 offset:29696
  s_waitcnt lgkmcnt(7)
  v_mfma_f32_32x32x16_bf16 v[160:175], v[60:63], v[48:51], v[160:175]
  ds_read_b64_tr_b16 v[84:85], v26 offset:28672
  ds_read_b64_tr_b16 v[86:87], v26 offset:29696
  s_add_u32 s55, s59, 20480
  s_cmp_lg_u32 s94, 0
  s_cbranch_scc1 .Lkv76g
  buffer_store_dwordx4 v[244:247], v32, s[80:83], s55 offen offset:3072
.Lkv76r:
  s_waitcnt lgkmcnt(7)
  v_mfma_f32_32x32x16_bf16 v[176:191], v[64:67], v[48:51], v[176:191]
  ds_read_b64_tr_b16 v[88:89], v27 offset:28672
  ds_read_b64_tr_b16 v[90:91], v27 offset:29696
  s_waitcnt lgkmcnt(6)
  v_mfma_f32_32x32x16_bf16 v[128:143], v[76:79], v[72:75], v[128:143]
  v_add_u32 v20, 0x8000, v20
  v_add_u32 v21, 0x8000, v21
  v_add_u32 v22, 0x8000, v22
  v_add_u32 v23, 0x8000, v23
  v_add_u32 v24, 0x18000, v24
  v_add_u32 v25, 0x18000, v25
  v_add_u32 v26, 0x18000, v26
  v_add_u32 v27, 0x18000, v27
  s_waitcnt lgkmcnt(0)
  s_waitcnt vmcnt(20)
  s_barrier
  ds_read_b128 v[48:51], v20 offset:0
  ds_read_b64_tr_b16 v[52:53], v24 offset:0
  ds_read_b64_tr_b16 v[54:55], v24 offset:1024
  s_add_u32 m0, s58, 16384
  s_add_u32 s57, s93, 768
  buffer_load_dwordx4 v36, s[32:35], s57 offen offset:0 lds
  s_waitcnt vmcnt(7)
  v_fma_f32 v1, v16, v192, v194
  v_fma_f32 v2, v16, v193, v195
  v_fma_f32 v34, -v17, v193, v1
  v_mfma_f32_32x32x16_bf16 v[144:159], v[80:83], v[72:75], v[144:159]
  ds_read_b64_tr_b16 v[56:57], v25 offset:0
  ds_read_b64_tr_b16 v[58:59], v25 offset:1024
  ds_read_b64_tr_b16 v[60:61], v26 offset:0
  ds_read_b64_tr_b16 v[62:63], v26 offset:1024
  buffer_load_dwordx4 v37, s[32:35], s57 offen offset:1024 lds
  v_fma_f32 v35, v17, v192, v2
  v_fma_f32 v1, v16, v34, v196
  v_fma_f32 v2, v16, v35, v197
  v_fma_f32 v30, -v17, v35, v1
  v_mfma_f32_32x32x16_bf16 v[160:175], v[84:87], v[72:75], v[160:175]
  ds_read_b64_tr_b16 v[64:65], v27 offset:0
  ds_read_b64_tr_b16 v[66:67], v27 offset:1024
  buffer_load_dwordx4 v38, s[32:35], s57 offen offset:2048 lds
  s_add_u32 s55, s59, 4096
  s_cmp_lg_u32 s94, 0
  s_cbranch_scc1 .Lkv77g
  buffer_store_dwordx4 v[248:251], v32, s[80:83], s55 offen offset:2048
.Lkv77r:
  v_fma_f32 v31, v17, v34, v2
  v_fma_f32 v1, v16, v30, v198
  v_mfma_f32_32x32x16_bf16 v[176:191], v[88:91], v[72:75], v[176:191]
  buffer_load_dwordx4 v39, s[32:35], s57 offen offset:3072 lds
  v_fma_f32 v2, v16, v31, v199
  v_fma_f32 v34, -v17, v31, v1
  v_fma_f32 v35, v17, v30, v2
  v_fma_f32 v1, v16, v34, v200
  s_waitcnt lgkmcnt(6)
  v_mfma_f32_32x32x16_bf16 v[128:143], v[52:55], v[48:51], v[128:143]
  ds_read_b128 v[72:75], v21 offset:0
  ds_read_b64_tr_b16 v[76:77], v24 offset:4096
  ds_read_b64_tr_b16 v[78:79], v24 offset:5120
  s_add_u32 m0, s58, 49152
  s_mov_b32 s57, 3670016
  buffer_load_dwordx4 v8, s[64:67], s57 offen offset:0 lds
  v_fma_f32 v2, v16, v35, v201
  v_fma_f32 v30, -v17, v35, v1
  v_fma_f32 v31, v17, v34, v2
  v_fma_f32 v1, v16, v30, v202
  s_waitcnt lgkmcnt(7)
  v_mfma_f32_32x32x16_bf16 v[144:159], v[56:59], v[48:51], v[144:159]
  ds_read_b64_tr_b16 v[80:81], v25 offset:4096
  ds_read_b64_tr_b16 v[82:83], v25 offset:5120
  buffer_load_dwordx4 v9, s[64:67], s57 offen offset:1024 lds
  s_add_u32 s55, s59, 16384
  s_cmp_lg_u32 s94, 0
  s_cbranch_scc1 .Lkv78g
  buffer_store_dwordx4 v[212:215], v32, s[84:87], s55 offen offset:3072
.Lkv78r:
  v_fma_f32 v2, v16, v31, v203
  v_fma_f32 v34, -v17, v31, v1
  s_waitcnt lgkmcnt(7)
  v_mfma_f32_32x32x16_bf16 v[160:175], v[60:63], v[48:51], v[160:175]
  ds_read_b64_tr_b16 v[84:85], v26 offset:4096
  ds_read_b64_tr_b16 v[86:87], v26 offset:5120
  buffer_load_dwordx4 v10, s[64:67], s57 offen offset:2048 lds
  s_add_u32 s55, s59, 4096
  s_cmp_lg_u32 s94, 0
  s_cbranch_scc1 .Lkv79g
  buffer_store_dwordx4 v[252:255], v32, s[80:83], s55 offen offset:3072
.Lkv79r:
  v_fma_f32 v35, v17, v30, v2
  v_fma_f32 v1, v16, v34, v204
  s_waitcnt lgkmcnt(7)
  v_mfma_f32_32x32x16_bf16 v[176:191], v[64:67], v[48:51], v[176:191]
  ds_read_b64_tr_b16 v[88:89], v27 offset:4096
  ds_read_b64_tr_b16 v[90:91], v27 offset:5120
  buffer_load_dwordx4 v11, s[64:67], s57 offen offset:3072 lds
  v_fma_f32 v2, v16, v35, v205
  v_fma_f32 v30, -v17, v35, v1
  v_fma_f32 v31, v17, v34, v2
  v_fma_f32 v1, v16, v30, v206
  s_waitcnt lgkmcnt(6)
  v_mfma_f32_32x32x16_bf16 v[128:143], v[76:79], v[72:75], v[128:143]
  ds_read_b128 v[48:51], v22 offset:0
  ds_read_b64_tr_b16 v[52:53], v24 offset:8192
  ds_read_b64_tr_b16 v[54:55], v24 offset:9216
  v_fma_f32 v2, v16, v31, v207
  v_fma_f32 v34, -v17, v31, v1
  v_fma_f32 v35, v17, v30, v2
  v_mov_b32 v30, v34
  s_waitcnt lgkmcnt(7)
  v_mfma_f32_32x32x16_bf16 v[144:159], v[80:83], v[72:75], v[144:159]
  ds_read_b64_tr_b16 v[56:57], v25 offset:8192
  ds_read_b64_tr_b16 v[58:59], v25 offset:9216
  v_mov_b32 v31, v35
  v_permlane32_swap_b32 v34, v30
  s_nop 0
  v_permlane32_swap_b32 v35, v31
  s_nop 0
  s_waitcnt lgkmcnt(7)
  v_mfma_f32_32x32x16_bf16 v[160:175], v[84:87], v[72:75], v[160:175]
  ds_read_b64_tr_b16 v[60:61], v26 offset:8192
  ds_read_b64_tr_b16 v[62:63], v26 offset:9216
  v_fma_f32 v1, v18, v34, v30
  v_fma_f32 v2, v18, v35, v31
  v_fma_f32 v16, -v19, v35, v1
  v_fma_f32 v17, v19, v34, v2
  s_waitcnt lgkmcnt(7)
  v_mfma_f32_32x32x16_bf16 v[176:191], v[88:91], v[72:75], v[176:191]
  ds_read_b64_tr_b16 v[64:65], v27 offset:8192
  ds_read_b64_tr_b16 v[66:67], v27 offset:9216
  v_fma_f32 v1, v4, v16, v6
  v_fma_f32 v2, v4, v17, v7
  v_fma_f32 v18, -v5, v17, v1
  v_fma_f32 v19, v5, v16, v2
  s_waitcnt lgkmcnt(6)
  v_mfma_f32_32x32x16_bf16 v[128:143], v[52:55], v[48:51], v[128:143]
  ds_read_b128 v[72:75], v23 offset:0
  ds_read_b64_tr_b16 v[76:77], v24 offset:12288
  ds_read_b64_tr_b16 v[78:79], v24 offset:13312
  v_fma_f32 v1, v12, v18, v28
  v_fma_f32 v2, v12, v19, v29
  v_fma_f32 v30, -v13, v19, v1
  v_fma_f32 v31, v13, v18, v2
  s_waitcnt lgkmcnt(7)
  v_mfma_f32_32x32x16_bf16 v[144:159], v[56:59], v[48:51], v[144:159]
  ds_read_b64_tr_b16 v[80:81], v25 offset:12288
  ds_read_b64_tr_b16 v[82:83], v25 offset:13312
  s_add_u32 s55, s59, 0
  s_cmp_lg_u32 s94, 0
  s_cbranch_scc1 .Lkv80g
  buffer_store_dwordx4 v[216:219], v32, s[84:87], s55 offen offset:2048
.Lkv80r:
  v_fma_f32 v1, v44, v30, v96
  v_fma_f32 v2, v44, v31, v112
  s_waitcnt lgkmcnt(7)
  v_mfma_f32_32x32x16_bf16 v[160:175], v[60:63], v[48:51], v[160:175]
  ds_read_b64_tr_b16 v[84:85], v26 offset:12288
  ds_read_b64_tr_b16 v[86:87], v26 offset:13312
  v_fma_f32 v96, -v45, v31, v1
  v_fma_f32 v112, v45, v30, v2
  v_fma_f32 v1, v44, v96, v97
  v_fma_f32 v2, v44, v112, v113
  s_waitcnt lgkmcnt(7)
  v_mfma_f32_32x32x16_bf16 v[176:191], v[64:67], v[48:51], v[176:191]
  ds_read_b64_tr_b16 v[88:89], v27 offset:12288
  ds_read_b64_tr_b16 v[90:91], v27 offset:13312
  v_fma_f32 v97, -v45, v112, v1
  v_fma_f32 v113, v45, v96, v2
  v_fma_f32 v1, v44, v97, v98
  v_fma_f32 v2, v44, v113, v114
  s_waitcnt lgkmcnt(6)
  v_mfma_f32_32x32x16_bf16 v[128:143], v[76:79], v[72:75], v[128:143]
  v_add_u32 v20, 0x10000, v20
  v_add_u32 v21, 0x10000, v21
  v_add_u32 v22, 0x10000, v22
  v_add_u32 v23, 0x10000, v23
  s_waitcnt lgkmcnt(0)
  s_waitcnt vmcnt(15)
  s_barrier
  ds_read_b128 v[48:51], v20 offset:0
  ds_read_b64_tr_b16 v[52:53], v24 offset:16384
  ds_read_b64_tr_b16 v[54:55], v24 offset:17408
  v_fma_f32 v98, -v45, v113, v1
  v_fma_f32 v114, v45, v97, v2
  v_fma_f32 v1, v44, v98, v99
  v_fma_f32 v2, v44, v114, v115
  v_mfma_f32_32x32x16_bf16 v[144:159], v[80:83], v[72:75], v[144:159]
  ds_read_b64_tr_b16 v[56:57], v25 offset:16384
  ds_read_b64_tr_b16 v[58:59], v25 offset:17408
  ds_read_b64_tr_b16 v[60:61], v26 offset:16384
  ds_read_b64_tr_b16 v[62:63], v26 offset:17408
  v_fma_f32 v99, -v45, v114, v1
  v_fma_f32 v115, v45, v98, v2
  v_fma_f32 v1, v44, v99, v100
  v_fma_f32 v2, v44, v115, v116
  v_mfma_f32_32x32x16_bf16 v[160:175], v[84:87], v[72:75], v[160:175]
  ds_read_b64_tr_b16 v[64:65], v27 offset:16384
  ds_read_b64_tr_b16 v[66:67], v27 offset:17408
  v_fma_f32 v100, -v45, v115, v1
  v_fma_f32 v116, v45, v99, v2
  v_fma_f32 v1, v44, v100, v101
  v_fma_f32 v2, v44, v116, v117
  v_mfma_f32_32x32x16_bf16 v[176:191], v[88:91], v[72:75], v[176:191]
  v_fma_f32 v101, -v45, v116, v1
  v_fma_f32 v117, v45, v100, v2
  v_fma_f32 v1, v44, v101, v102
  v_fma_f32 v2, v44, v117, v118
  s_waitcnt lgkmcnt(6)
  v_mfma_f32_32x32x16_bf16 v[128:143], v[52:55], v[48:51], v[128:143]
  ds_read_b128 v[72:75], v21 offset:0
  ds_read_b64_tr_b16 v[76:77], v24 offset:20480
  ds_read_b64_tr_b16 v[78:79], v24 offset:21504
  v_fma_f32 v102, -v45, v117, v1
  v_fma_f32 v118, v45, v101, v2
  v_fma_f32 v1, v44, v102, v103
  v_fma_f32 v2, v44, v118, v119
  s_waitcnt lgkmcnt(7)
  v_mfma_f32_32x32x16_bf16 v[144:159], v[56:59], v[48:51], v[144:159]
  ds_read_b64_tr_b16 v[80:81], v25 offset:20480
  ds_read_b64_tr_b16 v[82:83], v25 offset:21504
  s_add_u32 s55, s59, 0
  s_cmp_lg_u32 s94, 0
  s_cbranch_scc1 .Lkv81g
  buffer_store_dwordx4 v[220:223], v32, s[84:87], s55 offen offset:3072
.Lkv81r:
  v_fma_f32 v103, -v45, v118, v1
  v_fma_f32 v119, v45, v102, v2
  s_waitcnt lgkmcnt(7)
  v_mfma_f32_32x32x16_bf16 v[160:175], v[60:63], v[48:51], v[160:175]
  ds_read_b64_tr_b16 v[84:85], v26 offset:20480
  ds_read_b64_tr_b16 v[86:87], v26 offset:21504
  v_fma_f32 v1, v44, v103, v104
  v_fma_f32 v2, v44, v119, v120
  v_fma_f32 v104, -v45, v119, v1
  v_fma_f32 v120, v45, v103, v2
  s_waitcnt lgkmcnt(7)
  v_mfma_f32_32x32x16_bf16 v[176:191], v[64:67], v[48:51], v[176:191]
  ds_read_b64_tr_b16 v[88:89], v27 offset:20480
  ds_read_b64_tr_b16 v[90:91], v27 offset:21504
  v_fma_f32 v1, v44, v104, v105
  v_fma_f32 v2, v44, v120, v121
  v_fma_f32 v105, -v45, v120, v1
  v_fma_f32 v121, v45, v104, v2
  s_waitcnt lgkmcnt(6)
  v_mfma_f32_32x32x16_bf16 v[128:143], v[76:79], v[72:75], v[128:143]
  ds_read_b128 v[48:51], v22 offset:0
  ds_read_b64_tr_b16 v[52:53], v24 offset:24576
  ds_read_b64_tr_b16 v[54:55], v24 offset:25600
  v_fma_f32 v1, v44, v105, v106
  v_fma_f32 v2, v44, v121, v122
  v_fma_f32 v106, -v45, v121, v1
  v_fma_f32 v122, v45, v105, v2
  s_waitcnt lgkmcnt(7)
  v_mfma_f32_32x32x16_bf16 v[144:159], v[80:83], v[72:75], v[144:159]
  ds_read_b64_tr_b16 v[56:57], v25 offset:24576
  ds_read_b64_tr_b16 v[58:59], v25 offset:25600
  v_fma_f32 v1, v44, v106, v107
  v_fma_f32 v2, v44, v122, v123
  v_fma_f32 v107, -v45, v122, v1
  v_fma_f32 v123, v45, v106, v2
  s_waitcnt lgkmcnt(7)
  v_mfma_f32_32x32x16_bf16 v[160:175], v[84:87], v[72:75], v[160:175]
  ds_read_b64_tr_b16 v[60:61], v26 offset:24576
  ds_read_b64_tr_b16 v[62:63], v26 offset:25600
  v_fma_f32 v1, v44, v107, v108
  v_fma_f32 v2, v44, v123, v124
  v_fma_f32 v108, -v45, v123, v1
  v_fma_f32 v124, v45, v107, v2
  s_waitcnt lgkmcnt(7)
  v_mfma_f32_32x32x16_bf16 v[176:191], v[88:91], v[72:75], v[176:191]
  ds_read_b64_tr_b16 v[64:65], v27 offset:24576
  ds_read_b64_tr_b16 v[66:67], v27 offset:25600
  v_fma_f32 v1, v44, v108, v109
  v_fma_f32 v2, v44, v124, v125
  v_fma_f32 v109, -v45, v124, v1
  v_fma_f32 v125, v45, v108, v2
  s_waitcnt lgkmcnt(6)
  v_mfma_f32_32x32x16_bf16 v[128:143], v[52:55], v[48:51], v[128:143]
  ds_read_b128 v[72:75], v23 offset:0
  ds_read_b64_tr_b16 v[76:77], v24 offset:28672
  ds_read_b64_tr_b16 v[78:79], v24 offset:29696
  v_fma_f32 v1, v44, v109, v110
  v_fma_f32 v2, v44, v125, v126
  v_fma_f32 v110, -v45, v125, v1
  v_fma_f32 v126, v45, v109, v2
  s_waitcnt lgkmcnt(7)
  v_mfma_f32_32x32x16_bf16 v[144:159], v[56:59], v[48:51], v[144:159]
  ds_read_b64_tr_b16 v[80:81], v25 offset:28672
  ds_read_b64_tr_b16 v[82:83], v25 offset:29696
  s_add_u32 s55, s59, 20480
  s_cmp_lg_u32 s94, 0
  s_cbranch_scc1 .Lkv82g
  buffer_store_dwordx4 v[224:227], v32, s[84:87], s55 offen offset:0
.Lkv82r:
  v_fma_f32 v1, v44, v110, v111
  v_fma_f32 v2, v44, v126, v127
  s_waitcnt lgkmcnt(7)
  v_mfma_f32_32x32x16_bf16 v[160:175], v[60:63], v[48:51], v[160:175]
  ds_read_b64_tr_b16 v[84:85], v26 offset:28672
  ds_read_b64_tr_b16 v[86:87], v26 offset:29696
  v_fma_f32 v111, -v45, v126, v1
  v_fma_f32 v127, v45, v110, v2
  v_mul_f32 v28, v46, v96
  v_mul_f32 v29, v46, v112
  s_waitcnt lgkmcnt(7)
  v_mfma_f32_32x32x16_bf16 v[176:191], v[64:67], v[48:51], v[176:191]
  ds_read_b64_tr_b16 v[88:89], v27 offset:28672
  ds_read_b64_tr_b16 v[90:91], v27 offset:29696
  v_fma_f32 v28, -v47, v112, v28
  v_fma_f32 v29, -v47, v96, -v29
  v_mul_f32 v30, v46, v97
  v_mul_f32 v31, v46, v113
  s_waitcnt lgkmcnt(6)
  v_mfma_f32_32x32x16_bf16 v[128:143], v[76:79], v[72:75], v[128:143]
  v_add_u32 v20, 0xfffe0000, v20
  v_add_u32 v21, 0xfffe0000, v21
  v_add_u32 v22, 0xfffe0000, v22
  v_add_u32 v23, 0xfffe0000, v23
  v_add_u32 v24, 0xffff0000, v24
  v_add_u32 v25, 0xffff0000, v25
  v_add_u32 v26, 0xffff0000, v26
  v_add_u32 v27, 0xffff0000, v27
  s_waitcnt lgkmcnt(0)
  s_waitcnt vmcnt(3)
  s_barrier
  ds_read_b128 v[48:51], v20 offset:0
  ds_read_b64_tr_b16 v[52:53], v24 offset:0
  ds_read_b64_tr_b16 v[54:55], v24 offset:1024
  v_fma_f32 v30, -v47, v113, v30
  v_fma_f32 v31, -v47, v97, -v31
  v_cvt_pk_bf16_f32 v96, v28, v30
  v_cvt_pk_bf16_f32 v112, v29, v31
  v_mfma_f32_32x32x16_bf16 v[144:159], v[80:83], v[72:75], v[144:159]
  ds_read_b64_tr_b16 v[56:57], v25 offset:0
  ds_read_b64_tr_b16 v[58:59], v25 offset:1024
  ds_read_b64_tr_b16 v[60:61], v26 offset:0
  ds_read_b64_tr_b16 v[62:63], v26 offset:1024
  v_mul_f32 v28, v46, v98
  v_mul_f32 v29, v46, v114
  v_fma_f32 v28, -v47, v114, v28
  v_fma_f32 v29, -v47, v98, -v29
  v_mfma_f32_32x32x16_bf16 v[160:175], v[84:87], v[72:75], v[160:175]
  ds_read_b64_tr_b16 v[64:65], v27 offset:0
  ds_read_b64_tr_b16 v[66:67], v27 offset:1024
  v_mul_f32 v30, v46, v99
  v_mul_f32 v31, v46, v115
  v_fma_f32 v30, -v47, v115, v30
  v_fma_f32 v31, -v47, v99, -v31
  v_mfma_f32_32x32x16_bf16 v[176:191], v[88:91], v[72:75], v[176:191]
  v_cvt_pk_bf16_f32 v97, v28, v30
  v_cvt_pk_bf16_f32 v113, v29, v31
  v_mul_f32 v28, v46, v100
  v_mul_f32 v29, v46, v116
  s_waitcnt lgkmcnt(6)
  v_mfma_f32_32x32x16_bf16 v[128:143], v[52:55], v[48:51], v[128:143]
  ds_read_b128 v[72:75], v21 offset:0
  ds_read_b64_tr_b16 v[76:77], v24 offset:4096
  ds_read_b64_tr_b16 v[78:79], v24 offset:5120
  v_min_u32 v33, 1, v0
  v_lshlrev_b32 v33, 8, v33
  v_cmp_eq_u32 vcc, 0, v0
  v_mov_b32 v42, 0x101
  s_nop 0
  v_cndmask_b32 v42, 0, v42, vcc
  buffer_load_dword v41, v33, s[16:19], s88 offen sc0 sc1
  s_waitcnt lgkmcnt(7)
  v_mfma_f32_32x32x16_bf16 v[144:159], v[56:59], v[48:51], v[144:159]
  ds_read_b64_tr_b16 v[80:81], v25 offset:4096
  ds_read_b64_tr_b16 v[82:83], v25 offset:5120
  s_add_u32 s55, s59, 20480
  s_cmp_lg_u32 s94, 0
  s_cbranch_scc1 .Lkv83g
  buffer_store_dwordx4 v[228:231], v32, s[84:87], s55 offen offset:1024
.Lkv83r:
  v_fma_f32 v28, -v47, v116, v28
  v_fma_f32 v29, -v47, v100, -v29
  s_waitcnt lgkmcnt(7)
  v_mfma_f32_32x32x16_bf16 v[160:175], v[60:63], v[48:51], v[160:175]
  ds_read_b64_tr_b16 v[84:85], v26 offset:4096
  ds_read_b64_tr_b16 v[86:87], v26 offset:5120
  v_mul_f32 v30, v46, v101
  v_mul_f32 v31, v46, v117
  v_fma_f32 v30, -v47, v117, v30
  v_fma_f32 v31, -v47, v101, -v31
  s_waitcnt lgkmcnt(7)
  v_mfma_f32_32x32x16_bf16 v[176:191], v[64:67], v[48:51], v[176:191]
  ds_read_b64_tr_b16 v[88:89], v27 offset:4096
  ds_read_b64_tr_b16 v[90:91], v27 offset:5120
  v_cvt_pk_bf16_f32 v98, v28, v30
  v_cvt_pk_bf16_f32 v114, v29, v31
  v_mul_f32 v28, v46, v102
  v_mul_f32 v29, v46, v118
  s_waitcnt lgkmcnt(6)
  v_mfma_f32_32x32x16_bf16 v[128:143], v[76:79], v[72:75], v[128:143]
  ds_read_b128 v[48:51], v22 offset:0
  ds_read_b64_tr_b16 v[52:53], v24 offset:8192
  ds_read_b64_tr_b16 v[54:55], v24 offset:9216
  v_fma_f32 v28, -v47, v118, v28
  v_fma_f32 v29, -v47, v102, -v29
  v_mul_f32 v30, v46, v103
  v_mul_f32 v31, v46, v119
  s_waitcnt lgkmcnt(7)
  v_mfma_f32_32x32x16_bf16 v[144:159], v[80:83], v[72:75], v[144:159]
  ds_read_b64_tr_b16 v[56:57], v25 offset:8192
  ds_read_b64_tr_b16 v[58:59], v25 offset:9216
  v_fma_f32 v30, -v47, v119, v30
  v_fma_f32 v31, -v47, v103, -v31
  v_cvt_pk_bf16_f32 v99, v28, v30
  v_cvt_pk_bf16_f32 v115, v29, v31
  s_waitcnt lgkmcnt(7)
  v_mfma_f32_32x32x16_bf16 v[160:175], v[84:87], v[72:75], v[160:175]
  ds_read_b64_tr_b16 v[60:61], v26 offset:8192
  ds_read_b64_tr_b16 v[62:63], v26 offset:9216
  v_mul_f32 v28, v46, v104
  v_mul_f32 v29, v46, v120
  v_fma_f32 v28, -v47, v120, v28
  v_fma_f32 v29, -v47, v104, -v29
  s_waitcnt lgkmcnt(7)
  v_mfma_f32_32x32x16_bf16 v[176:191], v[88:91], v[72:75], v[176:191]
  ds_read_b64_tr_b16 v[64:65], v27 offset:8192
  ds_read_b64_tr_b16 v[66:67], v27 offset:9216
  v_mul_f32 v30, v46, v105
  v_mul_f32 v31, v46, v121
  v_fma_f32 v30, -v47, v121, v30
  v_fma_f32 v31, -v47, v105, -v31
  s_waitcnt lgkmcnt(6)
  v_mfma_f32_32x32x16_bf16 v[128:143], v[52:55], v[48:51], v[128:143]
  ds_read_b128 v[72:75], v23 offset:0
  ds_read_b64_tr_b16 v[76:77], v24 offset:12288
  ds_read_b64_tr_b16 v[78:79], v24 offset:13312
  v_cvt_pk_bf16_f32 v100, v28, v30
  v_cvt_pk_bf16_f32 v116, v29, v31
  v_mul_f32 v28, v46, v106
  v_mul_f32 v29, v46, v122
  s_waitcnt lgkmcnt(7)
  v_mfma_f32_32x32x16_bf16 v[144:159], v[56:59], v[48:51], v[144:159]
  ds_read_b64_tr_b16 v[80:81], v25 offset:12288
  ds_read_b64_tr_b16 v[82:83], v25 offset:13312
  s_add_u32 s55, s59, 4096
  s_cmp_lg_u32 s94, 0
  s_cbranch_scc1 .Lkv84g
  buffer_store_dwordx4 v[232:235], v32, s[84:87], s55 offen offset:0
.Lkv84r:
  v_fma_f32 v28, -v47, v122, v28
  v_fma_f32 v29, -v47, v106, -v29
  s_waitcnt lgkmcnt(7)
  v_mfma_f32_32x32x16_bf16 v[160:175], v[60:63], v[48:51], v[160:175]
  ds_read_b64_tr_b16 v[84:85], v26 offset:12288
  ds_read_b64_tr_b16 v[86:87], v26 offset:13312
  v_mul_f32 v30, v46, v107
  v_mul_f32 v31, v46, v123
  v_fma_f32 v30, -v47, v123, v30
  v_fma_f32 v31, -v47, v107, -v31
  s_waitcnt lgkmcnt(7)
  v_mfma_f32_32x32x16_bf16 v[176:191], v[64:67], v[48:51], v[176:191]
  ds_read_b64_tr_b16 v[88:89], v27 offset:12288
  ds_read_b64_tr_b16 v[90:91], v27 offset:13312
  v_cvt_pk_bf16_f32 v101, v28, v30
  v_cvt_pk_bf16_f32 v117, v29, v31
  v_mul_f32 v28, v46, v108
  v_mul_f32 v29, v46, v124
  s_waitcnt lgkmcnt(6)
  v_mfma_f32_32x32x16_bf16 v[128:143], v[76:79], v[72:75], v[128:143]
  v_add_u32 v20, 0x10000, v20
  v_add_u32 v21, 0x10000, v21
  v_add_u32 v22, 0x10000, v22
  v_add_u32 v23, 0x10000, v23
  s_waitcnt lgkmcnt(0)
  s_barrier
  ds_read_b128 v[48:51], v20 offset:0
  ds_read_b64_tr_b16 v[52:53], v24 offset:16384
  ds_read_b64_tr_b16 v[54:55], v24 offset:17408
  v_fma_f32 v28, -v47, v124, v28
  v_fma_f32 v29, -v47, v108, -v29
  v_mul_f32 v30, v46, v109
  v_mul_f32 v31, v46, v125
  v_mfma_f32_32x32x16_bf16 v[144:159], v[80:83], v[72:75], v[144:159]
  ds_read_b64_tr_b16 v[56:57], v25 offset:16384
  ds_read_b64_tr_b16 v[58:59], v25 offset:17408
  ds_read_b64_tr_b16 v[60:61], v26 offset:16384
  ds_read_b64_tr_b16 v[62:63], v26 offset:17408
  v_fma_f32 v30, -v47, v125, v30
  v_fma_f32 v31, -v47, v109, -v31
  v_cvt_pk_bf16_f32 v102, v28, v30
  v_cvt_pk_bf16_f32 v118, v29, v31
  v_mfma_f32_32x32x16_bf16 v[160:175], v[84:87], v[72:75], v[160:175]
  ds_read_b64_tr_b16 v[64:65], v27 offset:16384
  ds_read_b64_tr_b16 v[66:67], v27 offset:17408
  v_mul_f32 v28, v46, v110
  v_mul_f32 v29, v46, v126
  v_fma_f32 v28, -v47, v126, v28
  v_fma_f32 v29, -v47, v110, -v29
  v_mfma_f32_32x32x16_bf16 v[176:191], v[88:91], v[72:75], v[176:191]
  v_mul_f32 v30, v46, v111
  v_mul_f32 v31, v46, v127
  v_fma_f32 v30, -v47, v127, v30
  v_fma_f32 v31, -v47, v111, -v31
  s_waitcnt lgkmcnt(6)
  v_mfma_f32_32x32x16_bf16 v[128:143], v[52:55], v[48:51], v[128:143]
  ds_read_b128 v[72:75], v21 offset:0
  ds_read_b64_tr_b16 v[76:77], v24 offset:20480
  ds_read_b64_tr_b16 v[78:79], v24 offset:21504
  v_cvt_pk_bf16_f32 v103, v28, v30
  v_cvt_pk_bf16_f32 v119, v29, v31
  v_and_b32 v28, 31, v0
  v_lshlrev_b32 v28, 6, v28
  s_waitcnt lgkmcnt(7)
  v_mfma_f32_32x32x16_bf16 v[144:159], v[56:59], v[48:51], v[144:159]
  ds_read_b64_tr_b16 v[80:81], v25 offset:20480
  ds_read_b64_tr_b16 v[82:83], v25 offset:21504
  s_add_u32 s55, s59, 4096
  s_cmp_lg_u32 s94, 0
  s_cbranch_scc1 .Lkv85g
  buffer_store_dwordx4 v[236:239], v32, s[84:87], s55 offen offset:1024
.Lkv85r:
  v_and_b32 v30, 32, v0
  s_lshl_b32 s55, s52, 12
  s_add_u32 s55, s55, 131072
  v_add3_u32 v28, v28, v30, s55
  s_waitcnt lgkmcnt(7)
  v_mfma_f32_32x32x16_bf16 v[160:175], v[60:63], v[48:51], v[160:175]
  ds_read_b64_tr_b16 v[84:85], v26 offset:20480
  ds_read_b64_tr_b16 v[86:87], v26 offset:21504
  v_lshlrev_b32 v1, 4, v0
  v_and_b32 v1, 32, v1
  v_xor_b32 v28, v28, v1
  v_lshlrev_b32 v1, 2, v0
  s_waitcnt lgkmcnt(7)
  v_mfma_f32_32x32x16_bf16 v[176:191], v[64:67], v[48:51], v[176:191]
  ds_read_b64_tr_b16 v[88:89], v27 offset:20480
  ds_read_b64_tr_b16 v[90:91], v27 offset:21504
  v_and_b32 v1, 16, v1
  v_xor_b32 v28, v28, v1
  v_xor_b32 v30, 16, v28
  s_waitcnt lgkmcnt(6)
  v_mfma_f32_32x32x16_bf16 v[128:143], v[76:79], v[72:75], v[128:143]
  ds_read_b128 v[48:51], v22 offset:0
  ds_read_b64_tr_b16 v[52:53], v24 offset:24576
  ds_read_b64_tr_b16 v[54:55], v24 offset:25600
  s_waitcnt lgkmcnt(7)
  v_mfma_f32_32x32x16_bf16 v[144:159], v[80:83], v[72:75], v[144:159]
  ds_read_b64_tr_b16 v[56:57], v25 offset:24576
  ds_read_b64_tr_b16 v[58:59], v25 offset:25600
  s_waitcnt lgkmcnt(7)
  v_mfma_f32_32x32x16_bf16 v[160:175], v[84:87], v[72:75], v[160:175]
  ds_read_b64_tr_b16 v[60:61], v26 offset:24576
  ds_read_b64_tr_b16 v[62:63], v26 offset:25600
  s_waitcnt lgkmcnt(7)
  v_mfma_f32_32x32x16_bf16 v[176:191], v[88:91], v[72:75], v[176:191]
  ds_read_b64_tr_b16 v[64:65], v27 offset:24576
  ds_read_b64_tr_b16 v[66:67], v27 offset:25600
  s_waitcnt lgkmcnt(6)
  v_mfma_f32_32x32x16_bf16 v[128:143], v[52:55], v[48:51], v[128:143]
  ds_read_b128 v[72:75], v23 offset:0
  ds_read_b64_tr_b16 v[76:77], v24 offset:28672
  ds_read_b64_tr_b16 v[78:79], v24 offset:29696
  s_waitcnt lgkmcnt(7)
  v_mfma_f32_32x32x16_bf16 v[144:159], v[56:59], v[48:51], v[144:159]
  ds_read_b64_tr_b16 v[80:81], v25 offset:28672
  ds_read_b64_tr_b16 v[82:83], v25 offset:29696
  s_add_u32 s55, s59, 20480
  s_cmp_lg_u32 s94, 0
  s_cbranch_scc1 .Lkv86g
  buffer_store_dwordx4 v[240:243], v32, s[84:87], s55 offen offset:2048
.Lkv86r:
  s_waitcnt lgkmcnt(7)
  v_mfma_f32_32x32x16_bf16 v[160:175], v[60:63], v[48:51], v[160:175]
  ds_read_b64_tr_b16 v[84:85], v26 offset:28672
  ds_read_b64_tr_b16 v[86:87], v26 offset:29696
  s_waitcnt lgkmcnt(7)
  v_mfma_f32_32x32x16_bf16 v[176:191], v[64:67], v[48:51], v[176:191]
  ds_read_b64_tr_b16 v[88:89], v27 offset:28672
  ds_read_b64_tr_b16 v[90:91], v27 offset:29696
  s_waitcnt lgkmcnt(6)
  v_mfma_f32_32x32x16_bf16 v[128:143], v[76:79], v[72:75], v[128:143]
  v_add_u32 v20, 0x8000, v20
  v_add_u32 v21, 0x8000, v21
  v_add_u32 v22, 0x8000, v22
  v_add_u32 v23, 0x8000, v23
  v_add_u32 v24, 0x18000, v24
  v_add_u32 v25, 0x18000, v25
  v_add_u32 v26, 0x18000, v26
  v_add_u32 v27, 0x18000, v27
  s_waitcnt lgkmcnt(0)
  s_barrier
  s_waitcnt vmcnt(4)
.Lpl87c:
  v_and_b32 v43, v41, v42
  v_cmp_ne_u32 vcc, v43, v42
  s_nop 0
  s_cbranch_vccnz .Lpl87s
.Lpl87k:
  ds_read_b128 v[48:51], v20 offset:0
  ds_read_b64_tr_b16 v[52:53], v24 offset:0
  ds_read_b64_tr_b16 v[54:55], v24 offset:1024
  s_add_u32 m0, s58, 32768
  s_nop 0
  buffer_load_dwordx4 v32, s[16:19], s91 offen offset:0 lds
  v_mfma_f32_32x32x16_bf16 v[144:159], v[80:83], v[72:75], v[144:159]
  ds_read_b64_tr_b16 v[56:57], v25 offset:0
  ds_read_b64_tr_b16 v[58:59], v25 offset:1024
  ds_read_b64_tr_b16 v[60:61], v26 offset:0
  ds_read_b64_tr_b16 v[62:63], v26 offset:1024
  buffer_load_dwordx4 v32, s[16:19], s91 offen offset:1024 lds
  v_mfma_f32_32x32x16_bf16 v[160:175], v[84:87], v[72:75], v[160:175]
  ds_read_b64_tr_b16 v[64:65], v27 offset:0
  ds_read_b64_tr_b16 v[66:67], v27 offset:1024
  buffer_load_dwordx4 v32, s[16:19], s91 offen offset:2048 lds
  v_mfma_f32_32x32x16_bf16 v[176:191], v[88:91], v[72:75], v[176:191]
  buffer_load_dwordx4 v32, s[16:19], s91 offen offset:3072 lds
  s_waitcnt lgkmcnt(6)
  v_mfma_f32_32x32x16_bf16 v[128:143], v[52:55], v[48:51], v[128:143]
  ds_read_b128 v[72:75], v21 offset:0
  ds_read_b64_tr_b16 v[76:77], v24 offset:4096
  ds_read_b64_tr_b16 v[78:79], v24 offset:5120
  s_mov_b32 m0, s77
  s_min_u32 s57, s76, s69
  buffer_load_dwordx4 v32, s[16:19], s57 offen offset:0 lds
  s_waitcnt lgkmcnt(7)
  v_mfma_f32_32x32x16_bf16 v[144:159], v[56:59], v[48:51], v[144:159]
  ds_read_b64_tr_b16 v[80:81], v25 offset:4096
  ds_read_b64_tr_b16 v[82:83], v25 offset:5120
  buffer_load_dwordx4 v32, s[16:19], s57 offen offset:1024 lds
  s_add_u32 s55, s59, 20480
  s_cmp_lg_u32 s94, 0
  s_cbranch_scc1 .Lkv88g
  buffer_store_dwordx4 v[244:247], v32, s[84:87], s55 offen offset:3072
.Lkv88r:
  s_waitcnt lgkmcnt(7)
  v_mfma_f32_32x32x16_bf16 v[160:175], v[60:63], v[48:51], v[160:175]
  ds_read_b64_tr_b16 v[84:85], v26 offset:4096
  ds_read_b64_tr_b16 v[86:87], v26 offset:5120
  buffer_load_dwordx4 v32, s[16:19], s57 offen offset:2048 lds
  s_waitcnt lgkmcnt(7)
  v_mfma_f32_32x32x16_bf16 v[176:191], v[64:67], v[48:51], v[176:191]
  ds_read_b64_tr_b16 v[88:89], v27 offset:4096
  ds_read_b64_tr_b16 v[90:91], v27 offset:5120
  buffer_load_dwordx4 v32, s[16:19], s57 offen offset:3072 lds
  s_waitcnt lgkmcnt(6)
  v_mfma_f32_32x32x16_bf16 v[128:143], v[76:79], v[72:75], v[128:143]
  ds_read_b128 v[48:51], v22 offset:0
  ds_read_b64_tr_b16 v[52:53], v24 offset:8192
  ds_read_b64_tr_b16 v[54:55], v24 offset:9216
  s_add_u32 m0, s77, 4096
  s_add_u32 s57, s57, 4096
  buffer_load_dwordx4 v32, s[16:19], s57 offen offset:0 lds
  s_waitcnt lgkmcnt(7)
  v_mfma_f32_32x32x16_bf16 v[144:159], v[80:83], v[72:75], v[144:159]
  ds_read_b64_tr_b16 v[56:57], v25 offset:8192
  ds_read_b64_tr_b16 v[58:59], v25 offset:9216
  buffer_load_dwordx4 v32, s[16:19], s57 offen offset:1024 lds
  s_waitcnt lgkmcnt(7)
  v_mfma_f32_32x32x16_bf16 v[160:175], v[84:87], v[72:75], v[160:175]
  ds_read_b64_tr_b16 v[60:61], v26 offset:8192
  ds_read_b64_tr_b16 v[62:63], v26 offset:9216
  buffer_load_dwordx4 v32, s[16:19], s57 offen offset:2048 lds
  s_waitcnt lgkmcnt(7)
  v_mfma_f32_32x32x16_bf16 v[176:191], v[88:91], v[72:75], v[176:191]
  ds_read_b64_tr_b16 v[64:65], v27 offset:8192
  ds_read_b64_tr_b16 v[66:67], v27 offset:9216
  buffer_load_dwordx4 v32, s[16:19], s57 offen offset:3072 lds
  s_waitcnt lgkmcnt(6)
  v_mfma_f32_32x32x16_bf16 v[128:143], v[52:55], v[48:51], v[128:143]
  ds_read_b128 v[72:75], v23 offset:0
  ds_read_b64_tr_b16 v[76:77], v24 offset:12288
  ds_read_b64_tr_b16 v[78:79], v24 offset:13312
  s_waitcnt lgkmcnt(7)
  v_mfma_f32_32x32x16_bf16 v[144:159], v[56:59], v[48:51], v[144:159]
  ds_read_b64_tr_b16 v[80:81], v25 offset:12288
  ds_read_b64_tr_b16 v[82:83], v25 offset:13312
  s_add_u32 s55, s59, 4096
  s_cmp_lg_u32 s94, 0
  s_cbranch_scc1 .Lkv89g
  buffer_store_dwordx4 v[248:251], v32, s[84:87], s55 offen offset:2048
.Lkv89r:
  s_waitcnt lgkmcnt(7)
  v_mfma_f32_32x32x16_bf16 v[160:175], v[60:63], v[48:51], v[160:175]
  ds_read_b64_tr_b16 v[84:85], v26 offset:12288
  ds_read_b64_tr_b16 v[86:87], v26 offset:13312
  s_waitcnt lgkmcnt(7)
  v_mfma_f32_32x32x16_bf16 v[176:191], v[64:67], v[48:51], v[176:191]
  ds_read_b64_tr_b16 v[88:89], v27 offset:12288
  ds_read_b64_tr_b16 v[90:91], v27 offset:13312
  s_waitcnt lgkmcnt(6)
  v_mfma_f32_32x32x16_bf16 v[128:143], v[76:79], v[72:75], v[128:143]
  v_add_u32 v20, 0xfffe8000, v20
  v_add_u32 v21, 0xfffe8000, v21
  v_add_u32 v22, 0xfffe8000, v22
  v_add_u32 v23, 0xfffe8000, v23
  s_waitcnt lgkmcnt(0)
  s_barrier
  ds_read_b128 v[48:51], v20 offset:0
  ds_read_b64_tr_b16 v[52:53], v24 offset:16384
  ds_read_b64_tr_b16 v[54:55], v24 offset:17408
  s_add_u32 m0, s77, 32768
  s_sub_u32 s57, s76, 24576
  buffer_load_dwordx4 v32, s[16:19], s57 offen offset:0 lds
  v_mfma_f32_32x32x16_bf16 v[144:159], v[80:83], v[72:75], v[144:159]
  ds_read_b64_tr_b16 v[56:57], v25 offset:16384
  ds_read_b64_tr_b16 v[58:59], v25 offset:17408
  ds_read_b64_tr_b16 v[60:61], v26 offset:16384
  ds_read_b64_tr_b16 v[62:63], v26 offset:17408
  buffer_load_dwordx4 v32, s[16:19], s57 offen offset:1024 lds
  v_mfma_f32_32x32x16_bf16 v[160:175], v[84:87], v[72:75], v[160:175]
  ds_read_b64_tr_b16 v[64:65], v27 offset:16384
  ds_read_b64_tr_b16 v[66:67], v27 offset:17408
  buffer_load_dwordx4 v32, s[16:19], s57 offen offset:2048 lds
  v_mfma_f32_32x32x16_bf16 v[176:191], v[88:91], v[72:75], v[176:191]
  buffer_load_dwordx4 v32, s[16:19], s57 offen offset:3072 lds
  s_waitcnt lgkmcnt(6)
  v_mfma_f32_32x32x16_bf16 v[128:143], v[52:55], v[48:51], v[128:143]
  ds_read_b128 v[72:75], v21 offset:0
  ds_read_b64_tr_b16 v[76:77], v24 offset:20480
  ds_read_b64_tr_b16 v[78:79], v24 offset:21504
  s_add_u32 m0, s77, 36864
  s_add_u32 s57, s57, 4096
  buffer_load_dwordx4 v32, s[16:19], s57 offen offset:0 lds
  s_waitcnt lgkmcnt(7)
  v_mfma_f32_32x32x16_bf16 v[144:159], v[56:59], v[48:51], v[144:159]
  ds_read_b64_tr_b16 v[80:81], v25 offset:20480
  ds_read_b64_tr_b16 v[82:83], v25 offset:21504
  buffer_load_dwordx4 v32, s[16:19], s57 offen offset:1024 lds
  s_add_u32 s55, s59, 4096
  s_cmp_lg_u32 s94, 0
  s_cbranch_scc1 .Lkv90g
  buffer_store_dwordx4 v[252:255], v32, s[84:87], s55 offen offset:3072
.Lkv90r:
  s_waitcnt lgkmcnt(7)
  v_mfma_f32_32x32x16_bf16 v[160:175], v[60:63], v[48:51], v[160:175]
  ds_read_b64_tr_b16 v[84:85], v26 offset:20480
  ds_read_b64_tr_b16 v[86:87], v26 offset:21504
  buffer_load_dwordx4 v32, s[16:19], s57 offen offset:2048 lds
  s_waitcnt lgkmcnt(7)
  v_mfma_f32_32x32x16_bf16 v[176:191], v[64:67], v[48:51], v[176:191]
  ds_read_b64_tr_b16 v[88:89], v27 offset:20480
  ds_read_b64_tr_b16 v[90:91], v27 offset:21504
  buffer_load_dwordx4 v32, s[16:19], s57 offen offset:3072 lds
  s_add_u32 s76, s76, 65536
  s_xor_b32 s77, s77, 65536
  s_waitcnt lgkmcnt(6)
  v_mfma_f32_32x32x16_bf16 v[128:143], v[76:79], v[72:75], v[128:143]
  ds_read_b128 v[48:51], v22 offset:0
  ds_read_b64_tr_b16 v[52:53], v24 offset:24576
  ds_read_b64_tr_b16 v[54:55], v24 offset:25600
  s_waitcnt lgkmcnt(7)
  v_mfma_f32_32x32x16_bf16 v[144:159], v[80:83], v[72:75], v[144:159]
  ds_read_b64_tr_b16 v[56:57], v25 offset:24576
  ds_read_b64_tr_b16 v[58:59], v25 offset:25600
  s_waitcnt lgkmcnt(7)
  v_mfma_f32_32x32x16_bf16 v[160:175], v[84:87], v[72:75], v[160:175]
  ds_read_b64_tr_b16 v[60:61], v26 offset:24576
  ds_read_b64_tr_b16 v[62:63], v26 offset:25600
  s_waitcnt lgkmcnt(7)
  v_mfma_f32_32x32x16_bf16 v[176:191], v[88:91], v[72:75], v[176:191]
  ds_read_b64_tr_b16 v[64:65], v27 offset:24576
  ds_read_b64_tr_b16 v[66:67], v27 offset:25600
  s_waitcnt lgkmcnt(6)
  v_mfma_f32_32x32x16_bf16 v[128:143], v[52:55], v[48:51], v[128:143]
  ds_read_b128 v[72:75], v23 offset:0
  ds_read_b64_tr_b16 v[76:77], v24 offset:28672
  ds_read_b64_tr_b16 v[78:79], v24 offset:29696
  s_waitcnt lgkmcnt(7)
  v_mfma_f32_32x32x16_bf16 v[144:159], v[56:59], v[48:51], v[144:159]
  ds_read_b64_tr_b16 v[80:81], v25 offset:28672
  ds_read_b64_tr_b16 v[82:83], v25 offset:29696
  s_waitcnt lgkmcnt(7)
  v_mfma_f32_32x32x16_bf16 v[160:175], v[60:63], v[48:51], v[160:175]
  ds_read_b64_tr_b16 v[84:85], v26 offset:28672
  ds_read_b64_tr_b16 v[86:87], v26 offset:29696
  s_waitcnt lgkmcnt(7)
  v_mfma_f32_32x32x16_bf16 v[176:191], v[64:67], v[48:51], v[176:191]
  ds_read_b64_tr_b16 v[88:89], v27 offset:28672
  ds_read_b64_tr_b16 v[90:91], v27 offset:29696
  s_waitcnt lgkmcnt(6)
  v_mfma_f32_32x32x16_bf16 v[128:143], v[76:79], v[72:75], v[128:143]
  s_waitcnt lgkmcnt(0)
  s_waitcnt vmcnt(19)
  s_barrier
  ds_write_b128 v28, v[96:99] offset:0
  ds_write_b128 v30, v[100:103] offset:0
  ds_write_b128 v28, v[112:115] offset:2048
  ds_write_b128 v30, v[116:119] offset:2048
  v_mov_b32 v123, v33
  v_add_u32 v1, 16384, v32
  v_mov_b32 v2, v32
  ds_read_b128 v[192:195], v1 offset:16384
  ds_read_b128 v[196:199], v1 offset:17408
  ds_read_b128 v[200:203], v1 offset:18432
  v_mfma_f32_32x32x16_bf16 v[144:159], v[80:83], v[72:75], v[144:159]
  ds_read_b128 v[204:207], v1 offset:19456
  ds_read_b128 v[208:211], v1 offset:20480
  ds_read_b128 v[212:215], v1 offset:21504
  v_mfma_f32_32x32x16_bf16 v[160:175], v[84:87], v[72:75], v[160:175]
  ds_read_b128 v[216:219], v1 offset:22528
  ds_read_b128 v[220:223], v1 offset:23552
  v_mfma_f32_32x32x16_bf16 v[176:191], v[88:91], v[72:75], v[176:191]
  v_and_b32 v3, 31, v0
  v_lshrrev_b32 v5, 5, v0
  v_lshlrev_b32 v5, 2, v5
  v_sub_u32 v3, v3, v5
  v_mov_b32 v4, 0
  v_mov_b32 v5, 0
  v_mov_b64 v[48:49], 0
  v_mov_b64 v[50:51], 0
  v_mov_b64 v[52:53], 0
  v_mov_b64 v[54:55], 0
  v_mov_b64 v[56:57], 0
  v_mov_b64 v[58:59], 0
  v_mov_b64 v[60:61], 0
  v_mov_b64 v[62:63], 0
  s_cmp_lg_u32 s78, 0
  s_cbranch_scc1 .Lk2_p2
  v_mov_b32 v12, 0xf149f2ca
  v_cmp_gt_i32 vcc, 0, v3
  s_nop 1
  v_cndmask_b32 v48, v48, v12, vcc
  v_cmp_gt_i32 vcc, 1, v3
  s_nop 1
  v_cndmask_b32 v49, v49, v12, vcc
  v_cmp_gt_i32 vcc, 2, v3
  s_nop 1
  v_cndmask_b32 v50, v50, v12, vcc
  v_cmp_gt_i32 vcc, 3, v3
  s_nop 1
  v_cndmask_b32 v51, v51, v12, vcc
  v_cmp_gt_i32 vcc, 8, v3
  s_nop 1
  v_cndmask_b32 v52, v52, v12, vcc
  v_cmp_gt_i32 vcc, 9, v3
  s_nop 1
  v_cndmask_b32 v53, v53, v12, vcc
  v_cmp_gt_i32 vcc, 10, v3
  s_nop 1
  v_cndmask_b32 v54, v54, v12, vcc
  v_cmp_gt_i32 vcc, 11, v3
  s_nop 1
  v_cndmask_b32 v55, v55, v12, vcc
  v_cmp_gt_i32 vcc, 16, v3
  s_nop 1
  v_cndmask_b32 v56, v56, v12, vcc
  v_cmp_gt_i32 vcc, 17, v3
  s_nop 1
  v_cndmask_b32 v57, v57, v12, vcc
  v_cmp_gt_i32 vcc, 18, v3
  s_nop 1
  v_cndmask_b32 v58, v58, v12, vcc
  v_cmp_gt_i32 vcc, 19, v3
  s_nop 1
  v_cndmask_b32 v59, v59, v12, vcc
  v_cmp_gt_i32 vcc, 24, v3
  s_nop 1
  v_cndmask_b32 v60, v60, v12, vcc
  v_cmp_gt_i32 vcc, 25, v3
  s_nop 1
  v_cndmask_b32 v61, v61, v12, vcc
  v_cmp_gt_i32 vcc, 26, v3
  s_nop 1
  v_cndmask_b32 v62, v62, v12, vcc
  v_cmp_gt_i32 vcc, 27, v3
  s_nop 1
  v_cndmask_b32 v63, v63, v12, vcc
.Lk2_p2:
  s_mov_b32 s56, 0x3e0293ee
  s_mov_b32 s57, 0x3e0293ee
  v_mov_b64 v[104:105], 0
  v_mov_b64 v[106:107], 0
  v_pk_mul_f32 v[128:129], v[128:129], s[56:57]
  v_pk_mul_f32 v[130:131], v[130:131], s[56:57]
  v_pk_mul_f32 v[132:133], v[132:133], s[56:57]
  v_pk_mul_f32 v[134:135], v[134:135], s[56:57]
  v_pk_mul_f32 v[136:137], v[136:137], s[56:57]
  v_pk_mul_f32 v[138:139], v[138:139], s[56:57]
  v_pk_mul_f32 v[140:141], v[140:141], s[56:57]
  v_pk_mul_f32 v[142:143], v[142:143], s[56:57]
  v_cvt_pk_bf16_f32 v16, v128, v129
  v_cvt_pk_bf16_f32 v17, v130, v131
  v_cvt_pk_bf16_f32 v18, v132, v133
  v_cvt_pk_bf16_f32 v19, v134, v135
  v_cvt_pk_bf16_f32 v20, v136, v137
  v_cvt_pk_bf16_f32 v21, v138, v139
  v_cvt_pk_bf16_f32 v22, v140, v141
  v_cvt_pk_bf16_f32 v23, v142, v143
  s_waitcnt lgkmcnt(7)
  v_mfma_f32_32x32x16_bf16 v[64:79], v[192:195], v[16:19], v[48:63]
  s_waitcnt lgkmcnt(6)
  v_mfma_f32_32x32x16_bf16 v[64:79], v[196:199], v[20:23], v[64:79]
  ds_read_b128 v[192:195], v1 offset:24576
  ds_read_b128 v[196:199], v1 offset:25600
  v_mfma_f32_32x32x16_bf16 v[128:143], v[104:107], v[104:107], 0
  v_pk_mul_f32 v[144:145], v[144:145], s[56:57]
  v_pk_mul_f32 v[146:147], v[146:147], s[56:57]
  v_pk_mul_f32 v[148:149], v[148:149], s[56:57]
  v_pk_mul_f32 v[150:151], v[150:151], s[56:57]
  v_pk_mul_f32 v[152:153], v[152:153], s[56:57]
  v_pk_mul_f32 v[154:155], v[154:155], s[56:57]
  v_pk_mul_f32 v[156:157], v[156:157], s[56:57]
  v_pk_mul_f32 v[158:159], v[158:159], s[56:57]
  v_cvt_pk_bf16_f32 v24, v144, v145
  v_cvt_pk_bf16_f32 v25, v146, v147
  v_cvt_pk_bf16_f32 v26, v148, v149
  v_cvt_pk_bf16_f32 v27, v150, v151
  v_cvt_pk_bf16_f32 v28, v152, v153
  v_cvt_pk_bf16_f32 v29, v154, v155
  v_cvt_pk_bf16_f32 v30, v156, v157
  v_cvt_pk_bf16_f32 v31, v158, v159
  s_waitcnt lgkmcnt(7)
  v_mfma_f32_32x32x16_bf16 v[64:79], v[200:203], v[24:27], v[64:79]
  s_waitcnt lgkmcnt(6)
  v_mfma_f32_32x32x16_bf16 v[64:79], v[204:207], v[28:31], v[64:79]
  ds_read_b128 v[200:203], v1 offset:26624
  ds_read_b128 v[204:207], v1 offset:27648
  v_mfma_f32_32x32x16_bf16 v[144:159], v[104:107], v[104:107], 0
  v_pk_mul_f32 v[160:161], v[160:161], s[56:57]
  v_pk_mul_f32 v[162:163], v[162:163], s[56:57]
  v_pk_mul_f32 v[164:165], v[164:165], s[56:57]
  v_pk_mul_f32 v[166:167], v[166:167], s[56:57]
  v_pk_mul_f32 v[168:169], v[168:169], s[56:57]
  v_pk_mul_f32 v[170:171], v[170:171], s[56:57]
  v_pk_mul_f32 v[172:173], v[172:173], s[56:57]
  v_pk_mul_f32 v[174:175], v[174:175], s[56:57]
  v_cvt_pk_bf16_f32 v32, v160, v161
  v_cvt_pk_bf16_f32 v33, v162, v163
  v_cvt_pk_bf16_f32 v34, v164, v165
  v_cvt_pk_bf16_f32 v35, v166, v167
  v_cvt_pk_bf16_f32 v36, v168, v169
  v_cvt_pk_bf16_f32 v37, v170, v171
  v_cvt_pk_bf16_f32 v38, v172, v173
  v_cvt_pk_bf16_f32 v39, v174, v175
  s_waitcnt lgkmcnt(7)
  v_mfma_f32_32x32x16_bf16 v[64:79], v[208:211], v[32:35], v[64:79]
  s_waitcnt lgkmcnt(6)
  v_mfma_f32_32x32x16_bf16 v[64:79], v[212:215], v[36:39], v[64:79]
  ds_read_b128 v[208:211], v1 offset:28672
  ds_read_b128 v[212:215], v1 offset:29696
  v_mfma_f32_32x32x16_bf16 v[160:175], v[104:107], v[104:107], 0
  v_pk_mul_f32 v[176:177], v[176:177], s[56:57]
  v_pk_mul_f32 v[178:179], v[178:179], s[56:57]
  v_pk_mul_f32 v[180:181], v[180:181], s[56:57]
  v_pk_mul_f32 v[182:183], v[182:183], s[56:57]
  v_pk_mul_f32 v[184:185], v[184:185], s[56:57]
  v_pk_mul_f32 v[186:187], v[186:187], s[56:57]
  v_pk_mul_f32 v[188:189], v[188:189], s[56:57]
  v_pk_mul_f32 v[190:191], v[190:191], s[56:57]
  v_cvt_pk_bf16_f32 v40, v176, v177
  v_cvt_pk_bf16_f32 v41, v178, v179
  v_cvt_pk_bf16_f32 v42, v180, v181
  v_cvt_pk_bf16_f32 v43, v182, v183
  v_cvt_pk_bf16_f32 v44, v184, v185
  v_cvt_pk_bf16_f32 v45, v186, v187
  v_cvt_pk_bf16_f32 v46, v188, v189
  v_cvt_pk_bf16_f32 v47, v190, v191
  s_waitcnt lgkmcnt(7)
  v_mfma_f32_32x32x16_bf16 v[64:79], v[216:219], v[40:43], v[64:79]
  s_waitcnt lgkmcnt(6)
  v_mfma_f32_32x32x16_bf16 v[64:79], v[220:223], v[44:47], v[64:79]
  ds_read_b128 v[216:219], v1 offset:30720
  ds_read_b128 v[220:223], v1 offset:31744
  v_mfma_f32_32x32x16_bf16 v[176:191], v[104:107], v[104:107], 0
  s_nop 8
  v_max3_f32 v12, v64, v65, v66
  v_max3_f32 v13, v67, v68, v69
  v_max3_f32 v12, v12, v70, v71
  v_max3_f32 v13, v13, v72, v73
  v_max3_f32 v12, v12, v74, v75
  v_max3_f32 v13, v13, v76, v77
  v_max3_f32 v12, v12, v78, v79
  v_max_f32 v12, v12, v13
  v_mov_b32 v13, v12
  s_nop 1
  v_permlane32_swap_b32 v13, v12
  s_nop 1
  v_max_f32 v13, v12, v13
  v_sub_f32 v12, 0, v13
  v_sub_f32 v13, 0, v13
  v_pk_add_f32 v[64:65], v[64:65], v[12:13]
  v_pk_add_f32 v[66:67], v[66:67], v[12:13]
  v_pk_add_f32 v[68:69], v[68:69], v[12:13]
  v_pk_add_f32 v[70:71], v[70:71], v[12:13]
  v_pk_add_f32 v[72:73], v[72:73], v[12:13]
  v_pk_add_f32 v[74:75], v[74:75], v[12:13]
  v_pk_add_f32 v[76:77], v[76:77], v[12:13]
  v_pk_add_f32 v[78:79], v[78:79], v[12:13]
  v_mov_b64 v[48:49], v[12:13]
  v_mov_b64 v[50:51], v[12:13]
  v_mov_b64 v[52:53], v[12:13]
  v_mov_b64 v[54:55], v[12:13]
  v_mov_b64 v[56:57], v[12:13]
  v_mov_b64 v[58:59], v[12:13]
  v_mov_b64 v[60:61], v[12:13]
  v_mov_b64 v[62:63], v[12:13]
  v_exp_f32 v6, v64
  v_exp_f32 v7, v65
  v_add_f32 v4, v4, v6
  v_exp_f32 v8, v66
  v_add_f32 v5, v5, v7
  v_cvt_pk_bf16_f32 v96, v6, v7
  v_exp_f32 v9, v67
  v_add_f32 v4, v4, v8
  v_exp_f32 v10, v68
  v_add_f32 v5, v5, v9
  v_cvt_pk_bf16_f32 v97, v8, v9
  v_exp_f32 v11, v69
  v_add_f32 v4, v4, v10
  s_waitcnt vmcnt(0) lgkmcnt(0)
  s_barrier
  v_add_u32 v1, 49152, v1
  s_cmp_eq_u32 s72, 0
  s_cbranch_scc1 .Lk2s_te
  s_branch .Lk2s_l0
.Lk2s_loop:
  s_setprio 0
  s_waitcnt lgkmcnt(7)
  v_mfma_f32_32x32x16_bf16 v[64:79], v[192:195], v[16:19], v[48:63]
  ds_read_b128 v[224:227], v1 offset:57344
  v_exp_f32 v6, v86
  v_add_f32 v5, v5, v11
  v_cvt_pk_bf16_f32 v106, v10, v11
  s_waitcnt lgkmcnt(7)
  v_mfma_f32_32x32x16_bf16 v[64:79], v[196:199], v[20:23], v[64:79]
  ds_read_b128 v[232:235], v1 offset:59392
  v_exp_f32 v7, v87
  v_add_f32 v4, v4, v6
  s_waitcnt lgkmcnt(7)
  v_mfma_f32_32x32x16_bf16 v[64:79], v[200:203], v[24:27], v[64:79]
  ds_read_b128 v[240:243], v1 offset:61440
  v_exp_f32 v8, v88
  v_add_f32 v5, v5, v7
  v_cvt_pk_bf16_f32 v107, v6, v7
  s_waitcnt lgkmcnt(7)
  v_mfma_f32_32x32x16_bf16 v[64:79], v[204:207], v[28:31], v[64:79]
  ds_read_b128 v[248:251], v1 offset:63488
  v_exp_f32 v9, v89
  v_add_f32 v4, v4, v8
  s_waitcnt lgkmcnt(7)
  v_mfma_f32_32x32x16_bf16 v[64:79], v[208:211], v[32:35], v[64:79]
  ds_read_b128 v[228:231], v1 offset:58368
  v_exp_f32 v10, v90
  v_add_f32 v5, v5, v9
  v_cvt_pk_bf16_f32 v108, v8, v9
  s_waitcnt lgkmcnt(7)
  v_mfma_f32_32x32x16_bf16 v[64:79], v[212:215], v[36:39], v[64:79]
  ds_read_b128 v[236:239], v1 offset:60416
  v_exp_f32 v11, v91
  v_add_f32 v4, v4, v10
  s_waitcnt lgkmcnt(7)
  v_mfma_f32_32x32x16_bf16 v[64:79], v[216:219], v[40:43], v[64:79]
  ds_read_b128 v[244:247], v1 offset:62464
  v_exp_f32 v6, v92
  v_add_f32 v5, v5, v11
  v_cvt_pk_bf16_f32 v109, v10, v11
  s_waitcnt lgkmcnt(7)
  v_mfma_f32_32x32x16_bf16 v[64:79], v[220:223], v[44:47], v[64:79]
  ds_read_b128 v[252:255], v1 offset:64512
  v_exp_f32 v7, v93
  v_add_f32 v4, v4, v6
  s_waitcnt lgkmcnt(7)
  v_mfma_f32_32x32x16_bf16 v[128:143], v[224:227], v[104:107], v[128:143]
  ds_read_b128 v[192:195], v1 offset:24576
  ds_read_b128 v[196:199], v1 offset:25600
  v_exp_f32 v8, v94
  v_add_f32 v5, v5, v7
  v_cvt_pk_bf16_f32 v110, v6, v7
  s_waitcnt lgkmcnt(8)
  v_mfma_f32_32x32x16_bf16 v[144:159], v[232:235], v[104:107], v[144:159]
  ds_read_b128 v[200:203], v1 offset:26624
  ds_read_b128 v[204:207], v1 offset:27648
  v_exp_f32 v9, v95
  v_add_f32 v4, v4, v8
  s_waitcnt lgkmcnt(9)
  v_mfma_f32_32x32x16_bf16 v[160:175], v[240:243], v[104:107], v[160:175]
  ds_read_b128 v[208:211], v1 offset:28672
  ds_read_b128 v[212:215], v1 offset:29696
  v_add_f32 v5, v5, v9
  v_cvt_pk_bf16_f32 v111, v8, v9
  v_exp_f32 v6, v64
  s_waitcnt lgkmcnt(10)
  v_mfma_f32_32x32x16_bf16 v[176:191], v[248:251], v[104:107], v[176:191]
  ds_read_b128 v[216:219], v1 offset:30720
  ds_read_b128 v[220:223], v1 offset:31744
  v_exp_f32 v7, v65
  v_add_f32 v4, v4, v6
  s_waitcnt lgkmcnt(11)
  v_mfma_f32_32x32x16_bf16 v[128:143], v[228:231], v[108:111], v[128:143]
  v_exp_f32 v8, v66
  v_add_f32 v5, v5, v7
  v_cvt_pk_bf16_f32 v96, v6, v7
  s_waitcnt lgkmcnt(10)
  v_mfma_f32_32x32x16_bf16 v[144:159], v[236:239], v[108:111], v[144:159]
  v_exp_f32 v9, v67
  v_add_f32 v4, v4, v8
  s_waitcnt lgkmcnt(9)
  v_mfma_f32_32x32x16_bf16 v[160:175], v[244:247], v[108:111], v[160:175]
  v_exp_f32 v10, v68
  v_add_f32 v5, v5, v9
  v_cvt_pk_bf16_f32 v97, v8, v9
  s_waitcnt vmcnt(0) lgkmcnt(0)
  s_barrier
  v_xor_b32 v1, 0x10000, v1
  v_mfma_f32_32x32x16_bf16 v[176:191], v[252:255], v[108:111], v[176:191]
  v_exp_f32 v11, v69
  v_add_f32 v4, v4, v10
.Lk2s_l0:
  s_setprio 3
  v_mfma_f32_32x32x16_bf16 v[80:95], v[192:195], v[16:19], v[48:63]
  ds_read_b128 v[224:227], v1 offset:32768
  v_exp_f32 v6, v70
  v_add_f32 v5, v5, v11
  v_cvt_pk_bf16_f32 v98, v10, v11
  s_sub_u32 s101, s101, 1
  s_cbranch_scc1 .Lkc91a
.Lkc91k:
  s_mov_b32 m0, s77
  s_min_u32 s57, s76, s69
  buffer_load_dwordx4 v2, s[16:19], s57 offen offset:0 lds
  v_mfma_f32_32x32x16_bf16 v[80:95], v[196:199], v[20:23], v[80:95]
  ds_read_b128 v[232:235], v1 offset:34816
  v_exp_f32 v7, v71
  v_add_f32 v4, v4, v6
  buffer_load_dwordx4 v2, s[16:19], s57 offen offset:1024 lds
  v_mfma_f32_32x32x16_bf16 v[80:95], v[200:203], v[24:27], v[80:95]
  ds_read_b128 v[240:243], v1 offset:36864
  v_exp_f32 v8, v72
  v_add_f32 v5, v5, v7
  v_cvt_pk_bf16_f32 v99, v6, v7
  buffer_load_dwordx4 v2, s[16:19], s57 offen offset:2048 lds
  v_mfma_f32_32x32x16_bf16 v[80:95], v[204:207], v[28:31], v[80:95]
  ds_read_b128 v[248:251], v1 offset:38912
  v_exp_f32 v9, v73
  v_add_f32 v4, v4, v8
  buffer_load_dwordx4 v2, s[16:19], s57 offen offset:3072 lds
  v_mfma_f32_32x32x16_bf16 v[80:95], v[208:211], v[32:35], v[80:95]
  ds_read_b128 v[228:231], v1 offset:33792
  v_exp_f32 v10, v74
  v_add_f32 v5, v5, v9
  v_cvt_pk_bf16_f32 v100, v8, v9
  s_add_u32 m0, s77, 4096
  s_add_u32 s57, s57, 4096
  buffer_load_dwordx4 v2, s[16:19], s57 offen offset:0 lds
  v_mfma_f32_32x32x16_bf16 v[80:95], v[212:215], v[36:39], v[80:95]
  ds_read_b128 v[236:239], v1 offset:35840
  v_exp_f32 v11, v75
  v_add_f32 v4, v4, v10
  buffer_load_dwordx4 v2, s[16:19], s57 offen offset:1024 lds
  v_mfma_f32_32x32x16_bf16 v[80:95], v[216:219], v[40:43], v[80:95]
  ds_read_b128 v[244:247], v1 offset:37888
  v_exp_f32 v6, v76
  v_add_f32 v5, v5, v11
  v_cvt_pk_bf16_f32 v101, v10, v11
  buffer_load_dwordx4 v2, s[16:19], s57 offen offset:2048 lds
  v_mfma_f32_32x32x16_bf16 v[80:95], v[220:223], v[44:47], v[80:95]
  ds_read_b128 v[252:255], v1 offset:39936
  v_exp_f32 v7, v77
  v_add_f32 v4, v4, v6
  buffer_load_dwordx4 v2, s[16:19], s57 offen offset:3072 lds
  s_waitcnt lgkmcnt(7)
  v_mfma_f32_32x32x16_bf16 v[128:143], v[224:227], v[96:99], v[128:143]
  ds_read_b128 v[192:195], v1 offset:0
  v_exp_f32 v8, v78
  v_add_f32 v5, v5, v7
  v_cvt_pk_bf16_f32 v102, v6, v7
  s_add_u32 m0, s77, 32768
  s_sub_u32 s57, s76, 24576
  buffer_load_dwordx4 v2, s[16:19], s57 offen offset:0 lds
  s_waitcnt lgkmcnt(7)
  v_mfma_f32_32x32x16_bf16 v[144:159], v[232:235], v[96:99], v[144:159]
  ds_read_b128 v[196:199], v1 offset:1024
  v_exp_f32 v9, v79
  v_add_f32 v4, v4, v8
  buffer_load_dwordx4 v2, s[16:19], s57 offen offset:1024 lds
  s_waitcnt lgkmcnt(7)
  v_mfma_f32_32x32x16_bf16 v[160:175], v[240:243], v[96:99], v[160:175]
  ds_read_b128 v[200:203], v1 offset:2048
  v_add_f32 v5, v5, v9
  v_cvt_pk_bf16_f32 v103, v8, v9
  v_exp_f32 v6, v80
  buffer_load_dwordx4 v2, s[16:19], s57 offen offset:2048 lds
  s_waitcnt lgkmcnt(7)
  v_mfma_f32_32x32x16_bf16 v[176:191], v[248:251], v[96:99], v[176:191]
  ds_read_b128 v[204:207], v1 offset:3072
  v_exp_f32 v7, v81
  v_add_f32 v4, v4, v6
  buffer_load_dwordx4 v2, s[16:19], s57 offen offset:3072 lds
  s_waitcnt lgkmcnt(7)
  v_mfma_f32_32x32x16_bf16 v[128:143], v[228:231], v[100:103], v[128:143]
  ds_read_b128 v[208:211], v1 offset:4096
  v_exp_f32 v8, v82
  v_add_f32 v5, v5, v7
  v_cvt_pk_bf16_f32 v104, v6, v7
  s_add_u32 m0, s77, 36864
  s_add_u32 s57, s57, 4096
  buffer_load_dwordx4 v2, s[16:19], s57 offen offset:0 lds
  s_waitcnt lgkmcnt(7)
  v_mfma_f32_32x32x16_bf16 v[144:159], v[236:239], v[100:103], v[144:159]
  ds_read_b128 v[212:215], v1 offset:5120
  v_exp_f32 v9, v83
  v_add_f32 v4, v4, v8
  buffer_load_dwordx4 v2, s[16:19], s57 offen offset:1024 lds
  s_waitcnt lgkmcnt(7)
  v_mfma_f32_32x32x16_bf16 v[160:175], v[244:247], v[100:103], v[160:175]
  ds_read_b128 v[216:219], v1 offset:6144
  v_exp_f32 v10, v84
  v_add_f32 v5, v5, v9
  v_cvt_pk_bf16_f32 v105, v8, v9
  buffer_load_dwordx4 v2, s[16:19], s57 offen offset:2048 lds
  s_waitcnt lgkmcnt(7)
  v_mfma_f32_32x32x16_bf16 v[176:191], v[252:255], v[100:103], v[176:191]
  ds_read_b128 v[220:223], v1 offset:7168
  v_exp_f32 v11, v85
  v_add_f32 v4, v4, v10
  buffer_load_dwordx4 v2, s[16:19], s57 offen offset:3072 lds
  s_add_u32 s76, s76, 65536
  s_xor_b32 s77, s77, 65536
  s_setprio 2
  s_waitcnt lgkmcnt(7)
  v_mfma_f32_32x32x16_bf16 v[64:79], v[192:195], v[16:19], v[48:63]
  ds_read_b128 v[224:227], v1 offset:40960
  v_exp_f32 v6, v86
  v_add_f32 v5, v5, v11
  v_cvt_pk_bf16_f32 v106, v10, v11
  s_waitcnt lgkmcnt(7)
  v_mfma_f32_32x32x16_bf16 v[64:79], v[196:199], v[20:23], v[64:79]
  ds_read_b128 v[232:235], v1 offset:43008
  v_exp_f32 v7, v87
  v_add_f32 v4, v4, v6
  s_waitcnt lgkmcnt(7)
  v_mfma_f32_32x32x16_bf16 v[64:79], v[200:203], v[24:27], v[64:79]
  ds_read_b128 v[240:243], v1 offset:45056
  v_exp_f32 v8, v88
  v_add_f32 v5, v5, v7
  v_cvt_pk_bf16_f32 v107, v6, v7
  s_waitcnt lgkmcnt(7)
  v_mfma_f32_32x32x16_bf16 v[64:79], v[204:207], v[28:31], v[64:79]
  ds_read_b128 v[248:251], v1 offset:47104
  v_exp_f32 v9, v89
  v_add_f32 v4, v4, v8
  s_waitcnt lgkmcnt(7)
  v_mfma_f32_32x32x16_bf16 v[64:79], v[208:211], v[32:35], v[64:79]
  ds_read_b128 v[228:231], v1 offset:41984
  v_exp_f32 v10, v90
  v_add_f32 v5, v5, v9
  v_cvt_pk_bf16_f32 v108, v8, v9
  s_waitcnt lgkmcnt(7)
  v_mfma_f32_32x32x16_bf16 v[64:79], v[212:215], v[36:39], v[64:79]
  ds_read_b128 v[236:239], v1 offset:44032
  v_exp_f32 v11, v91
  v_add_f32 v4, v4, v10
  s_waitcnt lgkmcnt(7)
  v_mfma_f32_32x32x16_bf16 v[64:79], v[216:219], v[40:43], v[64:79]
  ds_read_b128 v[244:247], v1 offset:46080
  v_exp_f32 v6, v92
  v_add_f32 v5, v5, v11
  v_cvt_pk_bf16_f32 v109, v10, v11
  s_waitcnt lgkmcnt(7)
  v_mfma_f32_32x32x16_bf16 v[64:79], v[220:223], v[44:47], v[64:79]
  ds_read_b128 v[252:255], v1 offset:48128
  v_exp_f32 v7, v93
  v_add_f32 v4, v4, v6
  s_waitcnt lgkmcnt(7)
  v_mfma_f32_32x32x16_bf16 v[128:143], v[224:227], v[104:107], v[128:143]
  ds_read_b128 v[192:195], v1 offset:8192
  v_exp_f32 v8, v94
  v_add_f32 v5, v5, v7
  v_cvt_pk_bf16_f32 v110, v6, v7
  s_waitcnt lgkmcnt(7)
  v_mfma_f32_32x32x16_bf16 v[144:159], v[232:235], v[104:107], v[144:159]
  ds_read_b128 v[196:199], v1 offset:9216
  v_exp_f32 v9, v95
  v_add_f32 v4, v4, v8
  s_waitcnt lgkmcnt(7)
  v_mfma_f32_32x32x16_bf16 v[160:175], v[240:243], v[104:107], v[160:175]
  ds_read_b128 v[200:203], v1 offset:10240
  v_add_f32 v5, v5, v9
  v_cvt_pk_bf16_f32 v111, v8, v9
  v_exp_f32 v6, v64
  s_waitcnt lgkmcnt(7)
  v_mfma_f32_32x32x16_bf16 v[176:191], v[248:251], v[104:107], v[176:191]
  ds_read_b128 v[204:207], v1 offset:11264
  v_exp_f32 v7, v65
  v_add_f32 v4, v4, v6
  s_waitcnt lgkmcnt(7)
  v_mfma_f32_32x32x16_bf16 v[128:143], v[228:231], v[108:111], v[128:143]
  ds_read_b128 v[208:211], v1 offset:12288
  v_exp_f32 v8, v66
  v_add_f32 v5, v5, v7
  v_cvt_pk_bf16_f32 v96, v6, v7
  s_waitcnt lgkmcnt(7)
  v_mfma_f32_32x32x16_bf16 v[144:159], v[236:239], v[108:111], v[144:159]
  ds_read_b128 v[212:215], v1 offset:13312
  v_exp_f32 v9, v67
  v_add_f32 v4, v4, v8
  s_waitcnt lgkmcnt(7)
  v_mfma_f32_32x32x16_bf16 v[160:175], v[244:247], v[108:111], v[160:175]
  ds_read_b128 v[216:219], v1 offset:14336
  v_exp_f32 v10, v68
  v_add_f32 v5, v5, v9
  v_cvt_pk_bf16_f32 v97, v8, v9
  s_waitcnt lgkmcnt(7)
  v_mfma_f32_32x32x16_bf16 v[176:191], v[252:255], v[108:111], v[176:191]
  ds_read_b128 v[220:223], v1 offset:15360
  v_exp_f32 v11, v69
  v_add_f32 v4, v4, v10
  s_setprio 1
  s_waitcnt lgkmcnt(7)
  v_mfma_f32_32x32x16_bf16 v[80:95], v[192:195], v[16:19], v[48:63]
  ds_read_b128 v[224:227], v1 offset:49152
  v_exp_f32 v6, v70
  v_add_f32 v5, v5, v11
  v_cvt_pk_bf16_f32 v98, v10, v11
  s_waitcnt lgkmcnt(7)
  v_mfma_f32_32x32x16_bf16 v[80:95], v[196:199], v[20:23], v[80:95]
  ds_read_b128 v[232:235], v1 offset:51200
  v_exp_f32 v7, v71
  v_add_f32 v4, v4, v6
  s_waitcnt lgkmcnt(7)
  v_mfma_f32_32x32x16_bf16 v[80:95], v[200:203], v[24:27], v[80:95]
  ds_read_b128 v[240:243], v1 offset:53248
  v_exp_f32 v8, v72
  v_add_f32 v5, v5, v7
  v_cvt_pk_bf16_f32 v99, v6, v7
  s_waitcnt lgkmcnt(7)
  v_mfma_f32_32x32x16_bf16 v[80:95], v[204:207], v[28:31], v[80:95]
  ds_read_b128 v[248:251], v1 offset:55296
  v_exp_f32 v9, v73
  v_add_f32 v4, v4, v8
  s_waitcnt lgkmcnt(7)
  v_mfma_f32_32x32x16_bf16 v[80:95], v[208:211], v[32:35], v[80:95]
  ds_read_b128 v[228:231], v1 offset:50176
  v_exp_f32 v10, v74
  v_add_f32 v5, v5, v9
  v_cvt_pk_bf16_f32 v100, v8, v9
  s_waitcnt lgkmcnt(7)
  v_mfma_f32_32x32x16_bf16 v[80:95], v[212:215], v[36:39], v[80:95]
  ds_read_b128 v[236:239], v1 offset:52224
  v_exp_f32 v11, v75
  v_add_f32 v4, v4, v10
  s_waitcnt lgkmcnt(7)
  v_mfma_f32_32x32x16_bf16 v[80:95], v[216:219], v[40:43], v[80:95]
  ds_read_b128 v[244:247], v1 offset:54272
  v_exp_f32 v6, v76
  v_add_f32 v5, v5, v11
  v_cvt_pk_bf16_f32 v101, v10, v11
  s_waitcnt lgkmcnt(7)
  v_mfma_f32_32x32x16_bf16 v[80:95], v[220:223], v[44:47], v[80:95]
  ds_read_b128 v[252:255], v1 offset:56320
  v_exp_f32 v7, v77
  v_add_f32 v4, v4, v6
  s_waitcnt lgkmcnt(7)
  v_mfma_f32_32x32x16_bf16 v[128:143], v[224:227], v[96:99], v[128:143]
  ds_read_b128 v[192:195], v1 offset:16384
  v_exp_f32 v8, v78
  v_add_f32 v5, v5, v7
  v_cvt_pk_bf16_f32 v102, v6, v7
  s_waitcnt lgkmcnt(7)
  v_mfma_f32_32x32x16_bf16 v[144:159], v[232:235], v[96:99], v[144:159]
  ds_read_b128 v[196:199], v1 offset:17408
  v_exp_f32 v9, v79
  v_add_f32 v4, v4, v8
  s_waitcnt lgkmcnt(7)
  v_mfma_f32_32x32x16_bf16 v[160:175], v[240:243], v[96:99], v[160:175]
  ds_read_b128 v[200:203], v1 offset:18432
  v_add_f32 v5, v5, v9
  v_cvt_pk_bf16_f32 v103, v8, v9
  v_exp_f32 v6, v80
  s_waitcnt lgkmcnt(7)
  v_mfma_f32_32x32x16_bf16 v[176:191], v[248:251], v[96:99], v[176:191]
  ds_read_b128 v[204:207], v1 offset:19456
  v_exp_f32 v7, v81
  v_add_f32 v4, v4, v6
  s_waitcnt lgkmcnt(7)
  v_mfma_f32_32x32x16_bf16 v[128:143], v[228:231], v[100:103], v[128:143]
  ds_read_b128 v[208:211], v1 offset:20480
  v_exp_f32 v8, v82
  v_add_f32 v5, v5, v7
  v_cvt_pk_bf16_f32 v104, v6, v7
  s_waitcnt lgkmcnt(7)
  v_mfma_f32_32x32x16_bf16 v[144:159], v[236:239], v[100:103], v[144:159]
  ds_read_b128 v[212:215], v1 offset:21504
  v_exp_f32 v9, v83
  v_add_f32 v4, v4, v8
  s_waitcnt lgkmcnt(7)
  v_mfma_f32_32x32x16_bf16 v[160:175], v[244:247], v[100:103], v[160:175]
  ds_read_b128 v[216:219], v1 offset:22528
  v_exp_f32 v10, v84
  v_add_f32 v5, v5, v9
  v_cvt_pk_bf16_f32 v105, v8, v9
  s_waitcnt lgkmcnt(7)
  v_mfma_f32_32x32x16_bf16 v[176:191], v[252:255], v[100:103], v[176:191]
  ds_read_b128 v[220:223], v1 offset:23552
  v_exp_f32 v11, v85
  v_add_f32 v4, v4, v10
  s_sub_u32 s79, s79, 1
  s_cbranch_scc0 .Lk2s_loop
  s_cmp_lg_u32 s63, 0
  s_cbranch_scc1 .Lk2s_m0
  v_mov_b32 v12, 0xf149f2ca
  v_cmp_gt_i32 vcc, 0, v3
  s_nop 1
  v_cndmask_b32 v48, v48, v12, vcc
  v_cmp_gt_i32 vcc, 1, v3
  s_nop 1
  v_cndmask_b32 v49, v49, v12, vcc
  v_cmp_gt_i32 vcc, 2, v3
  s_nop 1
  v_cndmask_b32 v50, v50, v12, vcc
  v_cmp_gt_i32 vcc, 3, v3
  s_nop 1
  v_cndmask_b32 v51, v51, v12, vcc
  v_cmp_gt_i32 vcc, 8, v3
  s_nop 1
  v_cndmask_b32 v52, v52, v12, vcc
  v_cmp_gt_i32 vcc, 9, v3
  s_nop 1
  v_cndmask_b32 v53, v53, v12, vcc
  v_cmp_gt_i32 vcc, 10, v3
  s_nop 1
  v_cndmask_b32 v54, v54, v12, vcc
  v_cmp_gt_i32 vcc, 11, v3
  s_nop 1
  v_cndmask_b32 v55, v55, v12, vcc
  v_cmp_gt_i32 vcc, 16, v3
  s_nop 1
  v_cndmask_b32 v56, v56, v12, vcc
  v_cmp_gt_i32 vcc, 17, v3
  s_nop 1
  v_cndmask_b32 v57, v57, v12, vcc
  v_cmp_gt_i32 vcc, 18, v3
  s_nop 1
  v_cndmask_b32 v58, v58, v12, vcc
  v_cmp_gt_i32 vcc, 19, v3
  s_nop 1
  v_cndmask_b32 v59, v59, v12, vcc
  v_cmp_gt_i32 vcc, 24, v3
  s_nop 1
  v_cndmask_b32 v60, v60, v12, vcc
  v_cmp_gt_i32 vcc, 25, v3
  s_nop 1
  v_cndmask_b32 v61, v61, v12, vcc
  v_cmp_gt_i32 vcc, 26, v3
  s_nop 1
  v_cndmask_b32 v62, v62, v12, vcc
  v_cmp_gt_i32 vcc, 27, v3
  s_nop 1
  v_cndmask_b32 v63, v63, v12, vcc
.Lk2s_m0:
  s_setprio 0
  s_waitcnt lgkmcnt(7)
  v_mfma_f32_32x32x16_bf16 v[64:79], v[192:195], v[16:19], v[48:63]
  ds_read_b128 v[224:227], v1 offset:57344
  v_exp_f32 v6, v86
  v_add_f32 v5, v5, v11
  v_cvt_pk_bf16_f32 v106, v10, v11
  s_waitcnt lgkmcnt(7)
  v_mfma_f32_32x32x16_bf16 v[64:79], v[196:199], v[20:23], v[64:79]
  ds_read_b128 v[232:235], v1 offset:59392
  v_exp_f32 v7, v87
  v_add_f32 v4, v4, v6
  s_waitcnt lgkmcnt(7)
  v_mfma_f32_32x32x16_bf16 v[64:79], v[200:203], v[24:27], v[64:79]
  ds_read_b128 v[240:243], v1 offset:61440
  v_exp_f32 v8, v88
  v_add_f32 v5, v5, v7
  v_cvt_pk_bf16_f32 v107, v6, v7
  s_waitcnt lgkmcnt(7)
  v_mfma_f32_32x32x16_bf16 v[64:79], v[204:207], v[28:31], v[64:79]
  ds_read_b128 v[248:251], v1 offset:63488
  v_exp_f32 v9, v89
  v_add_f32 v4, v4, v8
  s_waitcnt lgkmcnt(7)
  v_mfma_f32_32x32x16_bf16 v[64:79], v[208:211], v[32:35], v[64:79]
  ds_read_b128 v[228:231], v1 offset:58368
  v_exp_f32 v10, v90
  v_add_f32 v5, v5, v9
  v_cvt_pk_bf16_f32 v108, v8, v9
  s_waitcnt lgkmcnt(7)
  v_mfma_f32_32x32x16_bf16 v[64:79], v[212:215], v[36:39], v[64:79]
  ds_read_b128 v[236:239], v1 offset:60416
  v_exp_f32 v11, v91
  v_add_f32 v4, v4, v10
  s_waitcnt lgkmcnt(7)
  v_mfma_f32_32x32x16_bf16 v[64:79], v[216:219], v[40:43], v[64:79]
  ds_read_b128 v[244:247], v1 offset:62464
  v_exp_f32 v6, v92
  v_add_f32 v5, v5, v11
  v_cvt_pk_bf16_f32 v109, v10, v11
  s_waitcnt lgkmcnt(7)
  v_mfma_f32_32x32x16_bf16 v[64:79], v[220:223], v[44:47], v[64:79]
  ds_read_b128 v[252:255], v1 offset:64512
  v_exp_f32 v7, v93
  v_add_f32 v4, v4, v6
  s_waitcnt lgkmcnt(7)
  v_mfma_f32_32x32x16_bf16 v[128:143], v[224:227], v[104:107], v[128:143]
  ds_read_b128 v[192:195], v1 offset:24576
  ds_read_b128 v[196:199], v1 offset:25600
  v_exp_f32 v8, v94
  v_add_f32 v5, v5, v7
  v_cvt_pk_bf16_f32 v110, v6, v7
  s_waitcnt lgkmcnt(8)
  v_mfma_f32_32x32x16_bf16 v[144:159], v[232:235], v[104:107], v[144:159]
  ds_read_b128 v[200:203], v1 offset:26624
  ds_read_b128 v[204:207], v1 offset:27648
  v_exp_f32 v9, v95
  v_add_f32 v4, v4, v8
  s_waitcnt lgkmcnt(9)
  v_mfma_f32_32x32x16_bf16 v[160:175], v[240:243], v[104:107], v[160:175]
  ds_read_b128 v[208:211], v1 offset:28672
  ds_read_b128 v[212:215], v1 offset:29696
  v_add_f32 v5, v5, v9
  v_cvt_pk_bf16_f32 v111, v8, v9
  v_exp_f32 v6, v64
  s_waitcnt lgkmcnt(10)
  v_mfma_f32_32x32x16_bf16 v[176:191], v[248:251], v[104:107], v[176:191]
  ds_read_b128 v[216:219], v1 offset:30720
  ds_read_b128 v[220:223], v1 offset:31744
  v_exp_f32 v7, v65
  v_add_f32 v4, v4, v6
  s_waitcnt lgkmcnt(11)
  v_mfma_f32_32x32x16_bf16 v[128:143], v[228:231], v[108:111], v[128:143]
  v_exp_f32 v8, v66
  v_add_f32 v5, v5, v7
  v_cvt_pk_bf16_f32 v96, v6, v7
  s_waitcnt lgkmcnt(10)
  v_mfma_f32_32x32x16_bf16 v[144:159], v[236:239], v[108:111], v[144:159]
  v_exp_f32 v9, v67
  v_add_f32 v4, v4, v8
  s_waitcnt lgkmcnt(9)
  v_mfma_f32_32x32x16_bf16 v[160:175], v[244:247], v[108:111], v[160:175]
  v_exp_f32 v10, v68
  v_add_f32 v5, v5, v9
  v_cvt_pk_bf16_f32 v97, v8, v9
  s_waitcnt vmcnt(0) lgkmcnt(0)
  s_barrier
  v_xor_b32 v1, 0x10000, v1
  v_mfma_f32_32x32x16_bf16 v[176:191], v[252:255], v[108:111], v[176:191]
  v_exp_f32 v11, v69
  v_add_f32 v4, v4, v10
.Lk2s_te:
  s_sub_u32 s101, s101, 1
  s_cbranch_scc1 .Lkc92a
.Lkc92k:
  s_mov_b32 m0, s77
  s_min_u32 s57, s76, s69
  buffer_load_dwordx4 v2, s[16:19], s57 offen offset:0 lds
  buffer_load_dwordx4 v2, s[16:19], s57 offen offset:1024 lds
  buffer_load_dwordx4 v2, s[16:19], s57 offen offset:2048 lds
  buffer_load_dwordx4 v2, s[16:19], s57 offen offset:3072 lds
  s_add_u32 m0, s77, 4096
  s_add_u32 s57, s57, 4096
  buffer_load_dwordx4 v2, s[16:19], s57 offen offset:0 lds
  buffer_load_dwordx4 v2, s[16:19], s57 offen offset:1024 lds
  buffer_load_dwordx4 v2, s[16:19], s57 offen offset:2048 lds
  buffer_load_dwordx4 v2, s[16:19], s57 offen offset:3072 lds
  s_add_u32 m0, s77, 32768
  s_sub_u32 s57, s76, 24576
  buffer_load_dwordx4 v2, s[16:19], s57 offen offset:0 lds
  buffer_load_dwordx4 v2, s[16:19], s57 offen offset:1024 lds
  buffer_load_dwordx4 v2, s[16:19], s57 offen offset:2048 lds
  buffer_load_dwordx4 v2, s[16:19], s57 offen offset:3072 lds
  s_add_u32 m0, s77, 36864
  s_add_u32 s57, s57, 4096
  buffer_load_dwordx4 v2, s[16:19], s57 offen offset:0 lds
  buffer_load_dwordx4 v2, s[16:19], s57 offen offset:1024 lds
  buffer_load_dwordx4 v2, s[16:19], s57 offen offset:2048 lds
  buffer_load_dwordx4 v2, s[16:19], s57 offen offset:3072 lds
  s_add_u32 s76, s76, 65536
  s_xor_b32 s77, s77, 65536
  v_lshrrev_b32 v118, 3, v0
  v_lshlrev_b32 v118, 6, v118
  v_and_or_b32 v118, v0, 7, v118
  v_lshlrev_b32 v118, 2, v118
  v_mov_b32 v113, 0x01010101
  v_add_u32 v114, 48263168, v118
  v_mov_b32 v112, 0
  s_cmp_lg_u32 s90, 1
  s_cbranch_scc1 .Lk2_p1l
  buffer_load_dword v112, v114, s[16:19], 0 offen sc0 sc1
.Lk2_p1l:
  s_cmp_lg_u32 s90, 1
  s_cbranch_scc1 .Lc193
  v_lshrrev_b32 v118, 3, v0
  v_lshlrev_b32 v118, 6, v118
  v_and_or_b32 v118, v0, 7, v118
  v_lshlrev_b32 v118, 2, v118
  v_and_b32 v118, 0x3ff, v118
  v_and_b32 v119, 28, v118
  v_sub_u32 v117, s24, v119
  v_subrev_u32 v119, s25, v119
  v_add_u32 v119, 4, v119
  v_med3_i32 v117, v117, 0, 4
  v_med3_i32 v119, v119, 0, 4
  v_lshlrev_b32 v117, 2, v117
  v_lshlrev_b32 v119, 2, v119
  v_mov_b32 v120, 0x01010101
  v_lshrrev_b32 v121, v119, v120
  v_lshrrev_b32 v121, v119, v121
  v_lshlrev_b32 v120, v117, v120
  v_lshlrev_b32 v120, v117, v120
  v_and_b32 v117, v120, v121
  s_cmp_ge_u32 s44, 2
  s_cbranch_scc1 .Lc193
  buffer_load_dword v116, v118, s[16:19], s47 offen sc0 sc1
.Lc193:
  s_cmp_lt_u32 s44, 2
  s_cbranch_scc1 .Lxt94
  v_lshrrev_b32 v119, 1, v0
  v_and_b32 v120, 1, v0
  v_mul_u32_u24 v119, 1280, v119
  v_lshl_add_u32 v119, v120, 7, v119
  s_mul_i32 s55, s48, 160
  s_andn2_b32 s56, s42, 1
  s_mul_i32 s56, s56, 20480
  s_add_u32 s56, s56, s55
  buffer_load_dword v119, v119, s[8:11], s56 offen
.Lxt94:
  s_lshl_b32 s55, s63, 13
  v_add_u32 v14, s55, v1
  s_cmp_eq_u32 s63, 0
  s_cbranch_scc1 .Lk2s_f0
  s_cmp_lg_u32 s63, 1
  s_cbranch_scc1 .Lk2s_m1
  v_mov_b32 v12, 0xf149f2ca
  v_cmp_gt_i32 vcc, 0, v3
  s_nop 1
  v_cndmask_b32 v48, v48, v12, vcc
  v_cmp_gt_i32 vcc, 1, v3
  s_nop 1
  v_cndmask_b32 v49, v49, v12, vcc
  v_cmp_gt_i32 vcc, 2, v3
  s_nop 1
  v_cndmask_b32 v50, v50, v12, vcc
  v_cmp_gt_i32 vcc, 3, v3
  s_nop 1
  v_cndmask_b32 v51, v51, v12, vcc
  v_cmp_gt_i32 vcc, 8, v3
  s_nop 1
  v_cndmask_b32 v52, v52, v12, vcc
  v_cmp_gt_i32 vcc, 9, v3
  s_nop 1
  v_cndmask_b32 v53, v53, v12, vcc
  v_cmp_gt_i32 vcc, 10, v3
  s_nop 1
  v_cndmask_b32 v54, v54, v12, vcc
  v_cmp_gt_i32 vcc, 11, v3
  s_nop 1
  v_cndmask_b32 v55, v55, v12, vcc
  v_cmp_gt_i32 vcc, 16, v3
  s_nop 1
  v_cndmask_b32 v56, v56, v12, vcc
  v_cmp_gt_i32 vcc, 17, v3
  s_nop 1
  v_cndmask_b32 v57, v57, v12, vcc
  v_cmp_gt_i32 vcc, 18, v3
  s_nop 1
  v_cndmask_b32 v58, v58, v12, vcc
  v_cmp_gt_i32 vcc, 19, v3
  s_nop 1
  v_cndmask_b32 v59, v59, v12, vcc
  v_cmp_gt_i32 vcc, 24, v3
  s_nop 1
  v_cndmask_b32 v60, v60, v12, vcc
  v_cmp_gt_i32 vcc, 25, v3
  s_nop 1
  v_cndmask_b32 v61, v61, v12, vcc
  v_cmp_gt_i32 vcc, 26, v3
  s_nop 1
  v_cndmask_b32 v62, v62, v12, vcc
  v_cmp_gt_i32 vcc, 27, v3
  s_nop 1
  v_cndmask_b32 v63, v63, v12, vcc
.Lk2s_m1:
  s_setprio 3
  s_nop 0
  v_mfma_f32_32x32x16_bf16 v[80:95], v[192:195], v[16:19], v[48:63]
  ds_read_b128 v[224:227], v1 offset:32768
  v_exp_f32 v6, v70
  v_add_f32 v5, v5, v11
  v_cvt_pk_bf16_f32 v98, v10, v11
  v_mfma_f32_32x32x16_bf16 v[80:95], v[196:199], v[20:23], v[80:95]
  ds_read_b128 v[232:235], v1 offset:34816
  v_exp_f32 v7, v71
  v_add_f32 v4, v4, v6
  v_mfma_f32_32x32x16_bf16 v[80:95], v[200:203], v[24:27], v[80:95]
  ds_read_b128 v[240:243], v1 offset:36864
  v_exp_f32 v8, v72
  v_add_f32 v5, v5, v7
  v_cvt_pk_bf16_f32 v99, v6, v7
  v_mfma_f32_32x32x16_bf16 v[80:95], v[204:207], v[28:31], v[80:95]
  ds_read_b128 v[248:251], v1 offset:38912
  v_exp_f32 v9, v73
  v_add_f32 v4, v4, v8
  v_mfma_f32_32x32x16_bf16 v[80:95], v[208:211], v[32:35], v[80:95]
  ds_read_b128 v[228:231], v1 offset:33792
  v_exp_f32 v10, v74
  v_add_f32 v5, v5, v9
  v_cvt_pk_bf16_f32 v100, v8, v9
  v_mfma_f32_32x32x16_bf16 v[80:95], v[212:215], v[36:39], v[80:95]
  ds_read_b128 v[236:239], v1 offset:35840
  v_exp_f32 v11, v75
  v_add_f32 v4, v4, v10
  v_mfma_f32_32x32x16_bf16 v[80:95], v[216:219], v[40:43], v[80:95]
  ds_read_b128 v[244:247], v1 offset:37888
  v_exp_f32 v6, v76
  v_add_f32 v5, v5, v11
  v_cvt_pk_bf16_f32 v101, v10, v11
  v_mfma_f32_32x32x16_bf16 v[80:95], v[220:223], v[44:47], v[80:95]
  ds_read_b128 v[252:255], v1 offset:39936
  v_exp_f32 v7, v77
  v_add_f32 v4, v4, v6
  s_waitcnt lgkmcnt(7)
  v_mfma_f32_32x32x16_bf16 v[128:143], v[224:227], v[96:99], v[128:143]
  ds_read_b128 v[192:195], v1 offset:0
  v_exp_f32 v8, v78
  v_add_f32 v5, v5, v7
  v_cvt_pk_bf16_f32 v102, v6, v7
  s_waitcnt lgkmcnt(7)
  v_mfma_f32_32x32x16_bf16 v[144:159], v[232:235], v[96:99], v[144:159]
  ds_read_b128 v[196:199], v1 offset:1024
  v_exp_f32 v9, v79
  v_add_f32 v4, v4, v8
  s_waitcnt lgkmcnt(7)
  v_mfma_f32_32x32x16_bf16 v[160:175], v[240:243], v[96:99], v[160:175]
  ds_read_b128 v[200:203], v1 offset:2048
  v_add_f32 v5, v5, v9
  v_cvt_pk_bf16_f32 v103, v8, v9
  v_exp_f32 v6, v80
  s_waitcnt lgkmcnt(7)
  v_mfma_f32_32x32x16_bf16 v[176:191], v[248:251], v[96:99], v[176:191]
  ds_read_b128 v[204:207], v1 offset:3072
  v_exp_f32 v7, v81
  v_add_f32 v4, v4, v6
  s_waitcnt lgkmcnt(7)
  v_mfma_f32_32x32x16_bf16 v[128:143], v[228:231], v[100:103], v[128:143]
  ds_read_b128 v[208:211], v1 offset:4096
  v_exp_f32 v8, v82
  v_add_f32 v5, v5, v7
  v_cvt_pk_bf16_f32 v104, v6, v7
  s_waitcnt lgkmcnt(7)
  v_mfma_f32_32x32x16_bf16 v[144:159], v[236:239], v[100:103], v[144:159]
  ds_read_b128 v[212:215], v1 offset:5120
  v_exp_f32 v9, v83
  v_add_f32 v4, v4, v8
  s_waitcnt lgkmcnt(7)
  v_mfma_f32_32x32x16_bf16 v[160:175], v[244:247], v[100:103], v[160:175]
  ds_read_b128 v[216:219], v1 offset:6144
  v_exp_f32 v10, v84
  v_add_f32 v5, v5, v9
  v_cvt_pk_bf16_f32 v105, v8, v9
  s_waitcnt lgkmcnt(7)
  v_mfma_f32_32x32x16_bf16 v[176:191], v[252:255], v[100:103], v[176:191]
  ds_read_b128 v[220:223], v1 offset:7168
  v_exp_f32 v11, v85
  v_add_f32 v4, v4, v10
  s_cmp_eq_u32 s63, 1
  s_cbranch_scc1 .Lk2s_f1
  s_cmp_lg_u32 s63, 2
  s_cbranch_scc1 .Lk2s_m2
  v_mov_b32 v12, 0xf149f2ca
  v_cmp_gt_i32 vcc, 0, v3
  s_nop 1
  v_cndmask_b32 v48, v48, v12, vcc
  v_cmp_gt_i32 vcc, 1, v3
  s_nop 1
  v_cndmask_b32 v49, v49, v12, vcc
  v_cmp_gt_i32 vcc, 2, v3
  s_nop 1
  v_cndmask_b32 v50, v50, v12, vcc
  v_cmp_gt_i32 vcc, 3, v3
  s_nop 1
  v_cndmask_b32 v51, v51, v12, vcc
  v_cmp_gt_i32 vcc, 8, v3
  s_nop 1
  v_cndmask_b32 v52, v52, v12, vcc
  v_cmp_gt_i32 vcc, 9, v3
  s_nop 1
  v_cndmask_b32 v53, v53, v12, vcc
  v_cmp_gt_i32 vcc, 10, v3
  s_nop 1
  v_cndmask_b32 v54, v54, v12, vcc
  v_cmp_gt_i32 vcc, 11, v3
  s_nop 1
  v_cndmask_b32 v55, v55, v12, vcc
  v_cmp_gt_i32 vcc, 16, v3
  s_nop 1
  v_cndmask_b32 v56, v56, v12, vcc
  v_cmp_gt_i32 vcc, 17, v3
  s_nop 1
  v_cndmask_b32 v57, v57, v12, vcc
  v_cmp_gt_i32 vcc, 18, v3
  s_nop 1
  v_cndmask_b32 v58, v58, v12, vcc
  v_cmp_gt_i32 vcc, 19, v3
  s_nop 1
  v_cndmask_b32 v59, v59, v12, vcc
  v_cmp_gt_i32 vcc, 24, v3
  s_nop 1
  v_cndmask_b32 v60, v60, v12, vcc
  v_cmp_gt_i32 vcc, 25, v3
  s_nop 1
  v_cndmask_b32 v61, v61, v12, vcc
  v_cmp_gt_i32 vcc, 26, v3
  s_nop 1
  v_cndmask_b32 v62, v62, v12, vcc
  v_cmp_gt_i32 vcc, 27, v3
  s_nop 1
  v_cndmask_b32 v63, v63, v12, vcc
.Lk2s_m2:
  s_setprio 2
  s_waitcnt lgkmcnt(7)
  v_mfma_f32_32x32x16_bf16 v[64:79], v[192:195], v[16:19], v[48:63]
  ds_read_b128 v[224:227], v1 offset:40960
  v_exp_f32 v6, v86
  v_add_f32 v5, v5, v11
  v_cvt_pk_bf16_f32 v106, v10, v11
  s_waitcnt lgkmcnt(7)
  v_mfma_f32_32x32x16_bf16 v[64:79], v[196:199], v[20:23], v[64:79]
  ds_read_b128 v[232:235], v1 offset:43008
  v_exp_f32 v7, v87
  v_add_f32 v4, v4, v6
  s_waitcnt lgkmcnt(7)
  v_mfma_f32_32x32x16_bf16 v[64:79], v[200:203], v[24:27], v[64:79]
  ds_read_b128 v[240:243], v1 offset:45056
  v_exp_f32 v8, v88
  v_add_f32 v5, v5, v7
  v_cvt_pk_bf16_f32 v107, v6, v7
  s_waitcnt lgkmcnt(7)
  v_mfma_f32_32x32x16_bf16 v[64:79], v[204:207], v[28:31], v[64:79]
  ds_read_b128 v[248:251], v1 offset:47104
  v_exp_f32 v9, v89
  v_add_f32 v4, v4, v8
  s_waitcnt lgkmcnt(7)
  v_mfma_f32_32x32x16_bf16 v[64:79], v[208:211], v[32:35], v[64:79]
  ds_read_b128 v[228:231], v1 offset:41984
  v_exp_f32 v10, v90
  v_add_f32 v5, v5, v9
  v_cvt_pk_bf16_f32 v108, v8, v9
  s_waitcnt lgkmcnt(7)
  v_mfma_f32_32x32x16_bf16 v[64:79], v[212:215], v[36:39], v[64:79]
  ds_read_b128 v[236:239], v1 offset:44032
  v_exp_f32 v11, v91
  v_add_f32 v4, v4, v10
  s_waitcnt lgkmcnt(7)
  v_mfma_f32_32x32x16_bf16 v[64:79], v[216:219], v[40:43], v[64:79]
  ds_read_b128 v[244:247], v1 offset:46080
  v_exp_f32 v6, v92
  v_add_f32 v5, v5, v11
  v_cvt_pk_bf16_f32 v109, v10, v11
  s_waitcnt lgkmcnt(7)
  v_mfma_f32_32x32x16_bf16 v[64:79], v[220:223], v[44:47], v[64:79]
  ds_read_b128 v[252:255], v1 offset:48128
  v_exp_f32 v7, v93
  v_add_f32 v4, v4, v6
  s_waitcnt lgkmcnt(7)
  v_mfma_f32_32x32x16_bf16 v[128:143], v[224:227], v[104:107], v[128:143]
  ds_read_b128 v[192:195], v1 offset:8192
  v_exp_f32 v8, v94
  v_add_f32 v5, v5, v7
  v_cvt_pk_bf16_f32 v110, v6, v7
  s_waitcnt lgkmcnt(7)
  v_mfma_f32_32x32x16_bf16 v[144:159], v[232:235], v[104:107], v[144:159]
  ds_read_b128 v[196:199], v1 offset:9216
  v_exp_f32 v9, v95
  v_add_f32 v4, v4, v8
  s_waitcnt lgkmcnt(7)
  v_mfma_f32_32x32x16_bf16 v[160:175], v[240:243], v[104:107], v[160:175]
  ds_read_b128 v[200:203], v1 offset:10240
  v_add_f32 v5, v5, v9
  v_cvt_pk_bf16_f32 v111, v8, v9
  v_exp_f32 v6, v64
  s_waitcnt lgkmcnt(7)
  v_mfma_f32_32x32x16_bf16 v[176:191], v[248:251], v[104:107], v[176:191]
  ds_read_b128 v[204:207], v1 offset:11264
  v_exp_f32 v7, v65
  v_add_f32 v4, v4, v6
  s_waitcnt lgkmcnt(7)
  v_mfma_f32_32x32x16_bf16 v[128:143], v[228:231], v[108:111], v[128:143]
  ds_read_b128 v[208:211], v1 offset:12288
  v_exp_f32 v8, v66
  v_add_f32 v5, v5, v7
  v_cvt_pk_bf16_f32 v96, v6, v7
  s_waitcnt lgkmcnt(7)
  v_mfma_f32_32x32x16_bf16 v[144:159], v[236:239], v[108:111], v[144:159]
  ds_read_b128 v[212:215], v1 offset:13312
  v_exp_f32 v9, v67
  v_add_f32 v4, v4, v8
  s_waitcnt lgkmcnt(7)
  v_mfma_f32_32x32x16_bf16 v[160:175], v[244:247], v[108:111], v[160:175]
  ds_read_b128 v[216:219], v1 offset:14336
  v_exp_f32 v10, v68
  v_add_f32 v5, v5, v9
  v_cvt_pk_bf16_f32 v97, v8, v9
  s_waitcnt lgkmcnt(7)
  v_mfma_f32_32x32x16_bf16 v[176:191], v[252:255], v[108:111], v[176:191]
  ds_read_b128 v[220:223], v1 offset:15360
  v_exp_f32 v11, v69
  v_add_f32 v4, v4, v10
  s_cmp_eq_u32 s63, 2
  s_cbranch_scc1 .Lk2s_f0
  s_cmp_lg_u32 s63, 3
  s_cbranch_scc1 .Lk2s_m3
  v_mov_b32 v12, 0xf149f2ca
  v_cmp_gt_i32 vcc, 0, v3
  s_nop 1
  v_cndmask_b32 v48, v48, v12, vcc
  v_cmp_gt_i32 vcc, 1, v3
  s_nop 1
  v_cndmask_b32 v49, v49, v12, vcc
  v_cmp_gt_i32 vcc, 2, v3
  s_nop 1
  v_cndmask_b32 v50, v50, v12, vcc
  v_cmp_gt_i32 vcc, 3, v3
  s_nop 1
  v_cndmask_b32 v51, v51, v12, vcc
  v_cmp_gt_i32 vcc, 8, v3
  s_nop 1
  v_cndmask_b32 v52, v52, v12, vcc
  v_cmp_gt_i32 vcc, 9, v3
  s_nop 1
  v_cndmask_b32 v53, v53, v12, vcc
  v_cmp_gt_i32 vcc, 10, v3
  s_nop 1
  v_cndmask_b32 v54, v54, v12, vcc
  v_cmp_gt_i32 vcc, 11, v3
  s_nop 1
  v_cndmask_b32 v55, v55, v12, vcc
  v_cmp_gt_i32 vcc, 16, v3
  s_nop 1
  v_cndmask_b32 v56, v56, v12, vcc
  v_cmp_gt_i32 vcc, 17, v3
  s_nop 1
  v_cndmask_b32 v57, v57, v12, vcc
  v_cmp_gt_i32 vcc, 18, v3
  s_nop 1
  v_cndmask_b32 v58, v58, v12, vcc
  v_cmp_gt_i32 vcc, 19, v3
  s_nop 1
  v_cndmask_b32 v59, v59, v12, vcc
  v_cmp_gt_i32 vcc, 24, v3
  s_nop 1
  v_cndmask_b32 v60, v60, v12, vcc
  v_cmp_gt_i32 vcc, 25, v3
  s_nop 1
  v_cndmask_b32 v61, v61, v12, vcc
  v_cmp_gt_i32 vcc, 26, v3
  s_nop 1
  v_cndmask_b32 v62, v62, v12, vcc
  v_cmp_gt_i32 vcc, 27, v3
  s_nop 1
  v_cndmask_b32 v63, v63, v12, vcc
.Lk2s_m3:
  s_setprio 1
  s_waitcnt lgkmcnt(7)
  v_mfma_f32_32x32x16_bf16 v[80:95], v[192:195], v[16:19], v[48:63]
  ds_read_b128 v[224:227], v1 offset:49152
  v_exp_f32 v6, v70
  v_add_f32 v5, v5, v11
  v_cvt_pk_bf16_f32 v98, v10, v11
  s_waitcnt lgkmcnt(7)
  v_mfma_f32_32x32x16_bf16 v[80:95], v[196:199], v[20:23], v[80:95]
  ds_read_b128 v[232:235], v1 offset:51200
  v_exp_f32 v7, v71
  v_add_f32 v4, v4, v6
  s_waitcnt lgkmcnt(7)
  v_mfma_f32_32x32x16_bf16 v[80:95], v[200:203], v[24:27], v[80:95]
  ds_read_b128 v[240:243], v1 offset:53248
  v_exp_f32 v8, v72
  v_add_f32 v5, v5, v7
  v_cvt_pk_bf16_f32 v99, v6, v7
  s_waitcnt lgkmcnt(7)
  v_mfma_f32_32x32x16_bf16 v[80:95], v[204:207], v[28:31], v[80:95]
  ds_read_b128 v[248:251], v1 offset:55296
  v_exp_f32 v9, v73
  v_add_f32 v4, v4, v8
  s_waitcnt lgkmcnt(7)
  v_mfma_f32_32x32x16_bf16 v[80:95], v[208:211], v[32:35], v[80:95]
  ds_read_b128 v[228:231], v1 offset:50176
  v_exp_f32 v10, v74
  v_add_f32 v5, v5, v9
  v_cvt_pk_bf16_f32 v100, v8, v9
  s_waitcnt lgkmcnt(7)
  v_mfma_f32_32x32x16_bf16 v[80:95], v[212:215], v[36:39], v[80:95]
  ds_read_b128 v[236:239], v1 offset:52224
  v_exp_f32 v11, v75
  v_add_f32 v4, v4, v10
  s_waitcnt lgkmcnt(7)
  v_mfma_f32_32x32x16_bf16 v[80:95], v[216:219], v[40:43], v[80:95]
  ds_read_b128 v[244:247], v1 offset:54272
  v_exp_f32 v6, v76
  v_add_f32 v5, v5, v11
  v_cvt_pk_bf16_f32 v101, v10, v11
  s_waitcnt lgkmcnt(7)
  v_mfma_f32_32x32x16_bf16 v[80:95], v[220:223], v[44:47], v[80:95]
  ds_read_b128 v[252:255], v1 offset:56320
  v_exp_f32 v7, v77
  v_add_f32 v4, v4, v6
  s_waitcnt lgkmcnt(7)
  v_mfma_f32_32x32x16_bf16 v[128:143], v[224:227], v[96:99], v[128:143]
  v_exp_f32 v8, v78
  v_add_f32 v5, v5, v7
  v_cvt_pk_bf16_f32 v102, v6, v7
  s_waitcnt lgkmcnt(6)
  v_mfma_f32_32x32x16_bf16 v[144:159], v[232:235], v[96:99], v[144:159]
  v_exp_f32 v9, v79
  v_add_f32 v4, v4, v8
  s_waitcnt lgkmcnt(5)
  v_mfma_f32_32x32x16_bf16 v[160:175], v[240:243], v[96:99], v[160:175]
  v_add_f32 v5, v5, v9
  v_cvt_pk_bf16_f32 v103, v8, v9
  v_exp_f32 v6, v80
  s_waitcnt lgkmcnt(4)
  v_mfma_f32_32x32x16_bf16 v[176:191], v[248:251], v[96:99], v[176:191]
  v_exp_f32 v7, v81
  v_add_f32 v4, v4, v6
  s_waitcnt lgkmcnt(3)
  v_mfma_f32_32x32x16_bf16 v[128:143], v[228:231], v[100:103], v[128:143]
  v_exp_f32 v8, v82
  v_add_f32 v5, v5, v7
  v_cvt_pk_bf16_f32 v104, v6, v7
  s_waitcnt lgkmcnt(2)
  v_mfma_f32_32x32x16_bf16 v[144:159], v[236:239], v[100:103], v[144:159]
  v_exp_f32 v9, v83
  v_add_f32 v4, v4, v8
  s_waitcnt lgkmcnt(1)
  v_mfma_f32_32x32x16_bf16 v[160:175], v[244:247], v[100:103], v[160:175]
  v_exp_f32 v10, v84
  v_add_f32 v5, v5, v9
  v_cvt_pk_bf16_f32 v105, v8, v9
  s_waitcnt lgkmcnt(0)
  v_mfma_f32_32x32x16_bf16 v[176:191], v[252:255], v[100:103], v[176:191]
  v_exp_f32 v11, v85
  v_add_f32 v4, v4, v10
.Lk2s_f1:
  ds_read_b128 v[224:227], v14 offset:32768
  ds_read_b128 v[232:235], v14 offset:34816
  ds_read_b128 v[240:243], v14 offset:36864
  ds_read_b128 v[248:251], v14 offset:38912
  ds_read_b128 v[228:231], v14 offset:33792
  ds_read_b128 v[236:239], v14 offset:35840
  ds_read_b128 v[244:247], v14 offset:37888
  ds_read_b128 v[252:255], v14 offset:39936
  v_exp_f32 v6, v86
  v_add_f32 v5, v5, v11
  v_cvt_pk_bf16_f32 v106, v10, v11
  v_exp_f32 v7, v87
  v_add_f32 v4, v4, v6
  v_exp_f32 v8, v88
  v_add_f32 v5, v5, v7
  v_cvt_pk_bf16_f32 v107, v6, v7
  v_exp_f32 v9, v89
  v_add_f32 v4, v4, v8
  v_exp_f32 v10, v90
  v_add_f32 v5, v5, v9
  v_cvt_pk_bf16_f32 v108, v8, v9
  v_exp_f32 v11, v91
  v_add_f32 v4, v4, v10
  v_exp_f32 v6, v92
  v_add_f32 v5, v5, v11
  v_cvt_pk_bf16_f32 v109, v10, v11
  v_exp_f32 v7, v93
  v_add_f32 v4, v4, v6
  v_exp_f32 v8, v94
  v_add_f32 v5, v5, v7
  v_cvt_pk_bf16_f32 v110, v6, v7
  v_exp_f32 v9, v95
  v_add_f32 v4, v4, v8
  v_add_f32 v5, v5, v9
  v_cvt_pk_bf16_f32 v111, v8, v9
  s_waitcnt lgkmcnt(7)
  v_mfma_f32_32x32x16_bf16 v[128:143], v[224:227], v[104:107], v[128:143]
  s_waitcnt lgkmcnt(6)
  v_mfma_f32_32x32x16_bf16 v[144:159], v[232:235], v[104:107], v[144:159]
  s_waitcnt lgkmcnt(5)
  v_mfma_f32_32x32x16_bf16 v[160:175], v[240:243], v[104:107], v[160:175]
  s_waitcnt lgkmcnt(4)
  v_mfma_f32_32x32x16_bf16 v[176:191], v[248:251], v[104:107], v[176:191]
  s_waitcnt lgkmcnt(3)
  v_mfma_f32_32x32x16_bf16 v[128:143], v[228:231], v[108:111], v[128:143]
  s_waitcnt lgkmcnt(2)
  v_mfma_f32_32x32x16_bf16 v[144:159], v[236:239], v[108:111], v[144:159]
  s_waitcnt lgkmcnt(1)
  v_mfma_f32_32x32x16_bf16 v[160:175], v[244:247], v[108:111], v[160:175]
  s_waitcnt lgkmcnt(0)
  v_mfma_f32_32x32x16_bf16 v[176:191], v[252:255], v[108:111], v[176:191]
  s_branch .Lk2s_done
.Lk2s_f0:
  ds_read_b128 v[224:227], v14 offset:32768
  ds_read_b128 v[232:235], v14 offset:34816
  ds_read_b128 v[240:243], v14 offset:36864
  ds_read_b128 v[248:251], v14 offset:38912
  ds_read_b128 v[228:231], v14 offset:33792
  ds_read_b128 v[236:239], v14 offset:35840
  ds_read_b128 v[244:247], v14 offset:37888
  ds_read_b128 v[252:255], v14 offset:39936
  v_exp_f32 v6, v70
  v_add_f32 v5, v5, v11
  v_cvt_pk_bf16_f32 v98, v10, v11
  v_exp_f32 v7, v71
  v_add_f32 v4, v4, v6
  v_exp_f32 v8, v72
  v_add_f32 v5, v5, v7
  v_cvt_pk_bf16_f32 v99, v6, v7
  v_exp_f32 v9, v73
  v_add_f32 v4, v4, v8
  v_exp_f32 v10, v74
  v_add_f32 v5, v5, v9
  v_cvt_pk_bf16_f32 v100, v8, v9
  v_exp_f32 v11, v75
  v_add_f32 v4, v4, v10
  v_exp_f32 v6, v76
  v_add_f32 v5, v5, v11
  v_cvt_pk_bf16_f32 v101, v10, v11
  v_exp_f32 v7, v77
  v_add_f32 v4, v4, v6
  v_exp_f32 v8, v78
  v_add_f32 v5, v5, v7
  v_cvt_pk_bf16_f32 v102, v6, v7
  v_exp_f32 v9, v79
  v_add_f32 v4, v4, v8
  v_add_f32 v5, v5, v9
  v_cvt_pk_bf16_f32 v103, v8, v9
  s_waitcnt lgkmcnt(7)
  v_mfma_f32_32x32x16_bf16 v[128:143], v[224:227], v[96:99], v[128:143]
  s_waitcnt lgkmcnt(6)
  v_mfma_f32_32x32x16_bf16 v[144:159], v[232:235], v[96:99], v[144:159]
  s_waitcnt lgkmcnt(5)
  v_mfma_f32_32x32x16_bf16 v[160:175], v[240:243], v[96:99], v[160:175]
  s_waitcnt lgkmcnt(4)
  v_mfma_f32_32x32x16_bf16 v[176:191], v[248:251], v[96:99], v[176:191]
  s_waitcnt lgkmcnt(3)
  v_mfma_f32_32x32x16_bf16 v[128:143], v[228:231], v[100:103], v[128:143]
  s_waitcnt lgkmcnt(2)
  v_mfma_f32_32x32x16_bf16 v[144:159], v[236:239], v[100:103], v[144:159]
  s_waitcnt lgkmcnt(1)
  v_mfma_f32_32x32x16_bf16 v[160:175], v[244:247], v[100:103], v[160:175]
  s_waitcnt lgkmcnt(0)
  v_mfma_f32_32x32x16_bf16 v[176:191], v[252:255], v[100:103], v[176:191]
.Lk2s_done:
  s_setprio 0
  v_add_f32 v4, v4, v5
  v_mov_b32 v12, v4
  s_nop 1
  v_permlane32_swap_b32 v12, v4
  v_mov_b32 v13, 0x4e800000
  v_add_f32 v4, v4, v12
  v_cmp_nlt_f32 vcc, v4, v13
  s_nop 0
  s_cbranch_vccnz .Lk2_safe
  v_rcp_f32 v4, v4
  s_lshl_b32 s55, s78, 5
  s_add_u32 s55, s55, s53
  s_lshl_b32 s55, s55, 13
  s_add_u32 s55, s55, 50331648
  s_add_u32 s56, s55, 4096
  v_mov_b32 v5, v4
  v_pk_mul_f32 v[128:129], v[128:129], v[4:5]
  v_pk_mul_f32 v[130:131], v[130:131], v[4:5]
  v_pk_mul_f32 v[132:133], v[132:133], v[4:5]
  v_pk_mul_f32 v[134:135], v[134:135], v[4:5]
  v_pk_mul_f32 v[136:137], v[136:137], v[4:5]
  v_pk_mul_f32 v[138:139], v[138:139], v[4:5]
  v_pk_mul_f32 v[140:141], v[140:141], v[4:5]
  v_pk_mul_f32 v[142:143], v[142:143], v[4:5]
  v_cvt_pk_bf16_f32 v128, v128, v129
  v_cvt_pk_bf16_f32 v129, v130, v131
  v_cvt_pk_bf16_f32 v130, v132, v133
  v_cvt_pk_bf16_f32 v131, v134, v135
  v_cvt_pk_bf16_f32 v132, v136, v137
  v_cvt_pk_bf16_f32 v133, v138, v139
  v_cvt_pk_bf16_f32 v134, v140, v141
  v_cvt_pk_bf16_f32 v135, v142, v143
  buffer_store_dwordx4 v[128:131], v2, s[16:19], s55 offen offset:0 sc1
  buffer_store_dwordx4 v[132:135], v2, s[16:19], s55 offen offset:1024 sc1
  v_pk_mul_f32 v[144:145], v[144:145], v[4:5]
  v_pk_mul_f32 v[146:147], v[146:147], v[4:5]
  v_pk_mul_f32 v[148:149], v[148:149], v[4:5]
  v_pk_mul_f32 v[150:151], v[150:151], v[4:5]
  v_pk_mul_f32 v[152:153], v[152:153], v[4:5]
  v_pk_mul_f32 v[154:155], v[154:155], v[4:5]
  v_pk_mul_f32 v[156:157], v[156:157], v[4:5]
  v_pk_mul_f32 v[158:159], v[158:159], v[4:5]
  v_cvt_pk_bf16_f32 v144, v144, v145
  v_cvt_pk_bf16_f32 v145, v146, v147
  v_cvt_pk_bf16_f32 v146, v148, v149
  v_cvt_pk_bf16_f32 v147, v150, v151
  v_cvt_pk_bf16_f32 v148, v152, v153
  v_cvt_pk_bf16_f32 v149, v154, v155
  v_cvt_pk_bf16_f32 v150, v156, v157
  v_cvt_pk_bf16_f32 v151, v158, v159
  buffer_store_dwordx4 v[144:147], v2, s[16:19], s55 offen offset:2048 sc1
  buffer_store_dwordx4 v[148:151], v2, s[16:19], s55 offen offset:3072 sc1
  v_pk_mul_f32 v[160:161], v[160:161], v[4:5]
  v_pk_mul_f32 v[162:163], v[162:163], v[4:5]
  v_pk_mul_f32 v[164:165], v[164:165], v[4:5]
  v_pk_mul_f32 v[166:167], v[166:167], v[4:5]
  v_pk_mul_f32 v[168:169], v[168:169], v[4:5]
  v_pk_mul_f32 v[170:171], v[170:171], v[4:5]
  v_pk_mul_f32 v[172:173], v[172:173], v[4:5]
  v_pk_mul_f32 v[174:175], v[174:175], v[4:5]
  v_cvt_pk_bf16_f32 v160, v160, v161
  v_cvt_pk_bf16_f32 v161, v162, v163
  v_cvt_pk_bf16_f32 v162, v164, v165
  v_cvt_pk_bf16_f32 v163, v166, v167
  v_cvt_pk_bf16_f32 v164, v168, v169
  v_cvt_pk_bf16_f32 v165, v170, v171
  v_cvt_pk_bf16_f32 v166, v172, v173
  v_cvt_pk_bf16_f32 v167, v174, v175
  buffer_store_dwordx4 v[160:163], v2, s[16:19], s56 offen offset:0 sc1
  buffer_store_dwordx4 v[164:167], v2, s[16:19], s56 offen offset:1024 sc1
  v_pk_mul_f32 v[176:177], v[176:177], v[4:5]
  v_pk_mul_f32 v[178:179], v[178:179], v[4:5]
  v_pk_mul_f32 v[180:181], v[180:181], v[4:5]
  v_pk_mul_f32 v[182:183], v[182:183], v[4:5]
  v_pk_mul_f32 v[184:185], v[184:185], v[4:5]
  v_pk_mul_f32 v[186:187], v[186:187], v[4:5]
  v_pk_mul_f32 v[188:189], v[188:189], v[4:5]
  v_pk_mul_f32 v[190:191], v[190:191], v[4:5]
  v_cvt_pk_bf16_f32 v176, v176, v177
  v_cvt_pk_bf16_f32 v177, v178, v179
  v_cvt_pk_bf16_f32 v178, v180, v181
  v_cvt_pk_bf16_f32 v179, v182, v183
  v_cvt_pk_bf16_f32 v180, v184, v185
  v_cvt_pk_bf16_f32 v181, v186, v187
  v_cvt_pk_bf16_f32 v182, v188, v189
  v_cvt_pk_bf16_f32 v183, v190, v191
  buffer_store_dwordx4 v[176:179], v2, s[16:19], s56 offen offset:2048 sc1
  buffer_store_dwordx4 v[180:183], v2, s[16:19], s56 offen offset:3072 sc1
.Lk2s_sd:
  s_cmp_lt_u32 s44, 2
  s_cbranch_scc1 .Lxd95
  v_lshrrev_b32 v6, 4, v0
  v_and_b32 v7, 15, v0
  v_mul_u32_u24 v7, 1280, v7
  v_lshlrev_b32 v6, 3, v6
  v_add_u32 v7, v7, v6
  s_mul_i32 s55, s48, 160
  s_xor_b32 s56, s42, 0
  s_mul_i32 s56, s56, 20480
  s_add_u32 s56, s56, s55
  buffer_load_dwordx2 v[224:225], v7, s[8:11], s56 offen offset:0
  buffer_load_dwordx2 v[226:227], v7, s[8:11], s56 offen offset:32
  buffer_load_dwordx2 v[228:229], v7, s[8:11], s56 offen offset:64
  buffer_load_dwordx2 v[230:231], v7, s[8:11], s56 offen offset:96
  buffer_load_dwordx2 v[232:233], v7, s[8:11], s56 offen offset:128
  s_xor_b32 s56, s42, 1
  s_mul_i32 s56, s56, 20480
  s_add_u32 s56, s56, s55
  buffer_load_dwordx2 v[234:235], v7, s[8:11], s56 offen offset:0
  buffer_load_dwordx2 v[236:237], v7, s[8:11], s56 offen offset:32
  buffer_load_dwordx2 v[238:239], v7, s[8:11], s56 offen offset:64
  buffer_load_dwordx2 v[240:241], v7, s[8:11], s56 offen offset:96
  buffer_load_dwordx2 v[242:243], v7, s[8:11], s56 offen offset:128
  buffer_load_dwordx2 v[244:245], v6, s[12:15], s55 offen offset:0
  buffer_load_dwordx2 v[246:247], v6, s[12:15], s55 offen offset:32
  buffer_load_dwordx2 v[248:249], v6, s[12:15], s55 offen offset:64
  buffer_load_dwordx2 v[250:251], v6, s[12:15], s55 offen offset:96
  buffer_load_dwordx2 v[252:253], v6, s[12:15], s55 offen offset:128
  s_waitcnt vmcnt(23)
  s_branch .Lxd95b
.Lxd95:
  s_waitcnt vmcnt(8)
.Lxd95b:
  s_cmp_eq_u32 s75, s90
  s_cbranch_scc1 .Lsv96p
.Lsv96q:
  s_cmp_lg_u32 s90, 1
  s_cbranch_scc1 .Lsv96r
  v_and_b32 v12, v116, v117
  v_cmp_ne_u32 vcc, v12, v117
  s_nop 0
  s_cmp_lg_u64 vcc, 0
  s_cselect_b32 s68, 1, 0
  s_xor_b32 s55, s68, 1
  v_mov_b32 v119, s55
  v_mov_b32 v115, 163776
  ds_write_b32 v115, v119
  s_waitcnt lgkmcnt(0)
.Lsv96r:
  s_nop 0
  s_barrier
  s_sub_u32 s75, s75, 1
  s_cmp_eq_u32 s75, 0
  s_cbranch_scc1 .Lsv96
  s_sub_u32 s101, s101, 1
  s_cbranch_scc1 .Lkc98a
.Lkc98k:
  s_mov_b32 m0, s77
  s_min_u32 s57, s76, s69
  buffer_load_dwordx4 v2, s[16:19], s57 offen offset:0 lds
  buffer_load_dwordx4 v2, s[16:19], s57 offen offset:1024 lds
  buffer_load_dwordx4 v2, s[16:19], s57 offen offset:2048 lds
  buffer_load_dwordx4 v2, s[16:19], s57 offen offset:3072 lds
  s_add_u32 m0, s77, 4096
  s_add_u32 s57, s57, 4096
  buffer_load_dwordx4 v2, s[16:19], s57 offen offset:0 lds
  buffer_load_dwordx4 v2, s[16:19], s57 offen offset:1024 lds
  buffer_load_dwordx4 v2, s[16:19], s57 offen offset:2048 lds
  buffer_load_dwordx4 v2, s[16:19], s57 offen offset:3072 lds
  s_add_u32 m0, s77, 32768
  s_sub_u32 s57, s76, 24576
  buffer_load_dwordx4 v2, s[16:19], s57 offen offset:0 lds
  buffer_load_dwordx4 v2, s[16:19], s57 offen offset:1024 lds
  buffer_load_dwordx4 v2, s[16:19], s57 offen offset:2048 lds
  buffer_load_dwordx4 v2, s[16:19], s57 offen offset:3072 lds
  s_add_u32 m0, s77, 36864
  s_add_u32 s57, s57, 4096
  buffer_load_dwordx4 v2, s[16:19], s57 offen offset:0 lds
  buffer_load_dwordx4 v2, s[16:19], s57 offen offset:1024 lds
  buffer_load_dwordx4 v2, s[16:19], s57 offen offset:2048 lds
  buffer_load_dwordx4 v2, s[16:19], s57 offen offset:3072 lds
  s_add_u32 s76, s76, 65536
  s_xor_b32 s77, s77, 65536
  s_waitcnt vmcnt(16)
  s_cmp_eq_u32 s89, 0
  s_cbranch_scc1 .Lcf99
  v_mov_b32 v12, 1
  s_mov_b64 exec, 1
  buffer_store_byte v12, off, s[16:19], s89 sc0 sc1
  s_mov_b64 exec, -1
  s_mov_b32 s89, 0
.Lcf99:
  s_cmp_ge_u32 s2, 160
  s_cbranch_scc1 .Lht101
  v_and_b32 v6, 32, v0
  v_lshlrev_b32 v6, 4, v6
  v_bfe_u32 v8, v0, 2, 2
  v_lshl_add_u32 v6, v8, 6, v6
  v_lshrrev_b32 v8, 1, v0
  v_xor_b32 v8, v8, v0
  v_bfe_u32 v8, v8, 3, 1
  v_lshl_add_u32 v6, v8, 5, v6
  v_and_b32 v8, 3, v0
  v_lshl_add_u32 v6, v8, 3, v6
  s_lshl_b32 s55, s73, 13
  s_add_u32 s55, s55, 131072
  v_add_u32 v6, s55, v6
  v_xor_b32 v7, 16, v6
  v_lshlrev_b32 v8, 4, v0
  ds_read_b64_tr_b16 v[192:193], v6 offset:0
  ds_read_b64_tr_b16 v[194:195], v7 offset:256
  ds_read_b64_tr_b16 v[196:197], v6 offset:1024
  ds_read_b64_tr_b16 v[198:199], v7 offset:1280
  ds_read_b64_tr_b16 v[200:201], v6 offset:4096
  ds_read_b64_tr_b16 v[202:203], v7 offset:4352
  ds_read_b64_tr_b16 v[204:205], v6 offset:5120
  ds_read_b64_tr_b16 v[206:207], v7 offset:5376
  ds_read_b64_tr_b16 v[208:209], v6 offset:2048
  ds_read_b64_tr_b16 v[210:211], v7 offset:2304
  ds_read_b64_tr_b16 v[212:213], v6 offset:3072
  ds_read_b64_tr_b16 v[214:215], v7 offset:3328
  ds_read_b64_tr_b16 v[216:217], v6 offset:6144
  ds_read_b64_tr_b16 v[218:219], v7 offset:6400
  ds_read_b64_tr_b16 v[220:221], v6 offset:7168
  ds_read_b64_tr_b16 v[222:223], v7 offset:7424
  s_lshl_b32 s55, s60, 2
  s_add_u32 s55, s55, s73
  s_mul_i32 s55, s55, 81920
  s_lshl_b32 s56, s61, 12
  s_add_u32 s55, s55, s56
  s_add_u32 s55, s55, 1048576
  s_add_u32 s56, s55, 40960
  s_waitcnt lgkmcnt(8)
  buffer_store_dwordx4 v[192:195], v8, s[36:39], s55 offen offset:0 sc1
  buffer_store_dwordx4 v[196:199], v8, s[36:39], s55 offen offset:1024 sc1
  buffer_store_dwordx4 v[200:203], v8, s[36:39], s55 offen offset:2048 sc1
  buffer_store_dwordx4 v[204:207], v8, s[36:39], s55 offen offset:3072 sc1
  s_waitcnt lgkmcnt(0)
  buffer_store_dwordx4 v[208:211], v8, s[36:39], s56 offen offset:0 sc1
  buffer_store_dwordx4 v[212:215], v8, s[36:39], s56 offen offset:1024 sc1
  buffer_store_dwordx4 v[216:219], v8, s[36:39], s56 offen offset:2048 sc1
  buffer_store_dwordx4 v[220:223], v8, s[36:39], s56 offen offset:3072 sc1
.Lht101:
.Lsv96:
.Lk2_svloop:
  s_cmp_eq_u32 s75, 1
  s_cbranch_scc1 .Lk2_e
  s_cmp_eq_u32 s75, 2
  s_cbranch_scc1 .Lk2_d
  s_cmp_eq_u32 s75, 0
  s_cbranch_scc1 .Lk2_z
  s_cmp_gt_u32 s75, 3
  s_cbranch_scc1 .Lk2_sv2
.Lk2_sv0:
  s_cmp_lg_u32 s52, 7
  s_cbranch_scc1 .Lc1102
  v_lshrrev_b32 v118, 3, v0
  v_lshlrev_b32 v118, 6, v118
  v_and_or_b32 v118, v0, 7, v118
  v_lshlrev_b32 v118, 2, v118
  v_and_b32 v118, 0x3ff, v118
  v_and_b32 v119, 28, v118
  v_sub_u32 v117, s24, v119
  v_subrev_u32 v119, s25, v119
  v_add_u32 v119, 4, v119
  v_med3_i32 v117, v117, 0, 4
  v_med3_i32 v119, v119, 0, 4
  v_lshlrev_b32 v117, 2, v117
  v_lshlrev_b32 v119, 2, v119
  v_mov_b32 v120, 0x01010101
  v_lshrrev_b32 v121, v119, v120
  v_lshrrev_b32 v121, v119, v121
  v_lshlrev_b32 v120, v117, v120
  v_lshlrev_b32 v120, v117, v120
  v_and_b32 v117, v120, v121
  s_cmp_ge_u32 s44, 2
  s_cbranch_scc1 .Lc1102
  buffer_load_dword v116, v118, s[16:19], s47 offen sc0 sc1
.Lc1102:
  s_cmp_lt_u32 s44, 2
  s_cbranch_scc1 .Lxc103
  v_lshlrev_b32 v6, 16, v244
  v_and_b32 v7, 0xffff0000, v244
  v_lshlrev_b32 v64, 16, v224
  v_and_b32 v65, 0xffff0000, v224
  v_mul_f32 v64, v64, v6
  v_mul_f32 v65, v65, v7
  v_cvt_pk_bf16_f32 v65, v64, v65
  v_lshlrev_b32 v64, 16, v65
  v_and_b32 v65, 0xffff0000, v65
  v_lshlrev_b32 v84, 16, v234
  v_and_b32 v85, 0xffff0000, v234
  v_mul_f32 v84, v84, v6
  v_mul_f32 v85, v85, v7
  v_cvt_pk_bf16_f32 v85, v84, v85
  v_lshlrev_b32 v84, 16, v85
  v_and_b32 v85, 0xffff0000, v85
  v_lshlrev_b32 v6, 16, v245
  v_and_b32 v7, 0xffff0000, v245
  v_lshlrev_b32 v66, 16, v225
  v_and_b32 v67, 0xffff0000, v225
  v_mul_f32 v66, v66, v6
  v_mul_f32 v67, v67, v7
  v_cvt_pk_bf16_f32 v67, v66, v67
  v_lshlrev_b32 v66, 16, v67
  v_and_b32 v67, 0xffff0000, v67
  v_lshlrev_b32 v86, 16, v235
  v_and_b32 v87, 0xffff0000, v235
  v_mul_f32 v86, v86, v6
  v_mul_f32 v87, v87, v7
  v_cvt_pk_bf16_f32 v87, v86, v87
  v_lshlrev_b32 v86, 16, v87
  v_and_b32 v87, 0xffff0000, v87
  v_lshlrev_b32 v6, 16, v246
  v_and_b32 v7, 0xffff0000, v246
  v_lshlrev_b32 v68, 16, v226
  v_and_b32 v69, 0xffff0000, v226
  v_mul_f32 v68, v68, v6
  v_mul_f32 v69, v69, v7
  v_cvt_pk_bf16_f32 v69, v68, v69
  v_lshlrev_b32 v68, 16, v69
  v_and_b32 v69, 0xffff0000, v69
  v_lshlrev_b32 v88, 16, v236
  v_and_b32 v89, 0xffff0000, v236
  v_mul_f32 v88, v88, v6
  v_mul_f32 v89, v89, v7
  v_cvt_pk_bf16_f32 v89, v88, v89
  v_lshlrev_b32 v88, 16, v89
  v_and_b32 v89, 0xffff0000, v89
  v_lshlrev_b32 v6, 16, v247
  v_and_b32 v7, 0xffff0000, v247
  v_lshlrev_b32 v70, 16, v227
  v_and_b32 v71, 0xffff0000, v227
  v_mul_f32 v70, v70, v6
  v_mul_f32 v71, v71, v7
  v_cvt_pk_bf16_f32 v71, v70, v71
  v_lshlrev_b32 v70, 16, v71
  v_and_b32 v71, 0xffff0000, v71
  v_lshlrev_b32 v90, 16, v237
  v_and_b32 v91, 0xffff0000, v237
  v_mul_f32 v90, v90, v6
  v_mul_f32 v91, v91, v7
  v_cvt_pk_bf16_f32 v91, v90, v91
  v_lshlrev_b32 v90, 16, v91
  v_and_b32 v91, 0xffff0000, v91
  v_lshlrev_b32 v6, 16, v248
  v_and_b32 v7, 0xffff0000, v248
  v_lshlrev_b32 v72, 16, v228
  v_and_b32 v73, 0xffff0000, v228
  v_mul_f32 v72, v72, v6
  v_mul_f32 v73, v73, v7
  v_cvt_pk_bf16_f32 v73, v72, v73
  v_lshlrev_b32 v72, 16, v73
  v_and_b32 v73, 0xffff0000, v73
  v_lshlrev_b32 v92, 16, v238
  v_and_b32 v93, 0xffff0000, v238
  v_mul_f32 v92, v92, v6
  v_mul_f32 v93, v93, v7
  v_cvt_pk_bf16_f32 v93, v92, v93
  v_lshlrev_b32 v92, 16, v93
  v_and_b32 v93, 0xffff0000, v93
  v_lshlrev_b32 v6, 16, v249
  v_and_b32 v7, 0xffff0000, v249
  v_lshlrev_b32 v74, 16, v229
  v_and_b32 v75, 0xffff0000, v229
  v_mul_f32 v74, v74, v6
  v_mul_f32 v75, v75, v7
  v_cvt_pk_bf16_f32 v75, v74, v75
  v_lshlrev_b32 v74, 16, v75
  v_and_b32 v75, 0xffff0000, v75
  v_lshlrev_b32 v94, 16, v239
  v_and_b32 v95, 0xffff0000, v239
  v_mul_f32 v94, v94, v6
  v_mul_f32 v95, v95, v7
  v_cvt_pk_bf16_f32 v95, v94, v95
  v_lshlrev_b32 v94, 16, v95
  v_and_b32 v95, 0xffff0000, v95
  v_lshlrev_b32 v6, 16, v250
  v_and_b32 v7, 0xffff0000, v250
  v_lshlrev_b32 v76, 16, v230
  v_and_b32 v77, 0xffff0000, v230
  v_mul_f32 v76, v76, v6
  v_mul_f32 v77, v77, v7
  v_cvt_pk_bf16_f32 v77, v76, v77
  v_lshlrev_b32 v76, 16, v77
  v_and_b32 v77, 0xffff0000, v77
  v_lshlrev_b32 v96, 16, v240
  v_and_b32 v97, 0xffff0000, v240
  v_mul_f32 v96, v96, v6
  v_mul_f32 v97, v97, v7
  v_cvt_pk_bf16_f32 v97, v96, v97
  v_lshlrev_b32 v96, 16, v97
  v_and_b32 v97, 0xffff0000, v97
  v_lshlrev_b32 v6, 16, v251
  v_and_b32 v7, 0xffff0000, v251
  v_lshlrev_b32 v78, 16, v231
  v_and_b32 v79, 0xffff0000, v231
  v_mul_f32 v78, v78, v6
  v_mul_f32 v79, v79, v7
  v_cvt_pk_bf16_f32 v79, v78, v79
  v_lshlrev_b32 v78, 16, v79
  v_and_b32 v79, 0xffff0000, v79
  v_lshlrev_b32 v98, 16, v241
  v_and_b32 v99, 0xffff0000, v241
  v_mul_f32 v98, v98, v6
  v_mul_f32 v99, v99, v7
  v_cvt_pk_bf16_f32 v99, v98, v99
  v_lshlrev_b32 v98, 16, v99
  v_and_b32 v99, 0xffff0000, v99
  v_lshlrev_b32 v6, 16, v252
  v_and_b32 v7, 0xffff0000, v252
  v_lshlrev_b32 v80, 16, v232
  v_and_b32 v81, 0xffff0000, v232
  v_mul_f32 v80, v80, v6
  v_mul_f32 v81, v81, v7
  v_cvt_pk_bf16_f32 v81, v80, v81
  v_lshlrev_b32 v80, 16, v81
  v_and_b32 v81, 0xffff0000, v81
  v_lshlrev_b32 v100, 16, v242
  v_and_b32 v101, 0xffff0000, v242
  v_mul_f32 v100, v100, v6
  v_mul_f32 v101, v101, v7
  v_cvt_pk_bf16_f32 v101, v100, v101
  v_lshlrev_b32 v100, 16, v101
  v_and_b32 v101, 0xffff0000, v101
  v_lshlrev_b32 v6, 16, v253
  v_and_b32 v7, 0xffff0000, v253
  v_lshlrev_b32 v82, 16, v233
  v_and_b32 v83, 0xffff0000, v233
  v_mul_f32 v82, v82, v6
  v_mul_f32 v83, v83, v7
  v_cvt_pk_bf16_f32 v83, v82, v83
  v_lshlrev_b32 v82, 16, v83
  v_and_b32 v83, 0xffff0000, v83
  v_lshlrev_b32 v102, 16, v243
  v_and_b32 v103, 0xffff0000, v243
  v_mul_f32 v102, v102, v6
  v_mul_f32 v103, v103, v7
  v_cvt_pk_bf16_f32 v103, v102, v103
  v_lshlrev_b32 v102, 16, v103
  v_and_b32 v103, 0xffff0000, v103
.Lxc103:
.Lk2_sv2:
  s_cmp_eq_u32 s75, s90
  s_cbranch_scc1 .Lsv104p
.Lsv104q:
  s_waitcnt vmcnt(0)
  s_cmp_gt_u32 s75, 3
  s_cbranch_scc1 .Lsv104r
  s_cmp_lg_u32 s52, 7
  s_cbranch_scc1 .Lsv104r
  v_and_b32 v12, v116, v117
  v_cmp_ne_u32 vcc, v12, v117
  s_nop 0
  s_cmp_lg_u64 vcc, 0
  s_cselect_b32 s68, 1, 0
  s_xor_b32 s55, s68, 1
  v_mov_b32 v119, s55
  v_mov_b32 v115, 163776
  ds_write_b32 v115, v119
  s_waitcnt lgkmcnt(0)
.Lsv104r:
  s_nop 0
  s_barrier
  s_cmp_lt_u32 s90, 16
  s_cbranch_scc1 .Lp1106
  v_mov_b32 v12, 1
  s_mov_b64 exec, 1
  buffer_store_byte v12, off, s[16:19], s90 sc0 sc1
  s_mov_b64 exec, -1
  s_mov_b32 s90, 0
.Lp1106:
  s_sub_u32 s75, s75, 1
  s_cmp_eq_u32 s75, 0
  s_cbranch_scc1 .Lsv104
  s_sub_u32 s101, s101, 1
  s_cbranch_scc1 .Lkc108a
.Lkc108k:
  s_mov_b32 m0, s77
  s_min_u32 s57, s76, s69
  buffer_load_dwordx4 v2, s[16:19], s57 offen offset:0 lds
  buffer_load_dwordx4 v2, s[16:19], s57 offen offset:1024 lds
  buffer_load_dwordx4 v2, s[16:19], s57 offen offset:2048 lds
  buffer_load_dwordx4 v2, s[16:19], s57 offen offset:3072 lds
  s_add_u32 m0, s77, 4096
  s_add_u32 s57, s57, 4096
  buffer_load_dwordx4 v2, s[16:19], s57 offen offset:0 lds
  buffer_load_dwordx4 v2, s[16:19], s57 offen offset:1024 lds
  buffer_load_dwordx4 v2, s[16:19], s57 offen offset:2048 lds
  buffer_load_dwordx4 v2, s[16:19], s57 offen offset:3072 lds
  s_add_u32 m0, s77, 32768
  s_sub_u32 s57, s76, 24576
  buffer_load_dwordx4 v2, s[16:19], s57 offen offset:0 lds
  buffer_load_dwordx4 v2, s[16:19], s57 offen offset:1024 lds
  buffer_load_dwordx4 v2, s[16:19], s57 offen offset:2048 lds
  buffer_load_dwordx4 v2, s[16:19], s57 offen offset:3072 lds
  s_add_u32 m0, s77, 36864
  s_add_u32 s57, s57, 4096
  buffer_load_dwordx4 v2, s[16:19], s57 offen offset:0 lds
  buffer_load_dwordx4 v2, s[16:19], s57 offen offset:1024 lds
  buffer_load_dwordx4 v2, s[16:19], s57 offen offset:2048 lds
  buffer_load_dwordx4 v2, s[16:19], s57 offen offset:3072 lds
  s_add_u32 s76, s76, 65536
  s_xor_b32 s77, s77, 65536
.Lsv104:
  s_branch .Lk2_svloop
.Lk2_z:
  s_waitcnt vmcnt(0)
  s_cmp_eq_u32 s89, 0
  s_cbranch_scc1 .Lcf109
  v_mov_b32 v12, 1
  s_mov_b64 exec, 1
  buffer_store_byte v12, off, s[16:19], s89 sc0 sc1
  s_mov_b64 exec, -1
  s_mov_b32 s89, 0
.Lcf109:
  s_cmp_lg_u32 s52, 7
  s_cbranch_scc1 .Lc1111
  s_cmp_eq_u32 s68, 0
  s_cbranch_scc1 .Lc1111
  buffer_load_dword v116, v118, s[16:19], s47 offen sc0 sc1
.Lc1111:
  s_mul_i32 s55, s73, 5120
  v_add_u32 v13, s55, v2
  s_add_u32 s56, s55, s27
  s_add_u32 m0, s55, 131072
  s_add_u32 s57, s22, 0
  buffer_load_dwordx4 v13, s[16:19], s57 offen offset:0 lds
  buffer_load_dwordx4 v13, s[16:19], s57 offen offset:1024 lds
  buffer_load_dwordx4 v13, s[16:19], s57 offen offset:2048 lds
  buffer_load_dwordx4 v13, s[16:19], s57 offen offset:3072 lds
  s_add_u32 m0, s55, 135168
  s_add_u32 s57, s22, 4096
  buffer_load_dwordx4 v13, s[16:19], s57 offen offset:0 lds
  s_add_u32 m0, s56, 0
  s_add_u32 s57, s22, 20480
  buffer_load_dwordx4 v13, s[16:19], s57 offen offset:0 lds
  buffer_load_dwordx4 v13, s[16:19], s57 offen offset:1024 lds
  buffer_load_dwordx4 v13, s[16:19], s57 offen offset:2048 lds
  buffer_load_dwordx4 v13, s[16:19], s57 offen offset:3072 lds
  s_add_u32 m0, s56, 4096
  s_add_u32 s57, s22, 24576
  buffer_load_dwordx4 v13, s[16:19], s57 offen offset:0 lds
  s_add_u32 m0, s56, 20480
  s_add_u32 s57, s22, 40960
  buffer_load_dwordx4 v13, s[16:19], s57 offen offset:0 lds
  buffer_load_dwordx4 v13, s[16:19], s57 offen offset:1024 lds
  buffer_load_dwordx4 v13, s[16:19], s57 offen offset:2048 lds
  buffer_load_dwordx4 v13, s[16:19], s57 offen offset:3072 lds
  s_add_u32 m0, s56, 24576
  s_add_u32 s57, s22, 45056
  buffer_load_dwordx4 v13, s[16:19], s57 offen offset:0 lds
  s_add_u32 m0, s56, 40960
  s_add_u32 s57, s22, 61440
  buffer_load_dwordx4 v13, s[16:19], s57 offen offset:0 lds
  buffer_load_dwordx4 v13, s[16:19], s57 offen offset:1024 lds
  buffer_load_dwordx4 v13, s[16:19], s57 offen offset:2048 lds
  buffer_load_dwordx4 v13, s[16:19], s57 offen offset:3072 lds
  s_add_u32 m0, s56, 45056
  s_add_u32 s57, s22, 65536
  buffer_load_dwordx4 v13, s[16:19], s57 offen offset:0 lds
  s_cmp_lt_u32 s44, 2
  s_cbranch_scc1 .Lxc112
  v_lshlrev_b32 v6, 16, v244
  v_and_b32 v7, 0xffff0000, v244
  v_lshlrev_b32 v64, 16, v224
  v_and_b32 v65, 0xffff0000, v224
  v_mul_f32 v64, v64, v6
  v_mul_f32 v65, v65, v7
  v_cvt_pk_bf16_f32 v65, v64, v65
  v_lshlrev_b32 v64, 16, v65
  v_and_b32 v65, 0xffff0000, v65
  v_lshlrev_b32 v84, 16, v234
  v_and_b32 v85, 0xffff0000, v234
  v_mul_f32 v84, v84, v6
  v_mul_f32 v85, v85, v7
  v_cvt_pk_bf16_f32 v85, v84, v85
  v_lshlrev_b32 v84, 16, v85
  v_and_b32 v85, 0xffff0000, v85
  v_lshlrev_b32 v6, 16, v245
  v_and_b32 v7, 0xffff0000, v245
  v_lshlrev_b32 v66, 16, v225
  v_and_b32 v67, 0xffff0000, v225
  v_mul_f32 v66, v66, v6
  v_mul_f32 v67, v67, v7
  v_cvt_pk_bf16_f32 v67, v66, v67
  v_lshlrev_b32 v66, 16, v67
  v_and_b32 v67, 0xffff0000, v67
  v_lshlrev_b32 v86, 16, v235
  v_and_b32 v87, 0xffff0000, v235
  v_mul_f32 v86, v86, v6
  v_mul_f32 v87, v87, v7
  v_cvt_pk_bf16_f32 v87, v86, v87
  v_lshlrev_b32 v86, 16, v87
  v_and_b32 v87, 0xffff0000, v87
  v_lshlrev_b32 v6, 16, v246
  v_and_b32 v7, 0xffff0000, v246
  v_lshlrev_b32 v68, 16, v226
  v_and_b32 v69, 0xffff0000, v226
  v_mul_f32 v68, v68, v6
  v_mul_f32 v69, v69, v7
  v_cvt_pk_bf16_f32 v69, v68, v69
  v_lshlrev_b32 v68, 16, v69
  v_and_b32 v69, 0xffff0000, v69
  v_lshlrev_b32 v88, 16, v236
  v_and_b32 v89, 0xffff0000, v236
  v_mul_f32 v88, v88, v6
  v_mul_f32 v89, v89, v7
  v_cvt_pk_bf16_f32 v89, v88, v89
  v_lshlrev_b32 v88, 16, v89
  v_and_b32 v89, 0xffff0000, v89
  v_lshlrev_b32 v6, 16, v247
  v_and_b32 v7, 0xffff0000, v247
  v_lshlrev_b32 v70, 16, v227
  v_and_b32 v71, 0xffff0000, v227
  v_mul_f32 v70, v70, v6
  v_mul_f32 v71, v71, v7
  v_cvt_pk_bf16_f32 v71, v70, v71
  v_lshlrev_b32 v70, 16, v71
  v_and_b32 v71, 0xffff0000, v71
  v_lshlrev_b32 v90, 16, v237
  v_and_b32 v91, 0xffff0000, v237
  v_mul_f32 v90, v90, v6
  v_mul_f32 v91, v91, v7
  v_cvt_pk_bf16_f32 v91, v90, v91
  v_lshlrev_b32 v90, 16, v91
  v_and_b32 v91, 0xffff0000, v91
  v_lshlrev_b32 v6, 16, v248
  v_and_b32 v7, 0xffff0000, v248
  v_lshlrev_b32 v72, 16, v228
  v_and_b32 v73, 0xffff0000, v228
  v_mul_f32 v72, v72, v6
  v_mul_f32 v73, v73, v7
  v_cvt_pk_bf16_f32 v73, v72, v73
  v_lshlrev_b32 v72, 16, v73
  v_and_b32 v73, 0xffff0000, v73
  v_lshlrev_b32 v92, 16, v238
  v_and_b32 v93, 0xffff0000, v238
  v_mul_f32 v92, v92, v6
  v_mul_f32 v93, v93, v7
  v_cvt_pk_bf16_f32 v93, v92, v93
  v_lshlrev_b32 v92, 16, v93
  v_and_b32 v93, 0xffff0000, v93
  v_lshlrev_b32 v6, 16, v249
  v_and_b32 v7, 0xffff0000, v249
  v_lshlrev_b32 v74, 16, v229
  v_and_b32 v75, 0xffff0000, v229
  v_mul_f32 v74, v74, v6
  v_mul_f32 v75, v75, v7
  v_cvt_pk_bf16_f32 v75, v74, v75
  v_lshlrev_b32 v74, 16, v75
  v_and_b32 v75, 0xffff0000, v75
  v_lshlrev_b32 v94, 16, v239
  v_and_b32 v95, 0xffff0000, v239
  v_mul_f32 v94, v94, v6
  v_mul_f32 v95, v95, v7
  v_cvt_pk_bf16_f32 v95, v94, v95
  v_lshlrev_b32 v94, 16, v95
  v_and_b32 v95, 0xffff0000, v95
  v_lshlrev_b32 v6, 16, v250
  v_and_b32 v7, 0xffff0000, v250
  v_lshlrev_b32 v76, 16, v230
  v_and_b32 v77, 0xffff0000, v230
  v_mul_f32 v76, v76, v6
  v_mul_f32 v77, v77, v7
  v_cvt_pk_bf16_f32 v77, v76, v77
  v_lshlrev_b32 v76, 16, v77
  v_and_b32 v77, 0xffff0000, v77
  v_lshlrev_b32 v96, 16, v240
  v_and_b32 v97, 0xffff0000, v240
  v_mul_f32 v96, v96, v6
  v_mul_f32 v97, v97, v7
  v_cvt_pk_bf16_f32 v97, v96, v97
  v_lshlrev_b32 v96, 16, v97
  v_and_b32 v97, 0xffff0000, v97
  v_lshlrev_b32 v6, 16, v251
  v_and_b32 v7, 0xffff0000, v251
  v_lshlrev_b32 v78, 16, v231
  v_and_b32 v79, 0xffff0000, v231
  v_mul_f32 v78, v78, v6
  v_mul_f32 v79, v79, v7
  v_cvt_pk_bf16_f32 v79, v78, v79
  v_lshlrev_b32 v78, 16, v79
  v_and_b32 v79, 0xffff0000, v79
  v_lshlrev_b32 v98, 16, v241
  v_and_b32 v99, 0xffff0000, v241
  v_mul_f32 v98, v98, v6
  v_mul_f32 v99, v99, v7
  v_cvt_pk_bf16_f32 v99, v98, v99
  v_lshlrev_b32 v98, 16, v99
  v_and_b32 v99, 0xffff0000, v99
  v_lshlrev_b32 v6, 16, v252
  v_and_b32 v7, 0xffff0000, v252
  v_lshlrev_b32 v80, 16, v232
  v_and_b32 v81, 0xffff0000, v232
  v_mul_f32 v80, v80, v6
  v_mul_f32 v81, v81, v7
  v_cvt_pk_bf16_f32 v81, v80, v81
  v_lshlrev_b32 v80, 16, v81
  v_and_b32 v81, 0xffff0000, v81
  v_lshlrev_b32 v100, 16, v242
  v_and_b32 v101, 0xffff0000, v242
  v_mul_f32 v100, v100, v6
  v_mul_f32 v101, v101, v7
  v_cvt_pk_bf16_f32 v101, v100, v101
  v_lshlrev_b32 v100, 16, v101
  v_and_b32 v101, 0xffff0000, v101
  v_lshlrev_b32 v6, 16, v253
  v_and_b32 v7, 0xffff0000, v253
  v_lshlrev_b32 v82, 16, v233
  v_and_b32 v83, 0xffff0000, v233
  v_mul_f32 v82, v82, v6
  v_mul_f32 v83, v83, v7
  v_cvt_pk_bf16_f32 v83, v82, v83
  v_lshlrev_b32 v82, 16, v83
  v_and_b32 v83, 0xffff0000, v83
  v_lshlrev_b32 v102, 16, v243
  v_and_b32 v103, 0xffff0000, v243
  v_mul_f32 v102, v102, v6
  v_mul_f32 v103, v103, v7
  v_cvt_pk_bf16_f32 v103, v102, v103
  v_lshlrev_b32 v102, 16, v103
  v_and_b32 v103, 0xffff0000, v103
.Lxc112:
  s_branch .Lk2_e4
.Lk2_d:
  s_cmp_eq_u32 s54, 6
  s_cbranch_scc1 .Lk2_sv0
  v_mov_b32 v115, 163776
  ds_read_b32 v119, v115
  s_waitcnt lgkmcnt(0)
  v_readfirstlane_b32 s55, v119
  s_nop 0
  s_cmp_lg_u32 s55, 1
  s_cselect_b32 s68, 1, 0
  s_cbranch_scc0 .Lk2_d2
  s_cmp_lg_u32 s52, 7
  s_cbranch_scc1 .Lc1113
  s_cmp_eq_u32 s68, 0
  s_cbranch_scc1 .Lc1113
  buffer_load_dword v116, v118, s[16:19], s47 offen sc0 sc1
.Lc1113:
  s_branch .Lk2_sv2
.Lk2_d2:
  s_mul_i32 s55, s49, 4352
  v_and_b32 v3, 0x300, v2
  v_add3_u32 v1, v3, v2, s55
  v_xor_b32 v3, 256, v1
  s_add_u32 s56, s20, 0
  buffer_load_dwordx4 v[192:195], v1, s[16:19], s56 offen offset:0
  buffer_load_dwordx4 v[196:199], v3, s[16:19], s56 offen offset:0
  buffer_load_dwordx4 v[200:203], v1, s[16:19], s56 offen offset:2048
  buffer_load_dwordx4 v[204:207], v3, s[16:19], s56 offen offset:2048
  s_add_u32 s56, s20, 8192
  buffer_load_dwordx4 v[208:211], v1, s[16:19], s56 offen offset:0
  buffer_load_dwordx4 v[212:215], v3, s[16:19], s56 offen offset:0
  buffer_load_dwordx4 v[216:219], v1, s[16:19], s56 offen offset:2048
  buffer_load_dwordx4 v[220:223], v3, s[16:19], s56 offen offset:2048
  s_add_u32 s56, s20, 16384
  buffer_load_dwordx4 v[48:51], v1, s[16:19], s56 offen offset:0
  buffer_load_dwordx4 v[52:55], v3, s[16:19], s56 offen offset:0
  buffer_load_dwordx4 v[56:59], v1, s[16:19], s56 offen offset:2048
  buffer_load_dwordx4 v[60:63], v3, s[16:19], s56 offen offset:2048
  s_cmp_eq_u32 s75, s90
  s_cbranch_scc1 .Lsv114p
.Lsv114q:
  s_waitcnt vmcnt(12)
  s_nop 0
  s_barrier
  s_cmp_lt_u32 s90, 16
  s_cbranch_scc1 .Lp1116
  v_mov_b32 v12, 1
  s_mov_b64 exec, 1
  buffer_store_byte v12, off, s[16:19], s90 sc0 sc1
  s_mov_b64 exec, -1
  s_mov_b32 s90, 0
.Lp1116:
  s_sub_u32 s75, s75, 1
  s_cmp_eq_u32 s75, 0
  s_cbranch_scc1 .Lsv114
  s_sub_u32 s101, s101, 1
  s_cbranch_scc1 .Lkc118a
.Lkc118k:
  s_mov_b32 m0, s77
  s_min_u32 s57, s76, s69
  buffer_load_dwordx4 v2, s[16:19], s57 offen offset:0 lds
  buffer_load_dwordx4 v2, s[16:19], s57 offen offset:1024 lds
  buffer_load_dwordx4 v2, s[16:19], s57 offen offset:2048 lds
  buffer_load_dwordx4 v2, s[16:19], s57 offen offset:3072 lds
  s_add_u32 m0, s77, 4096
  s_add_u32 s57, s57, 4096
  buffer_load_dwordx4 v2, s[16:19], s57 offen offset:0 lds
  buffer_load_dwordx4 v2, s[16:19], s57 offen offset:1024 lds
  buffer_load_dwordx4 v2, s[16:19], s57 offen offset:2048 lds
  buffer_load_dwordx4 v2, s[16:19], s57 offen offset:3072 lds
  s_add_u32 m0, s77, 32768
  s_sub_u32 s57, s76, 24576
  buffer_load_dwordx4 v2, s[16:19], s57 offen offset:0 lds
  buffer_load_dwordx4 v2, s[16:19], s57 offen offset:1024 lds
  buffer_load_dwordx4 v2, s[16:19], s57 offen offset:2048 lds
  buffer_load_dwordx4 v2, s[16:19], s57 offen offset:3072 lds
  s_add_u32 m0, s77, 36864
  s_add_u32 s57, s57, 4096
  buffer_load_dwordx4 v2, s[16:19], s57 offen offset:0 lds
  buffer_load_dwordx4 v2, s[16:19], s57 offen offset:1024 lds
  buffer_load_dwordx4 v2, s[16:19], s57 offen offset:2048 lds
  buffer_load_dwordx4 v2, s[16:19], s57 offen offset:3072 lds
  s_add_u32 s76, s76, 65536
  s_xor_b32 s77, s77, 65536
.Lsv114:
  s_mul_i32 s55, s73, 5120
  v_add_u32 v13, s55, v2
  s_add_u32 s56, s55, s27
  s_add_u32 m0, s55, 131072
  s_add_u32 s57, s22, 0
  buffer_load_dwordx4 v13, s[16:19], s57 offen offset:0 lds
  buffer_load_dwordx4 v13, s[16:19], s57 offen offset:1024 lds
  buffer_load_dwordx4 v13, s[16:19], s57 offen offset:2048 lds
  buffer_load_dwordx4 v13, s[16:19], s57 offen offset:3072 lds
  s_add_u32 m0, s55, 135168
  s_add_u32 s57, s22, 4096
  buffer_load_dwordx4 v13, s[16:19], s57 offen offset:0 lds
  s_add_u32 s56, s20, 24576
  buffer_load_dwordx4 v[112:115], v1, s[16:19], s56 offen offset:0
  buffer_load_dwordx4 v[116:119], v3, s[16:19], s56 offen offset:0
  buffer_load_dwordx4 v[120:123], v1, s[16:19], s56 offen offset:2048
  buffer_load_dwordx4 v[124:127], v3, s[16:19], s56 offen offset:2048
  s_add_u32 s56, s20, 32768
  buffer_load_dwordx4 v[16:19], v1, s[16:19], s56 offen offset:0
  buffer_load_dwordx4 v[20:23], v3, s[16:19], s56 offen offset:0
  buffer_load_dwordx4 v[24:27], v1, s[16:19], s56 offen offset:2048
  buffer_load_dwordx4 v[28:31], v3, s[16:19], s56 offen offset:2048
  s_waitcnt vmcnt(13)
  s_barrier
  s_mul_i32 s55, s73, 5120
  v_add_u32 v13, s55, v2
  s_add_u32 s56, s55, s27
  s_add_u32 m0, s56, 0
  s_add_u32 s57, s22, 20480
  buffer_load_dwordx4 v13, s[16:19], s57 offen offset:0 lds
  buffer_load_dwordx4 v13, s[16:19], s57 offen offset:1024 lds
  buffer_load_dwordx4 v13, s[16:19], s57 offen offset:2048 lds
  buffer_load_dwordx4 v13, s[16:19], s57 offen offset:3072 lds
  s_add_u32 m0, s56, 4096
  s_add_u32 s57, s22, 24576
  buffer_load_dwordx4 v13, s[16:19], s57 offen offset:0 lds
  s_add_u32 m0, s56, 20480
  s_add_u32 s57, s22, 40960
  buffer_load_dwordx4 v13, s[16:19], s57 offen offset:0 lds
  buffer_load_dwordx4 v13, s[16:19], s57 offen offset:1024 lds
  buffer_load_dwordx4 v13, s[16:19], s57 offen offset:2048 lds
  buffer_load_dwordx4 v13, s[16:19], s57 offen offset:3072 lds
  s_add_u32 m0, s56, 24576
  s_add_u32 s57, s22, 45056
  buffer_load_dwordx4 v13, s[16:19], s57 offen offset:0 lds
  s_add_u32 m0, s56, 40960
  s_add_u32 s57, s22, 61440
  buffer_load_dwordx4 v13, s[16:19], s57 offen offset:0 lds
  buffer_load_dwordx4 v13, s[16:19], s57 offen offset:1024 lds
  buffer_load_dwordx4 v13, s[16:19], s57 offen offset:2048 lds
  buffer_load_dwordx4 v13, s[16:19], s57 offen offset:3072 lds
  s_add_u32 m0, s56, 45056
  s_add_u32 s57, s22, 65536
  buffer_load_dwordx4 v13, s[16:19], s57 offen offset:0 lds
  s_branch .Lk2_e5
.Lk2_e:
  v_mov_b32 v115, 163776
  ds_read_b32 v119, v115
  s_waitcnt lgkmcnt(0)
  v_readfirstlane_b32 s55, v119
  s_nop 0
  s_cmp_lg_u32 s55, 1
  s_cselect_b32 s68, 1, 0
  s_cbranch_scc1 .Lk2_e2
  s_mul_i32 s55, s73, 5120
  v_add_u32 v13, s55, v2
  s_add_u32 s56, s55, s27
  s_add_u32 m0, s55, 131072
  s_add_u32 s57, s22, 0
  buffer_load_dwordx4 v13, s[16:19], s57 offen offset:0 lds
  buffer_load_dwordx4 v13, s[16:19], s57 offen offset:1024 lds
  buffer_load_dwordx4 v13, s[16:19], s57 offen offset:2048 lds
  buffer_load_dwordx4 v13, s[16:19], s57 offen offset:3072 lds
  s_add_u32 m0, s55, 135168
  s_add_u32 s57, s22, 4096
  buffer_load_dwordx4 v13, s[16:19], s57 offen offset:0 lds
  s_mul_i32 s55, s49, 4352
  v_and_b32 v3, 0x300, v2
  v_add3_u32 v1, v3, v2, s55
  v_xor_b32 v3, 256, v1
  s_add_u32 s56, s20, 0
  buffer_load_dwordx4 v[192:195], v1, s[16:19], s56 offen offset:0
  buffer_load_dwordx4 v[196:199], v3, s[16:19], s56 offen offset:0
  buffer_load_dwordx4 v[200:203], v1, s[16:19], s56 offen offset:2048
  buffer_load_dwordx4 v[204:207], v3, s[16:19], s56 offen offset:2048
  s_add_u32 s56, s20, 8192
  buffer_load_dwordx4 v[208:211], v1, s[16:19], s56 offen offset:0
  buffer_load_dwordx4 v[212:215], v3, s[16:19], s56 offen offset:0
  buffer_load_dwordx4 v[216:219], v1, s[16:19], s56 offen offset:2048
  buffer_load_dwordx4 v[220:223], v3, s[16:19], s56 offen offset:2048
  s_waitcnt vmcnt(13)
  s_barrier
  s_add_u32 s56, s20, 16384
  buffer_load_dwordx4 v[48:51], v1, s[16:19], s56 offen offset:0
  buffer_load_dwordx4 v[52:55], v3, s[16:19], s56 offen offset:0
  buffer_load_dwordx4 v[56:59], v1, s[16:19], s56 offen offset:2048
  buffer_load_dwordx4 v[60:63], v3, s[16:19], s56 offen offset:2048
  s_add_u32 s56, s20, 24576
  buffer_load_dwordx4 v[112:115], v1, s[16:19], s56 offen offset:0
  buffer_load_dwordx4 v[116:119], v3, s[16:19], s56 offen offset:0
  buffer_load_dwordx4 v[120:123], v1, s[16:19], s56 offen offset:2048
  buffer_load_dwordx4 v[124:127], v3, s[16:19], s56 offen offset:2048
  s_add_u32 s56, s20, 32768
  buffer_load_dwordx4 v[16:19], v1, s[16:19], s56 offen offset:0
  buffer_load_dwordx4 v[20:23], v3, s[16:19], s56 offen offset:0
  buffer_load_dwordx4 v[24:27], v1, s[16:19], s56 offen offset:2048
  buffer_load_dwordx4 v[28:31], v3, s[16:19], s56 offen offset:2048
  s_mul_i32 s55, s73, 5120
  v_add_u32 v13, s55, v2
  s_add_u32 s56, s55, s27
  s_add_u32 m0, s56, 0
  s_add_u32 s57, s22, 20480
  buffer_load_dwordx4 v13, s[16:19], s57 offen offset:0 lds
  buffer_load_dwordx4 v13, s[16:19], s57 offen offset:1024 lds
  buffer_load_dwordx4 v13, s[16:19], s57 offen offset:2048 lds
  buffer_load_dwordx4 v13, s[16:19], s57 offen offset:3072 lds
  s_add_u32 m0, s56, 4096
  s_add_u32 s57, s22, 24576
  buffer_load_dwordx4 v13, s[16:19], s57 offen offset:0 lds
  s_add_u32 m0, s56, 20480
  s_add_u32 s57, s22, 40960
  buffer_load_dwordx4 v13, s[16:19], s57 offen offset:0 lds
  buffer_load_dwordx4 v13, s[16:19], s57 offen offset:1024 lds
  buffer_load_dwordx4 v13, s[16:19], s57 offen offset:2048 lds
  buffer_load_dwordx4 v13, s[16:19], s57 offen offset:3072 lds
  s_add_u32 m0, s56, 24576
  s_add_u32 s57, s22, 45056
  buffer_load_dwordx4 v13, s[16:19], s57 offen offset:0 lds
  s_add_u32 m0, s56, 40960
  s_add_u32 s57, s22, 61440
  buffer_load_dwordx4 v13, s[16:19], s57 offen offset:0 lds
  buffer_load_dwordx4 v13, s[16:19], s57 offen offset:1024 lds
  buffer_load_dwordx4 v13, s[16:19], s57 offen offset:2048 lds
  buffer_load_dwordx4 v13, s[16:19], s57 offen offset:3072 lds
  s_add_u32 m0, s56, 45056
  s_add_u32 s57, s22, 65536
  buffer_load_dwordx4 v13, s[16:19], s57 offen offset:0 lds
  s_branch .Lk2_e5
.Lk2_e2:
  s_cmp_lg_u32 s52, 7
  s_cbranch_scc1 .Lc1119
  s_cmp_eq_u32 s68, 0
  s_cbranch_scc1 .Lc1119
  buffer_load_dword v116, v118, s[16:19], s47 offen sc0 sc1
.Lc1119:
  s_mul_i32 s55, s73, 5120
  v_add_u32 v13, s55, v2
  s_add_u32 s56, s55, s27
  s_add_u32 m0, s55, 131072
  s_add_u32 s57, s22, 0
  buffer_load_dwordx4 v13, s[16:19], s57 offen offset:0 lds
  buffer_load_dwordx4 v13, s[16:19], s57 offen offset:1024 lds
  buffer_load_dwordx4 v13, s[16:19], s57 offen offset:2048 lds
  buffer_load_dwordx4 v13, s[16:19], s57 offen offset:3072 lds
  s_add_u32 m0, s55, 135168
  s_add_u32 s57, s22, 4096
  buffer_load_dwordx4 v13, s[16:19], s57 offen offset:0 lds
  s_waitcnt vmcnt(5)
  s_cmp_lg_u32 s52, 7
  s_cbranch_scc1 .Lk2_e3
  v_and_b32 v12, v116, v117
  v_cmp_ne_u32 vcc, v12, v117
  s_nop 0
  s_cmp_lg_u64 vcc, 0
  s_cselect_b32 s68, 1, 0
  s_xor_b32 s55, s68, 1
  v_mov_b32 v119, s55
  v_mov_b32 v115, 163776
  ds_write_b32 v115, v119
  s_waitcnt lgkmcnt(0)
.Lk2_e3:
  s_barrier
  s_cmp_lg_u32 s52, 7
  s_cbranch_scc1 .Lc1120
  s_cmp_eq_u32 s68, 0
  s_cbranch_scc1 .Lc1120
  buffer_load_dword v116, v118, s[16:19], s47 offen sc0 sc1
.Lc1120:
  s_mul_i32 s55, s73, 5120
  v_add_u32 v13, s55, v2
  s_add_u32 s56, s55, s27
  s_add_u32 m0, s56, 0
  s_add_u32 s57, s22, 20480
  buffer_load_dwordx4 v13, s[16:19], s57 offen offset:0 lds
  buffer_load_dwordx4 v13, s[16:19], s57 offen offset:1024 lds
  buffer_load_dwordx4 v13, s[16:19], s57 offen offset:2048 lds
  buffer_load_dwordx4 v13, s[16:19], s57 offen offset:3072 lds
  s_add_u32 m0, s56, 4096
  s_add_u32 s57, s22, 24576
  buffer_load_dwordx4 v13, s[16:19], s57 offen offset:0 lds
  s_add_u32 m0, s56, 20480
  s_add_u32 s57, s22, 40960
  buffer_load_dwordx4 v13, s[16:19], s57 offen offset:0 lds
  buffer_load_dwordx4 v13, s[16:19], s57 offen offset:1024 lds
  buffer_load_dwordx4 v13, s[16:19], s57 offen offset:2048 lds
  buffer_load_dwordx4 v13, s[16:19], s57 offen offset:3072 lds
  s_add_u32 m0, s56, 24576
  s_add_u32 s57, s22, 45056
  buffer_load_dwordx4 v13, s[16:19], s57 offen offset:0 lds
  s_add_u32 m0, s56, 40960
  s_add_u32 s57, s22, 61440
  buffer_load_dwordx4 v13, s[16:19], s57 offen offset:0 lds
  buffer_load_dwordx4 v13, s[16:19], s57 offen offset:1024 lds
  buffer_load_dwordx4 v13, s[16:19], s57 offen offset:2048 lds
  buffer_load_dwordx4 v13, s[16:19], s57 offen offset:3072 lds
  s_add_u32 m0, s56, 45056
  s_add_u32 s57, s22, 65536
  buffer_load_dwordx4 v13, s[16:19], s57 offen offset:0 lds
.Lk2_e4:
  s_cmp_lg_u32 s52, 7
  s_cbranch_scc1 .Lk2_e6
  s_cmp_eq_u32 s68, 0
  s_cbranch_scc1 .Lk2_e7
  s_waitcnt vmcnt(15)
.Lpl121c:
  v_and_b32 v12, v116, v117
  v_cmp_ne_u32 vcc, v12, v117
  s_nop 0
  s_cbranch_vccnz .Lpl121s
.Lpl121k:
  v_mov_b32 v119, 1
  v_mov_b32 v115, 163776
  ds_write_b32 v115, v119
  s_waitcnt lgkmcnt(0)
.Lk2_e6:
.Lrs122:
  v_mov_b32 v115, 163776
  ds_read_b32 v119, v115
  s_waitcnt lgkmcnt(0)
  v_readfirstlane_b32 s55, v119
  s_nop 0
  s_cmp_lg_u32 s55, 1
  s_cselect_b32 s68, 1, 0
  s_cbranch_scc0 .Lrs122k
  s_sleep 2
  s_sub_u32 s95, s95, 1
  s_cselect_b32 s95, 0, s95
  s_cbranch_scc0 .Lrs122
.Lrs122k:
.Lk2_e7:
  s_mul_i32 s55, s49, 4352
  v_and_b32 v3, 0x300, v2
  v_add3_u32 v1, v3, v2, s55
  v_xor_b32 v3, 256, v1
  s_add_u32 s56, s20, 0
  buffer_load_dwordx4 v[192:195], v1, s[16:19], s56 offen offset:0
  buffer_load_dwordx4 v[196:199], v3, s[16:19], s56 offen offset:0
  buffer_load_dwordx4 v[200:203], v1, s[16:19], s56 offen offset:2048
  buffer_load_dwordx4 v[204:207], v3, s[16:19], s56 offen offset:2048
  s_add_u32 s56, s20, 8192
  buffer_load_dwordx4 v[208:211], v1, s[16:19], s56 offen offset:0
  buffer_load_dwordx4 v[212:215], v3, s[16:19], s56 offen offset:0
  buffer_load_dwordx4 v[216:219], v1, s[16:19], s56 offen offset:2048
  buffer_load_dwordx4 v[220:223], v3, s[16:19], s56 offen offset:2048
  s_add_u32 s56, s20, 16384
  buffer_load_dwordx4 v[48:51], v1, s[16:19], s56 offen offset:0
  buffer_load_dwordx4 v[52:55], v3, s[16:19], s56 offen offset:0
  buffer_load_dwordx4 v[56:59], v1, s[16:19], s56 offen offset:2048
  buffer_load_dwordx4 v[60:63], v3, s[16:19], s56 offen offset:2048
  s_add_u32 s56, s20, 24576
  buffer_load_dwordx4 v[112:115], v1, s[16:19], s56 offen offset:0
  buffer_load_dwordx4 v[116:119], v3, s[16:19], s56 offen offset:0
  buffer_load_dwordx4 v[120:123], v1, s[16:19], s56 offen offset:2048
  buffer_load_dwordx4 v[124:127], v3, s[16:19], s56 offen offset:2048
  s_add_u32 s56, s20, 32768
  buffer_load_dwordx4 v[16:19], v1, s[16:19], s56 offen offset:0
  buffer_load_dwordx4 v[20:23], v3, s[16:19], s56 offen offset:0
  buffer_load_dwordx4 v[24:27], v1, s[16:19], s56 offen offset:2048
  buffer_load_dwordx4 v[28:31], v3, s[16:19], s56 offen offset:2048
.Lk2_e5:
  s_waitcnt vmcnt(0)
  s_branch .Lp3
.Lk1_s1_2:
  buffer_load_dwordx4 v15, s[20:23], s57 offen offset:3072 lds
  s_sub_u32 s55, 0xfffe8000, s63
  v_add_u32 v20, s55, v20
  v_add_u32 v21, s55, v21
  v_add_u32 v22, s55, v22
  v_add_u32 v23, s55, v23
  v_add_u32 v24, 0xffff8000, v24
  v_add_u32 v25, 0xffff8000, v25
  v_add_u32 v26, 0xffff8000, v26
  v_add_u32 v27, 0xffff8000, v27
  s_waitcnt lgkmcnt(0)
  s_waitcnt vmcnt(4)
  s_barrier
  ds_read_b128 v[48:51], v20 offset:0
  ds_read_b64_tr_b16 v[56:57], v24 offset:0
  ds_read_b64_tr_b16 v[58:59], v24 offset:1024
  s_add_u32 m0, s58, 147456
  s_cmp_lt_u32 s2, 160
  s_cselect_b32 s26, s69, 0
  s_add_u32 s57, s75, 256
  buffer_load_dwordx4 v16, s[24:27], s57 offen offset:0 lds
  ds_read_b128 v[52:55], v20 offset:4096
  ds_read_b64_tr_b16 v[60:61], v25 offset:0
  ds_read_b64_tr_b16 v[62:63], v25 offset:1024
  buffer_load_dwordx4 v17, s[24:27], s57 offen offset:1024 lds
  ds_read_b64_tr_b16 v[64:65], v26 offset:0
  ds_read_b64_tr_b16 v[66:67], v26 offset:1024
  ds_read_b64_tr_b16 v[68:69], v27 offset:0
  ds_read_b64_tr_b16 v[70:71], v27 offset:1024
  buffer_load_dwordx4 v18, s[24:27], s57 offen offset:2048 lds
  buffer_load_dwordx4 v19, s[24:27], s57 offen offset:3072 lds
  s_branch .Lk1_s1_2r
.Lk1_s1_4:
  buffer_load_dwordx4 v15, s[20:23], s57 offen offset:3072 lds
  s_cmp_ge_u32 s2, 200
  s_cbranch_scc1 .Lk1_ro1_1sl
  s_load_dwordx4 s[40:43], s[0:1], 40
  s_sub_u32 s60, s2, 160
  v_and_b32 v2, 15, v0
  v_mul_u32_u24 v2, 1280, v2
  v_lshrrev_b32 v3, 4, v0
  v_lshl_add_u32 v2, v3, 4, v2
  s_lshl_b32 s60, s60, 3
  s_add_u32 s60, s60, s52
  s_mul_i32 s55, s60, 0xcccd
  s_lshr_b32 s55, s55, 21
  s_mul_i32 s56, s55, 40
  s_sub_u32 s56, s60, s56
  s_cmp_ge_u32 s56, 20
  s_waitcnt lgkmcnt(0)
  s_cselect_b32 s44, s42, s40
  s_cselect_b32 s45, s43, s41
  s_cselect_b32 s57, 20, 0
  s_mov_b32 s46, 819200
  s_mov_b32 s47, 0x00020000
  s_sub_u32 s56, s56, s57
  s_lshl_b32 s56, s56, 6
  s_mul_i32 s55, s55, 102400
  s_add_u32 s55, s55, s56
  buffer_load_dwordx4 v[96:99], v2, s[44:47], s55 offen
  s_add_u32 s55, s55, 20480
  buffer_load_dwordx4 v[100:103], v2, s[44:47], s55 offen
  s_add_u32 s55, s55, 20480
  buffer_load_dwordx4 v[104:107], v2, s[44:47], s55 offen
  s_add_u32 s55, s55, 20480
  buffer_load_dwordx4 v[108:111], v2, s[44:47], s55 offen
  s_add_u32 s55, s55, 20480
  buffer_load_dwordx4 v[112:115], v2, s[44:47], s55 offen
.Lk1_ro1_1sl:
  s_sub_u32 s55, 0xfffe8000, s63
  v_add_u32 v20, s55, v20
  v_add_u32 v21, s55, v21
  v_add_u32 v22, s55, v22
  v_add_u32 v23, s55, v23
  v_add_u32 v24, 0xffff8000, v24
  v_add_u32 v25, 0xffff8000, v25
  v_add_u32 v26, 0xffff8000, v26
  v_add_u32 v27, 0xffff8000, v27
  s_waitcnt lgkmcnt(0)
  s_waitcnt vmcnt(4)
  s_barrier
  ds_read_b128 v[48:51], v20 offset:0
  ds_read_b64_tr_b16 v[56:57], v24 offset:0
  ds_read_b64_tr_b16 v[58:59], v24 offset:1024
  s_add_u32 m0, s58, 114688
  s_cmp_lt_u32 s2, 160
  s_cselect_b32 s26, s69, 0
  s_add_u32 s57, s75, 512
  buffer_load_dwordx4 v16, s[24:27], s57 offen offset:0 lds
  ds_read_b128 v[52:55], v20 offset:4096
  ds_read_b64_tr_b16 v[60:61], v25 offset:0
  ds_read_b64_tr_b16 v[62:63], v25 offset:1024
  buffer_load_dwordx4 v17, s[24:27], s57 offen offset:1024 lds
  ds_read_b64_tr_b16 v[64:65], v26 offset:0
  ds_read_b64_tr_b16 v[66:67], v26 offset:1024
  ds_read_b64_tr_b16 v[68:69], v27 offset:0
  ds_read_b64_tr_b16 v[70:71], v27 offset:1024
  buffer_load_dwordx4 v18, s[24:27], s57 offen offset:2048 lds
  buffer_load_dwordx4 v19, s[24:27], s57 offen offset:3072 lds
  s_branch .Lk1_s1_4r
.Lk1_s1_6:
  buffer_load_dwordx4 v15, s[20:23], s57 offen offset:3072 lds
  s_cmp_ge_u32 s2, 200
  s_cbranch_scc1 .Lk1_ro1_2s
  s_mul_i32 s55, s60, 5120
  s_add_u32 s55, s55, 73400320
  s_add_u32 s56, s55, 4096
  s_waitcnt vmcnt(0)
  buffer_store_dwordx4 v[96:99], v32, s[16:19], s55 offen offset:0 sc1
  buffer_store_dwordx4 v[100:103], v32, s[16:19], s55 offen offset:1024 sc1
  buffer_store_dwordx4 v[104:107], v32, s[16:19], s55 offen offset:2048 sc1
  buffer_store_dwordx4 v[108:111], v32, s[16:19], s55 offen offset:3072 sc1
  buffer_store_dwordx4 v[112:115], v32, s[16:19], s56 offen offset:0 sc1
.Lk1_ro1_2s:
  s_sub_u32 s55, 0x10000, s63
  v_add_u32 v20, s55, v20
  v_add_u32 v21, s55, v21
  v_add_u32 v22, s55, v22
  v_add_u32 v23, s55, v23
  v_add_u32 v24, 0xffff8000, v24
  v_add_u32 v25, 0xffff8000, v25
  v_add_u32 v26, 0xffff8000, v26
  v_add_u32 v27, 0xffff8000, v27
  s_waitcnt lgkmcnt(0)
  s_waitcnt vmcnt(4)
  s_barrier
  ds_read_b128 v[48:51], v20 offset:0
  ds_read_b64_tr_b16 v[56:57], v24 offset:0
  ds_read_b64_tr_b16 v[58:59], v24 offset:1024
  s_add_u32 m0, s58, 81920
  s_mov_b32 s26, s69
  s_add_u32 s57, s75, 768
  buffer_load_dwordx4 v16, s[24:27], s57 offen offset:0 lds
  ds_read_b128 v[52:55], v20 offset:4096
  ds_read_b64_tr_b16 v[60:61], v25 offset:0
  ds_read_b64_tr_b16 v[62:63], v25 offset:1024
  buffer_load_dwordx4 v17, s[24:27], s57 offen offset:1024 lds
  ds_read_b64_tr_b16 v[64:65], v26 offset:0
  ds_read_b64_tr_b16 v[66:67], v26 offset:1024
  ds_read_b64_tr_b16 v[68:69], v27 offset:0
  ds_read_b64_tr_b16 v[70:71], v27 offset:1024
  buffer_load_dwordx4 v18, s[24:27], s57 offen offset:2048 lds
  buffer_load_dwordx4 v19, s[24:27], s57 offen offset:3072 lds
  s_branch .Lk1_s1_6r
.Lk1_s1_8:
  buffer_load_dwordx4 v15, s[20:23], s57 offen offset:3072 lds
  s_cmp_lt_u32 s2, 176
  s_cbranch_scc1 .Lk1_ro1_3
  v_lshrrev_b32 v2, 5, v0
  v_bfe_u32 v3, v0, 4, 1
  v_lshlrev_b32 v2, 4, v2
  v_lshl_add_u32 v2, v3, 2, v2
  v_bfe_u32 v3, v0, 2, 2
  v_add_u32 v2, v2, v3
  v_lshlrev_b32 v2, 8, v2
  s_lshr_b32 s55, s52, 1
  v_xor_b32 v3, s55, v3
  v_lshl_add_u32 v2, v3, 6, v2
  v_and_b32 v3, 3, v0
  v_lshl_add_u32 v2, v3, 3, v2
  s_and_b32 s55, s52, 1
  s_lshl_b32 s55, s55, 5
  v_add_u32 v2, s55, v2
  v_add_u32 v3, 65536, v2
  v_add_u32 v2, 32768, v2
  ds_read_b64_tr_b16 v[96:97], v2 offset:0
  ds_read_b64_tr_b16 v[98:99], v2 offset:2048
  ds_read_b64_tr_b16 v[100:101], v2 offset:8192
  ds_read_b64_tr_b16 v[102:103], v2 offset:10240
  ds_read_b64_tr_b16 v[104:105], v2 offset:16384
  ds_read_b64_tr_b16 v[106:107], v2 offset:18432
  ds_read_b64_tr_b16 v[108:109], v2 offset:24576
  ds_read_b64_tr_b16 v[110:111], v2 offset:26624
  ds_read_b64_tr_b16 v[112:113], v3 offset:0
  ds_read_b64_tr_b16 v[114:115], v3 offset:2048
  ds_read_b64_tr_b16 v[116:117], v3 offset:8192
  ds_read_b64_tr_b16 v[118:119], v3 offset:10240
  ds_read_b64_tr_b16 v[120:121], v3 offset:16384
  ds_read_b64_tr_b16 v[122:123], v3 offset:18432
  ds_read_b64_tr_b16 v[124:125], v3 offset:24576
  ds_read_b64_tr_b16 v[126:127], v3 offset:26624
  s_lshl_b32 s55, s77, 3
  s_add_u32 s55, s55, s52
  s_mul_i32 s56, s55, 0xcccd
  s_lshr_b32 s56, s56, 18
  s_mul_i32 s57, s56, 5
  s_sub_u32 s57, s55, s57
  s_lshl_b32 s56, s56, 7
  s_lshl_b32 s55, s76, 2
  s_add_u32 s56, s56, s55
  s_mul_i32 s56, s56, 5
  s_add_u32 s56, s56, s57
  s_lshl_b32 s56, s56, 10
  s_add_u32 s56, s56, 67108864
  s_waitcnt lgkmcnt(8)
  buffer_store_dwordx4 v[96:99], v32, s[16:19], s56 offen sc1
  s_add_u32 s56, s56, 5120
  buffer_store_dwordx4 v[100:103], v32, s[16:19], s56 offen sc1
  s_add_u32 s56, s56, 5120
  buffer_store_dwordx4 v[104:107], v32, s[16:19], s56 offen sc1
  s_add_u32 s56, s56, 5120
  buffer_store_dwordx4 v[108:111], v32, s[16:19], s56 offen sc1
  s_lshl_b32 s55, s79, 3
  s_add_u32 s55, s55, s52
  s_mul_i32 s56, s55, 0xcccd
  s_lshr_b32 s56, s56, 18
  s_mul_i32 s57, s56, 5
  s_sub_u32 s57, s55, s57
  s_lshl_b32 s56, s56, 7
  s_lshl_b32 s55, s78, 2
  s_add_u32 s56, s56, s55
  s_mul_i32 s56, s56, 5
  s_add_u32 s56, s56, s57
  s_lshl_b32 s56, s56, 10
  s_add_u32 s56, s56, 67108864
  s_waitcnt lgkmcnt(0)
  buffer_store_dwordx4 v[112:115], v32, s[16:19], s56 offen sc1
  s_add_u32 s56, s56, 5120
  buffer_store_dwordx4 v[116:119], v32, s[16:19], s56 offen sc1
  s_add_u32 s56, s56, 5120
  buffer_store_dwordx4 v[120:123], v32, s[16:19], s56 offen sc1
  s_add_u32 s56, s56, 5120
  buffer_store_dwordx4 v[124:127], v32, s[16:19], s56 offen sc1
.Lk1_ro1_3:
  s_sub_u32 s55, 0x10000, s63
  v_add_u32 v20, s55, v20
  v_add_u32 v21, s55, v21
  v_add_u32 v22, s55, v22
  v_add_u32 v23, s55, v23
  v_add_u32 v24, 0x20000, v24
  v_add_u32 v25, 0x20000, v25
  v_add_u32 v26, 0x20000, v26
  v_add_u32 v27, 0x20000, v27
  s_waitcnt lgkmcnt(0)
  s_waitcnt vmcnt(4)
  s_barrier
  ds_read_b128 v[48:51], v20 offset:0
  ds_read_b64_tr_b16 v[56:57], v24 offset:0
  ds_read_b64_tr_b16 v[58:59], v24 offset:1024
  s_add_u32 m0, s58, 49152
  s_cmp_lt_u32 s2, 160
  s_cselect_b32 s26, s69, 0
  s_add_u32 s57, s75, 1024
  buffer_load_dwordx4 v16, s[24:27], s57 offen offset:0 lds
  ds_read_b128 v[52:55], v20 offset:4096
  ds_read_b64_tr_b16 v[60:61], v25 offset:0
  ds_read_b64_tr_b16 v[62:63], v25 offset:1024
  buffer_load_dwordx4 v17, s[24:27], s57 offen offset:1024 lds
  ds_read_b64_tr_b16 v[64:65], v26 offset:0
  ds_read_b64_tr_b16 v[66:67], v26 offset:1024
  ds_read_b64_tr_b16 v[68:69], v27 offset:0
  ds_read_b64_tr_b16 v[70:71], v27 offset:1024
  buffer_load_dwordx4 v18, s[24:27], s57 offen offset:2048 lds
  buffer_load_dwordx4 v19, s[24:27], s57 offen offset:3072 lds
  s_branch .Lk1_s1_8r
.Lk1_s1_10:
  buffer_load_dwordx4 v7, s[4:7], s57 offen offset:3072 lds
  s_sub_u32 s55, 0x10000, s63
  v_add_u32 v20, s55, v20
  v_add_u32 v21, s55, v21
  v_add_u32 v22, s55, v22
  v_add_u32 v23, s55, v23
  v_add_u32 v24, 0xffff8000, v24
  v_add_u32 v25, 0xffff8000, v25
  v_add_u32 v26, 0xffff8000, v26
  v_add_u32 v27, 0xffff8000, v27
  s_waitcnt lgkmcnt(0)
  s_waitcnt vmcnt(4)
  s_barrier
  ds_read_b128 v[48:51], v20 offset:0
  ds_read_b64_tr_b16 v[56:57], v24 offset:0
  ds_read_b64_tr_b16 v[58:59], v24 offset:1024
  s_add_u32 m0, s58, 16384
  s_mov_b32 s57, 3670016
  buffer_load_dwordx4 v8, s[12:15], s57 offen offset:0 lds
  ds_read_b128 v[52:55], v20 offset:4096
  ds_read_b64_tr_b16 v[60:61], v25 offset:0
  ds_read_b64_tr_b16 v[62:63], v25 offset:1024
  buffer_load_dwordx4 v9, s[12:15], s57 offen offset:1024 lds
  ds_read_b64_tr_b16 v[64:65], v26 offset:0
  ds_read_b64_tr_b16 v[66:67], v26 offset:1024
  ds_read_b64_tr_b16 v[68:69], v27 offset:0
  ds_read_b64_tr_b16 v[70:71], v27 offset:1024
  buffer_load_dwordx4 v10, s[12:15], s57 offen offset:2048 lds
  buffer_load_dwordx4 v11, s[12:15], s57 offen offset:3072 lds
  s_branch .Lk1_s1_10r
.Ldc56s:
  s_sub_u32 s95, s95, 1
  s_cselect_b32 s95, 0, s95
  s_cbranch_scc1 .Ldc56k
  s_sleep 1
  buffer_load_dword v41, v42, s[28:31], 0 offen sc0 sc1
  s_waitcnt vmcnt(0)
  s_branch .Ldc56c
.Lkv57g:
  buffer_store_dwordx4 v[192:195], v32, s[80:83], s55 offen offset:0 sc1
  s_branch .Lkv57r
.Lkv58g:
  buffer_store_dwordx4 v[196:199], v32, s[80:83], s55 offen offset:1024 sc1
  s_branch .Lkv58r
.Lkv59g:
  buffer_store_dwordx4 v[192:195], v32, s[84:87], s55 offen offset:0 sc1
  s_branch .Lkv59r
.Lkv60g:
  buffer_store_dwordx4 v[200:203], v32, s[80:83], s55 offen offset:0 sc1
  s_branch .Lkv60r
.Lkv61g:
  buffer_store_dwordx4 v[204:207], v32, s[80:83], s55 offen offset:1024 sc1
  s_branch .Lkv61r
.Lkv62g:
  buffer_store_dwordx4 v[196:199], v32, s[84:87], s55 offen offset:1024 sc1
  s_branch .Lkv62r
.Lkv63g:
  buffer_store_dwordx4 v[208:211], v32, s[80:83], s55 offen offset:2048 sc1
  s_branch .Lkv63r
.Lkv64g:
  buffer_store_dwordx4 v[212:215], v32, s[80:83], s55 offen offset:3072 sc1
  s_branch .Lkv64r
.Lkv65g:
  buffer_store_dwordx4 v[216:219], v32, s[80:83], s55 offen offset:2048 sc1
  s_branch .Lkv65r
.Lkv66g:
  buffer_store_dwordx4 v[200:203], v32, s[84:87], s55 offen offset:0 sc1
  s_branch .Lkv66r
.Lkv67g:
  buffer_store_dwordx4 v[220:223], v32, s[80:83], s55 offen offset:3072 sc1
  s_branch .Lkv67r
.Lkv68g:
  buffer_store_dwordx4 v[224:227], v32, s[80:83], s55 offen offset:0 sc1
  s_branch .Lkv68r
.Lkv69g:
  buffer_store_dwordx4 v[228:231], v32, s[80:83], s55 offen offset:1024 sc1
  s_branch .Lkv69r
.Lkv70g:
  buffer_store_dwordx4 v[204:207], v32, s[84:87], s55 offen offset:1024 sc1
  s_branch .Lkv70r
.Lpl71s:
  s_sub_u32 s95, s95, 1
  s_cselect_b32 s95, 0, s95
  s_cbranch_scc1 .Lpl71k
  s_sleep 4
  buffer_load_dword v41, v33, s[36:39], 0 offen sc0 sc1
  s_waitcnt vmcnt(0)
  s_branch .Lpl71c
.Lkv72g:
  buffer_store_dwordx4 v[232:235], v32, s[80:83], s55 offen offset:0 sc1
  s_branch .Lkv72r
.Lkv73g:
  buffer_store_dwordx4 v[236:239], v32, s[80:83], s55 offen offset:1024 sc1
  s_branch .Lkv73r
.Lkv74g:
  buffer_store_dwordx4 v[240:243], v32, s[80:83], s55 offen offset:2048 sc1
  s_branch .Lkv74r
.Lkv75g:
  buffer_store_dwordx4 v[208:211], v32, s[84:87], s55 offen offset:2048 sc1
  s_branch .Lkv75r
.Lkv76g:
  buffer_store_dwordx4 v[244:247], v32, s[80:83], s55 offen offset:3072 sc1
  s_branch .Lkv76r
.Lkv77g:
  buffer_store_dwordx4 v[248:251], v32, s[80:83], s55 offen offset:2048 sc1
  s_branch .Lkv77r
.Lkv78g:
  buffer_store_dwordx4 v[212:215], v32, s[84:87], s55 offen offset:3072 sc1
  s_branch .Lkv78r
.Lkv79g:
  buffer_store_dwordx4 v[252:255], v32, s[80:83], s55 offen offset:3072 sc1
  s_branch .Lkv79r
.Lkv80g:
  buffer_store_dwordx4 v[216:219], v32, s[84:87], s55 offen offset:2048 sc1
  s_branch .Lkv80r
.Lkv81g:
  buffer_store_dwordx4 v[220:223], v32, s[84:87], s55 offen offset:3072 sc1
  s_branch .Lkv81r
.Lkv82g:
  buffer_store_dwordx4 v[224:227], v32, s[84:87], s55 offen offset:0 sc1
  s_branch .Lkv82r
.Lkv83g:
  buffer_store_dwordx4 v[228:231], v32, s[84:87], s55 offen offset:1024 sc1
  s_branch .Lkv83r
.Lkv84g:
  buffer_store_dwordx4 v[232:235], v32, s[84:87], s55 offen offset:0 sc1
  s_branch .Lkv84r
.Lkv85g:
  buffer_store_dwordx4 v[236:239], v32, s[84:87], s55 offen offset:1024 sc1
  s_branch .Lkv85r
.Lkv86g:
  buffer_store_dwordx4 v[240:243], v32, s[84:87], s55 offen offset:2048 sc1
  s_branch .Lkv86r
.Lpl87s:
  s_sub_u32 s95, s95, 1
  s_cselect_b32 s95, 0, s95
  s_cbranch_scc1 .Lpl87k
  s_sleep 4
  buffer_load_dword v41, v33, s[16:19], s88 offen sc0 sc1
  s_waitcnt vmcnt(0)
  s_branch .Lpl87c
.Lkv88g:
  buffer_store_dwordx4 v[244:247], v32, s[84:87], s55 offen offset:3072 sc1
  s_branch .Lkv88r
.Lkv89g:
  buffer_store_dwordx4 v[248:251], v32, s[84:87], s55 offen offset:2048 sc1
  s_branch .Lkv89r
.Lkv90g:
  buffer_store_dwordx4 v[252:255], v32, s[84:87], s55 offen offset:3072 sc1
  s_branch .Lkv90r
.Lkc91a:
  s_cmp_lg_u32 s100, 0
  s_cbranch_scc1 .Lkc91c
  s_mov_b32 s100, 1
  s_mov_b32 s101, 0
  buffer_load_dword v122, v123, s[16:19], s88 offen sc0 sc1
  s_branch .Lkc91k
.Lkc91c:
  v_cmp_ne_u32 vcc, 0x01010101, v122
  s_nop 0
  s_cbranch_vccz .Lkc91k
  s_sub_u32 s95, s95, 1
  s_cselect_b32 s95, 0, s95
  s_cbranch_scc1 .Lkc91k
  s_sleep 1
  buffer_load_dword v122, v123, s[16:19], s88 offen sc0 sc1
  s_waitcnt vmcnt(0)
  s_branch .Lkc91c
.Lkc92a:
  s_cmp_lg_u32 s100, 0
  s_cbranch_scc1 .Lkc92c
  s_mov_b32 s100, 1
  s_mov_b32 s101, 0
  buffer_load_dword v122, v123, s[16:19], s88 offen sc0 sc1
  s_branch .Lkc92k
.Lkc92c:
  v_cmp_ne_u32 vcc, 0x01010101, v122
  s_nop 0
  s_cbranch_vccz .Lkc92k
  s_sub_u32 s95, s95, 1
  s_cselect_b32 s95, 0, s95
  s_cbranch_scc1 .Lkc92k
  s_sleep 1
  buffer_load_dword v122, v123, s[16:19], s88 offen sc0 sc1
  s_waitcnt vmcnt(0)
  s_branch .Lkc92c
.Lpl97s:
  s_sub_u32 s95, s95, 1
  s_cselect_b32 s95, 0, s95
  s_cbranch_scc1 .Lpl97k
  s_sleep 4
  buffer_load_dword v112, v114, s[16:19], 0 offen sc0 sc1
  s_waitcnt vmcnt(0)
  s_branch .Lpl97c
.Lsv96p:
.Lpl97c:
  v_and_b32 v12, v112, v113
  v_cmp_ne_u32 vcc, v12, v113
  s_nop 0
  s_cbranch_vccnz .Lpl97s
.Lpl97k:
  s_branch .Lsv96q
.Lkc98a:
  s_cmp_lg_u32 s100, 0
  s_cbranch_scc1 .Lkc98c
  s_mov_b32 s100, 1
  s_mov_b32 s101, 0
  buffer_load_dword v122, v123, s[16:19], s88 offen sc0 sc1
  s_branch .Lkc98k
.Lkc98c:
  v_cmp_ne_u32 vcc, 0x01010101, v122
  s_nop 0
  s_cbranch_vccz .Lkc98k
  s_sub_u32 s95, s95, 1
  s_cselect_b32 s95, 0, s95
  s_cbranch_scc1 .Lkc98k
  s_sleep 1
  buffer_load_dword v122, v123, s[16:19], s88 offen sc0 sc1
  s_waitcnt vmcnt(0)
  s_branch .Lkc98c
.Lpl105s:
  s_sub_u32 s95, s95, 1
  s_cselect_b32 s95, 0, s95
  s_cbranch_scc1 .Lpl105k
  s_sleep 4
  buffer_load_dword v112, v114, s[16:19], 0 offen sc0 sc1
  s_waitcnt vmcnt(0)
  s_branch .Lpl105c
.Lsv104p:
.Lpl105c:
  v_and_b32 v12, v112, v113
  v_cmp_ne_u32 vcc, v12, v113
  s_nop 0
  s_cbranch_vccnz .Lpl105s
.Lpl105k:
  s_branch .Lsv104q
.Lkc108a:
  s_cmp_lg_u32 s100, 0
  s_cbranch_scc1 .Lkc108c
  s_mov_b32 s100, 1
  s_mov_b32 s101, 0
  buffer_load_dword v122, v123, s[16:19], s88 offen sc0 sc1
  s_branch .Lkc108k
.Lkc108c:
  v_cmp_ne_u32 vcc, 0x01010101, v122
  s_nop 0
  s_cbranch_vccz .Lkc108k
  s_sub_u32 s95, s95, 1
  s_cselect_b32 s95, 0, s95
  s_cbranch_scc1 .Lkc108k
  s_sleep 1
  buffer_load_dword v122, v123, s[16:19], s88 offen sc0 sc1
  s_waitcnt vmcnt(0)
  s_branch .Lkc108c
.Lpl115s:
  s_sub_u32 s95, s95, 1
  s_cselect_b32 s95, 0, s95
  s_cbranch_scc1 .Lpl115k
  s_sleep 4
  buffer_load_dword v112, v114, s[16:19], 0 offen sc0 sc1
  s_waitcnt vmcnt(0)
  s_branch .Lpl115c
.Lsv114p:
.Lpl115c:
  v_and_b32 v12, v112, v113
  v_cmp_ne_u32 vcc, v12, v113
  s_nop 0
  s_cbranch_vccnz .Lpl115s
.Lpl115k:
  s_branch .Lsv114q
.Lkc118a:
  s_cmp_lg_u32 s100, 0
  s_cbranch_scc1 .Lkc118c
  s_mov_b32 s100, 1
  s_mov_b32 s101, 0
  buffer_load_dword v122, v123, s[16:19], s88 offen sc0 sc1
  s_branch .Lkc118k
.Lkc118c:
  v_cmp_ne_u32 vcc, 0x01010101, v122
  s_nop 0
  s_cbranch_vccz .Lkc118k
  s_sub_u32 s95, s95, 1
  s_cselect_b32 s95, 0, s95
  s_cbranch_scc1 .Lkc118k
  s_sleep 1
  buffer_load_dword v122, v123, s[16:19], s88 offen sc0 sc1
  s_waitcnt vmcnt(0)
  s_branch .Lkc118c
.Lpl121s:
  s_sub_u32 s95, s95, 1
  s_cselect_b32 s95, 0, s95
  s_cbranch_scc1 .Lpl121k
  s_sleep 4
  buffer_load_dword v116, v118, s[16:19], s47 offen sc0 sc1
  s_waitcnt vmcnt(0)
  s_branch .Lpl121c
.Lk2_safe:
  s_waitcnt vmcnt(0) lgkmcnt(0)
  v_and_b32 v3, 31, v0
  v_lshrrev_b32 v5, 5, v0
  v_lshlrev_b32 v5, 2, v5
  v_sub_u32 v3, v3, v5
  v_mov_b32 v13, 0xff61b1e6
  v_mov_b32 v4, 0
  v_mov_b32 v128, 0
  v_mov_b32 v129, 0
  v_mov_b32 v130, 0
  v_mov_b32 v131, 0
  v_mov_b32 v132, 0
  v_mov_b32 v133, 0
  v_mov_b32 v134, 0
  v_mov_b32 v135, 0
  v_mov_b32 v136, 0
  v_mov_b32 v137, 0
  v_mov_b32 v138, 0
  v_mov_b32 v139, 0
  v_mov_b32 v140, 0
  v_mov_b32 v141, 0
  v_mov_b32 v142, 0
  v_mov_b32 v143, 0
  v_mov_b32 v144, 0
  v_mov_b32 v145, 0
  v_mov_b32 v146, 0
  v_mov_b32 v147, 0
  v_mov_b32 v148, 0
  v_mov_b32 v149, 0
  v_mov_b32 v150, 0
  v_mov_b32 v151, 0
  v_mov_b32 v152, 0
  v_mov_b32 v153, 0
  v_mov_b32 v154, 0
  v_mov_b32 v155, 0
  v_mov_b32 v156, 0
  v_mov_b32 v157, 0
  v_mov_b32 v158, 0
  v_mov_b32 v159, 0
  v_mov_b32 v160, 0
  v_mov_b32 v161, 0
  v_mov_b32 v162, 0
  v_mov_b32 v163, 0
  v_mov_b32 v164, 0
  v_mov_b32 v165, 0
  v_mov_b32 v166, 0
  v_mov_b32 v167, 0
  v_mov_b32 v168, 0
  v_mov_b32 v169, 0
  v_mov_b32 v170, 0
  v_mov_b32 v171, 0
  v_mov_b32 v172, 0
  v_mov_b32 v173, 0
  v_mov_b32 v174, 0
  v_mov_b32 v175, 0
  v_mov_b32 v176, 0
  v_mov_b32 v177, 0
  v_mov_b32 v178, 0
  v_mov_b32 v179, 0
  v_mov_b32 v180, 0
  v_mov_b32 v181, 0
  v_mov_b32 v182, 0
  v_mov_b32 v183, 0
  v_mov_b32 v184, 0
  v_mov_b32 v185, 0
  v_mov_b32 v186, 0
  v_mov_b32 v187, 0
  v_mov_b32 v188, 0
  v_mov_b32 v189, 0
  v_mov_b32 v190, 0
  v_mov_b32 v191, 0
  v_mov_b32 v48, 0
  v_mov_b32 v49, 0
  v_mov_b32 v50, 0
  v_mov_b32 v51, 0
  v_mov_b32 v52, 0
  v_mov_b32 v53, 0
  v_mov_b32 v54, 0
  v_mov_b32 v55, 0
  v_mov_b32 v56, 0
  v_mov_b32 v57, 0
  v_mov_b32 v58, 0
  v_mov_b32 v59, 0
  v_mov_b32 v60, 0
  v_mov_b32 v61, 0
  v_mov_b32 v62, 0
  v_mov_b32 v63, 0
  s_lshl_b32 s68, s53, 20
  s_mov_b32 s79, s78
.Lk2_sl:
  buffer_load_dwordx4 v[192:195], v2, s[16:19], s68 offen offset:0
  buffer_load_dwordx4 v[196:199], v2, s[16:19], s68 offen offset:1024
  buffer_load_dwordx4 v[200:203], v2, s[16:19], s68 offen offset:2048
  buffer_load_dwordx4 v[204:207], v2, s[16:19], s68 offen offset:3072
  s_add_u32 s68, s68, 4096
  buffer_load_dwordx4 v[208:211], v2, s[16:19], s68 offen offset:0
  buffer_load_dwordx4 v[212:215], v2, s[16:19], s68 offen offset:1024
  buffer_load_dwordx4 v[216:219], v2, s[16:19], s68 offen offset:2048
  buffer_load_dwordx4 v[220:223], v2, s[16:19], s68 offen offset:3072
  s_add_u32 s68, s68, 4096
  buffer_load_dwordx4 v[224:227], v2, s[16:19], s68 offen offset:0
  buffer_load_dwordx4 v[228:231], v2, s[16:19], s68 offen offset:1024
  buffer_load_dwordx4 v[232:235], v2, s[16:19], s68 offen offset:2048
  buffer_load_dwordx4 v[236:239], v2, s[16:19], s68 offen offset:3072
  s_add_u32 s68, s68, 4096
  buffer_load_dwordx4 v[240:243], v2, s[16:19], s68 offen offset:0
  buffer_load_dwordx4 v[244:247], v2, s[16:19], s68 offen offset:1024
  buffer_load_dwordx4 v[248:251], v2, s[16:19], s68 offen offset:2048
  buffer_load_dwordx4 v[252:255], v2, s[16:19], s68 offen offset:3072
  s_add_u32 s68, s68, 4096
  s_cmp_lg_u32 s79, 0
  s_cbranch_scc1 .Lk2_sm
  v_mov_b32 v12, 0xf149f2ca
  v_cmp_gt_i32 vcc, 0, v3
  s_nop 1
  v_cndmask_b32 v48, v48, v12, vcc
  v_cmp_gt_i32 vcc, 1, v3
  s_nop 1
  v_cndmask_b32 v49, v49, v12, vcc
  v_cmp_gt_i32 vcc, 2, v3
  s_nop 1
  v_cndmask_b32 v50, v50, v12, vcc
  v_cmp_gt_i32 vcc, 3, v3
  s_nop 1
  v_cndmask_b32 v51, v51, v12, vcc
  v_cmp_gt_i32 vcc, 8, v3
  s_nop 1
  v_cndmask_b32 v52, v52, v12, vcc
  v_cmp_gt_i32 vcc, 9, v3
  s_nop 1
  v_cndmask_b32 v53, v53, v12, vcc
  v_cmp_gt_i32 vcc, 10, v3
  s_nop 1
  v_cndmask_b32 v54, v54, v12, vcc
  v_cmp_gt_i32 vcc, 11, v3
  s_nop 1
  v_cndmask_b32 v55, v55, v12, vcc
  v_cmp_gt_i32 vcc, 16, v3
  s_nop 1
  v_cndmask_b32 v56, v56, v12, vcc
  v_cmp_gt_i32 vcc, 17, v3
  s_nop 1
  v_cndmask_b32 v57, v57, v12, vcc
  v_cmp_gt_i32 vcc, 18, v3
  s_nop 1
  v_cndmask_b32 v58, v58, v12, vcc
  v_cmp_gt_i32 vcc, 19, v3
  s_nop 1
  v_cndmask_b32 v59, v59, v12, vcc
  v_cmp_gt_i32 vcc, 24, v3
  s_nop 1
  v_cndmask_b32 v60, v60, v12, vcc
  v_cmp_gt_i32 vcc, 25, v3
  s_nop 1
  v_cndmask_b32 v61, v61, v12, vcc
  v_cmp_gt_i32 vcc, 26, v3
  s_nop 1
  v_cndmask_b32 v62, v62, v12, vcc
  v_cmp_gt_i32 vcc, 27, v3
  s_nop 1
  v_cndmask_b32 v63, v63, v12, vcc
.Lk2_sm:
  s_waitcnt vmcnt(0)
  s_nop 0
  v_mfma_f32_32x32x16_bf16 v[64:79], v[192:195], v[16:19], v[48:63]
  v_mfma_f32_32x32x16_bf16 v[64:79], v[196:199], v[20:23], v[64:79]
  v_mfma_f32_32x32x16_bf16 v[64:79], v[200:203], v[24:27], v[64:79]
  v_mfma_f32_32x32x16_bf16 v[64:79], v[204:207], v[28:31], v[64:79]
  v_mfma_f32_32x32x16_bf16 v[64:79], v[208:211], v[32:35], v[64:79]
  v_mfma_f32_32x32x16_bf16 v[64:79], v[212:215], v[36:39], v[64:79]
  v_mfma_f32_32x32x16_bf16 v[64:79], v[216:219], v[40:43], v[64:79]
  v_mfma_f32_32x32x16_bf16 v[64:79], v[220:223], v[44:47], v[64:79]
  s_nop 11
  v_max3_f32 v6, v64, v65, v66
  v_max3_f32 v7, v67, v68, v69
  v_max3_f32 v6, v6, v70, v71
  v_max3_f32 v7, v7, v72, v73
  v_max3_f32 v6, v6, v74, v75
  v_max3_f32 v7, v7, v76, v77
  v_max3_f32 v6, v6, v78, v79
  v_max_f32 v6, v6, v7
  v_mov_b32 v7, v6
  s_nop 1
  v_permlane32_swap_b32 v7, v6
  s_nop 1
  v_max_f32 v7, v6, v7
  v_max_f32 v7, v7, v13
  v_sub_f32 v8, v13, v7
  v_exp_f32 v8, v8
  v_mov_b32 v13, v7
  v_mul_f32 v128, v128, v8
  v_mul_f32 v129, v129, v8
  v_mul_f32 v130, v130, v8
  v_mul_f32 v131, v131, v8
  v_mul_f32 v132, v132, v8
  v_mul_f32 v133, v133, v8
  v_mul_f32 v134, v134, v8
  v_mul_f32 v135, v135, v8
  v_mul_f32 v136, v136, v8
  v_mul_f32 v137, v137, v8
  v_mul_f32 v138, v138, v8
  v_mul_f32 v139, v139, v8
  v_mul_f32 v140, v140, v8
  v_mul_f32 v141, v141, v8
  v_mul_f32 v142, v142, v8
  v_mul_f32 v143, v143, v8
  v_mul_f32 v144, v144, v8
  v_mul_f32 v145, v145, v8
  v_mul_f32 v146, v146, v8
  v_mul_f32 v147, v147, v8
  v_mul_f32 v148, v148, v8
  v_mul_f32 v149, v149, v8
  v_mul_f32 v150, v150, v8
  v_mul_f32 v151, v151, v8
  v_mul_f32 v152, v152, v8
  v_mul_f32 v153, v153, v8
  v_mul_f32 v154, v154, v8
  v_mul_f32 v155, v155, v8
  v_mul_f32 v156, v156, v8
  v_mul_f32 v157, v157, v8
  v_mul_f32 v158, v158, v8
  v_mul_f32 v159, v159, v8
  v_mul_f32 v160, v160, v8
  v_mul_f32 v161, v161, v8
  v_mul_f32 v162, v162, v8
  v_mul_f32 v163, v163, v8
  v_mul_f32 v164, v164, v8
  v_mul_f32 v165, v165, v8
  v_mul_f32 v166, v166, v8
  v_mul_f32 v167, v167, v8
  v_mul_f32 v168, v168, v8
  v_mul_f32 v169, v169, v8
  v_mul_f32 v170, v170, v8
  v_mul_f32 v171, v171, v8
  v_mul_f32 v172, v172, v8
  v_mul_f32 v173, v173, v8
  v_mul_f32 v174, v174, v8
  v_mul_f32 v175, v175, v8
  v_mul_f32 v176, v176, v8
  v_mul_f32 v177, v177, v8
  v_mul_f32 v178, v178, v8
  v_mul_f32 v179, v179, v8
  v_mul_f32 v180, v180, v8
  v_mul_f32 v181, v181, v8
  v_mul_f32 v182, v182, v8
  v_mul_f32 v183, v183, v8
  v_mul_f32 v184, v184, v8
  v_mul_f32 v185, v185, v8
  v_mul_f32 v186, v186, v8
  v_mul_f32 v187, v187, v8
  v_mul_f32 v188, v188, v8
  v_mul_f32 v189, v189, v8
  v_mul_f32 v190, v190, v8
  v_mul_f32 v191, v191, v8
  v_mul_f32 v4, v4, v8
  v_sub_f32 v64, v64, v13
  v_sub_f32 v65, v65, v13
  v_sub_f32 v66, v66, v13
  v_sub_f32 v67, v67, v13
  v_sub_f32 v68, v68, v13
  v_sub_f32 v69, v69, v13
  v_sub_f32 v70, v70, v13
  v_sub_f32 v71, v71, v13
  v_sub_f32 v72, v72, v13
  v_sub_f32 v73, v73, v13
  v_sub_f32 v74, v74, v13
  v_sub_f32 v75, v75, v13
  v_sub_f32 v76, v76, v13
  v_sub_f32 v77, v77, v13
  v_sub_f32 v78, v78, v13
  v_sub_f32 v79, v79, v13
  v_exp_f32 v64, v64
  v_exp_f32 v65, v65
  v_exp_f32 v66, v66
  v_exp_f32 v67, v67
  v_exp_f32 v68, v68
  v_exp_f32 v69, v69
  v_exp_f32 v70, v70
  v_exp_f32 v71, v71
  v_exp_f32 v72, v72
  v_exp_f32 v73, v73
  v_exp_f32 v74, v74
  v_exp_f32 v75, v75
  v_exp_f32 v76, v76
  v_exp_f32 v77, v77
  v_exp_f32 v78, v78
  v_exp_f32 v79, v79
  v_add_f32 v4, v4, v64
  v_add_f32 v4, v4, v65
  v_add_f32 v4, v4, v66
  v_add_f32 v4, v4, v67
  v_add_f32 v4, v4, v68
  v_add_f32 v4, v4, v69
  v_add_f32 v4, v4, v70
  v_add_f32 v4, v4, v71
  v_add_f32 v4, v4, v72
  v_add_f32 v4, v4, v73
  v_add_f32 v4, v4, v74
  v_add_f32 v4, v4, v75
  v_add_f32 v4, v4, v76
  v_add_f32 v4, v4, v77
  v_add_f32 v4, v4, v78
  v_add_f32 v4, v4, v79
  v_cvt_pk_bf16_f32 v96, v64, v65
  v_cvt_pk_bf16_f32 v97, v66, v67
  v_cvt_pk_bf16_f32 v98, v68, v69
  v_cvt_pk_bf16_f32 v99, v70, v71
  v_cvt_pk_bf16_f32 v100, v72, v73
  v_cvt_pk_bf16_f32 v101, v74, v75
  v_cvt_pk_bf16_f32 v102, v76, v77
  v_cvt_pk_bf16_f32 v103, v78, v79
  v_mfma_f32_32x32x16_bf16 v[128:143], v[224:227], v[96:99], v[128:143]
  v_mfma_f32_32x32x16_bf16 v[144:159], v[232:235], v[96:99], v[144:159]
  v_mfma_f32_32x32x16_bf16 v[160:175], v[240:243], v[96:99], v[160:175]
  v_mfma_f32_32x32x16_bf16 v[176:191], v[248:251], v[96:99], v[176:191]
  v_mfma_f32_32x32x16_bf16 v[128:143], v[228:231], v[100:103], v[128:143]
  v_mfma_f32_32x32x16_bf16 v[144:159], v[236:239], v[100:103], v[144:159]
  v_mfma_f32_32x32x16_bf16 v[160:175], v[244:247], v[100:103], v[160:175]
  v_mfma_f32_32x32x16_bf16 v[176:191], v[252:255], v[100:103], v[176:191]
  s_sub_u32 s79, s79, 1
  s_cbranch_scc0 .Lk2_sl
  v_mov_b32 v12, v4
  s_nop 1
  v_permlane32_swap_b32 v12, v4
  s_nop 1
  v_add_f32 v4, v4, v12
  v_rcp_f32 v4, v4
  s_lshl_b32 s55, s78, 5
  s_add_u32 s55, s55, s53
  s_lshl_b32 s55, s55, 13
  s_add_u32 s55, s55, 50331648
  s_add_u32 s56, s55, 4096
  v_mov_b32 v5, v4
  v_pk_mul_f32 v[128:129], v[128:129], v[4:5]
  v_pk_mul_f32 v[130:131], v[130:131], v[4:5]
  v_pk_mul_f32 v[132:133], v[132:133], v[4:5]
  v_pk_mul_f32 v[134:135], v[134:135], v[4:5]
  v_pk_mul_f32 v[136:137], v[136:137], v[4:5]
  v_pk_mul_f32 v[138:139], v[138:139], v[4:5]
  v_pk_mul_f32 v[140:141], v[140:141], v[4:5]
  v_pk_mul_f32 v[142:143], v[142:143], v[4:5]
  v_cvt_pk_bf16_f32 v128, v128, v129
  v_cvt_pk_bf16_f32 v129, v130, v131
  v_cvt_pk_bf16_f32 v130, v132, v133
  v_cvt_pk_bf16_f32 v131, v134, v135
  v_cvt_pk_bf16_f32 v132, v136, v137
  v_cvt_pk_bf16_f32 v133, v138, v139
  v_cvt_pk_bf16_f32 v134, v140, v141
  v_cvt_pk_bf16_f32 v135, v142, v143
  buffer_store_dwordx4 v[128:131], v2, s[16:19], s55 offen offset:0 sc1
  buffer_store_dwordx4 v[132:135], v2, s[16:19], s55 offen offset:1024 sc1
  v_pk_mul_f32 v[144:145], v[144:145], v[4:5]
  v_pk_mul_f32 v[146:147], v[146:147], v[4:5]
  v_pk_mul_f32 v[148:149], v[148:149], v[4:5]
  v_pk_mul_f32 v[150:151], v[150:151], v[4:5]
  v_pk_mul_f32 v[152:153], v[152:153], v[4:5]
  v_pk_mul_f32 v[154:155], v[154:155], v[4:5]
  v_pk_mul_f32 v[156:157], v[156:157], v[4:5]
  v_pk_mul_f32 v[158:159], v[158:159], v[4:5]
  v_cvt_pk_bf16_f32 v144, v144, v145
  v_cvt_pk_bf16_f32 v145, v146, v147
  v_cvt_pk_bf16_f32 v146, v148, v149
  v_cvt_pk_bf16_f32 v147, v150, v151
  v_cvt_pk_bf16_f32 v148, v152, v153
  v_cvt_pk_bf16_f32 v149, v154, v155
  v_cvt_pk_bf16_f32 v150, v156, v157
  v_cvt_pk_bf16_f32 v151, v158, v159
  buffer_store_dwordx4 v[144:147], v2, s[16:19], s55 offen offset:2048 sc1
  buffer_store_dwordx4 v[148:151], v2, s[16:19], s55 offen offset:3072 sc1
  v_pk_mul_f32 v[160:161], v[160:161], v[4:5]
  v_pk_mul_f32 v[162:163], v[162:163], v[4:5]
  v_pk_mul_f32 v[164:165], v[164:165], v[4:5]
  v_pk_mul_f32 v[166:167], v[166:167], v[4:5]
  v_pk_mul_f32 v[168:169], v[168:169], v[4:5]
  v_pk_mul_f32 v[170:171], v[170:171], v[4:5]
  v_pk_mul_f32 v[172:173], v[172:173], v[4:5]
  v_pk_mul_f32 v[174:175], v[174:175], v[4:5]
  v_cvt_pk_bf16_f32 v160, v160, v161
  v_cvt_pk_bf16_f32 v161, v162, v163
  v_cvt_pk_bf16_f32 v162, v164, v165
  v_cvt_pk_bf16_f32 v163, v166, v167
  v_cvt_pk_bf16_f32 v164, v168, v169
  v_cvt_pk_bf16_f32 v165, v170, v171
  v_cvt_pk_bf16_f32 v166, v172, v173
  v_cvt_pk_bf16_f32 v167, v174, v175
  buffer_store_dwordx4 v[160:163], v2, s[16:19], s56 offen offset:0 sc1
  buffer_store_dwordx4 v[164:167], v2, s[16:19], s56 offen offset:1024 sc1
  v_pk_mul_f32 v[176:177], v[176:177], v[4:5]
  v_pk_mul_f32 v[178:179], v[178:179], v[4:5]
  v_pk_mul_f32 v[180:181], v[180:181], v[4:5]
  v_pk_mul_f32 v[182:183], v[182:183], v[4:5]
  v_pk_mul_f32 v[184:185], v[184:185], v[4:5]
  v_pk_mul_f32 v[186:187], v[186:187], v[4:5]
  v_pk_mul_f32 v[188:189], v[188:189], v[4:5]
  v_pk_mul_f32 v[190:191], v[190:191], v[4:5]
  v_cvt_pk_bf16_f32 v176, v176, v177
  v_cvt_pk_bf16_f32 v177, v178, v179
  v_cvt_pk_bf16_f32 v178, v180, v181
  v_cvt_pk_bf16_f32 v179, v182, v183
  v_cvt_pk_bf16_f32 v180, v184, v185
  v_cvt_pk_bf16_f32 v181, v186, v187
  v_cvt_pk_bf16_f32 v182, v188, v189
  v_cvt_pk_bf16_f32 v183, v190, v191
  buffer_store_dwordx4 v[176:179], v2, s[16:19], s56 offen offset:2048 sc1
  buffer_store_dwordx4 v[180:183], v2, s[16:19], s56 offen offset:3072 sc1
  s_cmp_ge_u32 s52, 4
  s_cbranch_scc1 .Lk2s_sd
  v_mov_b32 v64, 0
  v_mov_b32 v65, 0
  v_mov_b32 v66, 0
  v_mov_b32 v67, 0
  v_mov_b32 v68, 0
  v_mov_b32 v69, 0
  v_mov_b32 v70, 0
  v_mov_b32 v71, 0
  v_mov_b32 v72, 0
  v_mov_b32 v73, 0
  v_mov_b32 v74, 0
  v_mov_b32 v75, 0
  v_mov_b32 v76, 0
  v_mov_b32 v77, 0
  v_mov_b32 v78, 0
  v_mov_b32 v79, 0
  v_mov_b32 v80, 0
  v_mov_b32 v81, 0
  v_mov_b32 v82, 0
  v_mov_b32 v83, 0
  v_mov_b32 v84, 0
  v_mov_b32 v85, 0
  v_mov_b32 v86, 0
  v_mov_b32 v87, 0
  v_mov_b32 v88, 0
  v_mov_b32 v89, 0
  v_mov_b32 v90, 0
  v_mov_b32 v91, 0
  v_mov_b32 v92, 0
  v_mov_b32 v93, 0
  v_mov_b32 v94, 0
  v_mov_b32 v95, 0
  v_mov_b32 v96, 0
  v_mov_b32 v97, 0
  v_mov_b32 v98, 0
  v_mov_b32 v99, 0
  v_mov_b32 v100, 0
  v_mov_b32 v101, 0
  v_mov_b32 v102, 0
  v_mov_b32 v103, 0
  s_branch .Lk2l_x
.Lp3:
  v_add_u32 v4, s41, v2
  s_mul_i32 s57, s49, 10240
  s_add_u32 s57, s57, 131072
  v_add_u32 v6, s57, v2
  s_cmp_ge_u32 s44, 2
  s_cbranch_scc1 .Lp3_r2
  s_cmp_eq_u32 s44, 1
  s_cbranch_scc1 .Lp3_r1
  s_barrier
  ds_read_b128 v[168:171], v6 offset:0
  ds_read_b128 v[172:175], v6 offset:1024
  ds_read_b128 v[176:179], v6 offset:2048
  ds_read_b128 v[180:183], v6 offset:3072
  ds_read_b128 v[184:187], v6 offset:4096
  s_cmp_ge_u32 s52, 4
  s_cbranch_scc1 .Lp3_x0
  s_add_u32 s56, s20, 24576
  buffer_load_dwordx4 v[112:115], v1, s[16:19], s56 offen offset:0
  buffer_load_dwordx4 v[116:119], v3, s[16:19], s56 offen offset:0
  s_add_u32 s56, s20, 24576
  buffer_load_dwordx4 v[120:123], v1, s[16:19], s56 offen offset:2048
  buffer_load_dwordx4 v[124:127], v3, s[16:19], s56 offen offset:2048
  s_add_u32 s56, s20, 32768
  buffer_load_dwordx4 v[16:19], v1, s[16:19], s56 offen offset:0
  buffer_load_dwordx4 v[20:23], v3, s[16:19], s56 offen offset:0
  s_add_u32 s56, s20, 32768
  buffer_load_dwordx4 v[24:27], v1, s[16:19], s56 offen offset:2048
  buffer_load_dwordx4 v[28:31], v3, s[16:19], s56 offen offset:2048
.Lp3_x0:
  s_mov_b32 m0, s51
  s_add_u32 s57, s22, 81920
  buffer_load_dwordx4 v4, s[16:19], s57 offen lds
  buffer_load_dwordx4 v4, s[16:19], s57 offen offset:1024 lds
  s_mov_b32 exec_hi, 0
  buffer_load_dwordx4 v4, s[16:19], s57 offen offset:2048 lds
  s_mov_b32 exec_hi, -1
  s_waitcnt vmcnt(30) lgkmcnt(4)
  v_mfma_f32_16x16x32_bf16 v[128:131], v[168:171], v[192:195], 0
  ds_read_b128 v[188:191], v6 offset:5120
  s_sub_u32 s55, s27, 131072
  v_add_u32 v5, s55, v6
  s_waitcnt vmcnt(29)
  v_mfma_f32_16x16x32_bf16 v[148:151], v[168:171], v[196:199], 0
  ds_read_b128 v[32:35], v6 offset:6144
  s_sub_u32 s55, s40, 131072
  v_add_u32 v7, s55, v6
  s_waitcnt lgkmcnt(5)
  v_mfma_f32_16x16x32_bf16 v[132:135], v[172:175], v[192:195], 0
  ds_read_b128 v[36:39], v6 offset:7168
  s_mul_i32 s55, s52, 5120
  s_add_u32 s55, s55, s40
  s_add_u32 s55, s55, 20480
  v_add_u32 v8, s55, v2
  v_mfma_f32_16x16x32_bf16 v[152:155], v[172:175], v[196:199], 0
  ds_read_b128 v[40:43], v6 offset:8192
  s_xor_b32 s55, s52, 4
  s_mul_i32 s55, s55, 5120
  s_add_u32 s55, s55, s40
  s_add_u32 s55, s55, 20480
  v_add_u32 v9, s55, v2
  s_waitcnt lgkmcnt(6)
  v_mfma_f32_16x16x32_bf16 v[136:139], v[176:179], v[192:195], 0
  ds_read_b128 v[44:47], v6 offset:9216
  v_and_b32 v10, 15, v0
  v_mul_u32_u24 v10, 5120, v10
  v_mfma_f32_16x16x32_bf16 v[156:159], v[176:179], v[196:199], 0
  v_and_b32 v14, 48, v0
  v_add_u32 v10, v10, v14
  s_waitcnt lgkmcnt(6)
  v_mfma_f32_16x16x32_bf16 v[140:143], v[180:183], v[192:195], 0
  v_mfma_f32_16x16x32_bf16 v[160:163], v[180:183], v[196:199], 0
  s_waitcnt lgkmcnt(5)
  v_mfma_f32_16x16x32_bf16 v[144:147], v[184:187], v[192:195], 0
  v_mfma_f32_16x16x32_bf16 v[164:167], v[184:187], v[196:199], 0
  s_add_u32 s56, s20, 40960
  buffer_load_dwordx4 v[192:195], v1, s[16:19], s56 offen offset:0
  buffer_load_dwordx4 v[196:199], v3, s[16:19], s56 offen offset:0
  s_waitcnt vmcnt(30) lgkmcnt(4)
  v_mfma_f32_16x16x32_bf16 v[128:131], v[188:191], v[200:203], v[128:131]
  s_waitcnt vmcnt(29)
  v_mfma_f32_16x16x32_bf16 v[148:151], v[188:191], v[204:207], v[148:151]
  s_waitcnt lgkmcnt(0)
  s_barrier
  ds_read_b128 v[168:171], v5 offset:0
  v_mfma_f32_16x16x32_bf16 v[132:135], v[32:35], v[200:203], v[132:135]
  ds_read_b128 v[172:175], v5 offset:1024
  v_mfma_f32_16x16x32_bf16 v[152:155], v[32:35], v[204:207], v[152:155]
  ds_read_b128 v[176:179], v5 offset:2048
  v_mfma_f32_16x16x32_bf16 v[136:139], v[36:39], v[200:203], v[136:139]
  ds_read_b128 v[180:183], v5 offset:3072
  s_add_u32 m0, s41, 131072
  s_add_u32 s57, s22, 102400
  buffer_load_dwordx4 v4, s[16:19], s57 offen lds
  v_mfma_f32_16x16x32_bf16 v[156:159], v[36:39], v[204:207], v[156:159]
  ds_read_b128 v[184:187], v5 offset:4096
  buffer_load_dwordx4 v4, s[16:19], s57 offen offset:1024 lds
  v_mfma_f32_16x16x32_bf16 v[140:143], v[40:43], v[200:203], v[140:143]
  s_mov_b32 exec_hi, 0
  buffer_load_dwordx4 v4, s[16:19], s57 offen offset:2048 lds
  s_mov_b32 exec_hi, -1
  s_nop 0
  v_mfma_f32_16x16x32_bf16 v[160:163], v[40:43], v[204:207], v[160:163]
  v_mfma_f32_16x16x32_bf16 v[144:147], v[44:47], v[200:203], v[144:147]
  v_mfma_f32_16x16x32_bf16 v[164:167], v[44:47], v[204:207], v[164:167]
  s_add_u32 s56, s20, 40960
  buffer_load_dwordx4 v[200:203], v1, s[16:19], s56 offen offset:2048
  buffer_load_dwordx4 v[204:207], v3, s[16:19], s56 offen offset:2048
  s_waitcnt vmcnt(18)
  s_cmp_eq_u32 s89, 0
  s_cbranch_scc1 .Lcf123
  v_mov_b32 v14, 1
  s_mov_b64 exec, 1
  buffer_store_byte v14, off, s[16:19], s89 sc0 sc1
  s_mov_b64 exec, -1
  s_mov_b32 s89, 0
.Lcf123:
  s_waitcnt lgkmcnt(4)
  v_mfma_f32_16x16x32_bf16 v[128:131], v[168:171], v[208:211], v[128:131]
  ds_read_b128 v[188:191], v5 offset:5120
  v_mfma_f32_16x16x32_bf16 v[148:151], v[168:171], v[212:215], v[148:151]
  ds_read_b128 v[32:35], v5 offset:6144
  s_waitcnt lgkmcnt(5)
  v_mfma_f32_16x16x32_bf16 v[132:135], v[172:175], v[208:211], v[132:135]
  ds_read_b128 v[36:39], v5 offset:7168
  v_mfma_f32_16x16x32_bf16 v[152:155], v[172:175], v[212:215], v[152:155]
  ds_read_b128 v[40:43], v5 offset:8192
  s_waitcnt lgkmcnt(6)
  v_mfma_f32_16x16x32_bf16 v[136:139], v[176:179], v[208:211], v[136:139]
  ds_read_b128 v[44:47], v5 offset:9216
  v_mfma_f32_16x16x32_bf16 v[156:159], v[176:179], v[212:215], v[156:159]
  s_waitcnt lgkmcnt(6)
  v_mfma_f32_16x16x32_bf16 v[140:143], v[180:183], v[208:211], v[140:143]
  v_mfma_f32_16x16x32_bf16 v[160:163], v[180:183], v[212:215], v[160:163]
  s_waitcnt lgkmcnt(5)
  v_mfma_f32_16x16x32_bf16 v[144:147], v[184:187], v[208:211], v[144:147]
  v_mfma_f32_16x16x32_bf16 v[164:167], v[184:187], v[212:215], v[164:167]
  s_add_u32 s56, s20, 49152
  buffer_load_dwordx4 v[208:211], v1, s[16:19], s56 offen offset:0
  buffer_load_dwordx4 v[212:215], v3, s[16:19], s56 offen offset:0
  s_waitcnt lgkmcnt(4)
  v_mfma_f32_16x16x32_bf16 v[128:131], v[188:191], v[216:219], v[128:131]
  v_mfma_f32_16x16x32_bf16 v[148:151], v[188:191], v[220:223], v[148:151]
  s_waitcnt lgkmcnt(0)
  s_barrier
  ds_read_b128 v[168:171], v5 offset:20480
  v_mfma_f32_16x16x32_bf16 v[132:135], v[32:35], v[216:219], v[132:135]
  ds_read_b128 v[172:175], v5 offset:21504
  v_mfma_f32_16x16x32_bf16 v[152:155], v[32:35], v[220:223], v[152:155]
  ds_read_b128 v[176:179], v5 offset:22528
  v_mfma_f32_16x16x32_bf16 v[136:139], v[36:39], v[216:219], v[136:139]
  ds_read_b128 v[180:183], v5 offset:23552
  s_add_u32 m0, s50, 0
  s_add_u32 s57, s22, 122880
  buffer_load_dwordx4 v4, s[16:19], s57 offen lds
  v_mfma_f32_16x16x32_bf16 v[156:159], v[36:39], v[220:223], v[156:159]
  ds_read_b128 v[184:187], v5 offset:24576
  buffer_load_dwordx4 v4, s[16:19], s57 offen offset:1024 lds
  v_mfma_f32_16x16x32_bf16 v[140:143], v[40:43], v[216:219], v[140:143]
  s_mov_b32 exec_hi, 0
  buffer_load_dwordx4 v4, s[16:19], s57 offen offset:2048 lds
  s_mov_b32 exec_hi, -1
  s_nop 0
  v_mfma_f32_16x16x32_bf16 v[160:163], v[40:43], v[220:223], v[160:163]
  v_mfma_f32_16x16x32_bf16 v[144:147], v[44:47], v[216:219], v[144:147]
  v_mfma_f32_16x16x32_bf16 v[164:167], v[44:47], v[220:223], v[164:167]
  s_add_u32 s56, s20, 49152
  buffer_load_dwordx4 v[216:219], v1, s[16:19], s56 offen offset:2048
  buffer_load_dwordx4 v[220:223], v3, s[16:19], s56 offen offset:2048
  s_waitcnt lgkmcnt(4)
  v_mfma_f32_16x16x32_bf16 v[128:131], v[168:171], v[48:51], v[128:131]
  ds_read_b128 v[188:191], v5 offset:25600
  v_mfma_f32_16x16x32_bf16 v[148:151], v[168:171], v[52:55], v[148:151]
  ds_read_b128 v[32:35], v5 offset:26624
  s_waitcnt lgkmcnt(5)
  v_mfma_f32_16x16x32_bf16 v[132:135], v[172:175], v[48:51], v[132:135]
  ds_read_b128 v[36:39], v5 offset:27648
  v_mfma_f32_16x16x32_bf16 v[152:155], v[172:175], v[52:55], v[152:155]
  ds_read_b128 v[40:43], v5 offset:28672
  s_waitcnt lgkmcnt(6)
  v_mfma_f32_16x16x32_bf16 v[136:139], v[176:179], v[48:51], v[136:139]
  ds_read_b128 v[44:47], v5 offset:29696
  v_mfma_f32_16x16x32_bf16 v[156:159], v[176:179], v[52:55], v[156:159]
  s_waitcnt lgkmcnt(6)
  v_mfma_f32_16x16x32_bf16 v[140:143], v[180:183], v[48:51], v[140:143]
  v_mfma_f32_16x16x32_bf16 v[160:163], v[180:183], v[52:55], v[160:163]
  s_waitcnt lgkmcnt(5)
  v_mfma_f32_16x16x32_bf16 v[144:147], v[184:187], v[48:51], v[144:147]
  v_mfma_f32_16x16x32_bf16 v[164:167], v[184:187], v[52:55], v[164:167]
  s_add_u32 s56, s20, 57344
  buffer_load_dwordx4 v[48:51], v1, s[16:19], s56 offen offset:0
  buffer_load_dwordx4 v[52:55], v3, s[16:19], s56 offen offset:0
  s_waitcnt lgkmcnt(4)
  v_mfma_f32_16x16x32_bf16 v[128:131], v[188:191], v[56:59], v[128:131]
  v_mfma_f32_16x16x32_bf16 v[148:151], v[188:191], v[60:63], v[148:151]
  s_waitcnt lgkmcnt(0)
  s_barrier
  ds_read_b128 v[168:171], v5 offset:40960
  v_mfma_f32_16x16x32_bf16 v[132:135], v[32:35], v[56:59], v[132:135]
  ds_read_b128 v[172:175], v5 offset:41984
  v_mfma_f32_16x16x32_bf16 v[152:155], v[32:35], v[60:63], v[152:155]
  ds_read_b128 v[176:179], v5 offset:43008
  v_mfma_f32_16x16x32_bf16 v[136:139], v[36:39], v[56:59], v[136:139]
  ds_read_b128 v[180:183], v5 offset:44032
  s_add_u32 m0, s50, 20480
  s_add_u32 s57, s22, 143360
  buffer_load_dwordx4 v4, s[16:19], s57 offen lds
  v_mfma_f32_16x16x32_bf16 v[156:159], v[36:39], v[60:63], v[156:159]
  ds_read_b128 v[184:187], v5 offset:45056
  buffer_load_dwordx4 v4, s[16:19], s57 offen offset:1024 lds
  v_mfma_f32_16x16x32_bf16 v[140:143], v[40:43], v[56:59], v[140:143]
  s_mov_b32 exec_hi, 0
  buffer_load_dwordx4 v4, s[16:19], s57 offen offset:2048 lds
  s_mov_b32 exec_hi, -1
  s_nop 0
  v_mfma_f32_16x16x32_bf16 v[160:163], v[40:43], v[60:63], v[160:163]
  v_mfma_f32_16x16x32_bf16 v[144:147], v[44:47], v[56:59], v[144:147]
  v_mfma_f32_16x16x32_bf16 v[164:167], v[44:47], v[60:63], v[164:167]
  s_add_u32 s56, s20, 57344
  buffer_load_dwordx4 v[56:59], v1, s[16:19], s56 offen offset:2048
  buffer_load_dwordx4 v[60:63], v3, s[16:19], s56 offen offset:2048
  s_waitcnt vmcnt(31) lgkmcnt(4)
  v_mfma_f32_16x16x32_bf16 v[128:131], v[168:171], v[112:115], v[128:131]
  ds_read_b128 v[188:191], v5 offset:46080
  s_waitcnt vmcnt(30)
  v_mfma_f32_16x16x32_bf16 v[148:151], v[168:171], v[116:119], v[148:151]
  ds_read_b128 v[32:35], v5 offset:47104
  s_waitcnt lgkmcnt(5)
  v_mfma_f32_16x16x32_bf16 v[132:135], v[172:175], v[112:115], v[132:135]
  ds_read_b128 v[36:39], v5 offset:48128
  v_mfma_f32_16x16x32_bf16 v[152:155], v[172:175], v[116:119], v[152:155]
  ds_read_b128 v[40:43], v5 offset:49152
  s_waitcnt lgkmcnt(6)
  v_mfma_f32_16x16x32_bf16 v[136:139], v[176:179], v[112:115], v[136:139]
  ds_read_b128 v[44:47], v5 offset:50176
  v_mfma_f32_16x16x32_bf16 v[156:159], v[176:179], v[116:119], v[156:159]
  s_waitcnt lgkmcnt(6)
  v_mfma_f32_16x16x32_bf16 v[140:143], v[180:183], v[112:115], v[140:143]
  v_mfma_f32_16x16x32_bf16 v[160:163], v[180:183], v[116:119], v[160:163]
  s_waitcnt lgkmcnt(5)
  v_mfma_f32_16x16x32_bf16 v[144:147], v[184:187], v[112:115], v[144:147]
  v_mfma_f32_16x16x32_bf16 v[164:167], v[184:187], v[116:119], v[164:167]
  s_add_u32 s56, s20, 65536
  buffer_load_dwordx4 v[112:115], v1, s[16:19], s56 offen offset:0
  buffer_load_dwordx4 v[116:119], v3, s[16:19], s56 offen offset:0
  s_waitcnt vmcnt(31) lgkmcnt(4)
  v_mfma_f32_16x16x32_bf16 v[128:131], v[188:191], v[120:123], v[128:131]
  s_waitcnt vmcnt(30)
  v_mfma_f32_16x16x32_bf16 v[148:151], v[188:191], v[124:127], v[148:151]
  s_waitcnt lgkmcnt(0)
  s_waitcnt vmcnt(23)
  s_barrier
  ds_read_b128 v[168:171], v7 offset:0
  v_mfma_f32_16x16x32_bf16 v[132:135], v[32:35], v[120:123], v[132:135]
  ds_read_b128 v[172:175], v7 offset:1024
  v_mfma_f32_16x16x32_bf16 v[152:155], v[32:35], v[124:127], v[152:155]
  ds_read_b128 v[176:179], v7 offset:2048
  v_mfma_f32_16x16x32_bf16 v[136:139], v[36:39], v[120:123], v[136:139]
  ds_read_b128 v[180:183], v7 offset:3072
  s_add_u32 m0, s50, 40960
  s_add_u32 s57, s22, 163840
  buffer_load_dwordx4 v4, s[16:19], s57 offen lds
  v_mfma_f32_16x16x32_bf16 v[156:159], v[36:39], v[124:127], v[156:159]
  ds_read_b128 v[184:187], v7 offset:4096
  buffer_load_dwordx4 v4, s[16:19], s57 offen offset:1024 lds
  v_mfma_f32_16x16x32_bf16 v[140:143], v[40:43], v[120:123], v[140:143]
  s_mov_b32 exec_hi, 0
  buffer_load_dwordx4 v4, s[16:19], s57 offen offset:2048 lds
  s_mov_b32 exec_hi, -1
  s_nop 0
  v_mfma_f32_16x16x32_bf16 v[160:163], v[40:43], v[124:127], v[160:163]
  v_mfma_f32_16x16x32_bf16 v[144:147], v[44:47], v[120:123], v[144:147]
  v_mfma_f32_16x16x32_bf16 v[164:167], v[44:47], v[124:127], v[164:167]
  s_add_u32 s56, s20, 65536
  buffer_load_dwordx4 v[120:123], v1, s[16:19], s56 offen offset:2048
  buffer_load_dwordx4 v[124:127], v3, s[16:19], s56 offen offset:2048
  s_waitcnt lgkmcnt(4)
  v_mfma_f32_16x16x32_bf16 v[128:131], v[168:171], v[16:19], v[128:131]
  ds_read_b128 v[188:191], v7 offset:5120
  v_mfma_f32_16x16x32_bf16 v[148:151], v[168:171], v[20:23], v[148:151]
  ds_read_b128 v[32:35], v7 offset:6144
  s_waitcnt lgkmcnt(5)
  v_mfma_f32_16x16x32_bf16 v[132:135], v[172:175], v[16:19], v[132:135]
  ds_read_b128 v[36:39], v7 offset:7168
  v_mfma_f32_16x16x32_bf16 v[152:155], v[172:175], v[20:23], v[152:155]
  ds_read_b128 v[40:43], v7 offset:8192
  s_waitcnt lgkmcnt(6)
  v_mfma_f32_16x16x32_bf16 v[136:139], v[176:179], v[16:19], v[136:139]
  ds_read_b128 v[44:47], v7 offset:9216
  v_mfma_f32_16x16x32_bf16 v[156:159], v[176:179], v[20:23], v[156:159]
  s_waitcnt lgkmcnt(6)
  v_mfma_f32_16x16x32_bf16 v[140:143], v[180:183], v[16:19], v[140:143]
  v_mfma_f32_16x16x32_bf16 v[160:163], v[180:183], v[20:23], v[160:163]
  s_waitcnt lgkmcnt(5)
  v_mfma_f32_16x16x32_bf16 v[144:147], v[184:187], v[16:19], v[144:147]
  v_mfma_f32_16x16x32_bf16 v[164:167], v[184:187], v[20:23], v[164:167]
  s_add_u32 s56, s20, 73728
  buffer_load_dwordx4 v[16:19], v1, s[16:19], s56 offen offset:0
  buffer_load_dwordx4 v[20:23], v3, s[16:19], s56 offen offset:0
  s_waitcnt lgkmcnt(4)
  v_mfma_f32_16x16x32_bf16 v[128:131], v[188:191], v[24:27], v[128:131]
  v_mfma_f32_16x16x32_bf16 v[148:151], v[188:191], v[28:31], v[148:151]
  s_waitcnt lgkmcnt(0)
  s_waitcnt vmcnt(25)
  s_barrier
  ds_read_b128 v[168:171], v6 offset:0
  v_mfma_f32_16x16x32_bf16 v[132:135], v[32:35], v[24:27], v[132:135]
  ds_read_b128 v[172:175], v6 offset:1024
  v_mfma_f32_16x16x32_bf16 v[152:155], v[32:35], v[28:31], v[152:155]
  ds_read_b128 v[176:179], v6 offset:2048
  v_mfma_f32_16x16x32_bf16 v[136:139], v[36:39], v[24:27], v[136:139]
  ds_read_b128 v[180:183], v6 offset:3072
  s_mov_b32 m0, s51
  s_add_u32 s57, s22, 184320
  buffer_load_dwordx4 v4, s[16:19], s57 offen lds
  v_mfma_f32_16x16x32_bf16 v[156:159], v[36:39], v[28:31], v[156:159]
  ds_read_b128 v[184:187], v6 offset:4096
  buffer_load_dwordx4 v4, s[16:19], s57 offen offset:1024 lds
  v_mfma_f32_16x16x32_bf16 v[140:143], v[40:43], v[24:27], v[140:143]
  s_mov_b32 exec_hi, 0
  buffer_load_dwordx4 v4, s[16:19], s57 offen offset:2048 lds
  s_mov_b32 exec_hi, -1
  s_nop 0
  v_mfma_f32_16x16x32_bf16 v[160:163], v[40:43], v[28:31], v[160:163]
  v_mfma_f32_16x16x32_bf16 v[144:147], v[44:47], v[24:27], v[144:147]
  v_mfma_f32_16x16x32_bf16 v[164:167], v[44:47], v[28:31], v[164:167]
  s_add_u32 s56, s20, 73728
  buffer_load_dwordx4 v[24:27], v1, s[16:19], s56 offen offset:2048
  buffer_load_dwordx4 v[28:31], v3, s[16:19], s56 offen offset:2048
  s_waitcnt lgkmcnt(4)
  v_mfma_f32_16x16x32_bf16 v[128:131], v[168:171], v[192:195], v[128:131]
  ds_read_b128 v[188:191], v6 offset:5120
  v_mfma_f32_16x16x32_bf16 v[148:151], v[168:171], v[196:199], v[148:151]
  ds_read_b128 v[32:35], v6 offset:6144
  s_waitcnt lgkmcnt(5)
  v_mfma_f32_16x16x32_bf16 v[132:135], v[172:175], v[192:195], v[132:135]
  ds_read_b128 v[36:39], v6 offset:7168
  v_mfma_f32_16x16x32_bf16 v[152:155], v[172:175], v[196:199], v[152:155]
  ds_read_b128 v[40:43], v6 offset:8192
  s_waitcnt lgkmcnt(6)
  v_mfma_f32_16x16x32_bf16 v[136:139], v[176:179], v[192:195], v[136:139]
  ds_read_b128 v[44:47], v6 offset:9216
  v_mfma_f32_16x16x32_bf16 v[156:159], v[176:179], v[196:199], v[156:159]
  s_waitcnt lgkmcnt(6)
  v_mfma_f32_16x16x32_bf16 v[140:143], v[180:183], v[192:195], v[140:143]
  v_mfma_f32_16x16x32_bf16 v[160:163], v[180:183], v[196:199], v[160:163]
  s_waitcnt lgkmcnt(5)
  v_mfma_f32_16x16x32_bf16 v[144:147], v[184:187], v[192:195], v[144:147]
  v_mfma_f32_16x16x32_bf16 v[164:167], v[184:187], v[196:199], v[164:167]
  s_add_u32 s56, s20, 81920
  buffer_load_dwordx4 v[192:195], v1, s[16:19], s56 offen offset:0
  buffer_load_dwordx4 v[196:199], v3, s[16:19], s56 offen offset:0
  s_waitcnt vmcnt(31) lgkmcnt(4)
  v_mfma_f32_16x16x32_bf16 v[128:131], v[188:191], v[200:203], v[128:131]
  s_waitcnt vmcnt(30)
  v_mfma_f32_16x16x32_bf16 v[148:151], v[188:191], v[204:207], v[148:151]
  s_waitcnt lgkmcnt(0)
  s_waitcnt vmcnt(25)
  s_barrier
  ds_read_b128 v[168:171], v5 offset:0
  v_mfma_f32_16x16x32_bf16 v[132:135], v[32:35], v[200:203], v[132:135]
  ds_read_b128 v[172:175], v5 offset:1024
  v_mfma_f32_16x16x32_bf16 v[152:155], v[32:35], v[204:207], v[152:155]
  ds_read_b128 v[176:179], v5 offset:2048
  v_mfma_f32_16x16x32_bf16 v[136:139], v[36:39], v[200:203], v[136:139]
  ds_read_b128 v[180:183], v5 offset:3072
  s_add_u32 m0, s41, 131072
  s_add_u32 s57, s22, 204800
  buffer_load_dwordx4 v4, s[16:19], s57 offen lds
  v_mfma_f32_16x16x32_bf16 v[156:159], v[36:39], v[204:207], v[156:159]
  ds_read_b128 v[184:187], v5 offset:4096
  buffer_load_dwordx4 v4, s[16:19], s57 offen offset:1024 lds
  v_mfma_f32_16x16x32_bf16 v[140:143], v[40:43], v[200:203], v[140:143]
  s_mov_b32 exec_hi, 0
  buffer_load_dwordx4 v4, s[16:19], s57 offen offset:2048 lds
  s_mov_b32 exec_hi, -1
  s_nop 0
  v_mfma_f32_16x16x32_bf16 v[160:163], v[40:43], v[204:207], v[160:163]
  v_mfma_f32_16x16x32_bf16 v[144:147], v[44:47], v[200:203], v[144:147]
  v_mfma_f32_16x16x32_bf16 v[164:167], v[44:47], v[204:207], v[164:167]
  s_add_u32 s56, s20, 81920
  buffer_load_dwordx4 v[200:203], v1, s[16:19], s56 offen offset:2048
  buffer_load_dwordx4 v[204:207], v3, s[16:19], s56 offen offset:2048
  s_waitcnt lgkmcnt(4)
  v_mfma_f32_16x16x32_bf16 v[128:131], v[168:171], v[208:211], v[128:131]
  ds_read_b128 v[188:191], v5 offset:5120
  v_mfma_f32_16x16x32_bf16 v[148:151], v[168:171], v[212:215], v[148:151]
  ds_read_b128 v[32:35], v5 offset:6144
  s_waitcnt lgkmcnt(5)
  v_mfma_f32_16x16x32_bf16 v[132:135], v[172:175], v[208:211], v[132:135]
  ds_read_b128 v[36:39], v5 offset:7168
  v_mfma_f32_16x16x32_bf16 v[152:155], v[172:175], v[212:215], v[152:155]
  ds_read_b128 v[40:43], v5 offset:8192
  s_waitcnt lgkmcnt(6)
  v_mfma_f32_16x16x32_bf16 v[136:139], v[176:179], v[208:211], v[136:139]
  ds_read_b128 v[44:47], v5 offset:9216
  v_mfma_f32_16x16x32_bf16 v[156:159], v[176:179], v[212:215], v[156:159]
  s_waitcnt lgkmcnt(6)
  v_mfma_f32_16x16x32_bf16 v[140:143], v[180:183], v[208:211], v[140:143]
  v_mfma_f32_16x16x32_bf16 v[160:163], v[180:183], v[212:215], v[160:163]
  s_waitcnt lgkmcnt(5)
  v_mfma_f32_16x16x32_bf16 v[144:147], v[184:187], v[208:211], v[144:147]
  v_mfma_f32_16x16x32_bf16 v[164:167], v[184:187], v[212:215], v[164:167]
  s_add_u32 s56, s20, 90112
  buffer_load_dwordx4 v[208:211], v1, s[16:19], s56 offen offset:0
  buffer_load_dwordx4 v[212:215], v3, s[16:19], s56 offen offset:0
  s_waitcnt vmcnt(31) lgkmcnt(4)
  v_mfma_f32_16x16x32_bf16 v[128:131], v[188:191], v[216:219], v[128:131]
  s_waitcnt vmcnt(30)
  v_mfma_f32_16x16x32_bf16 v[148:151], v[188:191], v[220:223], v[148:151]
  s_waitcnt lgkmcnt(0)
  s_waitcnt vmcnt(25)
  s_barrier
  ds_read_b128 v[168:171], v5 offset:20480
  v_mfma_f32_16x16x32_bf16 v[132:135], v[32:35], v[216:219], v[132:135]
  ds_read_b128 v[172:175], v5 offset:21504
  v_mfma_f32_16x16x32_bf16 v[152:155], v[32:35], v[220:223], v[152:155]
  ds_read_b128 v[176:179], v5 offset:22528
  v_mfma_f32_16x16x32_bf16 v[136:139], v[36:39], v[216:219], v[136:139]
  ds_read_b128 v[180:183], v5 offset:23552
  s_add_u32 m0, s50, 0
  s_add_u32 s57, s22, 225280
  buffer_load_dwordx4 v4, s[16:19], s57 offen lds
  v_mfma_f32_16x16x32_bf16 v[156:159], v[36:39], v[220:223], v[156:159]
  ds_read_b128 v[184:187], v5 offset:24576
  buffer_load_dwordx4 v4, s[16:19], s57 offen offset:1024 lds
  v_mfma_f32_16x16x32_bf16 v[140:143], v[40:43], v[216:219], v[140:143]
  s_mov_b32 exec_hi, 0
  buffer_load_dwordx4 v4, s[16:19], s57 offen offset:2048 lds
  s_mov_b32 exec_hi, -1
  s_nop 0
  v_mfma_f32_16x16x32_bf16 v[160:163], v[40:43], v[220:223], v[160:163]
  v_mfma_f32_16x16x32_bf16 v[144:147], v[44:47], v[216:219], v[144:147]
  v_mfma_f32_16x16x32_bf16 v[164:167], v[44:47], v[220:223], v[164:167]
  s_add_u32 s56, s20, 90112
  buffer_load_dwordx4 v[216:219], v1, s[16:19], s56 offen offset:2048
  buffer_load_dwordx4 v[220:223], v3, s[16:19], s56 offen offset:2048
  s_waitcnt lgkmcnt(4)
  v_mfma_f32_16x16x32_bf16 v[128:131], v[168:171], v[48:51], v[128:131]
  ds_read_b128 v[188:191], v5 offset:25600
  v_mfma_f32_16x16x32_bf16 v[148:151], v[168:171], v[52:55], v[148:151]
  ds_read_b128 v[32:35], v5 offset:26624
  s_waitcnt lgkmcnt(5)
  v_mfma_f32_16x16x32_bf16 v[132:135], v[172:175], v[48:51], v[132:135]
  ds_read_b128 v[36:39], v5 offset:27648
  v_mfma_f32_16x16x32_bf16 v[152:155], v[172:175], v[52:55], v[152:155]
  ds_read_b128 v[40:43], v5 offset:28672
  s_waitcnt lgkmcnt(6)
  v_mfma_f32_16x16x32_bf16 v[136:139], v[176:179], v[48:51], v[136:139]
  ds_read_b128 v[44:47], v5 offset:29696
  v_mfma_f32_16x16x32_bf16 v[156:159], v[176:179], v[52:55], v[156:159]
  s_waitcnt lgkmcnt(6)
  v_mfma_f32_16x16x32_bf16 v[140:143], v[180:183], v[48:51], v[140:143]
  v_mfma_f32_16x16x32_bf16 v[160:163], v[180:183], v[52:55], v[160:163]
  s_waitcnt lgkmcnt(5)
  v_mfma_f32_16x16x32_bf16 v[144:147], v[184:187], v[48:51], v[144:147]
  v_mfma_f32_16x16x32_bf16 v[164:167], v[184:187], v[52:55], v[164:167]
  s_add_u32 s56, s20, 98304
  buffer_load_dwordx4 v[48:51], v1, s[16:19], s56 offen offset:0
  buffer_load_dwordx4 v[52:55], v3, s[16:19], s56 offen offset:0
  s_waitcnt vmcnt(31) lgkmcnt(4)
  v_mfma_f32_16x16x32_bf16 v[128:131], v[188:191], v[56:59], v[128:131]
  s_waitcnt vmcnt(30)
  v_mfma_f32_16x16x32_bf16 v[148:151], v[188:191], v[60:63], v[148:151]
  s_waitcnt lgkmcnt(0)
  s_waitcnt vmcnt(25)
  s_barrier
  ds_read_b128 v[168:171], v5 offset:40960
  v_mfma_f32_16x16x32_bf16 v[132:135], v[32:35], v[56:59], v[132:135]
  ds_read_b128 v[172:175], v5 offset:41984
  v_mfma_f32_16x16x32_bf16 v[152:155], v[32:35], v[60:63], v[152:155]
  ds_read_b128 v[176:179], v5 offset:43008
  v_mfma_f32_16x16x32_bf16 v[136:139], v[36:39], v[56:59], v[136:139]
  ds_read_b128 v[180:183], v5 offset:44032
  s_add_u32 m0, s50, 20480
  s_add_u32 s57, s22, 245760
  buffer_load_dwordx4 v4, s[16:19], s57 offen lds
  v_mfma_f32_16x16x32_bf16 v[156:159], v[36:39], v[60:63], v[156:159]
  ds_read_b128 v[184:187], v5 offset:45056
  buffer_load_dwordx4 v4, s[16:19], s57 offen offset:1024 lds
  v_mfma_f32_16x16x32_bf16 v[140:143], v[40:43], v[56:59], v[140:143]
  s_mov_b32 exec_hi, 0
  buffer_load_dwordx4 v4, s[16:19], s57 offen offset:2048 lds
  s_mov_b32 exec_hi, -1
  s_nop 0
  v_mfma_f32_16x16x32_bf16 v[160:163], v[40:43], v[60:63], v[160:163]
  v_mfma_f32_16x16x32_bf16 v[144:147], v[44:47], v[56:59], v[144:147]
  v_mfma_f32_16x16x32_bf16 v[164:167], v[44:47], v[60:63], v[164:167]
  s_add_u32 s56, s20, 98304
  buffer_load_dwordx4 v[56:59], v1, s[16:19], s56 offen offset:2048
  buffer_load_dwordx4 v[60:63], v3, s[16:19], s56 offen offset:2048
  s_waitcnt lgkmcnt(4)
  v_mfma_f32_16x16x32_bf16 v[128:131], v[168:171], v[112:115], v[128:131]
  ds_read_b128 v[188:191], v5 offset:46080
  v_mfma_f32_16x16x32_bf16 v[148:151], v[168:171], v[116:119], v[148:151]
  ds_read_b128 v[32:35], v5 offset:47104
  s_waitcnt lgkmcnt(5)
  v_mfma_f32_16x16x32_bf16 v[132:135], v[172:175], v[112:115], v[132:135]
  ds_read_b128 v[36:39], v5 offset:48128
  v_mfma_f32_16x16x32_bf16 v[152:155], v[172:175], v[116:119], v[152:155]
  ds_read_b128 v[40:43], v5 offset:49152
  s_waitcnt lgkmcnt(6)
  v_mfma_f32_16x16x32_bf16 v[136:139], v[176:179], v[112:115], v[136:139]
  ds_read_b128 v[44:47], v5 offset:50176
  v_mfma_f32_16x16x32_bf16 v[156:159], v[176:179], v[116:119], v[156:159]
  s_waitcnt lgkmcnt(6)
  v_mfma_f32_16x16x32_bf16 v[140:143], v[180:183], v[112:115], v[140:143]
  v_mfma_f32_16x16x32_bf16 v[160:163], v[180:183], v[116:119], v[160:163]
  s_waitcnt lgkmcnt(5)
  v_mfma_f32_16x16x32_bf16 v[144:147], v[184:187], v[112:115], v[144:147]
  v_mfma_f32_16x16x32_bf16 v[164:167], v[184:187], v[116:119], v[164:167]
  s_add_u32 s56, s20, 106496
  buffer_load_dwordx4 v[112:115], v1, s[16:19], s56 offen offset:0
  buffer_load_dwordx4 v[116:119], v3, s[16:19], s56 offen offset:0
  s_waitcnt vmcnt(31) lgkmcnt(4)
  v_mfma_f32_16x16x32_bf16 v[128:131], v[188:191], v[120:123], v[128:131]
  s_waitcnt vmcnt(30)
  v_mfma_f32_16x16x32_bf16 v[148:151], v[188:191], v[124:127], v[148:151]
  s_waitcnt lgkmcnt(0)
  s_waitcnt vmcnt(25)
  s_barrier
  ds_read_b128 v[168:171], v7 offset:0
  v_mfma_f32_16x16x32_bf16 v[132:135], v[32:35], v[120:123], v[132:135]
  ds_read_b128 v[172:175], v7 offset:1024
  v_mfma_f32_16x16x32_bf16 v[152:155], v[32:35], v[124:127], v[152:155]
  ds_read_b128 v[176:179], v7 offset:2048
  v_mfma_f32_16x16x32_bf16 v[136:139], v[36:39], v[120:123], v[136:139]
  ds_read_b128 v[180:183], v7 offset:3072
  s_add_u32 m0, s50, 40960
  s_add_u32 s57, s22, 266240
  buffer_load_dwordx4 v4, s[16:19], s57 offen lds
  v_mfma_f32_16x16x32_bf16 v[156:159], v[36:39], v[124:127], v[156:159]
  ds_read_b128 v[184:187], v7 offset:4096
  buffer_load_dwordx4 v4, s[16:19], s57 offen offset:1024 lds
  v_mfma_f32_16x16x32_bf16 v[140:143], v[40:43], v[120:123], v[140:143]
  s_mov_b32 exec_hi, 0
  buffer_load_dwordx4 v4, s[16:19], s57 offen offset:2048 lds
  s_mov_b32 exec_hi, -1
  s_nop 0
  v_mfma_f32_16x16x32_bf16 v[160:163], v[40:43], v[124:127], v[160:163]
  v_mfma_f32_16x16x32_bf16 v[144:147], v[44:47], v[120:123], v[144:147]
  v_mfma_f32_16x16x32_bf16 v[164:167], v[44:47], v[124:127], v[164:167]
  s_add_u32 s56, s20, 106496
  buffer_load_dwordx4 v[120:123], v1, s[16:19], s56 offen offset:2048
  buffer_load_dwordx4 v[124:127], v3, s[16:19], s56 offen offset:2048
  s_waitcnt lgkmcnt(4)
  v_mfma_f32_16x16x32_bf16 v[128:131], v[168:171], v[16:19], v[128:131]
  ds_read_b128 v[188:191], v7 offset:5120
  v_mfma_f32_16x16x32_bf16 v[148:151], v[168:171], v[20:23], v[148:151]
  ds_read_b128 v[32:35], v7 offset:6144
  s_waitcnt lgkmcnt(5)
  v_mfma_f32_16x16x32_bf16 v[132:135], v[172:175], v[16:19], v[132:135]
  ds_read_b128 v[36:39], v7 offset:7168
  v_mfma_f32_16x16x32_bf16 v[152:155], v[172:175], v[20:23], v[152:155]
  ds_read_b128 v[40:43], v7 offset:8192
  s_waitcnt lgkmcnt(6)
  v_mfma_f32_16x16x32_bf16 v[136:139], v[176:179], v[16:19], v[136:139]
  ds_read_b128 v[44:47], v7 offset:9216
  v_mfma_f32_16x16x32_bf16 v[156:159], v[176:179], v[20:23], v[156:159]
  s_waitcnt lgkmcnt(6)
  v_mfma_f32_16x16x32_bf16 v[140:143], v[180:183], v[16:19], v[140:143]
  v_mfma_f32_16x16x32_bf16 v[160:163], v[180:183], v[20:23], v[160:163]
  s_waitcnt lgkmcnt(5)
  v_mfma_f32_16x16x32_bf16 v[144:147], v[184:187], v[16:19], v[144:147]
  v_mfma_f32_16x16x32_bf16 v[164:167], v[184:187], v[20:23], v[164:167]
  s_add_u32 s56, s20, 114688
  buffer_load_dwordx4 v[16:19], v1, s[16:19], s56 offen offset:0
  buffer_load_dwordx4 v[20:23], v3, s[16:19], s56 offen offset:0
  s_waitcnt vmcnt(31) lgkmcnt(4)
  v_mfma_f32_16x16x32_bf16 v[128:131], v[188:191], v[24:27], v[128:131]
  s_waitcnt vmcnt(30)
  v_mfma_f32_16x16x32_bf16 v[148:151], v[188:191], v[28:31], v[148:151]
  s_waitcnt lgkmcnt(0)
  s_waitcnt vmcnt(25)
  s_barrier
  ds_read_b128 v[168:171], v6 offset:0
  v_mfma_f32_16x16x32_bf16 v[132:135], v[32:35], v[24:27], v[132:135]
  ds_read_b128 v[172:175], v6 offset:1024
  v_mfma_f32_16x16x32_bf16 v[152:155], v[32:35], v[28:31], v[152:155]
  ds_read_b128 v[176:179], v6 offset:2048
  v_mfma_f32_16x16x32_bf16 v[136:139], v[36:39], v[24:27], v[136:139]
  ds_read_b128 v[180:183], v6 offset:3072
  s_mov_b32 m0, s51
  s_add_u32 s57, s22, 286720
  buffer_load_dwordx4 v4, s[16:19], s57 offen lds
  v_mfma_f32_16x16x32_bf16 v[156:159], v[36:39], v[28:31], v[156:159]
  ds_read_b128 v[184:187], v6 offset:4096
  buffer_load_dwordx4 v4, s[16:19], s57 offen offset:1024 lds
  v_mfma_f32_16x16x32_bf16 v[140:143], v[40:43], v[24:27], v[140:143]
  s_mov_b32 exec_hi, 0
  buffer_load_dwordx4 v4, s[16:19], s57 offen offset:2048 lds
  s_mov_b32 exec_hi, -1
  s_nop 0
  v_mfma_f32_16x16x32_bf16 v[160:163], v[40:43], v[28:31], v[160:163]
  v_mfma_f32_16x16x32_bf16 v[144:147], v[44:47], v[24:27], v[144:147]
  v_mfma_f32_16x16x32_bf16 v[164:167], v[44:47], v[28:31], v[164:167]
  s_add_u32 s56, s20, 114688
  buffer_load_dwordx4 v[24:27], v1, s[16:19], s56 offen offset:2048
  buffer_load_dwordx4 v[28:31], v3, s[16:19], s56 offen offset:2048
  s_waitcnt lgkmcnt(4)
  v_mfma_f32_16x16x32_bf16 v[128:131], v[168:171], v[192:195], v[128:131]
  ds_read_b128 v[188:191], v6 offset:5120
  v_mfma_f32_16x16x32_bf16 v[148:151], v[168:171], v[196:199], v[148:151]
  ds_read_b128 v[32:35], v6 offset:6144
  s_waitcnt lgkmcnt(5)
  v_mfma_f32_16x16x32_bf16 v[132:135], v[172:175], v[192:195], v[132:135]
  ds_read_b128 v[36:39], v6 offset:7168
  v_mfma_f32_16x16x32_bf16 v[152:155], v[172:175], v[196:199], v[152:155]
  ds_read_b128 v[40:43], v6 offset:8192
  s_waitcnt lgkmcnt(6)
  v_mfma_f32_16x16x32_bf16 v[136:139], v[176:179], v[192:195], v[136:139]
  ds_read_b128 v[44:47], v6 offset:9216
  v_mfma_f32_16x16x32_bf16 v[156:159], v[176:179], v[196:199], v[156:159]
  s_waitcnt lgkmcnt(6)
  v_mfma_f32_16x16x32_bf16 v[140:143], v[180:183], v[192:195], v[140:143]
  v_mfma_f32_16x16x32_bf16 v[160:163], v[180:183], v[196:199], v[160:163]
  s_waitcnt lgkmcnt(5)
  v_mfma_f32_16x16x32_bf16 v[144:147], v[184:187], v[192:195], v[144:147]
  v_mfma_f32_16x16x32_bf16 v[164:167], v[184:187], v[196:199], v[164:167]
  s_add_u32 s56, s20, 122880
  buffer_load_dwordx4 v[192:195], v1, s[16:19], s56 offen offset:0
  buffer_load_dwordx4 v[196:199], v3, s[16:19], s56 offen offset:0
  s_waitcnt vmcnt(31) lgkmcnt(4)
  v_mfma_f32_16x16x32_bf16 v[128:131], v[188:191], v[200:203], v[128:131]
  s_waitcnt vmcnt(30)
  v_mfma_f32_16x16x32_bf16 v[148:151], v[188:191], v[204:207], v[148:151]
  s_waitcnt lgkmcnt(0)
  s_waitcnt vmcnt(25)
  s_barrier
  ds_read_b128 v[168:171], v5 offset:0
  v_mfma_f32_16x16x32_bf16 v[132:135], v[32:35], v[200:203], v[132:135]
  ds_read_b128 v[172:175], v5 offset:1024
  v_mfma_f32_16x16x32_bf16 v[152:155], v[32:35], v[204:207], v[152:155]
  ds_read_b128 v[176:179], v5 offset:2048
  v_mfma_f32_16x16x32_bf16 v[136:139], v[36:39], v[200:203], v[136:139]
  ds_read_b128 v[180:183], v5 offset:3072
  s_add_u32 m0, s41, 131072
  s_add_u32 s57, s22, 307200
  buffer_load_dwordx4 v4, s[16:19], s57 offen lds
  v_mfma_f32_16x16x32_bf16 v[156:159], v[36:39], v[204:207], v[156:159]
  ds_read_b128 v[184:187], v5 offset:4096
  buffer_load_dwordx4 v4, s[16:19], s57 offen offset:1024 lds
  v_mfma_f32_16x16x32_bf16 v[140:143], v[40:43], v[200:203], v[140:143]
  s_mov_b32 exec_hi, 0
  buffer_load_dwordx4 v4, s[16:19], s57 offen offset:2048 lds
  s_mov_b32 exec_hi, -1
  s_nop 0
  v_mfma_f32_16x16x32_bf16 v[160:163], v[40:43], v[204:207], v[160:163]
  v_mfma_f32_16x16x32_bf16 v[144:147], v[44:47], v[200:203], v[144:147]
  v_mfma_f32_16x16x32_bf16 v[164:167], v[44:47], v[204:207], v[164:167]
  s_add_u32 s56, s20, 122880
  buffer_load_dwordx4 v[200:203], v1, s[16:19], s56 offen offset:2048
  buffer_load_dwordx4 v[204:207], v3, s[16:19], s56 offen offset:2048
  s_waitcnt lgkmcnt(4)
  v_mfma_f32_16x16x32_bf16 v[128:131], v[168:171], v[208:211], v[128:131]
  ds_read_b128 v[188:191], v5 offset:5120
  v_mfma_f32_16x16x32_bf16 v[148:151], v[168:171], v[212:215], v[148:151]
  ds_read_b128 v[32:35], v5 offset:6144
  s_waitcnt lgkmcnt(5)
  v_mfma_f32_16x16x32_bf16 v[132:135], v[172:175], v[208:211], v[132:135]
  ds_read_b128 v[36:39], v5 offset:7168
  v_mfma_f32_16x16x32_bf16 v[152:155], v[172:175], v[212:215], v[152:155]
  ds_read_b128 v[40:43], v5 offset:8192
  s_waitcnt lgkmcnt(6)
  v_mfma_f32_16x16x32_bf16 v[136:139], v[176:179], v[208:211], v[136:139]
  ds_read_b128 v[44:47], v5 offset:9216
  v_mfma_f32_16x16x32_bf16 v[156:159], v[176:179], v[212:215], v[156:159]
  s_waitcnt lgkmcnt(6)
  v_mfma_f32_16x16x32_bf16 v[140:143], v[180:183], v[208:211], v[140:143]
  v_mfma_f32_16x16x32_bf16 v[160:163], v[180:183], v[212:215], v[160:163]
  s_waitcnt lgkmcnt(5)
  v_mfma_f32_16x16x32_bf16 v[144:147], v[184:187], v[208:211], v[144:147]
  v_mfma_f32_16x16x32_bf16 v[164:167], v[184:187], v[212:215], v[164:167]
  s_add_u32 s56, s20, 131072
  buffer_load_dwordx4 v[208:211], v1, s[16:19], s56 offen offset:0
  buffer_load_dwordx4 v[212:215], v3, s[16:19], s56 offen offset:0
  s_waitcnt vmcnt(31) lgkmcnt(4)
  v_mfma_f32_16x16x32_bf16 v[128:131], v[188:191], v[216:219], v[128:131]
  s_waitcnt vmcnt(30)
  v_mfma_f32_16x16x32_bf16 v[148:151], v[188:191], v[220:223], v[148:151]
  s_waitcnt lgkmcnt(0)
  s_waitcnt vmcnt(25)
  s_barrier
  ds_read_b128 v[168:171], v5 offset:20480
  v_mfma_f32_16x16x32_bf16 v[132:135], v[32:35], v[216:219], v[132:135]
  ds_read_b128 v[172:175], v5 offset:21504
  v_mfma_f32_16x16x32_bf16 v[152:155], v[32:35], v[220:223], v[152:155]
  ds_read_b128 v[176:179], v5 offset:22528
  v_mfma_f32_16x16x32_bf16 v[136:139], v[36:39], v[216:219], v[136:139]
  ds_read_b128 v[180:183], v5 offset:23552
  s_add_u32 m0, s50, 0
  s_add_u32 s57, s22, 327680
  buffer_load_dwordx4 v4, s[16:19], s57 offen lds
  v_mfma_f32_16x16x32_bf16 v[156:159], v[36:39], v[220:223], v[156:159]
  ds_read_b128 v[184:187], v5 offset:24576
  buffer_load_dwordx4 v4, s[16:19], s57 offen offset:1024 lds
  v_mfma_f32_16x16x32_bf16 v[140:143], v[40:43], v[216:219], v[140:143]
  s_mov_b32 exec_hi, 0
  buffer_load_dwordx4 v4, s[16:19], s57 offen offset:2048 lds
  s_mov_b32 exec_hi, -1
  s_nop 0
  v_mfma_f32_16x16x32_bf16 v[160:163], v[40:43], v[220:223], v[160:163]
  v_mfma_f32_16x16x32_bf16 v[144:147], v[44:47], v[216:219], v[144:147]
  v_mfma_f32_16x16x32_bf16 v[164:167], v[44:47], v[220:223], v[164:167]
  s_add_u32 s56, s20, 131072
  buffer_load_dwordx4 v[216:219], v1, s[16:19], s56 offen offset:2048
  buffer_load_dwordx4 v[220:223], v3, s[16:19], s56 offen offset:2048
  s_waitcnt lgkmcnt(4)
  v_mfma_f32_16x16x32_bf16 v[128:131], v[168:171], v[48:51], v[128:131]
  ds_read_b128 v[188:191], v5 offset:25600
  v_mfma_f32_16x16x32_bf16 v[148:151], v[168:171], v[52:55], v[148:151]
  ds_read_b128 v[32:35], v5 offset:26624
  s_waitcnt lgkmcnt(5)
  v_mfma_f32_16x16x32_bf16 v[132:135], v[172:175], v[48:51], v[132:135]
  ds_read_b128 v[36:39], v5 offset:27648
  v_mfma_f32_16x16x32_bf16 v[152:155], v[172:175], v[52:55], v[152:155]
  ds_read_b128 v[40:43], v5 offset:28672
  s_waitcnt lgkmcnt(6)
  v_mfma_f32_16x16x32_bf16 v[136:139], v[176:179], v[48:51], v[136:139]
  ds_read_b128 v[44:47], v5 offset:29696
  v_mfma_f32_16x16x32_bf16 v[156:159], v[176:179], v[52:55], v[156:159]
  s_waitcnt lgkmcnt(6)
  v_mfma_f32_16x16x32_bf16 v[140:143], v[180:183], v[48:51], v[140:143]
  v_mfma_f32_16x16x32_bf16 v[160:163], v[180:183], v[52:55], v[160:163]
  s_waitcnt lgkmcnt(5)
  v_mfma_f32_16x16x32_bf16 v[144:147], v[184:187], v[48:51], v[144:147]
  v_mfma_f32_16x16x32_bf16 v[164:167], v[184:187], v[52:55], v[164:167]
  s_add_u32 s56, s20, 139264
  buffer_load_dwordx4 v[48:51], v1, s[16:19], s56 offen offset:0
  buffer_load_dwordx4 v[52:55], v3, s[16:19], s56 offen offset:0
  s_waitcnt vmcnt(31) lgkmcnt(4)
  v_mfma_f32_16x16x32_bf16 v[128:131], v[188:191], v[56:59], v[128:131]
  s_waitcnt vmcnt(30)
  v_mfma_f32_16x16x32_bf16 v[148:151], v[188:191], v[60:63], v[148:151]
  s_waitcnt lgkmcnt(0)
  s_waitcnt vmcnt(25)
  s_barrier
  ds_read_b128 v[168:171], v5 offset:40960
  v_mfma_f32_16x16x32_bf16 v[132:135], v[32:35], v[56:59], v[132:135]
  ds_read_b128 v[172:175], v5 offset:41984
  v_mfma_f32_16x16x32_bf16 v[152:155], v[32:35], v[60:63], v[152:155]
  ds_read_b128 v[176:179], v5 offset:43008
  v_mfma_f32_16x16x32_bf16 v[136:139], v[36:39], v[56:59], v[136:139]
  ds_read_b128 v[180:183], v5 offset:44032
  s_add_u32 m0, s50, 20480
  s_add_u32 s57, s22, 348160
  buffer_load_dwordx4 v4, s[16:19], s57 offen lds
  v_mfma_f32_16x16x32_bf16 v[156:159], v[36:39], v[60:63], v[156:159]
  ds_read_b128 v[184:187], v5 offset:45056
  buffer_load_dwordx4 v4, s[16:19], s57 offen offset:1024 lds
  v_mfma_f32_16x16x32_bf16 v[140:143], v[40:43], v[56:59], v[140:143]
  s_mov_b32 exec_hi, 0
  buffer_load_dwordx4 v4, s[16:19], s57 offen offset:2048 lds
  s_mov_b32 exec_hi, -1
  s_nop 0
  v_mfma_f32_16x16x32_bf16 v[160:163], v[40:43], v[60:63], v[160:163]
  v_mfma_f32_16x16x32_bf16 v[144:147], v[44:47], v[56:59], v[144:147]
  v_mfma_f32_16x16x32_bf16 v[164:167], v[44:47], v[60:63], v[164:167]
  s_add_u32 s56, s20, 139264
  buffer_load_dwordx4 v[56:59], v1, s[16:19], s56 offen offset:2048
  buffer_load_dwordx4 v[60:63], v3, s[16:19], s56 offen offset:2048
  s_waitcnt lgkmcnt(4)
  v_mfma_f32_16x16x32_bf16 v[128:131], v[168:171], v[112:115], v[128:131]
  ds_read_b128 v[188:191], v5 offset:46080
  v_mfma_f32_16x16x32_bf16 v[148:151], v[168:171], v[116:119], v[148:151]
  ds_read_b128 v[32:35], v5 offset:47104
  s_waitcnt lgkmcnt(5)
  v_mfma_f32_16x16x32_bf16 v[132:135], v[172:175], v[112:115], v[132:135]
  ds_read_b128 v[36:39], v5 offset:48128
  v_mfma_f32_16x16x32_bf16 v[152:155], v[172:175], v[116:119], v[152:155]
  ds_read_b128 v[40:43], v5 offset:49152
  s_waitcnt lgkmcnt(6)
  v_mfma_f32_16x16x32_bf16 v[136:139], v[176:179], v[112:115], v[136:139]
  ds_read_b128 v[44:47], v5 offset:50176
  v_mfma_f32_16x16x32_bf16 v[156:159], v[176:179], v[116:119], v[156:159]
  s_waitcnt lgkmcnt(6)
  v_mfma_f32_16x16x32_bf16 v[140:143], v[180:183], v[112:115], v[140:143]
  v_mfma_f32_16x16x32_bf16 v[160:163], v[180:183], v[116:119], v[160:163]
  s_waitcnt lgkmcnt(5)
  v_mfma_f32_16x16x32_bf16 v[144:147], v[184:187], v[112:115], v[144:147]
  v_mfma_f32_16x16x32_bf16 v[164:167], v[184:187], v[116:119], v[164:167]
  s_add_u32 s56, s20, 147456
  buffer_load_dwordx4 v[112:115], v1, s[16:19], s56 offen offset:0
  buffer_load_dwordx4 v[116:119], v3, s[16:19], s56 offen offset:0
  s_waitcnt vmcnt(31) lgkmcnt(4)
  v_mfma_f32_16x16x32_bf16 v[128:131], v[188:191], v[120:123], v[128:131]
  s_waitcnt vmcnt(30)
  v_mfma_f32_16x16x32_bf16 v[148:151], v[188:191], v[124:127], v[148:151]
  s_waitcnt lgkmcnt(0)
  s_waitcnt vmcnt(25)
  s_barrier
  ds_read_b128 v[168:171], v7 offset:0
  v_mfma_f32_16x16x32_bf16 v[132:135], v[32:35], v[120:123], v[132:135]
  ds_read_b128 v[172:175], v7 offset:1024
  v_mfma_f32_16x16x32_bf16 v[152:155], v[32:35], v[124:127], v[152:155]
  ds_read_b128 v[176:179], v7 offset:2048
  v_mfma_f32_16x16x32_bf16 v[136:139], v[36:39], v[120:123], v[136:139]
  ds_read_b128 v[180:183], v7 offset:3072
  s_add_u32 m0, s50, 40960
  s_add_u32 s57, s22, 368640
  buffer_load_dwordx4 v4, s[16:19], s57 offen lds
  v_mfma_f32_16x16x32_bf16 v[156:159], v[36:39], v[124:127], v[156:159]
  ds_read_b128 v[184:187], v7 offset:4096
  buffer_load_dwordx4 v4, s[16:19], s57 offen offset:1024 lds
  v_mfma_f32_16x16x32_bf16 v[140:143], v[40:43], v[120:123], v[140:143]
  s_mov_b32 exec_hi, 0
  buffer_load_dwordx4 v4, s[16:19], s57 offen offset:2048 lds
  s_mov_b32 exec_hi, -1
  s_nop 0
  v_mfma_f32_16x16x32_bf16 v[160:163], v[40:43], v[124:127], v[160:163]
  v_mfma_f32_16x16x32_bf16 v[144:147], v[44:47], v[120:123], v[144:147]
  v_mfma_f32_16x16x32_bf16 v[164:167], v[44:47], v[124:127], v[164:167]
  s_add_u32 s56, s20, 147456
  buffer_load_dwordx4 v[120:123], v1, s[16:19], s56 offen offset:2048
  buffer_load_dwordx4 v[124:127], v3, s[16:19], s56 offen offset:2048
  s_waitcnt lgkmcnt(4)
  v_mfma_f32_16x16x32_bf16 v[128:131], v[168:171], v[16:19], v[128:131]
  ds_read_b128 v[188:191], v7 offset:5120
  v_mfma_f32_16x16x32_bf16 v[148:151], v[168:171], v[20:23], v[148:151]
  ds_read_b128 v[32:35], v7 offset:6144
  s_waitcnt lgkmcnt(5)
  v_mfma_f32_16x16x32_bf16 v[132:135], v[172:175], v[16:19], v[132:135]
  ds_read_b128 v[36:39], v7 offset:7168
  v_mfma_f32_16x16x32_bf16 v[152:155], v[172:175], v[20:23], v[152:155]
  ds_read_b128 v[40:43], v7 offset:8192
  s_waitcnt lgkmcnt(6)
  v_mfma_f32_16x16x32_bf16 v[136:139], v[176:179], v[16:19], v[136:139]
  ds_read_b128 v[44:47], v7 offset:9216
  v_mfma_f32_16x16x32_bf16 v[156:159], v[176:179], v[20:23], v[156:159]
  s_waitcnt lgkmcnt(6)
  v_mfma_f32_16x16x32_bf16 v[140:143], v[180:183], v[16:19], v[140:143]
  v_mfma_f32_16x16x32_bf16 v[160:163], v[180:183], v[20:23], v[160:163]
  s_waitcnt lgkmcnt(5)
  v_mfma_f32_16x16x32_bf16 v[144:147], v[184:187], v[16:19], v[144:147]
  v_mfma_f32_16x16x32_bf16 v[164:167], v[184:187], v[20:23], v[164:167]
  s_add_u32 s56, s20, 155648
  buffer_load_dwordx4 v[16:19], v1, s[16:19], s56 offen offset:0
  buffer_load_dwordx4 v[20:23], v3, s[16:19], s56 offen offset:0
  s_waitcnt vmcnt(31) lgkmcnt(4)
  v_mfma_f32_16x16x32_bf16 v[128:131], v[188:191], v[24:27], v[128:131]
  s_waitcnt vmcnt(30)
  v_mfma_f32_16x16x32_bf16 v[148:151], v[188:191], v[28:31], v[148:151]
  s_waitcnt lgkmcnt(0)
  s_waitcnt vmcnt(25)
  s_barrier
  ds_read_b128 v[168:171], v6 offset:0
  v_mfma_f32_16x16x32_bf16 v[132:135], v[32:35], v[24:27], v[132:135]
  ds_read_b128 v[172:175], v6 offset:1024
  v_mfma_f32_16x16x32_bf16 v[152:155], v[32:35], v[28:31], v[152:155]
  ds_read_b128 v[176:179], v6 offset:2048
  v_mfma_f32_16x16x32_bf16 v[136:139], v[36:39], v[24:27], v[136:139]
  ds_read_b128 v[180:183], v6 offset:3072
  s_mov_b32 m0, s51
  s_add_u32 s57, s22, 389120
  buffer_load_dwordx4 v4, s[16:19], s57 offen lds
  v_mfma_f32_16x16x32_bf16 v[156:159], v[36:39], v[28:31], v[156:159]
  ds_read_b128 v[184:187], v6 offset:4096
  buffer_load_dwordx4 v4, s[16:19], s57 offen offset:1024 lds
  v_mfma_f32_16x16x32_bf16 v[140:143], v[40:43], v[24:27], v[140:143]
  s_mov_b32 exec_hi, 0
  buffer_load_dwordx4 v4, s[16:19], s57 offen offset:2048 lds
  s_mov_b32 exec_hi, -1
  s_nop 0
  v_mfma_f32_16x16x32_bf16 v[160:163], v[40:43], v[28:31], v[160:163]
  v_mfma_f32_16x16x32_bf16 v[144:147], v[44:47], v[24:27], v[144:147]
  v_mfma_f32_16x16x32_bf16 v[164:167], v[44:47], v[28:31], v[164:167]
  s_add_u32 s56, s20, 155648
  buffer_load_dwordx4 v[24:27], v1, s[16:19], s56 offen offset:2048
  buffer_load_dwordx4 v[28:31], v3, s[16:19], s56 offen offset:2048
  s_waitcnt lgkmcnt(4)
  v_mfma_f32_16x16x32_bf16 v[128:131], v[168:171], v[192:195], v[128:131]
  ds_read_b128 v[188:191], v6 offset:5120
  v_mfma_f32_16x16x32_bf16 v[148:151], v[168:171], v[196:199], v[148:151]
  ds_read_b128 v[32:35], v6 offset:6144
  s_waitcnt lgkmcnt(5)
  v_mfma_f32_16x16x32_bf16 v[132:135], v[172:175], v[192:195], v[132:135]
  ds_read_b128 v[36:39], v6 offset:7168
  v_mfma_f32_16x16x32_bf16 v[152:155], v[172:175], v[196:199], v[152:155]
  ds_read_b128 v[40:43], v6 offset:8192
  s_waitcnt lgkmcnt(6)
  v_mfma_f32_16x16x32_bf16 v[136:139], v[176:179], v[192:195], v[136:139]
  ds_read_b128 v[44:47], v6 offset:9216
  v_mfma_f32_16x16x32_bf16 v[156:159], v[176:179], v[196:199], v[156:159]
  s_waitcnt lgkmcnt(6)
  v_mfma_f32_16x16x32_bf16 v[140:143], v[180:183], v[192:195], v[140:143]
  v_mfma_f32_16x16x32_bf16 v[160:163], v[180:183], v[196:199], v[160:163]
  s_waitcnt lgkmcnt(5)
  v_mfma_f32_16x16x32_bf16 v[144:147], v[184:187], v[192:195], v[144:147]
  v_mfma_f32_16x16x32_bf16 v[164:167], v[184:187], v[196:199], v[164:167]
  s_add_u32 s56, s20, 163840
  buffer_load_dwordx4 v[192:195], v1, s[16:19], s56 offen offset:0
  buffer_load_dwordx4 v[196:199], v3, s[16:19], s56 offen offset:0
  s_waitcnt vmcnt(31) lgkmcnt(4)
  v_mfma_f32_16x16x32_bf16 v[128:131], v[188:191], v[200:203], v[128:131]
  s_waitcnt vmcnt(30)
  v_mfma_f32_16x16x32_bf16 v[148:151], v[188:191], v[204:207], v[148:151]
  s_waitcnt lgkmcnt(0)
  s_waitcnt vmcnt(25)
  s_barrier
  ds_read_b128 v[168:171], v5 offset:0
  v_mfma_f32_16x16x32_bf16 v[132:135], v[32:35], v[200:203], v[132:135]
  ds_read_b128 v[172:175], v5 offset:1024
  v_mfma_f32_16x16x32_bf16 v[152:155], v[32:35], v[204:207], v[152:155]
  ds_read_b128 v[176:179], v5 offset:2048
  v_mfma_f32_16x16x32_bf16 v[136:139], v[36:39], v[200:203], v[136:139]
  ds_read_b128 v[180:183], v5 offset:3072
  s_add_u32 m0, s41, 131072
  s_add_u32 s57, s22, 409600
  buffer_load_dwordx4 v4, s[16:19], s57 offen lds
  v_mfma_f32_16x16x32_bf16 v[156:159], v[36:39], v[204:207], v[156:159]
  ds_read_b128 v[184:187], v5 offset:4096
  buffer_load_dwordx4 v4, s[16:19], s57 offen offset:1024 lds
  v_mfma_f32_16x16x32_bf16 v[140:143], v[40:43], v[200:203], v[140:143]
  s_mov_b32 exec_hi, 0
  buffer_load_dwordx4 v4, s[16:19], s57 offen offset:2048 lds
  s_mov_b32 exec_hi, -1
  s_nop 0
  v_mfma_f32_16x16x32_bf16 v[160:163], v[40:43], v[204:207], v[160:163]
  v_mfma_f32_16x16x32_bf16 v[144:147], v[44:47], v[200:203], v[144:147]
  v_mfma_f32_16x16x32_bf16 v[164:167], v[44:47], v[204:207], v[164:167]
  s_add_u32 s56, s20, 163840
  buffer_load_dwordx4 v[200:203], v1, s[16:19], s56 offen offset:2048
  buffer_load_dwordx4 v[204:207], v3, s[16:19], s56 offen offset:2048
  s_waitcnt lgkmcnt(4)
  v_mfma_f32_16x16x32_bf16 v[128:131], v[168:171], v[208:211], v[128:131]
  ds_read_b128 v[188:191], v5 offset:5120
  v_mfma_f32_16x16x32_bf16 v[148:151], v[168:171], v[212:215], v[148:151]
  ds_read_b128 v[32:35], v5 offset:6144
  s_waitcnt lgkmcnt(5)
  v_mfma_f32_16x16x32_bf16 v[132:135], v[172:175], v[208:211], v[132:135]
  ds_read_b128 v[36:39], v5 offset:7168
  v_mfma_f32_16x16x32_bf16 v[152:155], v[172:175], v[212:215], v[152:155]
  ds_read_b128 v[40:43], v5 offset:8192
  s_waitcnt lgkmcnt(6)
  v_mfma_f32_16x16x32_bf16 v[136:139], v[176:179], v[208:211], v[136:139]
  ds_read_b128 v[44:47], v5 offset:9216
  v_mfma_f32_16x16x32_bf16 v[156:159], v[176:179], v[212:215], v[156:159]
  s_waitcnt lgkmcnt(6)
  v_mfma_f32_16x16x32_bf16 v[140:143], v[180:183], v[208:211], v[140:143]
  v_mfma_f32_16x16x32_bf16 v[160:163], v[180:183], v[212:215], v[160:163]
  s_waitcnt lgkmcnt(5)
  v_mfma_f32_16x16x32_bf16 v[144:147], v[184:187], v[208:211], v[144:147]
  v_mfma_f32_16x16x32_bf16 v[164:167], v[184:187], v[212:215], v[164:167]
  s_add_u32 s56, s20, 172032
  buffer_load_dwordx4 v[208:211], v1, s[16:19], s56 offen offset:0
  buffer_load_dwordx4 v[212:215], v3, s[16:19], s56 offen offset:0
  s_waitcnt vmcnt(31) lgkmcnt(4)
  v_mfma_f32_16x16x32_bf16 v[128:131], v[188:191], v[216:219], v[128:131]
  s_waitcnt vmcnt(30)
  v_mfma_f32_16x16x32_bf16 v[148:151], v[188:191], v[220:223], v[148:151]
  s_waitcnt lgkmcnt(0)
  s_waitcnt vmcnt(25)
  s_barrier
  ds_read_b128 v[168:171], v5 offset:20480
  v_mfma_f32_16x16x32_bf16 v[132:135], v[32:35], v[216:219], v[132:135]
  ds_read_b128 v[172:175], v5 offset:21504
  v_mfma_f32_16x16x32_bf16 v[152:155], v[32:35], v[220:223], v[152:155]
  ds_read_b128 v[176:179], v5 offset:22528
  v_mfma_f32_16x16x32_bf16 v[136:139], v[36:39], v[216:219], v[136:139]
  ds_read_b128 v[180:183], v5 offset:23552
  s_add_u32 m0, s50, 0
  s_add_u32 s57, s22, 430080
  buffer_load_dwordx4 v4, s[16:19], s57 offen lds
  v_mfma_f32_16x16x32_bf16 v[156:159], v[36:39], v[220:223], v[156:159]
  ds_read_b128 v[184:187], v5 offset:24576
  buffer_load_dwordx4 v4, s[16:19], s57 offen offset:1024 lds
  v_mfma_f32_16x16x32_bf16 v[140:143], v[40:43], v[216:219], v[140:143]
  s_mov_b32 exec_hi, 0
  buffer_load_dwordx4 v4, s[16:19], s57 offen offset:2048 lds
  s_mov_b32 exec_hi, -1
  s_nop 0
  v_mfma_f32_16x16x32_bf16 v[160:163], v[40:43], v[220:223], v[160:163]
  v_mfma_f32_16x16x32_bf16 v[144:147], v[44:47], v[216:219], v[144:147]
  v_mfma_f32_16x16x32_bf16 v[164:167], v[44:47], v[220:223], v[164:167]
  s_add_u32 s56, s20, 172032
  buffer_load_dwordx4 v[216:219], v1, s[16:19], s56 offen offset:2048
  buffer_load_dwordx4 v[220:223], v3, s[16:19], s56 offen offset:2048
  s_waitcnt lgkmcnt(4)
  v_mfma_f32_16x16x32_bf16 v[128:131], v[168:171], v[48:51], v[128:131]
  ds_read_b128 v[188:191], v5 offset:25600
  v_mfma_f32_16x16x32_bf16 v[148:151], v[168:171], v[52:55], v[148:151]
  ds_read_b128 v[32:35], v5 offset:26624
  s_waitcnt lgkmcnt(5)
  v_mfma_f32_16x16x32_bf16 v[132:135], v[172:175], v[48:51], v[132:135]
  ds_read_b128 v[36:39], v5 offset:27648
  v_mfma_f32_16x16x32_bf16 v[152:155], v[172:175], v[52:55], v[152:155]
  ds_read_b128 v[40:43], v5 offset:28672
  s_waitcnt lgkmcnt(6)
  v_mfma_f32_16x16x32_bf16 v[136:139], v[176:179], v[48:51], v[136:139]
  ds_read_b128 v[44:47], v5 offset:29696
  v_mfma_f32_16x16x32_bf16 v[156:159], v[176:179], v[52:55], v[156:159]
  s_waitcnt lgkmcnt(6)
  v_mfma_f32_16x16x32_bf16 v[140:143], v[180:183], v[48:51], v[140:143]
  v_mfma_f32_16x16x32_bf16 v[160:163], v[180:183], v[52:55], v[160:163]
  s_waitcnt lgkmcnt(5)
  v_mfma_f32_16x16x32_bf16 v[144:147], v[184:187], v[48:51], v[144:147]
  v_mfma_f32_16x16x32_bf16 v[164:167], v[184:187], v[52:55], v[164:167]
  s_add_u32 s56, s20, 180224
  buffer_load_dwordx4 v[48:51], v1, s[16:19], s56 offen offset:0
  buffer_load_dwordx4 v[52:55], v3, s[16:19], s56 offen offset:0
  s_waitcnt vmcnt(31) lgkmcnt(4)
  v_mfma_f32_16x16x32_bf16 v[128:131], v[188:191], v[56:59], v[128:131]
  s_waitcnt vmcnt(30)
  v_mfma_f32_16x16x32_bf16 v[148:151], v[188:191], v[60:63], v[148:151]
  s_waitcnt lgkmcnt(0)
  s_waitcnt vmcnt(25)
  s_barrier
  ds_read_b128 v[168:171], v5 offset:40960
  v_mfma_f32_16x16x32_bf16 v[132:135], v[32:35], v[56:59], v[132:135]
  ds_read_b128 v[172:175], v5 offset:41984
  v_mfma_f32_16x16x32_bf16 v[152:155], v[32:35], v[60:63], v[152:155]
  ds_read_b128 v[176:179], v5 offset:43008
  v_mfma_f32_16x16x32_bf16 v[136:139], v[36:39], v[56:59], v[136:139]
  ds_read_b128 v[180:183], v5 offset:44032
  s_add_u32 m0, s50, 20480
  s_add_u32 s57, s22, 450560
  buffer_load_dwordx4 v4, s[16:19], s57 offen lds
  v_mfma_f32_16x16x32_bf16 v[156:159], v[36:39], v[60:63], v[156:159]
  ds_read_b128 v[184:187], v5 offset:45056
  buffer_load_dwordx4 v4, s[16:19], s57 offen offset:1024 lds
  v_mfma_f32_16x16x32_bf16 v[140:143], v[40:43], v[56:59], v[140:143]
  s_mov_b32 exec_hi, 0
  buffer_load_dwordx4 v4, s[16:19], s57 offen offset:2048 lds
  s_mov_b32 exec_hi, -1
  s_nop 0
  v_mfma_f32_16x16x32_bf16 v[160:163], v[40:43], v[60:63], v[160:163]
  v_mfma_f32_16x16x32_bf16 v[144:147], v[44:47], v[56:59], v[144:147]
  v_mfma_f32_16x16x32_bf16 v[164:167], v[44:47], v[60:63], v[164:167]
  s_add_u32 s56, s20, 180224
  buffer_load_dwordx4 v[56:59], v1, s[16:19], s56 offen offset:2048
  buffer_load_dwordx4 v[60:63], v3, s[16:19], s56 offen offset:2048
  s_waitcnt lgkmcnt(4)
  v_mfma_f32_16x16x32_bf16 v[128:131], v[168:171], v[112:115], v[128:131]
  ds_read_b128 v[188:191], v5 offset:46080
  v_mfma_f32_16x16x32_bf16 v[148:151], v[168:171], v[116:119], v[148:151]
  ds_read_b128 v[32:35], v5 offset:47104
  s_waitcnt lgkmcnt(5)
  v_mfma_f32_16x16x32_bf16 v[132:135], v[172:175], v[112:115], v[132:135]
  ds_read_b128 v[36:39], v5 offset:48128
  v_mfma_f32_16x16x32_bf16 v[152:155], v[172:175], v[116:119], v[152:155]
  ds_read_b128 v[40:43], v5 offset:49152
  s_waitcnt lgkmcnt(6)
  v_mfma_f32_16x16x32_bf16 v[136:139], v[176:179], v[112:115], v[136:139]
  ds_read_b128 v[44:47], v5 offset:50176
  v_mfma_f32_16x16x32_bf16 v[156:159], v[176:179], v[116:119], v[156:159]
  s_waitcnt lgkmcnt(6)
  v_mfma_f32_16x16x32_bf16 v[140:143], v[180:183], v[112:115], v[140:143]
  v_mfma_f32_16x16x32_bf16 v[160:163], v[180:183], v[116:119], v[160:163]
  s_waitcnt lgkmcnt(5)
  v_mfma_f32_16x16x32_bf16 v[144:147], v[184:187], v[112:115], v[144:147]
  v_mfma_f32_16x16x32_bf16 v[164:167], v[184:187], v[116:119], v[164:167]
  s_add_u32 s56, s20, 188416
  buffer_load_dwordx4 v[112:115], v1, s[16:19], s56 offen offset:0
  buffer_load_dwordx4 v[116:119], v3, s[16:19], s56 offen offset:0
  s_waitcnt vmcnt(31) lgkmcnt(4)
  v_mfma_f32_16x16x32_bf16 v[128:131], v[188:191], v[120:123], v[128:131]
  s_waitcnt vmcnt(30)
  v_mfma_f32_16x16x32_bf16 v[148:151], v[188:191], v[124:127], v[148:151]
  s_waitcnt lgkmcnt(0)
  s_waitcnt vmcnt(25)
  s_barrier
  ds_read_b128 v[168:171], v7 offset:0
  v_mfma_f32_16x16x32_bf16 v[132:135], v[32:35], v[120:123], v[132:135]
  ds_read_b128 v[172:175], v7 offset:1024
  v_mfma_f32_16x16x32_bf16 v[152:155], v[32:35], v[124:127], v[152:155]
  ds_read_b128 v[176:179], v7 offset:2048
  v_mfma_f32_16x16x32_bf16 v[136:139], v[36:39], v[120:123], v[136:139]
  ds_read_b128 v[180:183], v7 offset:3072
  s_add_u32 m0, s50, 40960
  s_add_u32 s57, s22, 471040
  buffer_load_dwordx4 v4, s[16:19], s57 offen lds
  v_mfma_f32_16x16x32_bf16 v[156:159], v[36:39], v[124:127], v[156:159]
  ds_read_b128 v[184:187], v7 offset:4096
  buffer_load_dwordx4 v4, s[16:19], s57 offen offset:1024 lds
  v_mfma_f32_16x16x32_bf16 v[140:143], v[40:43], v[120:123], v[140:143]
  s_mov_b32 exec_hi, 0
  buffer_load_dwordx4 v4, s[16:19], s57 offen offset:2048 lds
  s_mov_b32 exec_hi, -1
  s_nop 0
  v_mfma_f32_16x16x32_bf16 v[160:163], v[40:43], v[124:127], v[160:163]
  v_mfma_f32_16x16x32_bf16 v[144:147], v[44:47], v[120:123], v[144:147]
  v_mfma_f32_16x16x32_bf16 v[164:167], v[44:47], v[124:127], v[164:167]
  s_add_u32 s56, s20, 188416
  buffer_load_dwordx4 v[120:123], v1, s[16:19], s56 offen offset:2048
  buffer_load_dwordx4 v[124:127], v3, s[16:19], s56 offen offset:2048
  s_waitcnt lgkmcnt(4)
  v_mfma_f32_16x16x32_bf16 v[128:131], v[168:171], v[16:19], v[128:131]
  ds_read_b128 v[188:191], v7 offset:5120
  v_mfma_f32_16x16x32_bf16 v[148:151], v[168:171], v[20:23], v[148:151]
  ds_read_b128 v[32:35], v7 offset:6144
  s_waitcnt lgkmcnt(5)
  v_mfma_f32_16x16x32_bf16 v[132:135], v[172:175], v[16:19], v[132:135]
  ds_read_b128 v[36:39], v7 offset:7168
  v_mfma_f32_16x16x32_bf16 v[152:155], v[172:175], v[20:23], v[152:155]
  ds_read_b128 v[40:43], v7 offset:8192
  s_waitcnt lgkmcnt(6)
  v_mfma_f32_16x16x32_bf16 v[136:139], v[176:179], v[16:19], v[136:139]
  ds_read_b128 v[44:47], v7 offset:9216
  v_mfma_f32_16x16x32_bf16 v[156:159], v[176:179], v[20:23], v[156:159]
  s_waitcnt lgkmcnt(6)
  v_mfma_f32_16x16x32_bf16 v[140:143], v[180:183], v[16:19], v[140:143]
  v_mfma_f32_16x16x32_bf16 v[160:163], v[180:183], v[20:23], v[160:163]
  s_waitcnt lgkmcnt(5)
  v_mfma_f32_16x16x32_bf16 v[144:147], v[184:187], v[16:19], v[144:147]
  v_mfma_f32_16x16x32_bf16 v[164:167], v[184:187], v[20:23], v[164:167]
  s_waitcnt vmcnt(29) lgkmcnt(4)
  v_mfma_f32_16x16x32_bf16 v[128:131], v[188:191], v[24:27], v[128:131]
  s_waitcnt vmcnt(28)
  v_mfma_f32_16x16x32_bf16 v[148:151], v[188:191], v[28:31], v[148:151]
  s_waitcnt lgkmcnt(0)
  s_waitcnt vmcnt(23)
  s_barrier
  ds_read_b128 v[168:171], v6 offset:0
  v_mfma_f32_16x16x32_bf16 v[132:135], v[32:35], v[24:27], v[132:135]
  ds_read_b128 v[172:175], v6 offset:1024
  v_mfma_f32_16x16x32_bf16 v[152:155], v[32:35], v[28:31], v[152:155]
  ds_read_b128 v[176:179], v6 offset:2048
  v_mfma_f32_16x16x32_bf16 v[136:139], v[36:39], v[24:27], v[136:139]
  ds_read_b128 v[180:183], v6 offset:3072
  v_mfma_f32_16x16x32_bf16 v[156:159], v[36:39], v[28:31], v[156:159]
  ds_read_b128 v[184:187], v6 offset:4096
  v_mfma_f32_16x16x32_bf16 v[140:143], v[40:43], v[24:27], v[140:143]
  v_mfma_f32_16x16x32_bf16 v[160:163], v[40:43], v[28:31], v[160:163]
  v_mfma_f32_16x16x32_bf16 v[144:147], v[44:47], v[24:27], v[144:147]
  v_mfma_f32_16x16x32_bf16 v[164:167], v[44:47], v[28:31], v[164:167]
  s_waitcnt lgkmcnt(4)
  v_mfma_f32_16x16x32_bf16 v[128:131], v[168:171], v[192:195], v[128:131]
  ds_read_b128 v[188:191], v6 offset:5120
  v_mov_b32 v12, 0x1
  buffer_load_dword v11, off, s[16:19], s45 sc0 sc1
  v_mfma_f32_16x16x32_bf16 v[148:151], v[168:171], v[196:199], v[148:151]
  ds_read_b128 v[32:35], v6 offset:6144
  s_waitcnt lgkmcnt(5)
  v_mfma_f32_16x16x32_bf16 v[132:135], v[172:175], v[192:195], v[132:135]
  ds_read_b128 v[36:39], v6 offset:7168
  v_mfma_f32_16x16x32_bf16 v[152:155], v[172:175], v[196:199], v[152:155]
  ds_read_b128 v[40:43], v6 offset:8192
  s_waitcnt lgkmcnt(6)
  v_mfma_f32_16x16x32_bf16 v[136:139], v[176:179], v[192:195], v[136:139]
  ds_read_b128 v[44:47], v6 offset:9216
  v_mfma_f32_16x16x32_bf16 v[156:159], v[176:179], v[196:199], v[156:159]
  s_waitcnt lgkmcnt(6)
  v_mfma_f32_16x16x32_bf16 v[140:143], v[180:183], v[192:195], v[140:143]
  v_mfma_f32_16x16x32_bf16 v[160:163], v[180:183], v[196:199], v[160:163]
  s_waitcnt lgkmcnt(5)
  v_mfma_f32_16x16x32_bf16 v[144:147], v[184:187], v[192:195], v[144:147]
  v_mfma_f32_16x16x32_bf16 v[164:167], v[184:187], v[196:199], v[164:167]
  s_waitcnt vmcnt(23) lgkmcnt(4)
  v_mfma_f32_16x16x32_bf16 v[128:131], v[188:191], v[200:203], v[128:131]
  s_waitcnt vmcnt(22)
  v_mfma_f32_16x16x32_bf16 v[148:151], v[188:191], v[204:207], v[148:151]
  s_waitcnt lgkmcnt(0)
  s_waitcnt vmcnt(17)
  s_barrier
  ds_read_b128 v[168:171], v5 offset:0
  v_mfma_f32_16x16x32_bf16 v[132:135], v[32:35], v[200:203], v[132:135]
  ds_read_b128 v[172:175], v5 offset:1024
  v_mfma_f32_16x16x32_bf16 v[152:155], v[32:35], v[204:207], v[152:155]
  ds_read_b128 v[176:179], v5 offset:2048
  v_mfma_f32_16x16x32_bf16 v[136:139], v[36:39], v[200:203], v[136:139]
  ds_read_b128 v[180:183], v5 offset:3072
  v_mfma_f32_16x16x32_bf16 v[156:159], v[36:39], v[204:207], v[156:159]
  ds_read_b128 v[184:187], v5 offset:4096
  v_mfma_f32_16x16x32_bf16 v[140:143], v[40:43], v[200:203], v[140:143]
  v_mfma_f32_16x16x32_bf16 v[160:163], v[40:43], v[204:207], v[160:163]
  v_mfma_f32_16x16x32_bf16 v[144:147], v[44:47], v[200:203], v[144:147]
  v_mfma_f32_16x16x32_bf16 v[164:167], v[44:47], v[204:207], v[164:167]
  s_waitcnt lgkmcnt(4)
  v_mfma_f32_16x16x32_bf16 v[128:131], v[168:171], v[208:211], v[128:131]
  ds_read_b128 v[188:191], v5 offset:5120
  v_mfma_f32_16x16x32_bf16 v[148:151], v[168:171], v[212:215], v[148:151]
  ds_read_b128 v[32:35], v5 offset:6144
  s_waitcnt lgkmcnt(5)
  v_mfma_f32_16x16x32_bf16 v[132:135], v[172:175], v[208:211], v[132:135]
  ds_read_b128 v[36:39], v5 offset:7168
  v_mfma_f32_16x16x32_bf16 v[152:155], v[172:175], v[212:215], v[152:155]
  ds_read_b128 v[40:43], v5 offset:8192
  s_waitcnt lgkmcnt(6)
  v_mfma_f32_16x16x32_bf16 v[136:139], v[176:179], v[208:211], v[136:139]
  ds_read_b128 v[44:47], v5 offset:9216
  v_mfma_f32_16x16x32_bf16 v[156:159], v[176:179], v[212:215], v[156:159]
  s_waitcnt lgkmcnt(6)
  v_mfma_f32_16x16x32_bf16 v[140:143], v[180:183], v[208:211], v[140:143]
  v_mfma_f32_16x16x32_bf16 v[160:163], v[180:183], v[212:215], v[160:163]
  s_waitcnt lgkmcnt(5)
  v_mfma_f32_16x16x32_bf16 v[144:147], v[184:187], v[208:211], v[144:147]
  v_mfma_f32_16x16x32_bf16 v[164:167], v[184:187], v[212:215], v[164:167]
  s_waitcnt vmcnt(16) lgkmcnt(4)
  v_mfma_f32_16x16x32_bf16 v[128:131], v[188:191], v[216:219], v[128:131]
  s_waitcnt vmcnt(15)
  v_mfma_f32_16x16x32_bf16 v[148:151], v[188:191], v[220:223], v[148:151]
  s_waitcnt lgkmcnt(0)
  s_waitcnt vmcnt(10)
  s_barrier
  ds_read_b128 v[168:171], v5 offset:20480
  v_mfma_f32_16x16x32_bf16 v[132:135], v[32:35], v[216:219], v[132:135]
  ds_read_b128 v[172:175], v5 offset:21504
  v_mfma_f32_16x16x32_bf16 v[152:155], v[32:35], v[220:223], v[152:155]
  ds_read_b128 v[176:179], v5 offset:22528
  v_mfma_f32_16x16x32_bf16 v[136:139], v[36:39], v[216:219], v[136:139]
  ds_read_b128 v[180:183], v5 offset:23552
  v_mfma_f32_16x16x32_bf16 v[156:159], v[36:39], v[220:223], v[156:159]
  ds_read_b128 v[184:187], v5 offset:24576
  v_mfma_f32_16x16x32_bf16 v[140:143], v[40:43], v[216:219], v[140:143]
  v_mfma_f32_16x16x32_bf16 v[160:163], v[40:43], v[220:223], v[160:163]
  v_mfma_f32_16x16x32_bf16 v[144:147], v[44:47], v[216:219], v[144:147]
  v_mfma_f32_16x16x32_bf16 v[164:167], v[44:47], v[220:223], v[164:167]
  s_waitcnt vmcnt(0)
  v_and_b32 v14, v11, v12
  v_cmp_ne_u32 vcc, v14, v12
  s_nop 0
  s_cbranch_vccnz .Lp3_late0
  s_waitcnt lgkmcnt(4)
  v_mfma_f32_16x16x32_bf16 v[128:131], v[168:171], v[48:51], v[128:131]
  ds_read_b128 v[188:191], v5 offset:25600
  buffer_load_dwordx4 v[64:67], v2, s[16:19], s43 offen offset:0 sc0 sc1
  v_mfma_f32_16x16x32_bf16 v[148:151], v[168:171], v[52:55], v[148:151]
  ds_read_b128 v[32:35], v5 offset:26624
  buffer_load_dwordx4 v[68:71], v2, s[16:19], s43 offen offset:1024 sc0 sc1
  s_waitcnt lgkmcnt(5)
  v_mfma_f32_16x16x32_bf16 v[132:135], v[172:175], v[48:51], v[132:135]
  ds_read_b128 v[36:39], v5 offset:27648
  buffer_load_dwordx2 v[72:73], v2, s[16:19], s43 offen offset:2048 sc0 sc1
  v_mfma_f32_16x16x32_bf16 v[152:155], v[172:175], v[52:55], v[152:155]
  ds_read_b128 v[40:43], v5 offset:28672
  s_waitcnt lgkmcnt(6)
  v_mfma_f32_16x16x32_bf16 v[136:139], v[176:179], v[48:51], v[136:139]
  ds_read_b128 v[44:47], v5 offset:29696
  v_mfma_f32_16x16x32_bf16 v[156:159], v[176:179], v[52:55], v[156:159]
  s_waitcnt lgkmcnt(6)
  v_mfma_f32_16x16x32_bf16 v[140:143], v[180:183], v[48:51], v[140:143]
  v_mfma_f32_16x16x32_bf16 v[160:163], v[180:183], v[52:55], v[160:163]
  s_waitcnt lgkmcnt(5)
  v_mfma_f32_16x16x32_bf16 v[144:147], v[184:187], v[48:51], v[144:147]
  v_mfma_f32_16x16x32_bf16 v[164:167], v[184:187], v[52:55], v[164:167]
  s_waitcnt lgkmcnt(4)
  v_mfma_f32_16x16x32_bf16 v[128:131], v[188:191], v[56:59], v[128:131]
  v_mfma_f32_16x16x32_bf16 v[148:151], v[188:191], v[60:63], v[148:151]
  s_waitcnt lgkmcnt(0)
  s_barrier
  ds_read_b128 v[168:171], v5 offset:40960
  v_mfma_f32_16x16x32_bf16 v[132:135], v[32:35], v[56:59], v[132:135]
  ds_read_b128 v[172:175], v5 offset:41984
  v_mfma_f32_16x16x32_bf16 v[152:155], v[32:35], v[60:63], v[152:155]
  ds_read_b128 v[176:179], v5 offset:43008
  v_mfma_f32_16x16x32_bf16 v[136:139], v[36:39], v[56:59], v[136:139]
  ds_read_b128 v[180:183], v5 offset:44032
  v_mfma_f32_16x16x32_bf16 v[156:159], v[36:39], v[60:63], v[156:159]
  ds_read_b128 v[184:187], v5 offset:45056
  v_mfma_f32_16x16x32_bf16 v[140:143], v[40:43], v[56:59], v[140:143]
  v_mfma_f32_16x16x32_bf16 v[160:163], v[40:43], v[60:63], v[160:163]
  v_mfma_f32_16x16x32_bf16 v[144:147], v[44:47], v[56:59], v[144:147]
  v_mfma_f32_16x16x32_bf16 v[164:167], v[44:47], v[60:63], v[164:167]
  s_waitcnt lgkmcnt(4)
  v_mfma_f32_16x16x32_bf16 v[128:131], v[168:171], v[112:115], v[128:131]
  ds_read_b128 v[188:191], v5 offset:46080
  v_mfma_f32_16x16x32_bf16 v[148:151], v[168:171], v[116:119], v[148:151]
  ds_read_b128 v[32:35], v5 offset:47104
  s_waitcnt lgkmcnt(5)
  v_mfma_f32_16x16x32_bf16 v[132:135], v[172:175], v[112:115], v[132:135]
  ds_read_b128 v[36:39], v5 offset:48128
  v_mfma_f32_16x16x32_bf16 v[152:155], v[172:175], v[116:119], v[152:155]
  ds_read_b128 v[40:43], v5 offset:49152
  s_waitcnt lgkmcnt(6)
  v_mfma_f32_16x16x32_bf16 v[136:139], v[176:179], v[112:115], v[136:139]
  ds_read_b128 v[44:47], v5 offset:50176
  v_mfma_f32_16x16x32_bf16 v[156:159], v[176:179], v[116:119], v[156:159]
  s_waitcnt lgkmcnt(6)
  v_mfma_f32_16x16x32_bf16 v[140:143], v[180:183], v[112:115], v[140:143]
  v_mfma_f32_16x16x32_bf16 v[160:163], v[180:183], v[116:119], v[160:163]
  s_waitcnt lgkmcnt(5)
  v_mfma_f32_16x16x32_bf16 v[144:147], v[184:187], v[112:115], v[144:147]
  v_mfma_f32_16x16x32_bf16 v[164:167], v[184:187], v[116:119], v[164:167]
  s_waitcnt lgkmcnt(4)
  v_mfma_f32_16x16x32_bf16 v[148:151], v[188:191], v[124:127], v[148:151]
  s_waitcnt lgkmcnt(3)
  v_mfma_f32_16x16x32_bf16 v[152:155], v[32:35], v[124:127], v[152:155]
  s_waitcnt lgkmcnt(2)
  v_mfma_f32_16x16x32_bf16 v[156:159], v[36:39], v[124:127], v[156:159]
  s_waitcnt lgkmcnt(1)
  v_mfma_f32_16x16x32_bf16 v[160:163], v[40:43], v[124:127], v[160:163]
  s_waitcnt lgkmcnt(0)
  v_mfma_f32_16x16x32_bf16 v[164:167], v[44:47], v[124:127], v[164:167]
  v_mfma_f32_16x16x32_bf16 v[128:131], v[188:191], v[120:123], v[128:131]
  v_mfma_f32_16x16x32_bf16 v[132:135], v[32:35], v[120:123], v[132:135]
  v_mfma_f32_16x16x32_bf16 v[136:139], v[36:39], v[120:123], v[136:139]
  v_mfma_f32_16x16x32_bf16 v[140:143], v[40:43], v[120:123], v[140:143]
  v_mfma_f32_16x16x32_bf16 v[144:147], v[44:47], v[120:123], v[144:147]
  ds_write_b128 v8, v[148:151] offset:0
  ds_write_b128 v8, v[152:155] offset:1024
  ds_write_b128 v8, v[156:159] offset:2048
  ds_write_b128 v8, v[160:163] offset:3072
  ds_write_b128 v8, v[164:167] offset:4096
  s_mul_i32 s55, s42, 81920
  s_mul_i32 s56, s48, 320
  s_add_u32 s55, s55, s56
  s_waitcnt lgkmcnt(0)
  s_barrier
  ds_read_b128 v[148:151], v9 offset:0
  ds_read_b128 v[152:155], v9 offset:1024
  ds_read_b128 v[156:159], v9 offset:2048
  ds_read_b128 v[160:163], v9 offset:3072
  ds_read_b128 v[164:167], v9 offset:4096
  s_waitcnt lgkmcnt(4)
  v_add_f32 v128, v128, v148
  v_add_f32 v129, v129, v149
  v_add_f32 v130, v130, v150
  v_add_f32 v131, v131, v151
  s_waitcnt vmcnt(2)
  v_lshlrev_b32 v74, 16, v64
  v_and_b32 v64, 0xffff0000, v64
  v_add_f32 v128, v128, v74
  v_add_f32 v129, v129, v64
  v_lshlrev_b32 v75, 16, v65
  v_and_b32 v65, 0xffff0000, v65
  v_add_f32 v130, v130, v75
  v_add_f32 v131, v131, v65
  buffer_store_dwordx4 v[128:131], v10, s[4:7], s55 offen offset:2560
  s_waitcnt lgkmcnt(3)
  v_add_f32 v132, v132, v152
  v_add_f32 v133, v133, v153
  v_add_f32 v134, v134, v154
  v_add_f32 v135, v135, v155
  v_lshlrev_b32 v74, 16, v66
  v_and_b32 v66, 0xffff0000, v66
  v_add_f32 v132, v132, v74
  v_add_f32 v133, v133, v66
  v_lshlrev_b32 v75, 16, v67
  v_and_b32 v67, 0xffff0000, v67
  v_add_f32 v134, v134, v75
  v_add_f32 v135, v135, v67
  buffer_store_dwordx4 v[132:135], v10, s[4:7], s55 offen offset:2624
  s_waitcnt lgkmcnt(2)
  v_add_f32 v136, v136, v156
  v_add_f32 v137, v137, v157
  v_add_f32 v138, v138, v158
  v_add_f32 v139, v139, v159
  s_waitcnt vmcnt(3)
  v_lshlrev_b32 v74, 16, v68
  v_and_b32 v68, 0xffff0000, v68
  v_add_f32 v136, v136, v74
  v_add_f32 v137, v137, v68
  v_lshlrev_b32 v75, 16, v69
  v_and_b32 v69, 0xffff0000, v69
  v_add_f32 v138, v138, v75
  v_add_f32 v139, v139, v69
  buffer_store_dwordx4 v[136:139], v10, s[4:7], s55 offen offset:2688
  s_waitcnt lgkmcnt(1)
  v_add_f32 v140, v140, v160
  v_add_f32 v141, v141, v161
  v_add_f32 v142, v142, v162
  v_add_f32 v143, v143, v163
  v_lshlrev_b32 v74, 16, v70
  v_and_b32 v70, 0xffff0000, v70
  v_add_f32 v140, v140, v74
  v_add_f32 v141, v141, v70
  v_lshlrev_b32 v75, 16, v71
  v_and_b32 v71, 0xffff0000, v71
  v_add_f32 v142, v142, v75
  v_add_f32 v143, v143, v71
  buffer_store_dwordx4 v[140:143], v10, s[4:7], s55 offen offset:2752
  s_waitcnt lgkmcnt(0)
  v_add_f32 v144, v144, v164
  v_add_f32 v145, v145, v165
  v_add_f32 v146, v146, v166
  v_add_f32 v147, v147, v167
  s_waitcnt vmcnt(4)
  v_lshlrev_b32 v74, 16, v72
  v_and_b32 v72, 0xffff0000, v72
  v_add_f32 v144, v144, v74
  v_add_f32 v145, v145, v72
  v_lshlrev_b32 v75, 16, v73
  v_and_b32 v73, 0xffff0000, v73
  v_add_f32 v146, v146, v75
  v_add_f32 v147, v147, v73
  buffer_store_dwordx4 v[144:147], v10, s[4:7], s55 offen offset:2816
  s_endpgm
.Lp3_late0:
  s_waitcnt lgkmcnt(4)
  v_mfma_f32_16x16x32_bf16 v[128:131], v[168:171], v[48:51], v[128:131]
  ds_read_b128 v[188:191], v5 offset:25600
  v_mfma_f32_16x16x32_bf16 v[148:151], v[168:171], v[52:55], v[148:151]
  ds_read_b128 v[32:35], v5 offset:26624
  s_waitcnt lgkmcnt(5)
  v_mfma_f32_16x16x32_bf16 v[132:135], v[172:175], v[48:51], v[132:135]
  ds_read_b128 v[36:39], v5 offset:27648
  v_mfma_f32_16x16x32_bf16 v[152:155], v[172:175], v[52:55], v[152:155]
  ds_read_b128 v[40:43], v5 offset:28672
  s_waitcnt lgkmcnt(6)
  v_mfma_f32_16x16x32_bf16 v[136:139], v[176:179], v[48:51], v[136:139]
  ds_read_b128 v[44:47], v5 offset:29696
  v_mfma_f32_16x16x32_bf16 v[156:159], v[176:179], v[52:55], v[156:159]
  s_waitcnt lgkmcnt(6)
  v_mfma_f32_16x16x32_bf16 v[140:143], v[180:183], v[48:51], v[140:143]
  v_mfma_f32_16x16x32_bf16 v[160:163], v[180:183], v[52:55], v[160:163]
  s_waitcnt lgkmcnt(5)
  v_mfma_f32_16x16x32_bf16 v[144:147], v[184:187], v[48:51], v[144:147]
  v_mfma_f32_16x16x32_bf16 v[164:167], v[184:187], v[52:55], v[164:167]
  s_waitcnt lgkmcnt(4)
  v_mfma_f32_16x16x32_bf16 v[128:131], v[188:191], v[56:59], v[128:131]
  v_mfma_f32_16x16x32_bf16 v[148:151], v[188:191], v[60:63], v[148:151]
  s_waitcnt lgkmcnt(0)
  s_barrier
  ds_read_b128 v[168:171], v5 offset:40960
  v_mfma_f32_16x16x32_bf16 v[132:135], v[32:35], v[56:59], v[132:135]
  ds_read_b128 v[172:175], v5 offset:41984
  v_mfma_f32_16x16x32_bf16 v[152:155], v[32:35], v[60:63], v[152:155]
  ds_read_b128 v[176:179], v5 offset:43008
  v_mfma_f32_16x16x32_bf16 v[136:139], v[36:39], v[56:59], v[136:139]
  ds_read_b128 v[180:183], v5 offset:44032
  v_mfma_f32_16x16x32_bf16 v[156:159], v[36:39], v[60:63], v[156:159]
  ds_read_b128 v[184:187], v5 offset:45056
  v_mfma_f32_16x16x32_bf16 v[140:143], v[40:43], v[56:59], v[140:143]
  v_mfma_f32_16x16x32_bf16 v[160:163], v[40:43], v[60:63], v[160:163]
  v_mfma_f32_16x16x32_bf16 v[144:147], v[44:47], v[56:59], v[144:147]
  v_mfma_f32_16x16x32_bf16 v[164:167], v[44:47], v[60:63], v[164:167]
  s_waitcnt lgkmcnt(4)
  v_mfma_f32_16x16x32_bf16 v[128:131], v[168:171], v[112:115], v[128:131]
  ds_read_b128 v[188:191], v5 offset:46080
  buffer_load_dword v11, off, s[16:19], s45 sc0 sc1
  v_mfma_f32_16x16x32_bf16 v[148:151], v[168:171], v[116:119], v[148:151]
  ds_read_b128 v[32:35], v5 offset:47104
  s_waitcnt lgkmcnt(5)
  v_mfma_f32_16x16x32_bf16 v[132:135], v[172:175], v[112:115], v[132:135]
  ds_read_b128 v[36:39], v5 offset:48128
  v_mfma_f32_16x16x32_bf16 v[152:155], v[172:175], v[116:119], v[152:155]
  ds_read_b128 v[40:43], v5 offset:49152
  s_waitcnt lgkmcnt(6)
  v_mfma_f32_16x16x32_bf16 v[136:139], v[176:179], v[112:115], v[136:139]
  ds_read_b128 v[44:47], v5 offset:50176
  v_mfma_f32_16x16x32_bf16 v[156:159], v[176:179], v[116:119], v[156:159]
  s_waitcnt lgkmcnt(6)
  v_mfma_f32_16x16x32_bf16 v[140:143], v[180:183], v[112:115], v[140:143]
  v_mfma_f32_16x16x32_bf16 v[160:163], v[180:183], v[116:119], v[160:163]
  s_waitcnt lgkmcnt(5)
  v_mfma_f32_16x16x32_bf16 v[144:147], v[184:187], v[112:115], v[144:147]
  v_mfma_f32_16x16x32_bf16 v[164:167], v[184:187], v[116:119], v[164:167]
  s_waitcnt lgkmcnt(4)
  v_mfma_f32_16x16x32_bf16 v[148:151], v[188:191], v[124:127], v[148:151]
  s_waitcnt lgkmcnt(3)
  v_mfma_f32_16x16x32_bf16 v[152:155], v[32:35], v[124:127], v[152:155]
  s_waitcnt lgkmcnt(2)
  v_mfma_f32_16x16x32_bf16 v[156:159], v[36:39], v[124:127], v[156:159]
  s_waitcnt lgkmcnt(1)
  v_mfma_f32_16x16x32_bf16 v[160:163], v[40:43], v[124:127], v[160:163]
  s_waitcnt lgkmcnt(0)
  v_mfma_f32_16x16x32_bf16 v[164:167], v[44:47], v[124:127], v[164:167]
  v_mfma_f32_16x16x32_bf16 v[128:131], v[188:191], v[120:123], v[128:131]
  v_mfma_f32_16x16x32_bf16 v[132:135], v[32:35], v[120:123], v[132:135]
  v_mfma_f32_16x16x32_bf16 v[136:139], v[36:39], v[120:123], v[136:139]
  v_mfma_f32_16x16x32_bf16 v[140:143], v[40:43], v[120:123], v[140:143]
  v_mfma_f32_16x16x32_bf16 v[144:147], v[44:47], v[120:123], v[144:147]
  ds_write_b128 v8, v[148:151] offset:0
  ds_write_b128 v8, v[152:155] offset:1024
  ds_write_b128 v8, v[156:159] offset:2048
  ds_write_b128 v8, v[160:163] offset:3072
  ds_write_b128 v8, v[164:167] offset:4096
  s_waitcnt lgkmcnt(0)
  s_barrier
  ds_read_b128 v[148:151], v9 offset:0
  ds_read_b128 v[152:155], v9 offset:1024
  ds_read_b128 v[156:159], v9 offset:2048
  ds_read_b128 v[160:163], v9 offset:3072
  ds_read_b128 v[164:167], v9 offset:4096
  s_waitcnt vmcnt(0)
.Lpl125c:
  v_and_b32 v14, v11, v12
  v_cmp_ne_u32 vcc, v14, v12
  s_nop 0
  s_cbranch_vccnz .Lpl125s
.Lpl125k:
  buffer_load_dwordx4 v[64:67], v2, s[16:19], s43 offen offset:0 sc0 sc1
  buffer_load_dwordx4 v[68:71], v2, s[16:19], s43 offen offset:1024 sc0 sc1
  buffer_load_dwordx2 v[72:73], v2, s[16:19], s43 offen offset:2048 sc0 sc1
  s_mul_i32 s55, s42, 81920
  s_mul_i32 s56, s48, 320
  s_add_u32 s55, s55, s56
  s_waitcnt lgkmcnt(4)
  v_add_f32 v128, v128, v148
  v_add_f32 v129, v129, v149
  v_add_f32 v130, v130, v150
  v_add_f32 v131, v131, v151
  s_waitcnt vmcnt(2)
  v_lshlrev_b32 v74, 16, v64
  v_and_b32 v64, 0xffff0000, v64
  v_add_f32 v128, v128, v74
  v_add_f32 v129, v129, v64
  v_lshlrev_b32 v75, 16, v65
  v_and_b32 v65, 0xffff0000, v65
  v_add_f32 v130, v130, v75
  v_add_f32 v131, v131, v65
  buffer_store_dwordx4 v[128:131], v10, s[4:7], s55 offen offset:2560
  s_waitcnt lgkmcnt(3)
  v_add_f32 v132, v132, v152
  v_add_f32 v133, v133, v153
  v_add_f32 v134, v134, v154
  v_add_f32 v135, v135, v155
  v_lshlrev_b32 v74, 16, v66
  v_and_b32 v66, 0xffff0000, v66
  v_add_f32 v132, v132, v74
  v_add_f32 v133, v133, v66
  v_lshlrev_b32 v75, 16, v67
  v_and_b32 v67, 0xffff0000, v67
  v_add_f32 v134, v134, v75
  v_add_f32 v135, v135, v67
  buffer_store_dwordx4 v[132:135], v10, s[4:7], s55 offen offset:2624
  s_waitcnt lgkmcnt(2)
  v_add_f32 v136, v136, v156
  v_add_f32 v137, v137, v157
  v_add_f32 v138, v138, v158
  v_add_f32 v139, v139, v159
  s_waitcnt vmcnt(3)
  v_lshlrev_b32 v74, 16, v68
  v_and_b32 v68, 0xffff0000, v68
  v_add_f32 v136, v136, v74
  v_add_f32 v137, v137, v68
  v_lshlrev_b32 v75, 16, v69
  v_and_b32 v69, 0xffff0000, v69
  v_add_f32 v138, v138, v75
  v_add_f32 v139, v139, v69
  buffer_store_dwordx4 v[136:139], v10, s[4:7], s55 offen offset:2688
  s_waitcnt lgkmcnt(1)
  v_add_f32 v140, v140, v160
  v_add_f32 v141, v141, v161
  v_add_f32 v142, v142, v162
  v_add_f32 v143, v143, v163
  v_lshlrev_b32 v74, 16, v70
  v_and_b32 v70, 0xffff0000, v70
  v_add_f32 v140, v140, v74
  v_add_f32 v141, v141, v70
  v_lshlrev_b32 v75, 16, v71
  v_and_b32 v71, 0xffff0000, v71
  v_add_f32 v142, v142, v75
  v_add_f32 v143, v143, v71
  buffer_store_dwordx4 v[140:143], v10, s[4:7], s55 offen offset:2752
  s_waitcnt lgkmcnt(0)
  v_add_f32 v144, v144, v164
  v_add_f32 v145, v145, v165
  v_add_f32 v146, v146, v166
  v_add_f32 v147, v147, v167
  s_waitcnt vmcnt(4)
  v_lshlrev_b32 v74, 16, v72
  v_and_b32 v72, 0xffff0000, v72
  v_add_f32 v144, v144, v74
  v_add_f32 v145, v145, v72
  v_lshlrev_b32 v75, 16, v73
  v_and_b32 v73, 0xffff0000, v73
  v_add_f32 v146, v146, v75
  v_add_f32 v147, v147, v73
  buffer_store_dwordx4 v[144:147], v10, s[4:7], s55 offen offset:2816
  s_endpgm
.Lp3_r1:
  s_barrier
  ds_read_b128 v[168:171], v6 offset:0
  ds_read_b128 v[172:175], v6 offset:1024
  ds_read_b128 v[176:179], v6 offset:2048
  ds_read_b128 v[180:183], v6 offset:3072
  ds_read_b128 v[184:187], v6 offset:4096
  s_cmp_ge_u32 s52, 4
  s_cbranch_scc1 .Lp3_x1
  s_add_u32 s56, s20, 24576
  buffer_load_dwordx4 v[112:115], v1, s[16:19], s56 offen offset:0
  buffer_load_dwordx4 v[116:119], v3, s[16:19], s56 offen offset:0
  s_add_u32 s56, s20, 24576
  buffer_load_dwordx4 v[120:123], v1, s[16:19], s56 offen offset:2048
  buffer_load_dwordx4 v[124:127], v3, s[16:19], s56 offen offset:2048
  s_add_u32 s56, s20, 32768
  buffer_load_dwordx4 v[16:19], v1, s[16:19], s56 offen offset:0
  buffer_load_dwordx4 v[20:23], v3, s[16:19], s56 offen offset:0
  s_add_u32 s56, s20, 32768
  buffer_load_dwordx4 v[24:27], v1, s[16:19], s56 offen offset:2048
  buffer_load_dwordx4 v[28:31], v3, s[16:19], s56 offen offset:2048
.Lp3_x1:
  s_mov_b32 m0, s51
  s_add_u32 s57, s22, 81920
  buffer_load_dwordx4 v4, s[16:19], s57 offen lds
  buffer_load_dwordx4 v4, s[16:19], s57 offen offset:1024 lds
  s_mov_b32 exec_hi, 0
  buffer_load_dwordx4 v4, s[16:19], s57 offen offset:2048 lds
  s_mov_b32 exec_hi, -1
  s_waitcnt vmcnt(30) lgkmcnt(4)
  v_mfma_f32_16x16x32_bf16 v[128:131], v[168:171], v[192:195], 0
  ds_read_b128 v[188:191], v6 offset:5120
  s_sub_u32 s55, s27, 131072
  v_add_u32 v5, s55, v6
  s_waitcnt vmcnt(29)
  v_mfma_f32_16x16x32_bf16 v[148:151], v[168:171], v[196:199], 0
  ds_read_b128 v[32:35], v6 offset:6144
  s_sub_u32 s55, s40, 131072
  v_add_u32 v7, s55, v6
  s_waitcnt lgkmcnt(5)
  v_mfma_f32_16x16x32_bf16 v[132:135], v[172:175], v[192:195], 0
  ds_read_b128 v[36:39], v6 offset:7168
  s_mul_i32 s55, s52, 5120
  s_add_u32 s55, s55, s40
  s_add_u32 s55, s55, 20480
  v_add_u32 v8, s55, v2
  v_mfma_f32_16x16x32_bf16 v[152:155], v[172:175], v[196:199], 0
  ds_read_b128 v[40:43], v6 offset:8192
  s_xor_b32 s55, s52, 4
  s_mul_i32 s55, s55, 5120
  s_add_u32 s55, s55, s40
  s_add_u32 s55, s55, 20480
  v_add_u32 v9, s55, v2
  s_waitcnt lgkmcnt(6)
  v_mfma_f32_16x16x32_bf16 v[136:139], v[176:179], v[192:195], 0
  ds_read_b128 v[44:47], v6 offset:9216
  v_and_b32 v10, 15, v0
  v_mul_u32_u24 v10, 5120, v10
  v_mfma_f32_16x16x32_bf16 v[156:159], v[176:179], v[196:199], 0
  v_and_b32 v14, 48, v0
  v_add_u32 v10, v10, v14
  s_waitcnt lgkmcnt(6)
  v_mfma_f32_16x16x32_bf16 v[140:143], v[180:183], v[192:195], 0
  v_mfma_f32_16x16x32_bf16 v[160:163], v[180:183], v[196:199], 0
  s_waitcnt lgkmcnt(5)
  v_mfma_f32_16x16x32_bf16 v[144:147], v[184:187], v[192:195], 0
  v_mfma_f32_16x16x32_bf16 v[164:167], v[184:187], v[196:199], 0
  s_add_u32 s56, s20, 40960
  buffer_load_dwordx4 v[192:195], v1, s[16:19], s56 offen offset:0
  buffer_load_dwordx4 v[196:199], v3, s[16:19], s56 offen offset:0
  s_waitcnt vmcnt(30) lgkmcnt(4)
  v_mfma_f32_16x16x32_bf16 v[128:131], v[188:191], v[200:203], v[128:131]
  v_min_u32 v13, 31, v0
  v_subrev_u32 v12, s26, v0
  v_cmp_gt_u32 vcc, 12, v12
  s_nop 1
  v_cndmask_b32 v12, 0, 1, vcc
  s_waitcnt vmcnt(29)
  v_mfma_f32_16x16x32_bf16 v[148:151], v[188:191], v[204:207], v[148:151]
  s_waitcnt lgkmcnt(0)
  s_barrier
  ds_read_b128 v[168:171], v5 offset:0
  v_mfma_f32_16x16x32_bf16 v[132:135], v[32:35], v[200:203], v[132:135]
  ds_read_b128 v[172:175], v5 offset:1024
  v_mfma_f32_16x16x32_bf16 v[152:155], v[32:35], v[204:207], v[152:155]
  ds_read_b128 v[176:179], v5 offset:2048
  v_mfma_f32_16x16x32_bf16 v[136:139], v[36:39], v[200:203], v[136:139]
  ds_read_b128 v[180:183], v5 offset:3072
  s_add_u32 m0, s41, 131072
  s_add_u32 s57, s22, 102400
  buffer_load_dwordx4 v4, s[16:19], s57 offen lds
  v_mfma_f32_16x16x32_bf16 v[156:159], v[36:39], v[204:207], v[156:159]
  ds_read_b128 v[184:187], v5 offset:4096
  buffer_load_dwordx4 v4, s[16:19], s57 offen offset:1024 lds
  v_mfma_f32_16x16x32_bf16 v[140:143], v[40:43], v[200:203], v[140:143]
  s_mov_b32 exec_hi, 0
  buffer_load_dwordx4 v4, s[16:19], s57 offen offset:2048 lds
  s_mov_b32 exec_hi, -1
  s_nop 0
  v_mfma_f32_16x16x32_bf16 v[160:163], v[40:43], v[204:207], v[160:163]
  v_mfma_f32_16x16x32_bf16 v[144:147], v[44:47], v[200:203], v[144:147]
  v_mfma_f32_16x16x32_bf16 v[164:167], v[44:47], v[204:207], v[164:167]
  s_add_u32 s56, s20, 40960
  buffer_load_dwordx4 v[200:203], v1, s[16:19], s56 offen offset:2048
  buffer_load_dwordx4 v[204:207], v3, s[16:19], s56 offen offset:2048
  s_waitcnt vmcnt(18)
  s_cmp_eq_u32 s89, 0
  s_cbranch_scc1 .Lcf126
  v_mov_b32 v14, 1
  s_mov_b64 exec, 1
  buffer_store_byte v14, off, s[16:19], s89 sc0 sc1
  s_mov_b64 exec, -1
  s_mov_b32 s89, 0
.Lcf126:
  s_waitcnt lgkmcnt(4)
  v_mfma_f32_16x16x32_bf16 v[128:131], v[168:171], v[208:211], v[128:131]
  ds_read_b128 v[188:191], v5 offset:5120
  v_mfma_f32_16x16x32_bf16 v[148:151], v[168:171], v[212:215], v[148:151]
  ds_read_b128 v[32:35], v5 offset:6144
  s_waitcnt lgkmcnt(5)
  v_mfma_f32_16x16x32_bf16 v[132:135], v[172:175], v[208:211], v[132:135]
  ds_read_b128 v[36:39], v5 offset:7168
  v_mfma_f32_16x16x32_bf16 v[152:155], v[172:175], v[212:215], v[152:155]
  ds_read_b128 v[40:43], v5 offset:8192
  s_waitcnt lgkmcnt(6)
  v_mfma_f32_16x16x32_bf16 v[136:139], v[176:179], v[208:211], v[136:139]
  ds_read_b128 v[44:47], v5 offset:9216
  v_mfma_f32_16x16x32_bf16 v[156:159], v[176:179], v[212:215], v[156:159]
  s_waitcnt lgkmcnt(6)
  v_mfma_f32_16x16x32_bf16 v[140:143], v[180:183], v[208:211], v[140:143]
  v_mfma_f32_16x16x32_bf16 v[160:163], v[180:183], v[212:215], v[160:163]
  s_waitcnt lgkmcnt(5)
  v_mfma_f32_16x16x32_bf16 v[144:147], v[184:187], v[208:211], v[144:147]
  v_mfma_f32_16x16x32_bf16 v[164:167], v[184:187], v[212:215], v[164:167]
  s_add_u32 s56, s20, 49152
  buffer_load_dwordx4 v[208:211], v1, s[16:19], s56 offen offset:0
  buffer_load_dwordx4 v[212:215], v3, s[16:19], s56 offen offset:0
  s_waitcnt lgkmcnt(4)
  v_mfma_f32_16x16x32_bf16 v[128:131], v[188:191], v[216:219], v[128:131]
  v_mfma_f32_16x16x32_bf16 v[148:151], v[188:191], v[220:223], v[148:151]
  s_waitcnt lgkmcnt(0)
  s_barrier
  ds_read_b128 v[168:171], v5 offset:20480
  v_mfma_f32_16x16x32_bf16 v[132:135], v[32:35], v[216:219], v[132:135]
  ds_read_b128 v[172:175], v5 offset:21504
  v_mfma_f32_16x16x32_bf16 v[152:155], v[32:35], v[220:223], v[152:155]
  ds_read_b128 v[176:179], v5 offset:22528
  v_mfma_f32_16x16x32_bf16 v[136:139], v[36:39], v[216:219], v[136:139]
  ds_read_b128 v[180:183], v5 offset:23552
  s_add_u32 m0, s50, 0
  s_add_u32 s57, s22, 122880
  buffer_load_dwordx4 v4, s[16:19], s57 offen lds
  v_mfma_f32_16x16x32_bf16 v[156:159], v[36:39], v[220:223], v[156:159]
  ds_read_b128 v[184:187], v5 offset:24576
  buffer_load_dwordx4 v4, s[16:19], s57 offen offset:1024 lds
  v_mfma_f32_16x16x32_bf16 v[140:143], v[40:43], v[216:219], v[140:143]
  s_mov_b32 exec_hi, 0
  buffer_load_dwordx4 v4, s[16:19], s57 offen offset:2048 lds
  s_mov_b32 exec_hi, -1
  s_nop 0
  v_mfma_f32_16x16x32_bf16 v[160:163], v[40:43], v[220:223], v[160:163]
  v_mfma_f32_16x16x32_bf16 v[144:147], v[44:47], v[216:219], v[144:147]
  v_mfma_f32_16x16x32_bf16 v[164:167], v[44:47], v[220:223], v[164:167]
  s_add_u32 s56, s20, 49152
  buffer_load_dwordx4 v[216:219], v1, s[16:19], s56 offen offset:2048
  buffer_load_dwordx4 v[220:223], v3, s[16:19], s56 offen offset:2048
  s_waitcnt lgkmcnt(4)
  v_mfma_f32_16x16x32_bf16 v[128:131], v[168:171], v[48:51], v[128:131]
  ds_read_b128 v[188:191], v5 offset:25600
  v_mfma_f32_16x16x32_bf16 v[148:151], v[168:171], v[52:55], v[148:151]
  ds_read_b128 v[32:35], v5 offset:26624
  s_waitcnt lgkmcnt(5)
  v_mfma_f32_16x16x32_bf16 v[132:135], v[172:175], v[48:51], v[132:135]
  ds_read_b128 v[36:39], v5 offset:27648
  v_mfma_f32_16x16x32_bf16 v[152:155], v[172:175], v[52:55], v[152:155]
  ds_read_b128 v[40:43], v5 offset:28672
  s_waitcnt lgkmcnt(6)
  v_mfma_f32_16x16x32_bf16 v[136:139], v[176:179], v[48:51], v[136:139]
  ds_read_b128 v[44:47], v5 offset:29696
  v_mfma_f32_16x16x32_bf16 v[156:159], v[176:179], v[52:55], v[156:159]
  s_waitcnt lgkmcnt(6)
  v_mfma_f32_16x16x32_bf16 v[140:143], v[180:183], v[48:51], v[140:143]
  v_mfma_f32_16x16x32_bf16 v[160:163], v[180:183], v[52:55], v[160:163]
  s_waitcnt lgkmcnt(5)
  v_mfma_f32_16x16x32_bf16 v[144:147], v[184:187], v[48:51], v[144:147]
  v_mfma_f32_16x16x32_bf16 v[164:167], v[184:187], v[52:55], v[164:167]
  s_add_u32 s56, s20, 57344
  buffer_load_dwordx4 v[48:51], v1, s[16:19], s56 offen offset:0
  buffer_load_dwordx4 v[52:55], v3, s[16:19], s56 offen offset:0
  s_waitcnt lgkmcnt(4)
  v_mfma_f32_16x16x32_bf16 v[128:131], v[188:191], v[56:59], v[128:131]
  v_mfma_f32_16x16x32_bf16 v[148:151], v[188:191], v[60:63], v[148:151]
  s_waitcnt lgkmcnt(0)
  s_barrier
  ds_read_b128 v[168:171], v5 offset:40960
  v_mfma_f32_16x16x32_bf16 v[132:135], v[32:35], v[56:59], v[132:135]
  ds_read_b128 v[172:175], v5 offset:41984
  v_mfma_f32_16x16x32_bf16 v[152:155], v[32:35], v[60:63], v[152:155]
  ds_read_b128 v[176:179], v5 offset:43008
  v_mfma_f32_16x16x32_bf16 v[136:139], v[36:39], v[56:59], v[136:139]
  ds_read_b128 v[180:183], v5 offset:44032
  s_add_u32 m0, s50, 20480
  s_add_u32 s57, s22, 143360
  buffer_load_dwordx4 v4, s[16:19], s57 offen lds
  v_mfma_f32_16x16x32_bf16 v[156:159], v[36:39], v[60:63], v[156:159]
  ds_read_b128 v[184:187], v5 offset:45056
  buffer_load_dwordx4 v4, s[16:19], s57 offen offset:1024 lds
  v_mfma_f32_16x16x32_bf16 v[140:143], v[40:43], v[56:59], v[140:143]
  s_mov_b32 exec_hi, 0
  buffer_load_dwordx4 v4, s[16:19], s57 offen offset:2048 lds
  s_mov_b32 exec_hi, -1
  s_nop 0
  v_mfma_f32_16x16x32_bf16 v[160:163], v[40:43], v[60:63], v[160:163]
  v_mfma_f32_16x16x32_bf16 v[144:147], v[44:47], v[56:59], v[144:147]
  v_mfma_f32_16x16x32_bf16 v[164:167], v[44:47], v[60:63], v[164:167]
  s_add_u32 s56, s20, 57344
  buffer_load_dwordx4 v[56:59], v1, s[16:19], s56 offen offset:2048
  buffer_load_dwordx4 v[60:63], v3, s[16:19], s56 offen offset:2048
  s_waitcnt vmcnt(31) lgkmcnt(4)
  v_mfma_f32_16x16x32_bf16 v[128:131], v[168:171], v[112:115], v[128:131]
  ds_read_b128 v[188:191], v5 offset:46080
  s_waitcnt vmcnt(30)
  v_mfma_f32_16x16x32_bf16 v[148:151], v[168:171], v[116:119], v[148:151]
  ds_read_b128 v[32:35], v5 offset:47104
  s_waitcnt lgkmcnt(5)
  v_mfma_f32_16x16x32_bf16 v[132:135], v[172:175], v[112:115], v[132:135]
  ds_read_b128 v[36:39], v5 offset:48128
  v_mfma_f32_16x16x32_bf16 v[152:155], v[172:175], v[116:119], v[152:155]
  ds_read_b128 v[40:43], v5 offset:49152
  s_waitcnt lgkmcnt(6)
  v_mfma_f32_16x16x32_bf16 v[136:139], v[176:179], v[112:115], v[136:139]
  ds_read_b128 v[44:47], v5 offset:50176
  v_mfma_f32_16x16x32_bf16 v[156:159], v[176:179], v[116:119], v[156:159]
  s_waitcnt lgkmcnt(6)
  v_mfma_f32_16x16x32_bf16 v[140:143], v[180:183], v[112:115], v[140:143]
  v_mfma_f32_16x16x32_bf16 v[160:163], v[180:183], v[116:119], v[160:163]
  s_waitcnt lgkmcnt(5)
  v_mfma_f32_16x16x32_bf16 v[144:147], v[184:187], v[112:115], v[144:147]
  v_mfma_f32_16x16x32_bf16 v[164:167], v[184:187], v[116:119], v[164:167]
  s_waitcnt vmcnt(29) lgkmcnt(4)
  v_mfma_f32_16x16x32_bf16 v[128:131], v[188:191], v[120:123], v[128:131]
  s_waitcnt vmcnt(28)
  v_mfma_f32_16x16x32_bf16 v[148:151], v[188:191], v[124:127], v[148:151]
  s_waitcnt lgkmcnt(0)
  s_waitcnt vmcnt(21)
  s_barrier
  ds_read_b128 v[168:171], v7 offset:0
  v_mfma_f32_16x16x32_bf16 v[132:135], v[32:35], v[120:123], v[132:135]
  ds_read_b128 v[172:175], v7 offset:1024
  v_mfma_f32_16x16x32_bf16 v[152:155], v[32:35], v[124:127], v[152:155]
  ds_read_b128 v[176:179], v7 offset:2048
  v_mfma_f32_16x16x32_bf16 v[136:139], v[36:39], v[120:123], v[136:139]
  ds_read_b128 v[180:183], v7 offset:3072
  s_add_u32 m0, s50, 40960
  s_add_u32 s57, s23, 0
  buffer_load_dwordx4 v4, s[16:19], s57 offen lds
  v_mfma_f32_16x16x32_bf16 v[156:159], v[36:39], v[124:127], v[156:159]
  ds_read_b128 v[184:187], v7 offset:4096
  buffer_load_dwordx4 v4, s[16:19], s57 offen offset:1024 lds
  v_mfma_f32_16x16x32_bf16 v[140:143], v[40:43], v[120:123], v[140:143]
  s_mov_b32 exec_hi, 0
  buffer_load_dwordx4 v4, s[16:19], s57 offen offset:2048 lds
  s_mov_b32 exec_hi, -1
  s_nop 0
  v_mfma_f32_16x16x32_bf16 v[160:163], v[40:43], v[124:127], v[160:163]
  v_mfma_f32_16x16x32_bf16 v[144:147], v[44:47], v[120:123], v[144:147]
  v_mfma_f32_16x16x32_bf16 v[164:167], v[44:47], v[124:127], v[164:167]
  buffer_load_ubyte v11, v13, s[16:19], s46 offen sc0 sc1
  s_waitcnt lgkmcnt(4)
  v_mfma_f32_16x16x32_bf16 v[128:131], v[168:171], v[16:19], v[128:131]
  ds_read_b128 v[188:191], v7 offset:5120
  v_mfma_f32_16x16x32_bf16 v[148:151], v[168:171], v[20:23], v[148:151]
  ds_read_b128 v[32:35], v7 offset:6144
  s_waitcnt lgkmcnt(5)
  v_mfma_f32_16x16x32_bf16 v[132:135], v[172:175], v[16:19], v[132:135]
  ds_read_b128 v[36:39], v7 offset:7168
  v_mfma_f32_16x16x32_bf16 v[152:155], v[172:175], v[20:23], v[152:155]
  ds_read_b128 v[40:43], v7 offset:8192
  s_waitcnt lgkmcnt(6)
  v_mfma_f32_16x16x32_bf16 v[136:139], v[176:179], v[16:19], v[136:139]
  ds_read_b128 v[44:47], v7 offset:9216
  v_mfma_f32_16x16x32_bf16 v[156:159], v[176:179], v[20:23], v[156:159]
  s_waitcnt lgkmcnt(6)
  v_mfma_f32_16x16x32_bf16 v[140:143], v[180:183], v[16:19], v[140:143]
  v_mfma_f32_16x16x32_bf16 v[160:163], v[180:183], v[20:23], v[160:163]
  s_waitcnt lgkmcnt(5)
  v_mfma_f32_16x16x32_bf16 v[144:147], v[184:187], v[16:19], v[144:147]
  v_mfma_f32_16x16x32_bf16 v[164:167], v[184:187], v[20:23], v[164:167]
  s_waitcnt lgkmcnt(4)
  v_mfma_f32_16x16x32_bf16 v[128:131], v[188:191], v[24:27], v[128:131]
  v_mfma_f32_16x16x32_bf16 v[148:151], v[188:191], v[28:31], v[148:151]
  s_waitcnt lgkmcnt(0)
  s_waitcnt vmcnt(20)
  s_barrier
  ds_read_b128 v[168:171], v6 offset:0
  v_mfma_f32_16x16x32_bf16 v[132:135], v[32:35], v[24:27], v[132:135]
  ds_read_b128 v[172:175], v6 offset:1024
  v_mfma_f32_16x16x32_bf16 v[152:155], v[32:35], v[28:31], v[152:155]
  ds_read_b128 v[176:179], v6 offset:2048
  v_mfma_f32_16x16x32_bf16 v[136:139], v[36:39], v[24:27], v[136:139]
  ds_read_b128 v[180:183], v6 offset:3072
  s_mov_b32 m0, s51
  s_add_u32 s57, s23, 20480
  buffer_load_dwordx4 v4, s[16:19], s57 offen lds
  v_mfma_f32_16x16x32_bf16 v[156:159], v[36:39], v[28:31], v[156:159]
  ds_read_b128 v[184:187], v6 offset:4096
  buffer_load_dwordx4 v4, s[16:19], s57 offen offset:1024 lds
  v_mfma_f32_16x16x32_bf16 v[140:143], v[40:43], v[24:27], v[140:143]
  s_mov_b32 exec_hi, 0
  buffer_load_dwordx4 v4, s[16:19], s57 offen offset:2048 lds
  s_mov_b32 exec_hi, -1
  s_nop 0
  v_mfma_f32_16x16x32_bf16 v[160:163], v[40:43], v[28:31], v[160:163]
  v_mfma_f32_16x16x32_bf16 v[144:147], v[44:47], v[24:27], v[144:147]
  v_mfma_f32_16x16x32_bf16 v[164:167], v[44:47], v[28:31], v[164:167]
  s_waitcnt vmcnt(3)
.Lpl128c:
  v_and_b32 v14, v11, v12
  v_cmp_ne_u32 vcc, v14, v12
  s_nop 0
  s_cbranch_vccnz .Lpl128s
.Lpl128k:
  s_add_u32 s56, s21, 0
  buffer_load_dwordx4 v[112:115], v1, s[16:19], s56 offen offset:0
  buffer_load_dwordx4 v[116:119], v3, s[16:19], s56 offen offset:0
  s_add_u32 s56, s21, 0
  buffer_load_dwordx4 v[120:123], v1, s[16:19], s56 offen offset:2048
  buffer_load_dwordx4 v[124:127], v3, s[16:19], s56 offen offset:2048
  s_add_u32 s56, s21, 8192
  buffer_load_dwordx4 v[16:19], v1, s[16:19], s56 offen offset:0
  buffer_load_dwordx4 v[20:23], v3, s[16:19], s56 offen offset:0
  s_add_u32 s56, s21, 8192
  buffer_load_dwordx4 v[24:27], v1, s[16:19], s56 offen offset:2048
  buffer_load_dwordx4 v[28:31], v3, s[16:19], s56 offen offset:2048
  s_waitcnt lgkmcnt(4)
  v_mfma_f32_16x16x32_bf16 v[128:131], v[168:171], v[192:195], v[128:131]
  ds_read_b128 v[188:191], v6 offset:5120
  v_mfma_f32_16x16x32_bf16 v[148:151], v[168:171], v[196:199], v[148:151]
  ds_read_b128 v[32:35], v6 offset:6144
  s_waitcnt lgkmcnt(5)
  v_mfma_f32_16x16x32_bf16 v[132:135], v[172:175], v[192:195], v[132:135]
  ds_read_b128 v[36:39], v6 offset:7168
  v_mfma_f32_16x16x32_bf16 v[152:155], v[172:175], v[196:199], v[152:155]
  ds_read_b128 v[40:43], v6 offset:8192
  s_waitcnt lgkmcnt(6)
  v_mfma_f32_16x16x32_bf16 v[136:139], v[176:179], v[192:195], v[136:139]
  ds_read_b128 v[44:47], v6 offset:9216
  v_mfma_f32_16x16x32_bf16 v[156:159], v[176:179], v[196:199], v[156:159]
  s_waitcnt lgkmcnt(6)
  v_mfma_f32_16x16x32_bf16 v[140:143], v[180:183], v[192:195], v[140:143]
  v_mfma_f32_16x16x32_bf16 v[160:163], v[180:183], v[196:199], v[160:163]
  s_waitcnt lgkmcnt(5)
  v_mfma_f32_16x16x32_bf16 v[144:147], v[184:187], v[192:195], v[144:147]
  v_mfma_f32_16x16x32_bf16 v[164:167], v[184:187], v[196:199], v[164:167]
  s_add_u32 s56, s21, 16384
  buffer_load_dwordx4 v[192:195], v1, s[16:19], s56 offen offset:0
  buffer_load_dwordx4 v[196:199], v3, s[16:19], s56 offen offset:0
  s_waitcnt lgkmcnt(4)
  v_mfma_f32_16x16x32_bf16 v[128:131], v[188:191], v[200:203], v[128:131]
  v_mfma_f32_16x16x32_bf16 v[148:151], v[188:191], v[204:207], v[148:151]
  s_waitcnt lgkmcnt(0)
  s_barrier
  ds_read_b128 v[168:171], v5 offset:0
  v_mfma_f32_16x16x32_bf16 v[132:135], v[32:35], v[200:203], v[132:135]
  ds_read_b128 v[172:175], v5 offset:1024
  v_mfma_f32_16x16x32_bf16 v[152:155], v[32:35], v[204:207], v[152:155]
  ds_read_b128 v[176:179], v5 offset:2048
  v_mfma_f32_16x16x32_bf16 v[136:139], v[36:39], v[200:203], v[136:139]
  ds_read_b128 v[180:183], v5 offset:3072
  s_add_u32 m0, s41, 131072
  s_add_u32 s57, s23, 40960
  buffer_load_dwordx4 v4, s[16:19], s57 offen lds
  v_mfma_f32_16x16x32_bf16 v[156:159], v[36:39], v[204:207], v[156:159]
  ds_read_b128 v[184:187], v5 offset:4096
  buffer_load_dwordx4 v4, s[16:19], s57 offen offset:1024 lds
  v_mfma_f32_16x16x32_bf16 v[140:143], v[40:43], v[200:203], v[140:143]
  s_mov_b32 exec_hi, 0
  buffer_load_dwordx4 v4, s[16:19], s57 offen offset:2048 lds
  s_mov_b32 exec_hi, -1
  s_nop 0
  v_mfma_f32_16x16x32_bf16 v[160:163], v[40:43], v[204:207], v[160:163]
  v_mfma_f32_16x16x32_bf16 v[144:147], v[44:47], v[200:203], v[144:147]
  v_mfma_f32_16x16x32_bf16 v[164:167], v[44:47], v[204:207], v[164:167]
  s_add_u32 s56, s21, 16384
  buffer_load_dwordx4 v[200:203], v1, s[16:19], s56 offen offset:2048
  buffer_load_dwordx4 v[204:207], v3, s[16:19], s56 offen offset:2048
  s_waitcnt lgkmcnt(4)
  v_mfma_f32_16x16x32_bf16 v[128:131], v[168:171], v[208:211], v[128:131]
  ds_read_b128 v[188:191], v5 offset:5120
  v_mfma_f32_16x16x32_bf16 v[148:151], v[168:171], v[212:215], v[148:151]
  ds_read_b128 v[32:35], v5 offset:6144
  s_waitcnt lgkmcnt(5)
  v_mfma_f32_16x16x32_bf16 v[132:135], v[172:175], v[208:211], v[132:135]
  ds_read_b128 v[36:39], v5 offset:7168
  v_mfma_f32_16x16x32_bf16 v[152:155], v[172:175], v[212:215], v[152:155]
  ds_read_b128 v[40:43], v5 offset:8192
  s_waitcnt lgkmcnt(6)
  v_mfma_f32_16x16x32_bf16 v[136:139], v[176:179], v[208:211], v[136:139]
  ds_read_b128 v[44:47], v5 offset:9216
  v_mfma_f32_16x16x32_bf16 v[156:159], v[176:179], v[212:215], v[156:159]
  s_waitcnt lgkmcnt(6)
  v_mfma_f32_16x16x32_bf16 v[140:143], v[180:183], v[208:211], v[140:143]
  v_mfma_f32_16x16x32_bf16 v[160:163], v[180:183], v[212:215], v[160:163]
  s_waitcnt lgkmcnt(5)
  v_mfma_f32_16x16x32_bf16 v[144:147], v[184:187], v[208:211], v[144:147]
  v_mfma_f32_16x16x32_bf16 v[164:167], v[184:187], v[212:215], v[164:167]
  s_add_u32 s56, s21, 24576
  buffer_load_dwordx4 v[208:211], v1, s[16:19], s56 offen offset:0
  buffer_load_dwordx4 v[212:215], v3, s[16:19], s56 offen offset:0
  s_waitcnt lgkmcnt(4)
  v_mfma_f32_16x16x32_bf16 v[128:131], v[188:191], v[216:219], v[128:131]
  v_mfma_f32_16x16x32_bf16 v[148:151], v[188:191], v[220:223], v[148:151]
  s_waitcnt lgkmcnt(0)
  s_barrier
  ds_read_b128 v[168:171], v5 offset:20480
  v_mfma_f32_16x16x32_bf16 v[132:135], v[32:35], v[216:219], v[132:135]
  ds_read_b128 v[172:175], v5 offset:21504
  v_mfma_f32_16x16x32_bf16 v[152:155], v[32:35], v[220:223], v[152:155]
  ds_read_b128 v[176:179], v5 offset:22528
  v_mfma_f32_16x16x32_bf16 v[136:139], v[36:39], v[216:219], v[136:139]
  ds_read_b128 v[180:183], v5 offset:23552
  s_add_u32 m0, s50, 0
  s_add_u32 s57, s23, 61440
  buffer_load_dwordx4 v4, s[16:19], s57 offen lds
  v_mfma_f32_16x16x32_bf16 v[156:159], v[36:39], v[220:223], v[156:159]
  ds_read_b128 v[184:187], v5 offset:24576
  buffer_load_dwordx4 v4, s[16:19], s57 offen offset:1024 lds
  v_mfma_f32_16x16x32_bf16 v[140:143], v[40:43], v[216:219], v[140:143]
  s_mov_b32 exec_hi, 0
  buffer_load_dwordx4 v4, s[16:19], s57 offen offset:2048 lds
  s_mov_b32 exec_hi, -1
  s_nop 0
  v_mfma_f32_16x16x32_bf16 v[160:163], v[40:43], v[220:223], v[160:163]
  v_mfma_f32_16x16x32_bf16 v[144:147], v[44:47], v[216:219], v[144:147]
  v_mfma_f32_16x16x32_bf16 v[164:167], v[44:47], v[220:223], v[164:167]
  s_add_u32 s56, s21, 24576
  buffer_load_dwordx4 v[216:219], v1, s[16:19], s56 offen offset:2048
  buffer_load_dwordx4 v[220:223], v3, s[16:19], s56 offen offset:2048
  s_waitcnt lgkmcnt(4)
  v_mfma_f32_16x16x32_bf16 v[128:131], v[168:171], v[48:51], v[128:131]
  ds_read_b128 v[188:191], v5 offset:25600
  v_mfma_f32_16x16x32_bf16 v[148:151], v[168:171], v[52:55], v[148:151]
  ds_read_b128 v[32:35], v5 offset:26624
  s_waitcnt lgkmcnt(5)
  v_mfma_f32_16x16x32_bf16 v[132:135], v[172:175], v[48:51], v[132:135]
  ds_read_b128 v[36:39], v5 offset:27648
  v_mfma_f32_16x16x32_bf16 v[152:155], v[172:175], v[52:55], v[152:155]
  ds_read_b128 v[40:43], v5 offset:28672
  s_waitcnt lgkmcnt(6)
  v_mfma_f32_16x16x32_bf16 v[136:139], v[176:179], v[48:51], v[136:139]
  ds_read_b128 v[44:47], v5 offset:29696
  v_mfma_f32_16x16x32_bf16 v[156:159], v[176:179], v[52:55], v[156:159]
  s_waitcnt lgkmcnt(6)
  v_mfma_f32_16x16x32_bf16 v[140:143], v[180:183], v[48:51], v[140:143]
  v_mfma_f32_16x16x32_bf16 v[160:163], v[180:183], v[52:55], v[160:163]
  s_waitcnt lgkmcnt(5)
  v_mfma_f32_16x16x32_bf16 v[144:147], v[184:187], v[48:51], v[144:147]
  v_mfma_f32_16x16x32_bf16 v[164:167], v[184:187], v[52:55], v[164:167]
  s_add_u32 s56, s21, 32768
  buffer_load_dwordx4 v[48:51], v1, s[16:19], s56 offen offset:0
  buffer_load_dwordx4 v[52:55], v3, s[16:19], s56 offen offset:0
  s_waitcnt lgkmcnt(4)
  v_mfma_f32_16x16x32_bf16 v[128:131], v[188:191], v[56:59], v[128:131]
  v_mfma_f32_16x16x32_bf16 v[148:151], v[188:191], v[60:63], v[148:151]
  s_waitcnt lgkmcnt(0)
  s_barrier
  ds_read_b128 v[168:171], v5 offset:40960
  v_mfma_f32_16x16x32_bf16 v[132:135], v[32:35], v[56:59], v[132:135]
  ds_read_b128 v[172:175], v5 offset:41984
  v_mfma_f32_16x16x32_bf16 v[152:155], v[32:35], v[60:63], v[152:155]
  ds_read_b128 v[176:179], v5 offset:43008
  v_mfma_f32_16x16x32_bf16 v[136:139], v[36:39], v[56:59], v[136:139]
  ds_read_b128 v[180:183], v5 offset:44032
  s_add_u32 m0, s50, 20480
  s_add_u32 s57, s23, 81920
  buffer_load_dwordx4 v4, s[16:19], s57 offen lds
  v_mfma_f32_16x16x32_bf16 v[156:159], v[36:39], v[60:63], v[156:159]
  ds_read_b128 v[184:187], v5 offset:45056
  buffer_load_dwordx4 v4, s[16:19], s57 offen offset:1024 lds
  v_mfma_f32_16x16x32_bf16 v[140:143], v[40:43], v[56:59], v[140:143]
  s_mov_b32 exec_hi, 0
  buffer_load_dwordx4 v4, s[16:19], s57 offen offset:2048 lds
  s_mov_b32 exec_hi, -1
  s_nop 0
  v_mfma_f32_16x16x32_bf16 v[160:163], v[40:43], v[60:63], v[160:163]
  v_mfma_f32_16x16x32_bf16 v[144:147], v[44:47], v[56:59], v[144:147]
  v_mfma_f32_16x16x32_bf16 v[164:167], v[44:47], v[60:63], v[164:167]
  s_add_u32 s56, s21, 32768
  buffer_load_dwordx4 v[56:59], v1, s[16:19], s56 offen offset:2048
  buffer_load_dwordx4 v[60:63], v3, s[16:19], s56 offen offset:2048
  s_waitcnt vmcnt(28) lgkmcnt(4)
  v_mfma_f32_16x16x32_bf16 v[224:227], v[168:171], v[112:115], 0
  ds_read_b128 v[188:191], v5 offset:46080
  s_waitcnt vmcnt(27)
  v_mfma_f32_16x16x32_bf16 v[244:247], v[168:171], v[116:119], 0
  ds_read_b128 v[32:35], v5 offset:47104
  s_waitcnt lgkmcnt(5)
  v_mfma_f32_16x16x32_bf16 v[228:231], v[172:175], v[112:115], 0
  ds_read_b128 v[36:39], v5 offset:48128
  ds_write_b128 v8, v[148:151] offset:0
  v_mfma_f32_16x16x32_bf16 v[248:251], v[172:175], v[116:119], 0
  ds_read_b128 v[40:43], v5 offset:49152
  ds_write_b128 v8, v[152:155] offset:1024
  s_waitcnt lgkmcnt(8)
  v_mfma_f32_16x16x32_bf16 v[232:235], v[176:179], v[112:115], 0
  ds_read_b128 v[44:47], v5 offset:50176
  ds_write_b128 v8, v[156:159] offset:2048
  v_mfma_f32_16x16x32_bf16 v[252:255], v[176:179], v[116:119], 0
  ds_write_b128 v8, v[160:163] offset:3072
  s_waitcnt lgkmcnt(10)
  v_mfma_f32_16x16x32_bf16 v[236:239], v[180:183], v[112:115], 0
  ds_write_b128 v8, v[164:167] offset:4096
  v_mfma_f32_16x16x32_bf16 v[104:107], v[180:183], v[116:119], 0
  s_waitcnt lgkmcnt(10)
  v_mfma_f32_16x16x32_bf16 v[240:243], v[184:187], v[112:115], 0
  v_mfma_f32_16x16x32_bf16 v[108:111], v[184:187], v[116:119], 0
  s_add_u32 s56, s21, 40960
  buffer_load_dwordx4 v[112:115], v1, s[16:19], s56 offen offset:0
  buffer_load_dwordx4 v[116:119], v3, s[16:19], s56 offen offset:0
  s_waitcnt vmcnt(28) lgkmcnt(9)
  v_mfma_f32_16x16x32_bf16 v[224:227], v[188:191], v[120:123], v[224:227]
  s_waitcnt vmcnt(27)
  v_mfma_f32_16x16x32_bf16 v[244:247], v[188:191], v[124:127], v[244:247]
  s_waitcnt lgkmcnt(0)
  s_barrier
  ds_read_b128 v[168:171], v7 offset:0
  v_mfma_f32_16x16x32_bf16 v[228:231], v[32:35], v[120:123], v[228:231]
  ds_read_b128 v[172:175], v7 offset:1024
  ds_read_b128 v[148:151], v9 offset:0
  v_mfma_f32_16x16x32_bf16 v[248:251], v[32:35], v[124:127], v[248:251]
  ds_read_b128 v[176:179], v7 offset:2048
  ds_read_b128 v[152:155], v9 offset:1024
  v_mfma_f32_16x16x32_bf16 v[232:235], v[36:39], v[120:123], v[232:235]
  ds_read_b128 v[180:183], v7 offset:3072
  s_add_u32 m0, s50, 40960
  s_add_u32 s57, s23, 102400
  buffer_load_dwordx4 v4, s[16:19], s57 offen lds
  ds_read_b128 v[156:159], v9 offset:2048
  v_mfma_f32_16x16x32_bf16 v[252:255], v[36:39], v[124:127], v[252:255]
  ds_read_b128 v[184:187], v7 offset:4096
  buffer_load_dwordx4 v4, s[16:19], s57 offen offset:1024 lds
  ds_read_b128 v[160:163], v9 offset:3072
  v_mfma_f32_16x16x32_bf16 v[236:239], v[40:43], v[120:123], v[236:239]
  s_mov_b32 exec_hi, 0
  buffer_load_dwordx4 v4, s[16:19], s57 offen offset:2048 lds
  s_mov_b32 exec_hi, -1
  ds_read_b128 v[164:167], v9 offset:4096
  v_mfma_f32_16x16x32_bf16 v[104:107], v[40:43], v[124:127], v[104:107]
  v_mfma_f32_16x16x32_bf16 v[240:243], v[44:47], v[120:123], v[240:243]
  v_mfma_f32_16x16x32_bf16 v[108:111], v[44:47], v[124:127], v[108:111]
  s_add_u32 s56, s21, 40960
  buffer_load_dwordx4 v[120:123], v1, s[16:19], s56 offen offset:2048
  buffer_load_dwordx4 v[124:127], v3, s[16:19], s56 offen offset:2048
  s_waitcnt vmcnt(31) lgkmcnt(9)
  v_mfma_f32_16x16x32_bf16 v[224:227], v[168:171], v[16:19], v[224:227]
  ds_read_b128 v[188:191], v7 offset:5120
  s_waitcnt lgkmcnt(8)
  v_add_f32 v128, v128, v148
  v_add_f32 v129, v129, v149
  v_add_f32 v130, v130, v150
  v_add_f32 v131, v131, v151
  v_cvt_pk_bf16_f32 v128, v128, v129
  v_cvt_pk_bf16_f32 v129, v130, v131
  s_waitcnt vmcnt(30)
  v_mfma_f32_16x16x32_bf16 v[244:247], v[168:171], v[20:23], v[244:247]
  ds_read_b128 v[32:35], v7 offset:6144
  s_waitcnt lgkmcnt(7)
  v_add_f32 v132, v132, v152
  v_add_f32 v133, v133, v153
  v_add_f32 v134, v134, v154
  v_add_f32 v135, v135, v155
  v_cvt_pk_bf16_f32 v130, v132, v133
  v_cvt_pk_bf16_f32 v131, v134, v135
  s_sub_u32 s55, s43, 40960
  buffer_store_dwordx4 v[128:131], v2, s[16:19], s55 offen offset:0 sc0 sc1
  v_mfma_f32_16x16x32_bf16 v[228:231], v[172:175], v[16:19], v[228:231]
  ds_read_b128 v[36:39], v7 offset:7168
  s_waitcnt lgkmcnt(6)
  v_add_f32 v136, v136, v156
  v_add_f32 v137, v137, v157
  v_add_f32 v138, v138, v158
  v_add_f32 v139, v139, v159
  v_cvt_pk_bf16_f32 v132, v136, v137
  v_cvt_pk_bf16_f32 v133, v138, v139
  v_mfma_f32_16x16x32_bf16 v[248:251], v[172:175], v[20:23], v[248:251]
  ds_read_b128 v[40:43], v7 offset:8192
  s_waitcnt lgkmcnt(5)
  v_add_f32 v140, v140, v160
  v_add_f32 v141, v141, v161
  v_add_f32 v142, v142, v162
  v_add_f32 v143, v143, v163
  v_cvt_pk_bf16_f32 v134, v140, v141
  v_cvt_pk_bf16_f32 v135, v142, v143
  buffer_store_dwordx4 v[132:135], v2, s[16:19], s55 offen offset:1024 sc0 sc1
  v_mfma_f32_16x16x32_bf16 v[232:235], v[176:179], v[16:19], v[232:235]
  ds_read_b128 v[44:47], v7 offset:9216
  s_waitcnt lgkmcnt(5)
  v_add_f32 v144, v144, v164
  v_add_f32 v145, v145, v165
  v_add_f32 v146, v146, v166
  v_add_f32 v147, v147, v167
  v_cvt_pk_bf16_f32 v136, v144, v145
  v_cvt_pk_bf16_f32 v137, v146, v147
  buffer_store_dwordx2 v[136:137], v2, s[16:19], s55 offen offset:2048 sc0 sc1
  v_mfma_f32_16x16x32_bf16 v[252:255], v[176:179], v[20:23], v[252:255]
  v_mfma_f32_16x16x32_bf16 v[236:239], v[180:183], v[16:19], v[236:239]
  v_mfma_f32_16x16x32_bf16 v[104:107], v[180:183], v[20:23], v[104:107]
  v_mfma_f32_16x16x32_bf16 v[240:243], v[184:187], v[16:19], v[240:243]
  v_mfma_f32_16x16x32_bf16 v[108:111], v[184:187], v[20:23], v[108:111]
  s_add_u32 s56, s21, 49152
  buffer_load_dwordx4 v[16:19], v1, s[16:19], s56 offen offset:0
  buffer_load_dwordx4 v[20:23], v3, s[16:19], s56 offen offset:0
  s_waitcnt vmcnt(34) lgkmcnt(4)
  v_mfma_f32_16x16x32_bf16 v[224:227], v[188:191], v[24:27], v[224:227]
  s_waitcnt vmcnt(33)
  v_mfma_f32_16x16x32_bf16 v[244:247], v[188:191], v[28:31], v[244:247]
  s_waitcnt lgkmcnt(0)
  s_waitcnt vmcnt(28)
  s_barrier
  ds_read_b128 v[168:171], v6 offset:0
  v_mfma_f32_16x16x32_bf16 v[228:231], v[32:35], v[24:27], v[228:231]
  ds_read_b128 v[172:175], v6 offset:1024
  v_mfma_f32_16x16x32_bf16 v[248:251], v[32:35], v[28:31], v[248:251]
  ds_read_b128 v[176:179], v6 offset:2048
  v_mfma_f32_16x16x32_bf16 v[232:235], v[36:39], v[24:27], v[232:235]
  ds_read_b128 v[180:183], v6 offset:3072
  s_mov_b32 m0, s51
  s_add_u32 s57, s23, 122880
  buffer_load_dwordx4 v4, s[16:19], s57 offen lds
  v_mfma_f32_16x16x32_bf16 v[252:255], v[36:39], v[28:31], v[252:255]
  ds_read_b128 v[184:187], v6 offset:4096
  buffer_load_dwordx4 v4, s[16:19], s57 offen offset:1024 lds
  v_mfma_f32_16x16x32_bf16 v[236:239], v[40:43], v[24:27], v[236:239]
  s_mov_b32 exec_hi, 0
  buffer_load_dwordx4 v4, s[16:19], s57 offen offset:2048 lds
  s_mov_b32 exec_hi, -1
  s_nop 0
  v_mfma_f32_16x16x32_bf16 v[104:107], v[40:43], v[28:31], v[104:107]
  v_mfma_f32_16x16x32_bf16 v[240:243], v[44:47], v[24:27], v[240:243]
  v_mfma_f32_16x16x32_bf16 v[108:111], v[44:47], v[28:31], v[108:111]
  s_add_u32 s56, s21, 49152
  buffer_load_dwordx4 v[24:27], v1, s[16:19], s56 offen offset:2048
  buffer_load_dwordx4 v[28:31], v3, s[16:19], s56 offen offset:2048
  s_waitcnt lgkmcnt(4)
  v_mfma_f32_16x16x32_bf16 v[224:227], v[168:171], v[192:195], v[224:227]
  ds_read_b128 v[188:191], v6 offset:5120
  v_mfma_f32_16x16x32_bf16 v[244:247], v[168:171], v[196:199], v[244:247]
  ds_read_b128 v[32:35], v6 offset:6144
  s_waitcnt lgkmcnt(5)
  v_mfma_f32_16x16x32_bf16 v[228:231], v[172:175], v[192:195], v[228:231]
  ds_read_b128 v[36:39], v6 offset:7168
  v_mfma_f32_16x16x32_bf16 v[248:251], v[172:175], v[196:199], v[248:251]
  ds_read_b128 v[40:43], v6 offset:8192
  s_waitcnt lgkmcnt(6)
  v_mfma_f32_16x16x32_bf16 v[232:235], v[176:179], v[192:195], v[232:235]
  ds_read_b128 v[44:47], v6 offset:9216
  v_mfma_f32_16x16x32_bf16 v[252:255], v[176:179], v[196:199], v[252:255]
  s_waitcnt lgkmcnt(6)
  v_mfma_f32_16x16x32_bf16 v[236:239], v[180:183], v[192:195], v[236:239]
  v_mfma_f32_16x16x32_bf16 v[104:107], v[180:183], v[196:199], v[104:107]
  s_waitcnt lgkmcnt(5)
  v_mfma_f32_16x16x32_bf16 v[240:243], v[184:187], v[192:195], v[240:243]
  v_mfma_f32_16x16x32_bf16 v[108:111], v[184:187], v[196:199], v[108:111]
  s_add_u32 s56, s21, 57344
  buffer_load_dwordx4 v[192:195], v1, s[16:19], s56 offen offset:0
  buffer_load_dwordx4 v[196:199], v3, s[16:19], s56 offen offset:0
  s_waitcnt vmcnt(34) lgkmcnt(4)
  v_mfma_f32_16x16x32_bf16 v[224:227], v[188:191], v[200:203], v[224:227]
  s_waitcnt vmcnt(33)
  v_mfma_f32_16x16x32_bf16 v[244:247], v[188:191], v[204:207], v[244:247]
  s_waitcnt lgkmcnt(0)
  s_waitcnt vmcnt(28)
  s_barrier
  ds_read_b128 v[168:171], v5 offset:0
  v_mfma_f32_16x16x32_bf16 v[228:231], v[32:35], v[200:203], v[228:231]
  ds_read_b128 v[172:175], v5 offset:1024
  v_mfma_f32_16x16x32_bf16 v[248:251], v[32:35], v[204:207], v[248:251]
  ds_read_b128 v[176:179], v5 offset:2048
  v_mfma_f32_16x16x32_bf16 v[232:235], v[36:39], v[200:203], v[232:235]
  ds_read_b128 v[180:183], v5 offset:3072
  s_add_u32 m0, s41, 131072
  s_add_u32 s57, s23, 143360
  buffer_load_dwordx4 v4, s[16:19], s57 offen lds
  v_mfma_f32_16x16x32_bf16 v[252:255], v[36:39], v[204:207], v[252:255]
  ds_read_b128 v[184:187], v5 offset:4096
  buffer_load_dwordx4 v4, s[16:19], s57 offen offset:1024 lds
  v_mfma_f32_16x16x32_bf16 v[236:239], v[40:43], v[200:203], v[236:239]
  s_mov_b32 exec_hi, 0
  buffer_load_dwordx4 v4, s[16:19], s57 offen offset:2048 lds
  s_mov_b32 exec_hi, -1
  s_nop 0
  v_mfma_f32_16x16x32_bf16 v[104:107], v[40:43], v[204:207], v[104:107]
  v_mfma_f32_16x16x32_bf16 v[240:243], v[44:47], v[200:203], v[240:243]
  v_mfma_f32_16x16x32_bf16 v[108:111], v[44:47], v[204:207], v[108:111]
  s_add_u32 s56, s21, 57344
  buffer_load_dwordx4 v[200:203], v1, s[16:19], s56 offen offset:2048
  buffer_load_dwordx4 v[204:207], v3, s[16:19], s56 offen offset:2048
  s_waitcnt lgkmcnt(4)
  v_mfma_f32_16x16x32_bf16 v[224:227], v[168:171], v[208:211], v[224:227]
  ds_read_b128 v[188:191], v5 offset:5120
  v_mfma_f32_16x16x32_bf16 v[244:247], v[168:171], v[212:215], v[244:247]
  ds_read_b128 v[32:35], v5 offset:6144
  s_waitcnt lgkmcnt(5)
  v_mfma_f32_16x16x32_bf16 v[228:231], v[172:175], v[208:211], v[228:231]
  ds_read_b128 v[36:39], v5 offset:7168
  v_mfma_f32_16x16x32_bf16 v[248:251], v[172:175], v[212:215], v[248:251]
  ds_read_b128 v[40:43], v5 offset:8192
  s_waitcnt lgkmcnt(6)
  v_mfma_f32_16x16x32_bf16 v[232:235], v[176:179], v[208:211], v[232:235]
  ds_read_b128 v[44:47], v5 offset:9216
  v_mfma_f32_16x16x32_bf16 v[252:255], v[176:179], v[212:215], v[252:255]
  s_waitcnt lgkmcnt(6)
  v_mfma_f32_16x16x32_bf16 v[236:239], v[180:183], v[208:211], v[236:239]
  v_mfma_f32_16x16x32_bf16 v[104:107], v[180:183], v[212:215], v[104:107]
  s_waitcnt lgkmcnt(5)
  v_mfma_f32_16x16x32_bf16 v[240:243], v[184:187], v[208:211], v[240:243]
  v_mfma_f32_16x16x32_bf16 v[108:111], v[184:187], v[212:215], v[108:111]
  s_add_u32 s56, s21, 65536
  buffer_load_dwordx4 v[208:211], v1, s[16:19], s56 offen offset:0
  buffer_load_dwordx4 v[212:215], v3, s[16:19], s56 offen offset:0
  s_waitcnt vmcnt(34) lgkmcnt(4)
  v_mfma_f32_16x16x32_bf16 v[224:227], v[188:191], v[216:219], v[224:227]
  s_waitcnt vmcnt(33)
  v_mfma_f32_16x16x32_bf16 v[244:247], v[188:191], v[220:223], v[244:247]
  s_waitcnt lgkmcnt(0)
  s_waitcnt vmcnt(28)
  s_barrier
  ds_read_b128 v[168:171], v5 offset:20480
  v_mfma_f32_16x16x32_bf16 v[228:231], v[32:35], v[216:219], v[228:231]
  ds_read_b128 v[172:175], v5 offset:21504
  v_mfma_f32_16x16x32_bf16 v[248:251], v[32:35], v[220:223], v[248:251]
  ds_read_b128 v[176:179], v5 offset:22528
  v_mfma_f32_16x16x32_bf16 v[232:235], v[36:39], v[216:219], v[232:235]
  ds_read_b128 v[180:183], v5 offset:23552
  s_add_u32 m0, s50, 0
  s_add_u32 s57, s23, 163840
  buffer_load_dwordx4 v4, s[16:19], s57 offen lds
  v_mfma_f32_16x16x32_bf16 v[252:255], v[36:39], v[220:223], v[252:255]
  ds_read_b128 v[184:187], v5 offset:24576
  buffer_load_dwordx4 v4, s[16:19], s57 offen offset:1024 lds
  v_mfma_f32_16x16x32_bf16 v[236:239], v[40:43], v[216:219], v[236:239]
  s_mov_b32 exec_hi, 0
  buffer_load_dwordx4 v4, s[16:19], s57 offen offset:2048 lds
  s_mov_b32 exec_hi, -1
  s_nop 0
  v_mfma_f32_16x16x32_bf16 v[104:107], v[40:43], v[220:223], v[104:107]
  v_mfma_f32_16x16x32_bf16 v[240:243], v[44:47], v[216:219], v[240:243]
  v_mfma_f32_16x16x32_bf16 v[108:111], v[44:47], v[220:223], v[108:111]
  s_add_u32 s56, s21, 65536
  buffer_load_dwordx4 v[216:219], v1, s[16:19], s56 offen offset:2048
  buffer_load_dwordx4 v[220:223], v3, s[16:19], s56 offen offset:2048
  s_waitcnt vmcnt(21)
  s_add_u32 s55, s45, s44
  s_sub_u32 s55, s55, 1
  v_mov_b32 v14, 1
  s_mov_b64 exec, 1
  buffer_store_byte v14, off, s[16:19], s55 sc0 sc1
  s_mov_b64 exec, -1
  s_waitcnt lgkmcnt(4)
  v_mfma_f32_16x16x32_bf16 v[224:227], v[168:171], v[48:51], v[224:227]
  ds_read_b128 v[188:191], v5 offset:25600
  v_mfma_f32_16x16x32_bf16 v[244:247], v[168:171], v[52:55], v[244:247]
  ds_read_b128 v[32:35], v5 offset:26624
  s_waitcnt lgkmcnt(5)
  v_mfma_f32_16x16x32_bf16 v[228:231], v[172:175], v[48:51], v[228:231]
  ds_read_b128 v[36:39], v5 offset:27648
  v_mfma_f32_16x16x32_bf16 v[248:251], v[172:175], v[52:55], v[248:251]
  ds_read_b128 v[40:43], v5 offset:28672
  s_waitcnt lgkmcnt(6)
  v_mfma_f32_16x16x32_bf16 v[232:235], v[176:179], v[48:51], v[232:235]
  ds_read_b128 v[44:47], v5 offset:29696
  v_mfma_f32_16x16x32_bf16 v[252:255], v[176:179], v[52:55], v[252:255]
  s_waitcnt lgkmcnt(6)
  v_mfma_f32_16x16x32_bf16 v[236:239], v[180:183], v[48:51], v[236:239]
  v_mfma_f32_16x16x32_bf16 v[104:107], v[180:183], v[52:55], v[104:107]
  s_waitcnt lgkmcnt(5)
  v_mfma_f32_16x16x32_bf16 v[240:243], v[184:187], v[48:51], v[240:243]
  v_mfma_f32_16x16x32_bf16 v[108:111], v[184:187], v[52:55], v[108:111]
  s_add_u32 s56, s21, 73728
  buffer_load_dwordx4 v[48:51], v1, s[16:19], s56 offen offset:0
  buffer_load_dwordx4 v[52:55], v3, s[16:19], s56 offen offset:0
  s_waitcnt lgkmcnt(4)
  v_mfma_f32_16x16x32_bf16 v[224:227], v[188:191], v[56:59], v[224:227]
  v_mfma_f32_16x16x32_bf16 v[244:247], v[188:191], v[60:63], v[244:247]
  s_waitcnt lgkmcnt(0)
  s_barrier
  ds_read_b128 v[168:171], v5 offset:40960
  v_mfma_f32_16x16x32_bf16 v[228:231], v[32:35], v[56:59], v[228:231]
  ds_read_b128 v[172:175], v5 offset:41984
  v_mfma_f32_16x16x32_bf16 v[248:251], v[32:35], v[60:63], v[248:251]
  ds_read_b128 v[176:179], v5 offset:43008
  v_mfma_f32_16x16x32_bf16 v[232:235], v[36:39], v[56:59], v[232:235]
  ds_read_b128 v[180:183], v5 offset:44032
  s_add_u32 m0, s50, 20480
  s_add_u32 s57, s23, 184320
  buffer_load_dwordx4 v4, s[16:19], s57 offen lds
  v_mfma_f32_16x16x32_bf16 v[252:255], v[36:39], v[60:63], v[252:255]
  ds_read_b128 v[184:187], v5 offset:45056
  buffer_load_dwordx4 v4, s[16:19], s57 offen offset:1024 lds
  v_mfma_f32_16x16x32_bf16 v[236:239], v[40:43], v[56:59], v[236:239]
  s_mov_b32 exec_hi, 0
  buffer_load_dwordx4 v4, s[16:19], s57 offen offset:2048 lds
  s_mov_b32 exec_hi, -1
  s_nop 0
  v_mfma_f32_16x16x32_bf16 v[104:107], v[40:43], v[60:63], v[104:107]
  v_mfma_f32_16x16x32_bf16 v[240:243], v[44:47], v[56:59], v[240:243]
  v_mfma_f32_16x16x32_bf16 v[108:111], v[44:47], v[60:63], v[108:111]
  s_add_u32 s56, s21, 73728
  buffer_load_dwordx4 v[56:59], v1, s[16:19], s56 offen offset:2048
  buffer_load_dwordx4 v[60:63], v3, s[16:19], s56 offen offset:2048
  s_waitcnt lgkmcnt(4)
  v_mfma_f32_16x16x32_bf16 v[224:227], v[168:171], v[112:115], v[224:227]
  ds_read_b128 v[188:191], v5 offset:46080
  v_mfma_f32_16x16x32_bf16 v[244:247], v[168:171], v[116:119], v[244:247]
  ds_read_b128 v[32:35], v5 offset:47104
  s_waitcnt lgkmcnt(5)
  v_mfma_f32_16x16x32_bf16 v[228:231], v[172:175], v[112:115], v[228:231]
  ds_read_b128 v[36:39], v5 offset:48128
  v_mfma_f32_16x16x32_bf16 v[248:251], v[172:175], v[116:119], v[248:251]
  ds_read_b128 v[40:43], v5 offset:49152
  s_waitcnt lgkmcnt(6)
  v_mfma_f32_16x16x32_bf16 v[232:235], v[176:179], v[112:115], v[232:235]
  ds_read_b128 v[44:47], v5 offset:50176
  v_mfma_f32_16x16x32_bf16 v[252:255], v[176:179], v[116:119], v[252:255]
  s_waitcnt lgkmcnt(6)
  v_mfma_f32_16x16x32_bf16 v[236:239], v[180:183], v[112:115], v[236:239]
  v_mfma_f32_16x16x32_bf16 v[104:107], v[180:183], v[116:119], v[104:107]
  s_waitcnt lgkmcnt(5)
  v_mfma_f32_16x16x32_bf16 v[240:243], v[184:187], v[112:115], v[240:243]
  v_mfma_f32_16x16x32_bf16 v[108:111], v[184:187], v[116:119], v[108:111]
  s_add_u32 s56, s21, 81920
  buffer_load_dwordx4 v[112:115], v1, s[16:19], s56 offen offset:0
  buffer_load_dwordx4 v[116:119], v3, s[16:19], s56 offen offset:0
  s_waitcnt lgkmcnt(4)
  v_mfma_f32_16x16x32_bf16 v[224:227], v[188:191], v[120:123], v[224:227]
  v_mfma_f32_16x16x32_bf16 v[244:247], v[188:191], v[124:127], v[244:247]
  s_waitcnt lgkmcnt(0)
  s_waitcnt vmcnt(26)
  s_barrier
  ds_read_b128 v[168:171], v7 offset:0
  v_mfma_f32_16x16x32_bf16 v[228:231], v[32:35], v[120:123], v[228:231]
  ds_read_b128 v[172:175], v7 offset:1024
  v_mfma_f32_16x16x32_bf16 v[248:251], v[32:35], v[124:127], v[248:251]
  ds_read_b128 v[176:179], v7 offset:2048
  v_mfma_f32_16x16x32_bf16 v[232:235], v[36:39], v[120:123], v[232:235]
  ds_read_b128 v[180:183], v7 offset:3072
  s_add_u32 m0, s50, 40960
  s_add_u32 s57, s23, 204800
  buffer_load_dwordx4 v4, s[16:19], s57 offen lds
  v_mfma_f32_16x16x32_bf16 v[252:255], v[36:39], v[124:127], v[252:255]
  ds_read_b128 v[184:187], v7 offset:4096
  buffer_load_dwordx4 v4, s[16:19], s57 offen offset:1024 lds
  v_mfma_f32_16x16x32_bf16 v[236:239], v[40:43], v[120:123], v[236:239]
  s_mov_b32 exec_hi, 0
  buffer_load_dwordx4 v4, s[16:19], s57 offen offset:2048 lds
  s_mov_b32 exec_hi, -1
  s_nop 0
  v_mfma_f32_16x16x32_bf16 v[104:107], v[40:43], v[124:127], v[104:107]
  v_mfma_f32_16x16x32_bf16 v[240:243], v[44:47], v[120:123], v[240:243]
  v_mfma_f32_16x16x32_bf16 v[108:111], v[44:47], v[124:127], v[108:111]
  s_add_u32 s56, s21, 81920
  buffer_load_dwordx4 v[120:123], v1, s[16:19], s56 offen offset:2048
  buffer_load_dwordx4 v[124:127], v3, s[16:19], s56 offen offset:2048
  s_waitcnt lgkmcnt(4)
  v_mfma_f32_16x16x32_bf16 v[224:227], v[168:171], v[16:19], v[224:227]
  ds_read_b128 v[188:191], v7 offset:5120
  v_mfma_f32_16x16x32_bf16 v[244:247], v[168:171], v[20:23], v[244:247]
  ds_read_b128 v[32:35], v7 offset:6144
  s_waitcnt lgkmcnt(5)
  v_mfma_f32_16x16x32_bf16 v[228:231], v[172:175], v[16:19], v[228:231]
  ds_read_b128 v[36:39], v7 offset:7168
  v_mfma_f32_16x16x32_bf16 v[248:251], v[172:175], v[20:23], v[248:251]
  ds_read_b128 v[40:43], v7 offset:8192
  s_waitcnt lgkmcnt(6)
  v_mfma_f32_16x16x32_bf16 v[232:235], v[176:179], v[16:19], v[232:235]
  ds_read_b128 v[44:47], v7 offset:9216
  v_mfma_f32_16x16x32_bf16 v[252:255], v[176:179], v[20:23], v[252:255]
  s_waitcnt lgkmcnt(6)
  v_mfma_f32_16x16x32_bf16 v[236:239], v[180:183], v[16:19], v[236:239]
  v_mfma_f32_16x16x32_bf16 v[104:107], v[180:183], v[20:23], v[104:107]
  s_waitcnt lgkmcnt(5)
  v_mfma_f32_16x16x32_bf16 v[240:243], v[184:187], v[16:19], v[240:243]
  v_mfma_f32_16x16x32_bf16 v[108:111], v[184:187], v[20:23], v[108:111]
  s_add_u32 s56, s21, 90112
  buffer_load_dwordx4 v[16:19], v1, s[16:19], s56 offen offset:0
  buffer_load_dwordx4 v[20:23], v3, s[16:19], s56 offen offset:0
  s_waitcnt vmcnt(32) lgkmcnt(4)
  v_mfma_f32_16x16x32_bf16 v[224:227], v[188:191], v[24:27], v[224:227]
  s_waitcnt vmcnt(31)
  v_mfma_f32_16x16x32_bf16 v[244:247], v[188:191], v[28:31], v[244:247]
  s_waitcnt lgkmcnt(0)
  s_waitcnt vmcnt(26)
  s_barrier
  ds_read_b128 v[168:171], v6 offset:0
  v_mfma_f32_16x16x32_bf16 v[228:231], v[32:35], v[24:27], v[228:231]
  ds_read_b128 v[172:175], v6 offset:1024
  v_mfma_f32_16x16x32_bf16 v[248:251], v[32:35], v[28:31], v[248:251]
  ds_read_b128 v[176:179], v6 offset:2048
  v_mfma_f32_16x16x32_bf16 v[232:235], v[36:39], v[24:27], v[232:235]
  ds_read_b128 v[180:183], v6 offset:3072
  s_mov_b32 m0, s51
  s_add_u32 s57, s23, 225280
  buffer_load_dwordx4 v4, s[16:19], s57 offen lds
  v_mfma_f32_16x16x32_bf16 v[252:255], v[36:39], v[28:31], v[252:255]
  ds_read_b128 v[184:187], v6 offset:4096
  buffer_load_dwordx4 v4, s[16:19], s57 offen offset:1024 lds
  v_mfma_f32_16x16x32_bf16 v[236:239], v[40:43], v[24:27], v[236:239]
  s_mov_b32 exec_hi, 0
  buffer_load_dwordx4 v4, s[16:19], s57 offen offset:2048 lds
  s_mov_b32 exec_hi, -1
  s_nop 0
  v_mfma_f32_16x16x32_bf16 v[104:107], v[40:43], v[28:31], v[104:107]
  v_mfma_f32_16x16x32_bf16 v[240:243], v[44:47], v[24:27], v[240:243]
  v_mfma_f32_16x16x32_bf16 v[108:111], v[44:47], v[28:31], v[108:111]
  s_add_u32 s56, s21, 90112
  buffer_load_dwordx4 v[24:27], v1, s[16:19], s56 offen offset:2048
  buffer_load_dwordx4 v[28:31], v3, s[16:19], s56 offen offset:2048
  s_waitcnt lgkmcnt(4)
  v_mfma_f32_16x16x32_bf16 v[224:227], v[168:171], v[192:195], v[224:227]
  ds_read_b128 v[188:191], v6 offset:5120
  v_mfma_f32_16x16x32_bf16 v[244:247], v[168:171], v[196:199], v[244:247]
  ds_read_b128 v[32:35], v6 offset:6144
  s_waitcnt lgkmcnt(5)
  v_mfma_f32_16x16x32_bf16 v[228:231], v[172:175], v[192:195], v[228:231]
  ds_read_b128 v[36:39], v6 offset:7168
  v_mfma_f32_16x16x32_bf16 v[248:251], v[172:175], v[196:199], v[248:251]
  ds_read_b128 v[40:43], v6 offset:8192
  s_waitcnt lgkmcnt(6)
  v_mfma_f32_16x16x32_bf16 v[232:235], v[176:179], v[192:195], v[232:235]
  ds_read_b128 v[44:47], v6 offset:9216
  v_mfma_f32_16x16x32_bf16 v[252:255], v[176:179], v[196:199], v[252:255]
  s_waitcnt lgkmcnt(6)
  v_mfma_f32_16x16x32_bf16 v[236:239], v[180:183], v[192:195], v[236:239]
  v_mfma_f32_16x16x32_bf16 v[104:107], v[180:183], v[196:199], v[104:107]
  s_waitcnt lgkmcnt(5)
  v_mfma_f32_16x16x32_bf16 v[240:243], v[184:187], v[192:195], v[240:243]
  v_mfma_f32_16x16x32_bf16 v[108:111], v[184:187], v[196:199], v[108:111]
  s_waitcnt vmcnt(30) lgkmcnt(4)
  v_mfma_f32_16x16x32_bf16 v[224:227], v[188:191], v[200:203], v[224:227]
  s_waitcnt vmcnt(29)
  v_mfma_f32_16x16x32_bf16 v[244:247], v[188:191], v[204:207], v[244:247]
  s_waitcnt lgkmcnt(0)
  s_waitcnt vmcnt(24)
  s_barrier
  ds_read_b128 v[168:171], v5 offset:0
  v_mfma_f32_16x16x32_bf16 v[228:231], v[32:35], v[200:203], v[228:231]
  ds_read_b128 v[172:175], v5 offset:1024
  v_mfma_f32_16x16x32_bf16 v[248:251], v[32:35], v[204:207], v[248:251]
  ds_read_b128 v[176:179], v5 offset:2048
  v_mfma_f32_16x16x32_bf16 v[232:235], v[36:39], v[200:203], v[232:235]
  ds_read_b128 v[180:183], v5 offset:3072
  v_mfma_f32_16x16x32_bf16 v[252:255], v[36:39], v[204:207], v[252:255]
  ds_read_b128 v[184:187], v5 offset:4096
  v_mfma_f32_16x16x32_bf16 v[236:239], v[40:43], v[200:203], v[236:239]
  v_mfma_f32_16x16x32_bf16 v[104:107], v[40:43], v[204:207], v[104:107]
  v_mfma_f32_16x16x32_bf16 v[240:243], v[44:47], v[200:203], v[240:243]
  v_mfma_f32_16x16x32_bf16 v[108:111], v[44:47], v[204:207], v[108:111]
  s_waitcnt lgkmcnt(4)
  v_mfma_f32_16x16x32_bf16 v[224:227], v[168:171], v[208:211], v[224:227]
  ds_read_b128 v[188:191], v5 offset:5120
  v_mfma_f32_16x16x32_bf16 v[244:247], v[168:171], v[212:215], v[244:247]
  ds_read_b128 v[32:35], v5 offset:6144
  s_waitcnt lgkmcnt(5)
  v_mfma_f32_16x16x32_bf16 v[228:231], v[172:175], v[208:211], v[228:231]
  ds_read_b128 v[36:39], v5 offset:7168
  v_mfma_f32_16x16x32_bf16 v[248:251], v[172:175], v[212:215], v[248:251]
  ds_read_b128 v[40:43], v5 offset:8192
  s_waitcnt lgkmcnt(6)
  v_mfma_f32_16x16x32_bf16 v[232:235], v[176:179], v[208:211], v[232:235]
  ds_read_b128 v[44:47], v5 offset:9216
  v_mfma_f32_16x16x32_bf16 v[252:255], v[176:179], v[212:215], v[252:255]
  s_waitcnt lgkmcnt(6)
  v_mfma_f32_16x16x32_bf16 v[236:239], v[180:183], v[208:211], v[236:239]
  v_mfma_f32_16x16x32_bf16 v[104:107], v[180:183], v[212:215], v[104:107]
  s_waitcnt lgkmcnt(5)
  v_mfma_f32_16x16x32_bf16 v[240:243], v[184:187], v[208:211], v[240:243]
  v_mfma_f32_16x16x32_bf16 v[108:111], v[184:187], v[212:215], v[108:111]
  s_waitcnt vmcnt(23) lgkmcnt(4)
  v_mfma_f32_16x16x32_bf16 v[224:227], v[188:191], v[216:219], v[224:227]
  s_waitcnt vmcnt(22)
  v_mfma_f32_16x16x32_bf16 v[244:247], v[188:191], v[220:223], v[244:247]
  s_waitcnt lgkmcnt(0)
  s_waitcnt vmcnt(16)
  s_barrier
  ds_read_b128 v[168:171], v5 offset:20480
  v_mfma_f32_16x16x32_bf16 v[228:231], v[32:35], v[216:219], v[228:231]
  ds_read_b128 v[172:175], v5 offset:21504
  v_mfma_f32_16x16x32_bf16 v[248:251], v[32:35], v[220:223], v[248:251]
  ds_read_b128 v[176:179], v5 offset:22528
  v_mfma_f32_16x16x32_bf16 v[232:235], v[36:39], v[216:219], v[232:235]
  ds_read_b128 v[180:183], v5 offset:23552
  v_mfma_f32_16x16x32_bf16 v[252:255], v[36:39], v[220:223], v[252:255]
  ds_read_b128 v[184:187], v5 offset:24576
  v_mfma_f32_16x16x32_bf16 v[236:239], v[40:43], v[216:219], v[236:239]
  v_mfma_f32_16x16x32_bf16 v[104:107], v[40:43], v[220:223], v[104:107]
  v_mfma_f32_16x16x32_bf16 v[240:243], v[44:47], v[216:219], v[240:243]
  v_mfma_f32_16x16x32_bf16 v[108:111], v[44:47], v[220:223], v[108:111]
  s_waitcnt lgkmcnt(4)
  v_mfma_f32_16x16x32_bf16 v[224:227], v[168:171], v[48:51], v[224:227]
  ds_read_b128 v[188:191], v5 offset:25600
  v_mfma_f32_16x16x32_bf16 v[244:247], v[168:171], v[52:55], v[244:247]
  ds_read_b128 v[32:35], v5 offset:26624
  s_waitcnt lgkmcnt(5)
  v_mfma_f32_16x16x32_bf16 v[228:231], v[172:175], v[48:51], v[228:231]
  ds_read_b128 v[36:39], v5 offset:27648
  v_mfma_f32_16x16x32_bf16 v[248:251], v[172:175], v[52:55], v[248:251]
  ds_read_b128 v[40:43], v5 offset:28672
  s_waitcnt lgkmcnt(6)
  v_mfma_f32_16x16x32_bf16 v[232:235], v[176:179], v[48:51], v[232:235]
  ds_read_b128 v[44:47], v5 offset:29696
  v_mfma_f32_16x16x32_bf16 v[252:255], v[176:179], v[52:55], v[252:255]
  s_waitcnt lgkmcnt(6)
  v_mfma_f32_16x16x32_bf16 v[236:239], v[180:183], v[48:51], v[236:239]
  v_mfma_f32_16x16x32_bf16 v[104:107], v[180:183], v[52:55], v[104:107]
  s_waitcnt lgkmcnt(5)
  v_mfma_f32_16x16x32_bf16 v[240:243], v[184:187], v[48:51], v[240:243]
  v_mfma_f32_16x16x32_bf16 v[108:111], v[184:187], v[52:55], v[108:111]
  s_waitcnt vmcnt(15) lgkmcnt(4)
  v_mfma_f32_16x16x32_bf16 v[224:227], v[188:191], v[56:59], v[224:227]
  s_waitcnt vmcnt(14)
  v_mfma_f32_16x16x32_bf16 v[244:247], v[188:191], v[60:63], v[244:247]
  s_waitcnt lgkmcnt(0)
  s_waitcnt vmcnt(9)
  s_barrier
  ds_read_b128 v[168:171], v5 offset:40960
  v_mfma_f32_16x16x32_bf16 v[228:231], v[32:35], v[56:59], v[228:231]
  ds_read_b128 v[172:175], v5 offset:41984
  v_mfma_f32_16x16x32_bf16 v[248:251], v[32:35], v[60:63], v[248:251]
  ds_read_b128 v[176:179], v5 offset:43008
  v_mfma_f32_16x16x32_bf16 v[232:235], v[36:39], v[56:59], v[232:235]
  ds_read_b128 v[180:183], v5 offset:44032
  v_mfma_f32_16x16x32_bf16 v[252:255], v[36:39], v[60:63], v[252:255]
  ds_read_b128 v[184:187], v5 offset:45056
  v_mfma_f32_16x16x32_bf16 v[236:239], v[40:43], v[56:59], v[236:239]
  v_mfma_f32_16x16x32_bf16 v[104:107], v[40:43], v[60:63], v[104:107]
  v_mfma_f32_16x16x32_bf16 v[240:243], v[44:47], v[56:59], v[240:243]
  v_mfma_f32_16x16x32_bf16 v[108:111], v[44:47], v[60:63], v[108:111]
  s_waitcnt lgkmcnt(4)
  v_mfma_f32_16x16x32_bf16 v[224:227], v[168:171], v[112:115], v[224:227]
  ds_read_b128 v[188:191], v5 offset:46080
  v_mov_b32 v12, 0x10100
  buffer_load_dword v11, off, s[16:19], s45 sc0 sc1
  v_mfma_f32_16x16x32_bf16 v[244:247], v[168:171], v[116:119], v[244:247]
  ds_read_b128 v[32:35], v5 offset:47104
  s_waitcnt lgkmcnt(5)
  v_mfma_f32_16x16x32_bf16 v[228:231], v[172:175], v[112:115], v[228:231]
  ds_read_b128 v[36:39], v5 offset:48128
  v_mfma_f32_16x16x32_bf16 v[248:251], v[172:175], v[116:119], v[248:251]
  ds_read_b128 v[40:43], v5 offset:49152
  s_waitcnt lgkmcnt(6)
  v_mfma_f32_16x16x32_bf16 v[232:235], v[176:179], v[112:115], v[232:235]
  ds_read_b128 v[44:47], v5 offset:50176
  v_mfma_f32_16x16x32_bf16 v[252:255], v[176:179], v[116:119], v[252:255]
  s_waitcnt lgkmcnt(6)
  v_mfma_f32_16x16x32_bf16 v[236:239], v[180:183], v[112:115], v[236:239]
  v_mfma_f32_16x16x32_bf16 v[104:107], v[180:183], v[116:119], v[104:107]
  s_waitcnt lgkmcnt(5)
  v_mfma_f32_16x16x32_bf16 v[240:243], v[184:187], v[112:115], v[240:243]
  v_mfma_f32_16x16x32_bf16 v[108:111], v[184:187], v[116:119], v[108:111]
  s_waitcnt vmcnt(9) lgkmcnt(4)
  v_mfma_f32_16x16x32_bf16 v[224:227], v[188:191], v[120:123], v[224:227]
  s_waitcnt vmcnt(8)
  v_mfma_f32_16x16x32_bf16 v[244:247], v[188:191], v[124:127], v[244:247]
  s_waitcnt lgkmcnt(0)
  s_waitcnt vmcnt(3)
  s_barrier
  ds_read_b128 v[168:171], v7 offset:0
  v_mfma_f32_16x16x32_bf16 v[228:231], v[32:35], v[120:123], v[228:231]
  ds_read_b128 v[172:175], v7 offset:1024
  v_mfma_f32_16x16x32_bf16 v[248:251], v[32:35], v[124:127], v[248:251]
  ds_read_b128 v[176:179], v7 offset:2048
  v_mfma_f32_16x16x32_bf16 v[232:235], v[36:39], v[120:123], v[232:235]
  ds_read_b128 v[180:183], v7 offset:3072
  v_mfma_f32_16x16x32_bf16 v[252:255], v[36:39], v[124:127], v[252:255]
  ds_read_b128 v[184:187], v7 offset:4096
  v_mfma_f32_16x16x32_bf16 v[236:239], v[40:43], v[120:123], v[236:239]
  v_mfma_f32_16x16x32_bf16 v[104:107], v[40:43], v[124:127], v[104:107]
  v_mfma_f32_16x16x32_bf16 v[240:243], v[44:47], v[120:123], v[240:243]
  v_mfma_f32_16x16x32_bf16 v[108:111], v[44:47], v[124:127], v[108:111]
  s_waitcnt vmcnt(0)
  v_and_b32 v14, v11, v12
  v_cmp_ne_u32 vcc, v14, v12
  s_nop 0
  s_cbranch_vccnz .Lp3_late1
  s_waitcnt lgkmcnt(4)
  v_mfma_f32_16x16x32_bf16 v[224:227], v[168:171], v[16:19], v[224:227]
  ds_read_b128 v[188:191], v7 offset:5120
  buffer_load_dwordx4 v[64:67], v2, s[16:19], s43 offen offset:0 sc0 sc1
  v_mfma_f32_16x16x32_bf16 v[244:247], v[168:171], v[20:23], v[244:247]
  ds_read_b128 v[32:35], v7 offset:6144
  buffer_load_dwordx4 v[68:71], v2, s[16:19], s43 offen offset:1024 sc0 sc1
  s_waitcnt lgkmcnt(5)
  v_mfma_f32_16x16x32_bf16 v[228:231], v[172:175], v[16:19], v[228:231]
  ds_read_b128 v[36:39], v7 offset:7168
  buffer_load_dwordx2 v[72:73], v2, s[16:19], s43 offen offset:2048 sc0 sc1
  v_mfma_f32_16x16x32_bf16 v[248:251], v[172:175], v[20:23], v[248:251]
  ds_read_b128 v[40:43], v7 offset:8192
  s_add_u32 s55, s43, 40960
  buffer_load_dwordx4 v[84:87], v2, s[16:19], s55 offen offset:0 sc0 sc1
  s_waitcnt lgkmcnt(6)
  v_mfma_f32_16x16x32_bf16 v[232:235], v[176:179], v[16:19], v[232:235]
  ds_read_b128 v[44:47], v7 offset:9216
  buffer_load_dwordx4 v[88:91], v2, s[16:19], s55 offen offset:1024 sc0 sc1
  v_mfma_f32_16x16x32_bf16 v[252:255], v[176:179], v[20:23], v[252:255]
  buffer_load_dwordx2 v[92:93], v2, s[16:19], s55 offen offset:2048 sc0 sc1
  s_waitcnt lgkmcnt(6)
  v_mfma_f32_16x16x32_bf16 v[236:239], v[180:183], v[16:19], v[236:239]
  v_mfma_f32_16x16x32_bf16 v[104:107], v[180:183], v[20:23], v[104:107]
  s_waitcnt lgkmcnt(5)
  v_mfma_f32_16x16x32_bf16 v[240:243], v[184:187], v[16:19], v[240:243]
  v_mfma_f32_16x16x32_bf16 v[108:111], v[184:187], v[20:23], v[108:111]
  s_waitcnt lgkmcnt(4)
  v_mfma_f32_16x16x32_bf16 v[244:247], v[188:191], v[28:31], v[244:247]
  s_waitcnt lgkmcnt(3)
  v_mfma_f32_16x16x32_bf16 v[248:251], v[32:35], v[28:31], v[248:251]
  s_waitcnt lgkmcnt(2)
  v_mfma_f32_16x16x32_bf16 v[252:255], v[36:39], v[28:31], v[252:255]
  s_waitcnt lgkmcnt(1)
  v_mfma_f32_16x16x32_bf16 v[104:107], v[40:43], v[28:31], v[104:107]
  s_waitcnt lgkmcnt(0)
  v_mfma_f32_16x16x32_bf16 v[108:111], v[44:47], v[28:31], v[108:111]
  v_mfma_f32_16x16x32_bf16 v[224:227], v[188:191], v[24:27], v[224:227]
  v_mfma_f32_16x16x32_bf16 v[228:231], v[32:35], v[24:27], v[228:231]
  v_mfma_f32_16x16x32_bf16 v[232:235], v[36:39], v[24:27], v[232:235]
  v_mfma_f32_16x16x32_bf16 v[236:239], v[40:43], v[24:27], v[236:239]
  v_mfma_f32_16x16x32_bf16 v[240:243], v[44:47], v[24:27], v[240:243]
  ds_write_b128 v8, v[244:247] offset:0
  ds_write_b128 v8, v[248:251] offset:1024
  ds_write_b128 v8, v[252:255] offset:2048
  ds_write_b128 v8, v[104:107] offset:3072
  ds_write_b128 v8, v[108:111] offset:4096
  s_mul_i32 s55, s42, 81920
  s_mul_i32 s56, s48, 320
  s_add_u32 s55, s55, s56
  s_waitcnt lgkmcnt(0)
  s_barrier
  ds_read_b128 v[244:247], v9 offset:0
  ds_read_b128 v[248:251], v9 offset:1024
  ds_read_b128 v[252:255], v9 offset:2048
  ds_read_b128 v[104:107], v9 offset:3072
  ds_read_b128 v[108:111], v9 offset:4096
  s_waitcnt lgkmcnt(4)
  v_add_f32 v224, v224, v244
  v_add_f32 v225, v225, v245
  v_add_f32 v226, v226, v246
  v_add_f32 v227, v227, v247
  s_waitcnt vmcnt(5)
  v_lshlrev_b32 v74, 16, v64
  v_and_b32 v64, 0xffff0000, v64
  v_add_f32 v224, v224, v74
  v_add_f32 v225, v225, v64
  v_lshlrev_b32 v75, 16, v65
  v_and_b32 v65, 0xffff0000, v65
  v_add_f32 v226, v226, v75
  v_add_f32 v227, v227, v65
  s_waitcnt vmcnt(2)
  v_lshlrev_b32 v94, 16, v84
  v_and_b32 v84, 0xffff0000, v84
  v_add_f32 v224, v224, v94
  v_add_f32 v225, v225, v84
  v_lshlrev_b32 v95, 16, v85
  v_and_b32 v85, 0xffff0000, v85
  v_add_f32 v226, v226, v95
  v_add_f32 v227, v227, v85
  buffer_store_dwordx4 v[224:227], v10, s[4:7], s55 offen offset:2560
  s_waitcnt lgkmcnt(3)
  v_add_f32 v228, v228, v248
  v_add_f32 v229, v229, v249
  v_add_f32 v230, v230, v250
  v_add_f32 v231, v231, v251
  v_lshlrev_b32 v74, 16, v66
  v_and_b32 v66, 0xffff0000, v66
  v_add_f32 v228, v228, v74
  v_add_f32 v229, v229, v66
  v_lshlrev_b32 v75, 16, v67
  v_and_b32 v67, 0xffff0000, v67
  v_add_f32 v230, v230, v75
  v_add_f32 v231, v231, v67
  v_lshlrev_b32 v94, 16, v86
  v_and_b32 v86, 0xffff0000, v86
  v_add_f32 v228, v228, v94
  v_add_f32 v229, v229, v86
  v_lshlrev_b32 v95, 16, v87
  v_and_b32 v87, 0xffff0000, v87
  v_add_f32 v230, v230, v95
  v_add_f32 v231, v231, v87
  buffer_store_dwordx4 v[228:231], v10, s[4:7], s55 offen offset:2624
  s_waitcnt lgkmcnt(2)
  v_add_f32 v232, v232, v252
  v_add_f32 v233, v233, v253
  v_add_f32 v234, v234, v254
  v_add_f32 v235, v235, v255
  v_lshlrev_b32 v74, 16, v68
  v_and_b32 v68, 0xffff0000, v68
  v_add_f32 v232, v232, v74
  v_add_f32 v233, v233, v68
  v_lshlrev_b32 v75, 16, v69
  v_and_b32 v69, 0xffff0000, v69
  v_add_f32 v234, v234, v75
  v_add_f32 v235, v235, v69
  s_waitcnt vmcnt(3)
  v_lshlrev_b32 v94, 16, v88
  v_and_b32 v88, 0xffff0000, v88
  v_add_f32 v232, v232, v94
  v_add_f32 v233, v233, v88
  v_lshlrev_b32 v95, 16, v89
  v_and_b32 v89, 0xffff0000, v89
  v_add_f32 v234, v234, v95
  v_add_f32 v235, v235, v89
  buffer_store_dwordx4 v[232:235], v10, s[4:7], s55 offen offset:2688
  s_waitcnt lgkmcnt(1)
  v_add_f32 v236, v236, v104
  v_add_f32 v237, v237, v105
  v_add_f32 v238, v238, v106
  v_add_f32 v239, v239, v107
  v_lshlrev_b32 v74, 16, v70
  v_and_b32 v70, 0xffff0000, v70
  v_add_f32 v236, v236, v74
  v_add_f32 v237, v237, v70
  v_lshlrev_b32 v75, 16, v71
  v_and_b32 v71, 0xffff0000, v71
  v_add_f32 v238, v238, v75
  v_add_f32 v239, v239, v71
  v_lshlrev_b32 v94, 16, v90
  v_and_b32 v90, 0xffff0000, v90
  v_add_f32 v236, v236, v94
  v_add_f32 v237, v237, v90
  v_lshlrev_b32 v95, 16, v91
  v_and_b32 v91, 0xffff0000, v91
  v_add_f32 v238, v238, v95
  v_add_f32 v239, v239, v91
  buffer_store_dwordx4 v[236:239], v10, s[4:7], s55 offen offset:2752
  s_waitcnt lgkmcnt(0)
  v_add_f32 v240, v240, v108
  v_add_f32 v241, v241, v109
  v_add_f32 v242, v242, v110
  v_add_f32 v243, v243, v111
  v_lshlrev_b32 v74, 16, v72
  v_and_b32 v72, 0xffff0000, v72
  v_add_f32 v240, v240, v74
  v_add_f32 v241, v241, v72
  v_lshlrev_b32 v75, 16, v73
  v_and_b32 v73, 0xffff0000, v73
  v_add_f32 v242, v242, v75
  v_add_f32 v243, v243, v73
  s_waitcnt vmcnt(4)
  v_lshlrev_b32 v94, 16, v92
  v_and_b32 v92, 0xffff0000, v92
  v_add_f32 v240, v240, v94
  v_add_f32 v241, v241, v92
  v_lshlrev_b32 v95, 16, v93
  v_and_b32 v93, 0xffff0000, v93
  v_add_f32 v242, v242, v95
  v_add_f32 v243, v243, v93
  buffer_store_dwordx4 v[240:243], v10, s[4:7], s55 offen offset:2816
  s_endpgm
.Lp3_late1:
  s_waitcnt lgkmcnt(4)
  v_mfma_f32_16x16x32_bf16 v[224:227], v[168:171], v[16:19], v[224:227]
  ds_read_b128 v[188:191], v7 offset:5120
  buffer_load_dword v11, off, s[16:19], s45 sc0 sc1
  v_mfma_f32_16x16x32_bf16 v[244:247], v[168:171], v[20:23], v[244:247]
  ds_read_b128 v[32:35], v7 offset:6144
  s_waitcnt lgkmcnt(5)
  v_mfma_f32_16x16x32_bf16 v[228:231], v[172:175], v[16:19], v[228:231]
  ds_read_b128 v[36:39], v7 offset:7168
  v_mfma_f32_16x16x32_bf16 v[248:251], v[172:175], v[20:23], v[248:251]
  ds_read_b128 v[40:43], v7 offset:8192
  s_waitcnt lgkmcnt(6)
  v_mfma_f32_16x16x32_bf16 v[232:235], v[176:179], v[16:19], v[232:235]
  ds_read_b128 v[44:47], v7 offset:9216
  v_mfma_f32_16x16x32_bf16 v[252:255], v[176:179], v[20:23], v[252:255]
  s_waitcnt lgkmcnt(6)
  v_mfma_f32_16x16x32_bf16 v[236:239], v[180:183], v[16:19], v[236:239]
  v_mfma_f32_16x16x32_bf16 v[104:107], v[180:183], v[20:23], v[104:107]
  s_waitcnt lgkmcnt(5)
  v_mfma_f32_16x16x32_bf16 v[240:243], v[184:187], v[16:19], v[240:243]
  v_mfma_f32_16x16x32_bf16 v[108:111], v[184:187], v[20:23], v[108:111]
  s_waitcnt lgkmcnt(4)
  v_mfma_f32_16x16x32_bf16 v[244:247], v[188:191], v[28:31], v[244:247]
  s_waitcnt lgkmcnt(3)
  v_mfma_f32_16x16x32_bf16 v[248:251], v[32:35], v[28:31], v[248:251]
  s_waitcnt lgkmcnt(2)
  v_mfma_f32_16x16x32_bf16 v[252:255], v[36:39], v[28:31], v[252:255]
  s_waitcnt lgkmcnt(1)
  v_mfma_f32_16x16x32_bf16 v[104:107], v[40:43], v[28:31], v[104:107]
  s_waitcnt lgkmcnt(0)
  v_mfma_f32_16x16x32_bf16 v[108:111], v[44:47], v[28:31], v[108:111]
  v_mfma_f32_16x16x32_bf16 v[224:227], v[188:191], v[24:27], v[224:227]
  v_mfma_f32_16x16x32_bf16 v[228:231], v[32:35], v[24:27], v[228:231]
  v_mfma_f32_16x16x32_bf16 v[232:235], v[36:39], v[24:27], v[232:235]
  v_mfma_f32_16x16x32_bf16 v[236:239], v[40:43], v[24:27], v[236:239]
  v_mfma_f32_16x16x32_bf16 v[240:243], v[44:47], v[24:27], v[240:243]
  ds_write_b128 v8, v[244:247] offset:0
  ds_write_b128 v8, v[248:251] offset:1024
  ds_write_b128 v8, v[252:255] offset:2048
  ds_write_b128 v8, v[104:107] offset:3072
  ds_write_b128 v8, v[108:111] offset:4096
  s_waitcnt lgkmcnt(0)
  s_barrier
  ds_read_b128 v[244:247], v9 offset:0
  ds_read_b128 v[248:251], v9 offset:1024
  ds_read_b128 v[252:255], v9 offset:2048
  ds_read_b128 v[104:107], v9 offset:3072
  ds_read_b128 v[108:111], v9 offset:4096
  s_waitcnt vmcnt(0)
.Lpl130c:
  v_and_b32 v14, v11, v12
  v_cmp_ne_u32 vcc, v14, v12
  s_nop 0
  s_cbranch_vccnz .Lpl130s
.Lpl130k:
  buffer_load_dwordx4 v[64:67], v2, s[16:19], s43 offen offset:0 sc0 sc1
  buffer_load_dwordx4 v[68:71], v2, s[16:19], s43 offen offset:1024 sc0 sc1
  buffer_load_dwordx2 v[72:73], v2, s[16:19], s43 offen offset:2048 sc0 sc1
  s_add_u32 s55, s43, 40960
  buffer_load_dwordx4 v[84:87], v2, s[16:19], s55 offen offset:0 sc0 sc1
  buffer_load_dwordx4 v[88:91], v2, s[16:19], s55 offen offset:1024 sc0 sc1
  buffer_load_dwordx2 v[92:93], v2, s[16:19], s55 offen offset:2048 sc0 sc1
  s_mul_i32 s55, s42, 81920
  s_mul_i32 s56, s48, 320
  s_add_u32 s55, s55, s56
  s_waitcnt lgkmcnt(4)
  v_add_f32 v224, v224, v244
  v_add_f32 v225, v225, v245
  v_add_f32 v226, v226, v246
  v_add_f32 v227, v227, v247
  s_waitcnt vmcnt(5)
  v_lshlrev_b32 v74, 16, v64
  v_and_b32 v64, 0xffff0000, v64
  v_add_f32 v224, v224, v74
  v_add_f32 v225, v225, v64
  v_lshlrev_b32 v75, 16, v65
  v_and_b32 v65, 0xffff0000, v65
  v_add_f32 v226, v226, v75
  v_add_f32 v227, v227, v65
  s_waitcnt vmcnt(2)
  v_lshlrev_b32 v94, 16, v84
  v_and_b32 v84, 0xffff0000, v84
  v_add_f32 v224, v224, v94
  v_add_f32 v225, v225, v84
  v_lshlrev_b32 v95, 16, v85
  v_and_b32 v85, 0xffff0000, v85
  v_add_f32 v226, v226, v95
  v_add_f32 v227, v227, v85
  buffer_store_dwordx4 v[224:227], v10, s[4:7], s55 offen offset:2560
  s_waitcnt lgkmcnt(3)
  v_add_f32 v228, v228, v248
  v_add_f32 v229, v229, v249
  v_add_f32 v230, v230, v250
  v_add_f32 v231, v231, v251
  v_lshlrev_b32 v74, 16, v66
  v_and_b32 v66, 0xffff0000, v66
  v_add_f32 v228, v228, v74
  v_add_f32 v229, v229, v66
  v_lshlrev_b32 v75, 16, v67
  v_and_b32 v67, 0xffff0000, v67
  v_add_f32 v230, v230, v75
  v_add_f32 v231, v231, v67
  v_lshlrev_b32 v94, 16, v86
  v_and_b32 v86, 0xffff0000, v86
  v_add_f32 v228, v228, v94
  v_add_f32 v229, v229, v86
  v_lshlrev_b32 v95, 16, v87
  v_and_b32 v87, 0xffff0000, v87
  v_add_f32 v230, v230, v95
  v_add_f32 v231, v231, v87
  buffer_store_dwordx4 v[228:231], v10, s[4:7], s55 offen offset:2624
  s_waitcnt lgkmcnt(2)
  v_add_f32 v232, v232, v252
  v_add_f32 v233, v233, v253
  v_add_f32 v234, v234, v254
  v_add_f32 v235, v235, v255
  v_lshlrev_b32 v74, 16, v68
  v_and_b32 v68, 0xffff0000, v68
  v_add_f32 v232, v232, v74
  v_add_f32 v233, v233, v68
  v_lshlrev_b32 v75, 16, v69
  v_and_b32 v69, 0xffff0000, v69
  v_add_f32 v234, v234, v75
  v_add_f32 v235, v235, v69
  s_waitcnt vmcnt(3)
  v_lshlrev_b32 v94, 16, v88
  v_and_b32 v88, 0xffff0000, v88
  v_add_f32 v232, v232, v94
  v_add_f32 v233, v233, v88
  v_lshlrev_b32 v95, 16, v89
  v_and_b32 v89, 0xffff0000, v89
  v_add_f32 v234, v234, v95
  v_add_f32 v235, v235, v89
  buffer_store_dwordx4 v[232:235], v10, s[4:7], s55 offen offset:2688
  s_waitcnt lgkmcnt(1)
  v_add_f32 v236, v236, v104
  v_add_f32 v237, v237, v105
  v_add_f32 v238, v238, v106
  v_add_f32 v239, v239, v107
  v_lshlrev_b32 v74, 16, v70
  v_and_b32 v70, 0xffff0000, v70
  v_add_f32 v236, v236, v74
  v_add_f32 v237, v237, v70
  v_lshlrev_b32 v75, 16, v71
  v_and_b32 v71, 0xffff0000, v71
  v_add_f32 v238, v238, v75
  v_add_f32 v239, v239, v71
  v_lshlrev_b32 v94, 16, v90
  v_and_b32 v90, 0xffff0000, v90
  v_add_f32 v236, v236, v94
  v_add_f32 v237, v237, v90
  v_lshlrev_b32 v95, 16, v91
  v_and_b32 v91, 0xffff0000, v91
  v_add_f32 v238, v238, v95
  v_add_f32 v239, v239, v91
  buffer_store_dwordx4 v[236:239], v10, s[4:7], s55 offen offset:2752
  s_waitcnt lgkmcnt(0)
  v_add_f32 v240, v240, v108
  v_add_f32 v241, v241, v109
  v_add_f32 v242, v242, v110
  v_add_f32 v243, v243, v111
  v_lshlrev_b32 v74, 16, v72
  v_and_b32 v72, 0xffff0000, v72
  v_add_f32 v240, v240, v74
  v_add_f32 v241, v241, v72
  v_lshlrev_b32 v75, 16, v73
  v_and_b32 v73, 0xffff0000, v73
  v_add_f32 v242, v242, v75
  v_add_f32 v243, v243, v73
  s_waitcnt vmcnt(4)
  v_lshlrev_b32 v94, 16, v92
  v_and_b32 v92, 0xffff0000, v92
  v_add_f32 v240, v240, v94
  v_add_f32 v241, v241, v92
  v_lshlrev_b32 v95, 16, v93
  v_and_b32 v93, 0xffff0000, v93
  v_add_f32 v242, v242, v95
  v_add_f32 v243, v243, v93
  buffer_store_dwordx4 v[240:243], v10, s[4:7], s55 offen offset:2816
  s_endpgm
.Lp3_r2:
  s_barrier
  ds_read_b128 v[168:171], v6 offset:0
  ds_read_b128 v[172:175], v6 offset:1024
  ds_read_b128 v[176:179], v6 offset:2048
  ds_read_b128 v[180:183], v6 offset:3072
  ds_read_b128 v[184:187], v6 offset:4096
  s_cmp_ge_u32 s52, 4
  s_cbranch_scc1 .Lp3_x2
  s_add_u32 s56, s20, 24576
  buffer_load_dwordx4 v[112:115], v1, s[16:19], s56 offen offset:0
  buffer_load_dwordx4 v[116:119], v3, s[16:19], s56 offen offset:0
  s_add_u32 s56, s20, 24576
  buffer_load_dwordx4 v[120:123], v1, s[16:19], s56 offen offset:2048
  buffer_load_dwordx4 v[124:127], v3, s[16:19], s56 offen offset:2048
  s_add_u32 s56, s20, 32768
  buffer_load_dwordx4 v[16:19], v1, s[16:19], s56 offen offset:0
  buffer_load_dwordx4 v[20:23], v3, s[16:19], s56 offen offset:0
  s_add_u32 s56, s20, 32768
  buffer_load_dwordx4 v[24:27], v1, s[16:19], s56 offen offset:2048
  buffer_load_dwordx4 v[28:31], v3, s[16:19], s56 offen offset:2048
.Lp3_x2:
  s_mov_b32 m0, s51
  s_add_u32 s57, s22, 81920
  buffer_load_dwordx4 v4, s[16:19], s57 offen lds
  buffer_load_dwordx4 v4, s[16:19], s57 offen offset:1024 lds
  s_mov_b32 exec_hi, 0
  buffer_load_dwordx4 v4, s[16:19], s57 offen offset:2048 lds
  s_mov_b32 exec_hi, -1
  s_waitcnt vmcnt(30) lgkmcnt(4)
  v_mfma_f32_16x16x32_bf16 v[64:67], v[168:171], v[192:195], v[64:67]
  ds_read_b128 v[188:191], v6 offset:5120
  s_sub_u32 s55, s27, 131072
  v_add_u32 v5, s55, v6
  s_waitcnt vmcnt(29)
  v_mfma_f32_16x16x32_bf16 v[84:87], v[168:171], v[196:199], v[84:87]
  ds_read_b128 v[32:35], v6 offset:6144
  s_sub_u32 s55, s40, 131072
  v_add_u32 v7, s55, v6
  s_waitcnt lgkmcnt(5)
  v_mfma_f32_16x16x32_bf16 v[68:71], v[172:175], v[192:195], v[68:71]
  ds_read_b128 v[36:39], v6 offset:7168
  s_mul_i32 s55, s52, 5120
  s_add_u32 s55, s55, s40
  s_add_u32 s55, s55, 20480
  v_add_u32 v8, s55, v2
  v_mfma_f32_16x16x32_bf16 v[88:91], v[172:175], v[196:199], v[88:91]
  ds_read_b128 v[40:43], v6 offset:8192
  s_xor_b32 s55, s52, 4
  s_mul_i32 s55, s55, 5120
  s_add_u32 s55, s55, s40
  s_add_u32 s55, s55, 20480
  v_add_u32 v9, s55, v2
  s_waitcnt lgkmcnt(6)
  v_mfma_f32_16x16x32_bf16 v[72:75], v[176:179], v[192:195], v[72:75]
  ds_read_b128 v[44:47], v6 offset:9216
  v_and_b32 v10, 15, v0
  v_mul_u32_u24 v10, 5120, v10
  v_mfma_f32_16x16x32_bf16 v[92:95], v[176:179], v[196:199], v[92:95]
  v_and_b32 v14, 48, v0
  v_add_u32 v10, v10, v14
  s_waitcnt lgkmcnt(6)
  v_mfma_f32_16x16x32_bf16 v[76:79], v[180:183], v[192:195], v[76:79]
  v_mfma_f32_16x16x32_bf16 v[96:99], v[180:183], v[196:199], v[96:99]
  s_waitcnt lgkmcnt(5)
  v_mfma_f32_16x16x32_bf16 v[80:83], v[184:187], v[192:195], v[80:83]
  v_mfma_f32_16x16x32_bf16 v[100:103], v[184:187], v[196:199], v[100:103]
  s_add_u32 s56, s20, 40960
  buffer_load_dwordx4 v[192:195], v1, s[16:19], s56 offen offset:0
  buffer_load_dwordx4 v[196:199], v3, s[16:19], s56 offen offset:0
  s_waitcnt vmcnt(30) lgkmcnt(4)
  v_mfma_f32_16x16x32_bf16 v[64:67], v[188:191], v[200:203], v[64:67]
  v_min_u32 v13, 31, v0
  v_subrev_u32 v12, s26, v0
  v_cmp_gt_u32 vcc, 10, v12
  s_nop 1
  v_cndmask_b32 v12, 0, 1, vcc
  s_waitcnt vmcnt(29)
  v_mfma_f32_16x16x32_bf16 v[84:87], v[188:191], v[204:207], v[84:87]
  s_waitcnt lgkmcnt(0)
  s_barrier
  ds_read_b128 v[168:171], v5 offset:0
  v_mfma_f32_16x16x32_bf16 v[68:71], v[32:35], v[200:203], v[68:71]
  ds_read_b128 v[172:175], v5 offset:1024
  v_mfma_f32_16x16x32_bf16 v[88:91], v[32:35], v[204:207], v[88:91]
  ds_read_b128 v[176:179], v5 offset:2048
  v_mfma_f32_16x16x32_bf16 v[72:75], v[36:39], v[200:203], v[72:75]
  ds_read_b128 v[180:183], v5 offset:3072
  s_add_u32 m0, s41, 131072
  s_add_u32 s57, s22, 102400
  buffer_load_dwordx4 v4, s[16:19], s57 offen lds
  v_mfma_f32_16x16x32_bf16 v[92:95], v[36:39], v[204:207], v[92:95]
  ds_read_b128 v[184:187], v5 offset:4096
  buffer_load_dwordx4 v4, s[16:19], s57 offen offset:1024 lds
  v_mfma_f32_16x16x32_bf16 v[76:79], v[40:43], v[200:203], v[76:79]
  s_mov_b32 exec_hi, 0
  buffer_load_dwordx4 v4, s[16:19], s57 offen offset:2048 lds
  s_mov_b32 exec_hi, -1
  s_nop 0
  v_mfma_f32_16x16x32_bf16 v[96:99], v[40:43], v[204:207], v[96:99]
  v_mfma_f32_16x16x32_bf16 v[80:83], v[44:47], v[200:203], v[80:83]
  v_mfma_f32_16x16x32_bf16 v[100:103], v[44:47], v[204:207], v[100:103]
  s_add_u32 s56, s20, 40960
  buffer_load_dwordx4 v[200:203], v1, s[16:19], s56 offen offset:2048
  buffer_load_dwordx4 v[204:207], v3, s[16:19], s56 offen offset:2048
  s_waitcnt vmcnt(18)
  s_cmp_eq_u32 s89, 0
  s_cbranch_scc1 .Lcf131
  v_mov_b32 v14, 1
  s_mov_b64 exec, 1
  buffer_store_byte v14, off, s[16:19], s89 sc0 sc1
  s_mov_b64 exec, -1
  s_mov_b32 s89, 0
.Lcf131:
  s_waitcnt lgkmcnt(4)
  v_mfma_f32_16x16x32_bf16 v[64:67], v[168:171], v[208:211], v[64:67]
  ds_read_b128 v[188:191], v5 offset:5120
  v_mfma_f32_16x16x32_bf16 v[84:87], v[168:171], v[212:215], v[84:87]
  ds_read_b128 v[32:35], v5 offset:6144
  s_waitcnt lgkmcnt(5)
  v_mfma_f32_16x16x32_bf16 v[68:71], v[172:175], v[208:211], v[68:71]
  ds_read_b128 v[36:39], v5 offset:7168
  v_mfma_f32_16x16x32_bf16 v[88:91], v[172:175], v[212:215], v[88:91]
  ds_read_b128 v[40:43], v5 offset:8192
  s_waitcnt lgkmcnt(6)
  v_mfma_f32_16x16x32_bf16 v[72:75], v[176:179], v[208:211], v[72:75]
  ds_read_b128 v[44:47], v5 offset:9216
  v_mfma_f32_16x16x32_bf16 v[92:95], v[176:179], v[212:215], v[92:95]
  s_waitcnt lgkmcnt(6)
  v_mfma_f32_16x16x32_bf16 v[76:79], v[180:183], v[208:211], v[76:79]
  v_mfma_f32_16x16x32_bf16 v[96:99], v[180:183], v[212:215], v[96:99]
  s_waitcnt lgkmcnt(5)
  v_mfma_f32_16x16x32_bf16 v[80:83], v[184:187], v[208:211], v[80:83]
  v_mfma_f32_16x16x32_bf16 v[100:103], v[184:187], v[212:215], v[100:103]
  s_waitcnt lgkmcnt(4)
  v_mfma_f32_16x16x32_bf16 v[64:67], v[188:191], v[216:219], v[64:67]
  v_mfma_f32_16x16x32_bf16 v[84:87], v[188:191], v[220:223], v[84:87]
  s_waitcnt lgkmcnt(0)
  s_barrier
  ds_read_b128 v[168:171], v5 offset:20480
  v_mfma_f32_16x16x32_bf16 v[68:71], v[32:35], v[216:219], v[68:71]
  ds_read_b128 v[172:175], v5 offset:21504
  v_mfma_f32_16x16x32_bf16 v[88:91], v[32:35], v[220:223], v[88:91]
  ds_read_b128 v[176:179], v5 offset:22528
  v_mfma_f32_16x16x32_bf16 v[72:75], v[36:39], v[216:219], v[72:75]
  ds_read_b128 v[180:183], v5 offset:23552
  s_add_u32 m0, s50, 0
  s_add_u32 s57, s23, 0
  buffer_load_dwordx4 v4, s[16:19], s57 offen lds
  v_mfma_f32_16x16x32_bf16 v[92:95], v[36:39], v[220:223], v[92:95]
  ds_read_b128 v[184:187], v5 offset:24576
  buffer_load_dwordx4 v4, s[16:19], s57 offen offset:1024 lds
  v_mfma_f32_16x16x32_bf16 v[76:79], v[40:43], v[216:219], v[76:79]
  s_mov_b32 exec_hi, 0
  buffer_load_dwordx4 v4, s[16:19], s57 offen offset:2048 lds
  s_mov_b32 exec_hi, -1
  s_nop 0
  v_mfma_f32_16x16x32_bf16 v[96:99], v[40:43], v[220:223], v[96:99]
  v_mfma_f32_16x16x32_bf16 v[80:83], v[44:47], v[216:219], v[80:83]
  v_mfma_f32_16x16x32_bf16 v[100:103], v[44:47], v[220:223], v[100:103]
  s_waitcnt lgkmcnt(4)
  v_mfma_f32_16x16x32_bf16 v[64:67], v[168:171], v[48:51], v[64:67]
  ds_read_b128 v[188:191], v5 offset:25600
  v_mfma_f32_16x16x32_bf16 v[84:87], v[168:171], v[52:55], v[84:87]
  ds_read_b128 v[32:35], v5 offset:26624
  s_waitcnt lgkmcnt(5)
  v_mfma_f32_16x16x32_bf16 v[68:71], v[172:175], v[48:51], v[68:71]
  ds_read_b128 v[36:39], v5 offset:27648
  v_mfma_f32_16x16x32_bf16 v[88:91], v[172:175], v[52:55], v[88:91]
  ds_read_b128 v[40:43], v5 offset:28672
  s_waitcnt lgkmcnt(6)
  v_mfma_f32_16x16x32_bf16 v[72:75], v[176:179], v[48:51], v[72:75]
  ds_read_b128 v[44:47], v5 offset:29696
  v_mfma_f32_16x16x32_bf16 v[92:95], v[176:179], v[52:55], v[92:95]
  s_waitcnt lgkmcnt(6)
  v_mfma_f32_16x16x32_bf16 v[76:79], v[180:183], v[48:51], v[76:79]
  v_mfma_f32_16x16x32_bf16 v[96:99], v[180:183], v[52:55], v[96:99]
  s_waitcnt lgkmcnt(5)
  v_mfma_f32_16x16x32_bf16 v[80:83], v[184:187], v[48:51], v[80:83]
  v_mfma_f32_16x16x32_bf16 v[100:103], v[184:187], v[52:55], v[100:103]
  s_waitcnt lgkmcnt(4)
  v_mfma_f32_16x16x32_bf16 v[64:67], v[188:191], v[56:59], v[64:67]
  v_mfma_f32_16x16x32_bf16 v[84:87], v[188:191], v[60:63], v[84:87]
  s_waitcnt lgkmcnt(0)
  s_barrier
  ds_read_b128 v[168:171], v5 offset:40960
  v_mfma_f32_16x16x32_bf16 v[68:71], v[32:35], v[56:59], v[68:71]
  ds_read_b128 v[172:175], v5 offset:41984
  v_mfma_f32_16x16x32_bf16 v[88:91], v[32:35], v[60:63], v[88:91]
  ds_read_b128 v[176:179], v5 offset:43008
  v_mfma_f32_16x16x32_bf16 v[72:75], v[36:39], v[56:59], v[72:75]
  ds_read_b128 v[180:183], v5 offset:44032
  s_add_u32 m0, s50, 20480
  s_add_u32 s57, s23, 20480
  buffer_load_dwordx4 v4, s[16:19], s57 offen lds
  v_mfma_f32_16x16x32_bf16 v[92:95], v[36:39], v[60:63], v[92:95]
  ds_read_b128 v[184:187], v5 offset:45056
  buffer_load_dwordx4 v4, s[16:19], s57 offen offset:1024 lds
  v_mfma_f32_16x16x32_bf16 v[76:79], v[40:43], v[56:59], v[76:79]
  s_mov_b32 exec_hi, 0
  buffer_load_dwordx4 v4, s[16:19], s57 offen offset:2048 lds
  s_mov_b32 exec_hi, -1
  s_nop 0
  v_mfma_f32_16x16x32_bf16 v[96:99], v[40:43], v[60:63], v[96:99]
  v_mfma_f32_16x16x32_bf16 v[80:83], v[44:47], v[56:59], v[80:83]
  v_mfma_f32_16x16x32_bf16 v[100:103], v[44:47], v[60:63], v[100:103]
  s_waitcnt vmcnt(23) lgkmcnt(4)
  v_mfma_f32_16x16x32_bf16 v[64:67], v[168:171], v[112:115], v[64:67]
  ds_read_b128 v[188:191], v5 offset:46080
  s_waitcnt vmcnt(22)
  v_mfma_f32_16x16x32_bf16 v[84:87], v[168:171], v[116:119], v[84:87]
  ds_read_b128 v[32:35], v5 offset:47104
  s_waitcnt lgkmcnt(5)
  v_mfma_f32_16x16x32_bf16 v[68:71], v[172:175], v[112:115], v[68:71]
  ds_read_b128 v[36:39], v5 offset:48128
  v_mfma_f32_16x16x32_bf16 v[88:91], v[172:175], v[116:119], v[88:91]
  ds_read_b128 v[40:43], v5 offset:49152
  s_waitcnt lgkmcnt(6)
  v_mfma_f32_16x16x32_bf16 v[72:75], v[176:179], v[112:115], v[72:75]
  ds_read_b128 v[44:47], v5 offset:50176
  v_mfma_f32_16x16x32_bf16 v[92:95], v[176:179], v[116:119], v[92:95]
  s_waitcnt lgkmcnt(6)
  v_mfma_f32_16x16x32_bf16 v[76:79], v[180:183], v[112:115], v[76:79]
  v_mfma_f32_16x16x32_bf16 v[96:99], v[180:183], v[116:119], v[96:99]
  s_waitcnt lgkmcnt(5)
  v_mfma_f32_16x16x32_bf16 v[80:83], v[184:187], v[112:115], v[80:83]
  v_mfma_f32_16x16x32_bf16 v[100:103], v[184:187], v[116:119], v[100:103]
  s_waitcnt vmcnt(21) lgkmcnt(4)
  v_mfma_f32_16x16x32_bf16 v[64:67], v[188:191], v[120:123], v[64:67]
  s_waitcnt vmcnt(20)
  v_mfma_f32_16x16x32_bf16 v[84:87], v[188:191], v[124:127], v[84:87]
  s_waitcnt lgkmcnt(0)
  s_waitcnt vmcnt(13)
  s_barrier
  ds_read_b128 v[168:171], v7 offset:0
  v_mfma_f32_16x16x32_bf16 v[68:71], v[32:35], v[120:123], v[68:71]
  ds_read_b128 v[172:175], v7 offset:1024
  v_mfma_f32_16x16x32_bf16 v[88:91], v[32:35], v[124:127], v[88:91]
  ds_read_b128 v[176:179], v7 offset:2048
  v_mfma_f32_16x16x32_bf16 v[72:75], v[36:39], v[120:123], v[72:75]
  ds_read_b128 v[180:183], v7 offset:3072
  s_add_u32 m0, s50, 40960
  s_add_u32 s57, s23, 40960
  buffer_load_dwordx4 v4, s[16:19], s57 offen lds
  v_mfma_f32_16x16x32_bf16 v[92:95], v[36:39], v[124:127], v[92:95]
  ds_read_b128 v[184:187], v7 offset:4096
  buffer_load_dwordx4 v4, s[16:19], s57 offen offset:1024 lds
  v_mfma_f32_16x16x32_bf16 v[76:79], v[40:43], v[120:123], v[76:79]
  s_mov_b32 exec_hi, 0
  buffer_load_dwordx4 v4, s[16:19], s57 offen offset:2048 lds
  s_mov_b32 exec_hi, -1
  s_nop 0
  v_mfma_f32_16x16x32_bf16 v[96:99], v[40:43], v[124:127], v[96:99]
  v_mfma_f32_16x16x32_bf16 v[80:83], v[44:47], v[120:123], v[80:83]
  v_mfma_f32_16x16x32_bf16 v[100:103], v[44:47], v[124:127], v[100:103]
  buffer_load_ubyte v11, v13, s[16:19], s46 offen sc0 sc1
  s_waitcnt lgkmcnt(4)
  v_mfma_f32_16x16x32_bf16 v[64:67], v[168:171], v[16:19], v[64:67]
  ds_read_b128 v[188:191], v7 offset:5120
  v_mfma_f32_16x16x32_bf16 v[84:87], v[168:171], v[20:23], v[84:87]
  ds_read_b128 v[32:35], v7 offset:6144
  s_waitcnt lgkmcnt(5)
  v_mfma_f32_16x16x32_bf16 v[68:71], v[172:175], v[16:19], v[68:71]
  ds_read_b128 v[36:39], v7 offset:7168
  v_mfma_f32_16x16x32_bf16 v[88:91], v[172:175], v[20:23], v[88:91]
  ds_read_b128 v[40:43], v7 offset:8192
  s_waitcnt lgkmcnt(6)
  v_mfma_f32_16x16x32_bf16 v[72:75], v[176:179], v[16:19], v[72:75]
  ds_read_b128 v[44:47], v7 offset:9216
  v_mfma_f32_16x16x32_bf16 v[92:95], v[176:179], v[20:23], v[92:95]
  s_waitcnt lgkmcnt(6)
  v_mfma_f32_16x16x32_bf16 v[76:79], v[180:183], v[16:19], v[76:79]
  v_mfma_f32_16x16x32_bf16 v[96:99], v[180:183], v[20:23], v[96:99]
  s_waitcnt lgkmcnt(5)
  v_mfma_f32_16x16x32_bf16 v[80:83], v[184:187], v[16:19], v[80:83]
  v_mfma_f32_16x16x32_bf16 v[100:103], v[184:187], v[20:23], v[100:103]
  s_waitcnt lgkmcnt(4)
  v_mfma_f32_16x16x32_bf16 v[64:67], v[188:191], v[24:27], v[64:67]
  v_mfma_f32_16x16x32_bf16 v[84:87], v[188:191], v[28:31], v[84:87]
  s_waitcnt lgkmcnt(0)
  s_waitcnt vmcnt(12)
  s_barrier
  ds_read_b128 v[168:171], v6 offset:0
  v_mfma_f32_16x16x32_bf16 v[68:71], v[32:35], v[24:27], v[68:71]
  ds_read_b128 v[172:175], v6 offset:1024
  v_mfma_f32_16x16x32_bf16 v[88:91], v[32:35], v[28:31], v[88:91]
  ds_read_b128 v[176:179], v6 offset:2048
  v_mfma_f32_16x16x32_bf16 v[72:75], v[36:39], v[24:27], v[72:75]
  ds_read_b128 v[180:183], v6 offset:3072
  s_mov_b32 m0, s51
  s_add_u32 s57, s23, 61440
  buffer_load_dwordx4 v4, s[16:19], s57 offen lds
  v_mfma_f32_16x16x32_bf16 v[92:95], v[36:39], v[28:31], v[92:95]
  ds_read_b128 v[184:187], v6 offset:4096
  buffer_load_dwordx4 v4, s[16:19], s57 offen offset:1024 lds
  v_mfma_f32_16x16x32_bf16 v[76:79], v[40:43], v[24:27], v[76:79]
  s_mov_b32 exec_hi, 0
  buffer_load_dwordx4 v4, s[16:19], s57 offen offset:2048 lds
  s_mov_b32 exec_hi, -1
  s_nop 0
  v_mfma_f32_16x16x32_bf16 v[96:99], v[40:43], v[28:31], v[96:99]
  v_mfma_f32_16x16x32_bf16 v[80:83], v[44:47], v[24:27], v[80:83]
  v_mfma_f32_16x16x32_bf16 v[100:103], v[44:47], v[28:31], v[100:103]
  s_waitcnt vmcnt(3)
.Lpl133c:
  v_and_b32 v14, v11, v12
  v_cmp_ne_u32 vcc, v14, v12
  s_nop 0
  s_cbranch_vccnz .Lpl133s
.Lpl133k:
  s_add_u32 s56, s21, 0
  buffer_load_dwordx4 v[208:211], v1, s[16:19], s56 offen offset:0
  buffer_load_dwordx4 v[212:215], v3, s[16:19], s56 offen offset:0
  s_add_u32 s56, s21, 0
  buffer_load_dwordx4 v[216:219], v1, s[16:19], s56 offen offset:2048
  buffer_load_dwordx4 v[220:223], v3, s[16:19], s56 offen offset:2048
  s_add_u32 s56, s21, 8192
  buffer_load_dwordx4 v[48:51], v1, s[16:19], s56 offen offset:0
  buffer_load_dwordx4 v[52:55], v3, s[16:19], s56 offen offset:0
  s_add_u32 s56, s21, 8192
  buffer_load_dwordx4 v[56:59], v1, s[16:19], s56 offen offset:2048
  buffer_load_dwordx4 v[60:63], v3, s[16:19], s56 offen offset:2048
  s_add_u32 s56, s21, 16384
  buffer_load_dwordx4 v[112:115], v1, s[16:19], s56 offen offset:0
  buffer_load_dwordx4 v[116:119], v3, s[16:19], s56 offen offset:0
  s_add_u32 s56, s21, 16384
  buffer_load_dwordx4 v[120:123], v1, s[16:19], s56 offen offset:2048
  buffer_load_dwordx4 v[124:127], v3, s[16:19], s56 offen offset:2048
  s_add_u32 s56, s21, 24576
  buffer_load_dwordx4 v[16:19], v1, s[16:19], s56 offen offset:0
  buffer_load_dwordx4 v[20:23], v3, s[16:19], s56 offen offset:0
  s_add_u32 s56, s21, 24576
  buffer_load_dwordx4 v[24:27], v1, s[16:19], s56 offen offset:2048
  buffer_load_dwordx4 v[28:31], v3, s[16:19], s56 offen offset:2048
  s_waitcnt lgkmcnt(4)
  v_mfma_f32_16x16x32_bf16 v[64:67], v[168:171], v[192:195], v[64:67]
  ds_read_b128 v[188:191], v6 offset:5120
  v_mfma_f32_16x16x32_bf16 v[84:87], v[168:171], v[196:199], v[84:87]
  ds_read_b128 v[32:35], v6 offset:6144
  s_waitcnt lgkmcnt(5)
  v_mfma_f32_16x16x32_bf16 v[68:71], v[172:175], v[192:195], v[68:71]
  ds_read_b128 v[36:39], v6 offset:7168
  v_mfma_f32_16x16x32_bf16 v[88:91], v[172:175], v[196:199], v[88:91]
  ds_read_b128 v[40:43], v6 offset:8192
  s_waitcnt lgkmcnt(6)
  v_mfma_f32_16x16x32_bf16 v[72:75], v[176:179], v[192:195], v[72:75]
  ds_read_b128 v[44:47], v6 offset:9216
  v_mfma_f32_16x16x32_bf16 v[92:95], v[176:179], v[196:199], v[92:95]
  s_waitcnt lgkmcnt(6)
  v_mfma_f32_16x16x32_bf16 v[76:79], v[180:183], v[192:195], v[76:79]
  v_mfma_f32_16x16x32_bf16 v[96:99], v[180:183], v[196:199], v[96:99]
  s_waitcnt lgkmcnt(5)
  v_mfma_f32_16x16x32_bf16 v[80:83], v[184:187], v[192:195], v[80:83]
  v_mfma_f32_16x16x32_bf16 v[100:103], v[184:187], v[196:199], v[100:103]
  s_add_u32 s56, s21, 32768
  buffer_load_dwordx4 v[192:195], v1, s[16:19], s56 offen offset:0
  buffer_load_dwordx4 v[196:199], v3, s[16:19], s56 offen offset:0
  s_waitcnt lgkmcnt(4)
  v_mfma_f32_16x16x32_bf16 v[64:67], v[188:191], v[200:203], v[64:67]
  v_mfma_f32_16x16x32_bf16 v[84:87], v[188:191], v[204:207], v[84:87]
  s_waitcnt lgkmcnt(0)
  s_barrier
  ds_read_b128 v[168:171], v5 offset:0
  v_mfma_f32_16x16x32_bf16 v[68:71], v[32:35], v[200:203], v[68:71]
  ds_read_b128 v[172:175], v5 offset:1024
  v_mfma_f32_16x16x32_bf16 v[88:91], v[32:35], v[204:207], v[88:91]
  ds_read_b128 v[176:179], v5 offset:2048
  v_mfma_f32_16x16x32_bf16 v[72:75], v[36:39], v[200:203], v[72:75]
  ds_read_b128 v[180:183], v5 offset:3072
  s_add_u32 m0, s41, 131072
  s_add_u32 s57, s23, 81920
  buffer_load_dwordx4 v4, s[16:19], s57 offen lds
  v_mfma_f32_16x16x32_bf16 v[92:95], v[36:39], v[204:207], v[92:95]
  ds_read_b128 v[184:187], v5 offset:4096
  buffer_load_dwordx4 v4, s[16:19], s57 offen offset:1024 lds
  v_mfma_f32_16x16x32_bf16 v[76:79], v[40:43], v[200:203], v[76:79]
  s_mov_b32 exec_hi, 0
  buffer_load_dwordx4 v4, s[16:19], s57 offen offset:2048 lds
  s_mov_b32 exec_hi, -1
  s_nop 0
  v_mfma_f32_16x16x32_bf16 v[96:99], v[40:43], v[204:207], v[96:99]
  v_mfma_f32_16x16x32_bf16 v[80:83], v[44:47], v[200:203], v[80:83]
  v_mfma_f32_16x16x32_bf16 v[100:103], v[44:47], v[204:207], v[100:103]
  s_add_u32 s56, s21, 32768
  buffer_load_dwordx4 v[200:203], v1, s[16:19], s56 offen offset:2048
  buffer_load_dwordx4 v[204:207], v3, s[16:19], s56 offen offset:2048
  s_waitcnt vmcnt(22) lgkmcnt(4)
  v_mfma_f32_16x16x32_bf16 v[224:227], v[168:171], v[208:211], 0
  ds_read_b128 v[188:191], v5 offset:5120
  s_waitcnt vmcnt(21)
  v_mfma_f32_16x16x32_bf16 v[244:247], v[168:171], v[212:215], 0
  ds_read_b128 v[32:35], v5 offset:6144
  s_waitcnt lgkmcnt(5)
  v_mfma_f32_16x16x32_bf16 v[228:231], v[172:175], v[208:211], 0
  ds_read_b128 v[36:39], v5 offset:7168
  v_mfma_f32_16x16x32_bf16 v[248:251], v[172:175], v[212:215], 0
  ds_read_b128 v[40:43], v5 offset:8192
  s_waitcnt lgkmcnt(6)
  v_mfma_f32_16x16x32_bf16 v[232:235], v[176:179], v[208:211], 0
  ds_read_b128 v[44:47], v5 offset:9216
  v_mfma_f32_16x16x32_bf16 v[252:255], v[176:179], v[212:215], 0
  s_waitcnt lgkmcnt(6)
  v_mfma_f32_16x16x32_bf16 v[236:239], v[180:183], v[208:211], 0
  v_mfma_f32_16x16x32_bf16 v[104:107], v[180:183], v[212:215], 0
  s_waitcnt lgkmcnt(5)
  v_mfma_f32_16x16x32_bf16 v[240:243], v[184:187], v[208:211], 0
  v_mfma_f32_16x16x32_bf16 v[108:111], v[184:187], v[212:215], 0
  s_add_u32 s56, s21, 40960
  buffer_load_dwordx4 v[208:211], v1, s[16:19], s56 offen offset:0
  buffer_load_dwordx4 v[212:215], v3, s[16:19], s56 offen offset:0
  s_waitcnt vmcnt(22) lgkmcnt(4)
  v_mfma_f32_16x16x32_bf16 v[224:227], v[188:191], v[216:219], v[224:227]
  s_waitcnt vmcnt(21)
  v_mfma_f32_16x16x32_bf16 v[244:247], v[188:191], v[220:223], v[244:247]
  s_waitcnt lgkmcnt(0)
  s_barrier
  ds_read_b128 v[168:171], v5 offset:20480
  v_mfma_f32_16x16x32_bf16 v[228:231], v[32:35], v[216:219], v[228:231]
  ds_read_b128 v[172:175], v5 offset:21504
  v_mfma_f32_16x16x32_bf16 v[248:251], v[32:35], v[220:223], v[248:251]
  ds_read_b128 v[176:179], v5 offset:22528
  v_mfma_f32_16x16x32_bf16 v[232:235], v[36:39], v[216:219], v[232:235]
  ds_read_b128 v[180:183], v5 offset:23552
  s_add_u32 m0, s50, 0
  s_add_u32 s57, s23, 102400
  buffer_load_dwordx4 v4, s[16:19], s57 offen lds
  v_mfma_f32_16x16x32_bf16 v[252:255], v[36:39], v[220:223], v[252:255]
  ds_read_b128 v[184:187], v5 offset:24576
  buffer_load_dwordx4 v4, s[16:19], s57 offen offset:1024 lds
  v_mfma_f32_16x16x32_bf16 v[236:239], v[40:43], v[216:219], v[236:239]
  s_mov_b32 exec_hi, 0
  buffer_load_dwordx4 v4, s[16:19], s57 offen offset:2048 lds
  s_mov_b32 exec_hi, -1
  s_nop 0
  v_mfma_f32_16x16x32_bf16 v[104:107], v[40:43], v[220:223], v[104:107]
  v_mfma_f32_16x16x32_bf16 v[240:243], v[44:47], v[216:219], v[240:243]
  v_mfma_f32_16x16x32_bf16 v[108:111], v[44:47], v[220:223], v[108:111]
  s_add_u32 s56, s21, 40960
  buffer_load_dwordx4 v[216:219], v1, s[16:19], s56 offen offset:2048
  buffer_load_dwordx4 v[220:223], v3, s[16:19], s56 offen offset:2048
  s_waitcnt vmcnt(25) lgkmcnt(4)
  v_mfma_f32_16x16x32_bf16 v[224:227], v[168:171], v[48:51], v[224:227]
  ds_read_b128 v[188:191], v5 offset:25600
  s_waitcnt vmcnt(24)
  v_mfma_f32_16x16x32_bf16 v[244:247], v[168:171], v[52:55], v[244:247]
  ds_read_b128 v[32:35], v5 offset:26624
  s_waitcnt lgkmcnt(5)
  v_mfma_f32_16x16x32_bf16 v[228:231], v[172:175], v[48:51], v[228:231]
  ds_read_b128 v[36:39], v5 offset:27648
  v_mfma_f32_16x16x32_bf16 v[248:251], v[172:175], v[52:55], v[248:251]
  ds_read_b128 v[40:43], v5 offset:28672
  s_waitcnt lgkmcnt(6)
  v_mfma_f32_16x16x32_bf16 v[232:235], v[176:179], v[48:51], v[232:235]
  ds_read_b128 v[44:47], v5 offset:29696
  v_mfma_f32_16x16x32_bf16 v[252:255], v[176:179], v[52:55], v[252:255]
  s_waitcnt lgkmcnt(6)
  v_mfma_f32_16x16x32_bf16 v[236:239], v[180:183], v[48:51], v[236:239]
  v_mfma_f32_16x16x32_bf16 v[104:107], v[180:183], v[52:55], v[104:107]
  s_waitcnt lgkmcnt(5)
  v_mfma_f32_16x16x32_bf16 v[240:243], v[184:187], v[48:51], v[240:243]
  v_mfma_f32_16x16x32_bf16 v[108:111], v[184:187], v[52:55], v[108:111]
  s_add_u32 s56, s21, 49152
  buffer_load_dwordx4 v[48:51], v1, s[16:19], s56 offen offset:0
  buffer_load_dwordx4 v[52:55], v3, s[16:19], s56 offen offset:0
  s_waitcnt vmcnt(25) lgkmcnt(4)
  v_mfma_f32_16x16x32_bf16 v[224:227], v[188:191], v[56:59], v[224:227]
  s_waitcnt vmcnt(24)
  v_mfma_f32_16x16x32_bf16 v[244:247], v[188:191], v[60:63], v[244:247]
  s_waitcnt lgkmcnt(0)
  s_barrier
  ds_read_b128 v[168:171], v5 offset:40960
  v_mfma_f32_16x16x32_bf16 v[228:231], v[32:35], v[56:59], v[228:231]
  ds_read_b128 v[172:175], v5 offset:41984
  v_mfma_f32_16x16x32_bf16 v[248:251], v[32:35], v[60:63], v[248:251]
  ds_read_b128 v[176:179], v5 offset:43008
  v_mfma_f32_16x16x32_bf16 v[232:235], v[36:39], v[56:59], v[232:235]
  ds_read_b128 v[180:183], v5 offset:44032
  s_add_u32 m0, s50, 20480
  s_add_u32 s57, s23, 122880
  buffer_load_dwordx4 v4, s[16:19], s57 offen lds
  v_mfma_f32_16x16x32_bf16 v[252:255], v[36:39], v[60:63], v[252:255]
  ds_read_b128 v[184:187], v5 offset:45056
  buffer_load_dwordx4 v4, s[16:19], s57 offen offset:1024 lds
  v_mfma_f32_16x16x32_bf16 v[236:239], v[40:43], v[56:59], v[236:239]
  s_mov_b32 exec_hi, 0
  buffer_load_dwordx4 v4, s[16:19], s57 offen offset:2048 lds
  s_mov_b32 exec_hi, -1
  s_nop 0
  v_mfma_f32_16x16x32_bf16 v[104:107], v[40:43], v[60:63], v[104:107]
  v_mfma_f32_16x16x32_bf16 v[240:243], v[44:47], v[56:59], v[240:243]
  v_mfma_f32_16x16x32_bf16 v[108:111], v[44:47], v[60:63], v[108:111]
  s_add_u32 s56, s21, 49152
  buffer_load_dwordx4 v[56:59], v1, s[16:19], s56 offen offset:2048
  buffer_load_dwordx4 v[60:63], v3, s[16:19], s56 offen offset:2048
  s_waitcnt vmcnt(28) lgkmcnt(4)
  v_mfma_f32_16x16x32_bf16 v[224:227], v[168:171], v[112:115], v[224:227]
  ds_read_b128 v[188:191], v5 offset:46080
  s_waitcnt vmcnt(27)
  v_mfma_f32_16x16x32_bf16 v[244:247], v[168:171], v[116:119], v[244:247]
  ds_read_b128 v[32:35], v5 offset:47104
  s_waitcnt lgkmcnt(5)
  v_mfma_f32_16x16x32_bf16 v[228:231], v[172:175], v[112:115], v[228:231]
  ds_read_b128 v[36:39], v5 offset:48128
  v_mfma_f32_16x16x32_bf16 v[248:251], v[172:175], v[116:119], v[248:251]
  ds_read_b128 v[40:43], v5 offset:49152
  s_waitcnt lgkmcnt(6)
  v_mfma_f32_16x16x32_bf16 v[232:235], v[176:179], v[112:115], v[232:235]
  ds_read_b128 v[44:47], v5 offset:50176
  v_mfma_f32_16x16x32_bf16 v[252:255], v[176:179], v[116:119], v[252:255]
  s_waitcnt lgkmcnt(6)
  v_mfma_f32_16x16x32_bf16 v[236:239], v[180:183], v[112:115], v[236:239]
  v_mfma_f32_16x16x32_bf16 v[104:107], v[180:183], v[116:119], v[104:107]
  s_waitcnt lgkmcnt(5)
  v_mfma_f32_16x16x32_bf16 v[240:243], v[184:187], v[112:115], v[240:243]
  v_mfma_f32_16x16x32_bf16 v[108:111], v[184:187], v[116:119], v[108:111]
  s_add_u32 s56, s21, 57344
  buffer_load_dwordx4 v[112:115], v1, s[16:19], s56 offen offset:0
  buffer_load_dwordx4 v[116:119], v3, s[16:19], s56 offen offset:0
  s_waitcnt vmcnt(28) lgkmcnt(4)
  v_mfma_f32_16x16x32_bf16 v[224:227], v[188:191], v[120:123], v[224:227]
  s_waitcnt vmcnt(27)
  v_mfma_f32_16x16x32_bf16 v[244:247], v[188:191], v[124:127], v[244:247]
  s_waitcnt lgkmcnt(0)
  s_barrier
  ds_read_b128 v[168:171], v7 offset:0
  v_mfma_f32_16x16x32_bf16 v[228:231], v[32:35], v[120:123], v[228:231]
  ds_read_b128 v[172:175], v7 offset:1024
  v_mfma_f32_16x16x32_bf16 v[248:251], v[32:35], v[124:127], v[248:251]
  ds_read_b128 v[176:179], v7 offset:2048
  v_mfma_f32_16x16x32_bf16 v[232:235], v[36:39], v[120:123], v[232:235]
  ds_read_b128 v[180:183], v7 offset:3072
  s_add_u32 m0, s50, 40960
  s_add_u32 s57, s23, 143360
  buffer_load_dwordx4 v4, s[16:19], s57 offen lds
  v_mfma_f32_16x16x32_bf16 v[252:255], v[36:39], v[124:127], v[252:255]
  ds_read_b128 v[184:187], v7 offset:4096
  buffer_load_dwordx4 v4, s[16:19], s57 offen offset:1024 lds
  v_mfma_f32_16x16x32_bf16 v[236:239], v[40:43], v[120:123], v[236:239]
  s_mov_b32 exec_hi, 0
  buffer_load_dwordx4 v4, s[16:19], s57 offen offset:2048 lds
  s_mov_b32 exec_hi, -1
  s_nop 0
  v_mfma_f32_16x16x32_bf16 v[104:107], v[40:43], v[124:127], v[104:107]
  v_mfma_f32_16x16x32_bf16 v[240:243], v[44:47], v[120:123], v[240:243]
  v_mfma_f32_16x16x32_bf16 v[108:111], v[44:47], v[124:127], v[108:111]
  s_add_u32 s56, s21, 57344
  buffer_load_dwordx4 v[120:123], v1, s[16:19], s56 offen offset:2048
  buffer_load_dwordx4 v[124:127], v3, s[16:19], s56 offen offset:2048
  s_waitcnt vmcnt(31) lgkmcnt(4)
  v_mfma_f32_16x16x32_bf16 v[224:227], v[168:171], v[16:19], v[224:227]
  ds_read_b128 v[188:191], v7 offset:5120
  s_waitcnt vmcnt(30)
  v_mfma_f32_16x16x32_bf16 v[244:247], v[168:171], v[20:23], v[244:247]
  ds_read_b128 v[32:35], v7 offset:6144
  s_waitcnt lgkmcnt(5)
  v_mfma_f32_16x16x32_bf16 v[228:231], v[172:175], v[16:19], v[228:231]
  ds_read_b128 v[36:39], v7 offset:7168
  v_mfma_f32_16x16x32_bf16 v[248:251], v[172:175], v[20:23], v[248:251]
  ds_read_b128 v[40:43], v7 offset:8192
  s_waitcnt lgkmcnt(6)
  v_mfma_f32_16x16x32_bf16 v[232:235], v[176:179], v[16:19], v[232:235]
  ds_read_b128 v[44:47], v7 offset:9216
  v_mfma_f32_16x16x32_bf16 v[252:255], v[176:179], v[20:23], v[252:255]
  s_waitcnt lgkmcnt(6)
  v_mfma_f32_16x16x32_bf16 v[236:239], v[180:183], v[16:19], v[236:239]
  v_mfma_f32_16x16x32_bf16 v[104:107], v[180:183], v[20:23], v[104:107]
  s_waitcnt lgkmcnt(5)
  v_mfma_f32_16x16x32_bf16 v[240:243], v[184:187], v[16:19], v[240:243]
  v_mfma_f32_16x16x32_bf16 v[108:111], v[184:187], v[20:23], v[108:111]
  s_add_u32 s56, s21, 65536
  buffer_load_dwordx4 v[16:19], v1, s[16:19], s56 offen offset:0
  buffer_load_dwordx4 v[20:23], v3, s[16:19], s56 offen offset:0
  s_waitcnt vmcnt(31) lgkmcnt(4)
  v_mfma_f32_16x16x32_bf16 v[224:227], v[188:191], v[24:27], v[224:227]
  s_waitcnt vmcnt(30)
  v_mfma_f32_16x16x32_bf16 v[244:247], v[188:191], v[28:31], v[244:247]
  s_waitcnt lgkmcnt(0)
  s_waitcnt vmcnt(25)
  s_barrier
  ds_read_b128 v[168:171], v6 offset:0
  v_mfma_f32_16x16x32_bf16 v[228:231], v[32:35], v[24:27], v[228:231]
  ds_read_b128 v[172:175], v6 offset:1024
  v_mfma_f32_16x16x32_bf16 v[248:251], v[32:35], v[28:31], v[248:251]
  ds_read_b128 v[176:179], v6 offset:2048
  v_mfma_f32_16x16x32_bf16 v[232:235], v[36:39], v[24:27], v[232:235]
  ds_read_b128 v[180:183], v6 offset:3072
  s_mov_b32 m0, s51
  s_add_u32 s57, s23, 163840
  buffer_load_dwordx4 v4, s[16:19], s57 offen lds
  v_mfma_f32_16x16x32_bf16 v[252:255], v[36:39], v[28:31], v[252:255]
  ds_read_b128 v[184:187], v6 offset:4096
  buffer_load_dwordx4 v4, s[16:19], s57 offen offset:1024 lds
  v_mfma_f32_16x16x32_bf16 v[236:239], v[40:43], v[24:27], v[236:239]
  s_mov_b32 exec_hi, 0
  buffer_load_dwordx4 v4, s[16:19], s57 offen offset:2048 lds
  s_mov_b32 exec_hi, -1
  s_nop 0
  v_mfma_f32_16x16x32_bf16 v[104:107], v[40:43], v[28:31], v[104:107]
  v_mfma_f32_16x16x32_bf16 v[240:243], v[44:47], v[24:27], v[240:243]
  v_mfma_f32_16x16x32_bf16 v[108:111], v[44:47], v[28:31], v[108:111]
  s_add_u32 s56, s21, 65536
  buffer_load_dwordx4 v[24:27], v1, s[16:19], s56 offen offset:2048
  buffer_load_dwordx4 v[28:31], v3, s[16:19], s56 offen offset:2048
  s_waitcnt lgkmcnt(4)
  v_mfma_f32_16x16x32_bf16 v[224:227], v[168:171], v[192:195], v[224:227]
  ds_read_b128 v[188:191], v6 offset:5120
  v_mfma_f32_16x16x32_bf16 v[244:247], v[168:171], v[196:199], v[244:247]
  ds_read_b128 v[32:35], v6 offset:6144
  s_waitcnt lgkmcnt(5)
  v_mfma_f32_16x16x32_bf16 v[228:231], v[172:175], v[192:195], v[228:231]
  ds_read_b128 v[36:39], v6 offset:7168
  v_mfma_f32_16x16x32_bf16 v[248:251], v[172:175], v[196:199], v[248:251]
  ds_read_b128 v[40:43], v6 offset:8192
  s_waitcnt lgkmcnt(6)
  v_mfma_f32_16x16x32_bf16 v[232:235], v[176:179], v[192:195], v[232:235]
  ds_read_b128 v[44:47], v6 offset:9216
  v_mfma_f32_16x16x32_bf16 v[252:255], v[176:179], v[196:199], v[252:255]
  s_waitcnt lgkmcnt(6)
  v_mfma_f32_16x16x32_bf16 v[236:239], v[180:183], v[192:195], v[236:239]
  v_mfma_f32_16x16x32_bf16 v[104:107], v[180:183], v[196:199], v[104:107]
  s_waitcnt lgkmcnt(5)
  v_mfma_f32_16x16x32_bf16 v[240:243], v[184:187], v[192:195], v[240:243]
  v_mfma_f32_16x16x32_bf16 v[108:111], v[184:187], v[196:199], v[108:111]
  s_add_u32 s56, s21, 73728
  buffer_load_dwordx4 v[192:195], v1, s[16:19], s56 offen offset:0
  buffer_load_dwordx4 v[196:199], v3, s[16:19], s56 offen offset:0
  s_waitcnt vmcnt(31) lgkmcnt(4)
  v_mfma_f32_16x16x32_bf16 v[224:227], v[188:191], v[200:203], v[224:227]
  s_waitcnt vmcnt(30)
  v_mfma_f32_16x16x32_bf16 v[244:247], v[188:191], v[204:207], v[244:247]
  s_waitcnt lgkmcnt(0)
  s_waitcnt vmcnt(25)
  s_barrier
  ds_read_b128 v[168:171], v5 offset:0
  v_mfma_f32_16x16x32_bf16 v[228:231], v[32:35], v[200:203], v[228:231]
  ds_read_b128 v[172:175], v5 offset:1024
  v_mfma_f32_16x16x32_bf16 v[248:251], v[32:35], v[204:207], v[248:251]
  ds_read_b128 v[176:179], v5 offset:2048
  v_mfma_f32_16x16x32_bf16 v[232:235], v[36:39], v[200:203], v[232:235]
  ds_read_b128 v[180:183], v5 offset:3072
  s_add_u32 m0, s41, 131072
  s_add_u32 s57, s23, 184320
  buffer_load_dwordx4 v4, s[16:19], s57 offen lds
  v_mfma_f32_16x16x32_bf16 v[252:255], v[36:39], v[204:207], v[252:255]
  ds_read_b128 v[184:187], v5 offset:4096
  buffer_load_dwordx4 v4, s[16:19], s57 offen offset:1024 lds
  v_mfma_f32_16x16x32_bf16 v[236:239], v[40:43], v[200:203], v[236:239]
  s_mov_b32 exec_hi, 0
  buffer_load_dwordx4 v4, s[16:19], s57 offen offset:2048 lds
  s_mov_b32 exec_hi, -1
  s_nop 0
  v_mfma_f32_16x16x32_bf16 v[104:107], v[40:43], v[204:207], v[104:107]
  v_mfma_f32_16x16x32_bf16 v[240:243], v[44:47], v[200:203], v[240:243]
  v_mfma_f32_16x16x32_bf16 v[108:111], v[44:47], v[204:207], v[108:111]
  s_add_u32 s56, s21, 73728
  buffer_load_dwordx4 v[200:203], v1, s[16:19], s56 offen offset:2048
  buffer_load_dwordx4 v[204:207], v3, s[16:19], s56 offen offset:2048
  s_waitcnt lgkmcnt(4)
  v_mfma_f32_16x16x32_bf16 v[224:227], v[168:171], v[208:211], v[224:227]
  ds_read_b128 v[188:191], v5 offset:5120
  v_mfma_f32_16x16x32_bf16 v[244:247], v[168:171], v[212:215], v[244:247]
  ds_read_b128 v[32:35], v5 offset:6144
  s_waitcnt lgkmcnt(5)
  v_mfma_f32_16x16x32_bf16 v[228:231], v[172:175], v[208:211], v[228:231]
  ds_read_b128 v[36:39], v5 offset:7168
  v_mfma_f32_16x16x32_bf16 v[248:251], v[172:175], v[212:215], v[248:251]
  ds_read_b128 v[40:43], v5 offset:8192
  s_waitcnt lgkmcnt(6)
  v_mfma_f32_16x16x32_bf16 v[232:235], v[176:179], v[208:211], v[232:235]
  ds_read_b128 v[44:47], v5 offset:9216
  v_mfma_f32_16x16x32_bf16 v[252:255], v[176:179], v[212:215], v[252:255]
  s_waitcnt lgkmcnt(6)
  v_mfma_f32_16x16x32_bf16 v[236:239], v[180:183], v[208:211], v[236:239]
  v_mfma_f32_16x16x32_bf16 v[104:107], v[180:183], v[212:215], v[104:107]
  s_waitcnt lgkmcnt(5)
  v_mfma_f32_16x16x32_bf16 v[240:243], v[184:187], v[208:211], v[240:243]
  v_mfma_f32_16x16x32_bf16 v[108:111], v[184:187], v[212:215], v[108:111]
  s_add_u32 s56, s20, 49152
  buffer_load_dwordx4 v[208:211], v1, s[16:19], s56 offen offset:0
  buffer_load_dwordx4 v[212:215], v3, s[16:19], s56 offen offset:0
  s_waitcnt vmcnt(31) lgkmcnt(4)
  v_mfma_f32_16x16x32_bf16 v[224:227], v[188:191], v[216:219], v[224:227]
  s_waitcnt vmcnt(30)
  v_mfma_f32_16x16x32_bf16 v[244:247], v[188:191], v[220:223], v[244:247]
  s_waitcnt lgkmcnt(0)
  s_waitcnt vmcnt(25)
  s_barrier
  ds_read_b128 v[168:171], v5 offset:20480
  v_mfma_f32_16x16x32_bf16 v[228:231], v[32:35], v[216:219], v[228:231]
  ds_read_b128 v[172:175], v5 offset:21504
  v_mfma_f32_16x16x32_bf16 v[248:251], v[32:35], v[220:223], v[248:251]
  ds_read_b128 v[176:179], v5 offset:22528
  v_mfma_f32_16x16x32_bf16 v[232:235], v[36:39], v[216:219], v[232:235]
  ds_read_b128 v[180:183], v5 offset:23552
  s_add_u32 m0, s50, 0
  s_add_u32 s57, s22, 122880
  buffer_load_dwordx4 v4, s[16:19], s57 offen lds
  v_mfma_f32_16x16x32_bf16 v[252:255], v[36:39], v[220:223], v[252:255]
  ds_read_b128 v[184:187], v5 offset:24576
  buffer_load_dwordx4 v4, s[16:19], s57 offen offset:1024 lds
  v_mfma_f32_16x16x32_bf16 v[236:239], v[40:43], v[216:219], v[236:239]
  s_mov_b32 exec_hi, 0
  buffer_load_dwordx4 v4, s[16:19], s57 offen offset:2048 lds
  s_mov_b32 exec_hi, -1
  s_nop 0
  v_mfma_f32_16x16x32_bf16 v[104:107], v[40:43], v[220:223], v[104:107]
  v_mfma_f32_16x16x32_bf16 v[240:243], v[44:47], v[216:219], v[240:243]
  v_mfma_f32_16x16x32_bf16 v[108:111], v[44:47], v[220:223], v[108:111]
  s_add_u32 s56, s20, 49152
  buffer_load_dwordx4 v[216:219], v1, s[16:19], s56 offen offset:2048
  buffer_load_dwordx4 v[220:223], v3, s[16:19], s56 offen offset:2048
  s_waitcnt lgkmcnt(4)
  v_mfma_f32_16x16x32_bf16 v[224:227], v[168:171], v[48:51], v[224:227]
  ds_read_b128 v[188:191], v5 offset:25600
  v_mfma_f32_16x16x32_bf16 v[244:247], v[168:171], v[52:55], v[244:247]
  ds_read_b128 v[32:35], v5 offset:26624
  s_waitcnt lgkmcnt(5)
  v_mfma_f32_16x16x32_bf16 v[228:231], v[172:175], v[48:51], v[228:231]
  ds_read_b128 v[36:39], v5 offset:27648
  v_mfma_f32_16x16x32_bf16 v[248:251], v[172:175], v[52:55], v[248:251]
  ds_read_b128 v[40:43], v5 offset:28672
  s_waitcnt lgkmcnt(6)
  v_mfma_f32_16x16x32_bf16 v[232:235], v[176:179], v[48:51], v[232:235]
  ds_read_b128 v[44:47], v5 offset:29696
  v_mfma_f32_16x16x32_bf16 v[252:255], v[176:179], v[52:55], v[252:255]
  s_waitcnt lgkmcnt(6)
  v_mfma_f32_16x16x32_bf16 v[236:239], v[180:183], v[48:51], v[236:239]
  v_mfma_f32_16x16x32_bf16 v[104:107], v[180:183], v[52:55], v[104:107]
  s_waitcnt lgkmcnt(5)
  v_mfma_f32_16x16x32_bf16 v[240:243], v[184:187], v[48:51], v[240:243]
  v_mfma_f32_16x16x32_bf16 v[108:111], v[184:187], v[52:55], v[108:111]
  s_add_u32 s56, s20, 57344
  buffer_load_dwordx4 v[48:51], v1, s[16:19], s56 offen offset:0
  buffer_load_dwordx4 v[52:55], v3, s[16:19], s56 offen offset:0
  s_waitcnt vmcnt(31) lgkmcnt(4)
  v_mfma_f32_16x16x32_bf16 v[224:227], v[188:191], v[56:59], v[224:227]
  s_waitcnt vmcnt(30)
  v_mfma_f32_16x16x32_bf16 v[244:247], v[188:191], v[60:63], v[244:247]
  s_waitcnt lgkmcnt(0)
  s_waitcnt vmcnt(25)
  s_barrier
  ds_read_b128 v[168:171], v5 offset:40960
  v_mfma_f32_16x16x32_bf16 v[228:231], v[32:35], v[56:59], v[228:231]
  ds_read_b128 v[172:175], v5 offset:41984
  v_mfma_f32_16x16x32_bf16 v[248:251], v[32:35], v[60:63], v[248:251]
  ds_read_b128 v[176:179], v5 offset:43008
  v_mfma_f32_16x16x32_bf16 v[232:235], v[36:39], v[56:59], v[232:235]
  ds_read_b128 v[180:183], v5 offset:44032
  s_add_u32 m0, s50, 20480
  s_add_u32 s57, s22, 143360
  buffer_load_dwordx4 v4, s[16:19], s57 offen lds
  v_mfma_f32_16x16x32_bf16 v[252:255], v[36:39], v[60:63], v[252:255]
  ds_read_b128 v[184:187], v5 offset:45056
  buffer_load_dwordx4 v4, s[16:19], s57 offen offset:1024 lds
  v_mfma_f32_16x16x32_bf16 v[236:239], v[40:43], v[56:59], v[236:239]
  s_mov_b32 exec_hi, 0
  buffer_load_dwordx4 v4, s[16:19], s57 offen offset:2048 lds
  s_mov_b32 exec_hi, -1
  s_nop 0
  v_mfma_f32_16x16x32_bf16 v[104:107], v[40:43], v[60:63], v[104:107]
  v_mfma_f32_16x16x32_bf16 v[240:243], v[44:47], v[56:59], v[240:243]
  v_mfma_f32_16x16x32_bf16 v[108:111], v[44:47], v[60:63], v[108:111]
  s_add_u32 s56, s20, 57344
  buffer_load_dwordx4 v[56:59], v1, s[16:19], s56 offen offset:2048
  buffer_load_dwordx4 v[60:63], v3, s[16:19], s56 offen offset:2048
  s_waitcnt lgkmcnt(4)
  v_mfma_f32_16x16x32_bf16 v[224:227], v[168:171], v[112:115], v[224:227]
  ds_read_b128 v[188:191], v5 offset:46080
  v_mfma_f32_16x16x32_bf16 v[244:247], v[168:171], v[116:119], v[244:247]
  ds_read_b128 v[32:35], v5 offset:47104
  s_waitcnt lgkmcnt(5)
  v_mfma_f32_16x16x32_bf16 v[228:231], v[172:175], v[112:115], v[228:231]
  ds_read_b128 v[36:39], v5 offset:48128
  v_mfma_f32_16x16x32_bf16 v[248:251], v[172:175], v[116:119], v[248:251]
  ds_read_b128 v[40:43], v5 offset:49152
  s_waitcnt lgkmcnt(6)
  v_mfma_f32_16x16x32_bf16 v[232:235], v[176:179], v[112:115], v[232:235]
  ds_read_b128 v[44:47], v5 offset:50176
  v_mfma_f32_16x16x32_bf16 v[252:255], v[176:179], v[116:119], v[252:255]
  s_waitcnt lgkmcnt(6)
  v_mfma_f32_16x16x32_bf16 v[236:239], v[180:183], v[112:115], v[236:239]
  v_mfma_f32_16x16x32_bf16 v[104:107], v[180:183], v[116:119], v[104:107]
  s_waitcnt lgkmcnt(5)
  v_mfma_f32_16x16x32_bf16 v[240:243], v[184:187], v[112:115], v[240:243]
  v_mfma_f32_16x16x32_bf16 v[108:111], v[184:187], v[116:119], v[108:111]
  s_add_u32 s56, s20, 65536
  buffer_load_dwordx4 v[112:115], v1, s[16:19], s56 offen offset:0
  buffer_load_dwordx4 v[116:119], v3, s[16:19], s56 offen offset:0
  s_waitcnt vmcnt(31) lgkmcnt(4)
  v_mfma_f32_16x16x32_bf16 v[224:227], v[188:191], v[120:123], v[224:227]
  s_waitcnt vmcnt(30)
  v_mfma_f32_16x16x32_bf16 v[244:247], v[188:191], v[124:127], v[244:247]
  s_waitcnt lgkmcnt(0)
  s_waitcnt vmcnt(25)
  s_barrier
  ds_read_b128 v[168:171], v7 offset:0
  v_mfma_f32_16x16x32_bf16 v[228:231], v[32:35], v[120:123], v[228:231]
  ds_read_b128 v[172:175], v7 offset:1024
  v_mfma_f32_16x16x32_bf16 v[248:251], v[32:35], v[124:127], v[248:251]
  ds_read_b128 v[176:179], v7 offset:2048
  v_mfma_f32_16x16x32_bf16 v[232:235], v[36:39], v[120:123], v[232:235]
  ds_read_b128 v[180:183], v7 offset:3072
  s_add_u32 m0, s50, 40960
  s_add_u32 s57, s22, 163840
  buffer_load_dwordx4 v4, s[16:19], s57 offen lds
  v_mfma_f32_16x16x32_bf16 v[252:255], v[36:39], v[124:127], v[252:255]
  ds_read_b128 v[184:187], v7 offset:4096
  buffer_load_dwordx4 v4, s[16:19], s57 offen offset:1024 lds
  v_mfma_f32_16x16x32_bf16 v[236:239], v[40:43], v[120:123], v[236:239]
  s_mov_b32 exec_hi, 0
  buffer_load_dwordx4 v4, s[16:19], s57 offen offset:2048 lds
  s_mov_b32 exec_hi, -1
  s_nop 0
  v_mfma_f32_16x16x32_bf16 v[104:107], v[40:43], v[124:127], v[104:107]
  v_mfma_f32_16x16x32_bf16 v[240:243], v[44:47], v[120:123], v[240:243]
  v_mfma_f32_16x16x32_bf16 v[108:111], v[44:47], v[124:127], v[108:111]
  s_add_u32 s56, s20, 65536
  buffer_load_dwordx4 v[120:123], v1, s[16:19], s56 offen offset:2048
  buffer_load_dwordx4 v[124:127], v3, s[16:19], s56 offen offset:2048
  s_waitcnt lgkmcnt(4)
  v_mfma_f32_16x16x32_bf16 v[224:227], v[168:171], v[16:19], v[224:227]
  ds_read_b128 v[188:191], v7 offset:5120
  v_mfma_f32_16x16x32_bf16 v[244:247], v[168:171], v[20:23], v[244:247]
  ds_read_b128 v[32:35], v7 offset:6144
  s_waitcnt lgkmcnt(5)
  v_mfma_f32_16x16x32_bf16 v[228:231], v[172:175], v[16:19], v[228:231]
  ds_read_b128 v[36:39], v7 offset:7168
  v_mfma_f32_16x16x32_bf16 v[248:251], v[172:175], v[20:23], v[248:251]
  ds_read_b128 v[40:43], v7 offset:8192
  s_waitcnt lgkmcnt(6)
  v_mfma_f32_16x16x32_bf16 v[232:235], v[176:179], v[16:19], v[232:235]
  ds_read_b128 v[44:47], v7 offset:9216
  v_mfma_f32_16x16x32_bf16 v[252:255], v[176:179], v[20:23], v[252:255]
  s_waitcnt lgkmcnt(6)
  v_mfma_f32_16x16x32_bf16 v[236:239], v[180:183], v[16:19], v[236:239]
  v_mfma_f32_16x16x32_bf16 v[104:107], v[180:183], v[20:23], v[104:107]
  s_waitcnt lgkmcnt(5)
  v_mfma_f32_16x16x32_bf16 v[240:243], v[184:187], v[16:19], v[240:243]
  v_mfma_f32_16x16x32_bf16 v[108:111], v[184:187], v[20:23], v[108:111]
  s_add_u32 s56, s20, 73728
  buffer_load_dwordx4 v[16:19], v1, s[16:19], s56 offen offset:0
  buffer_load_dwordx4 v[20:23], v3, s[16:19], s56 offen offset:0
  s_waitcnt vmcnt(31) lgkmcnt(4)
  v_mfma_f32_16x16x32_bf16 v[224:227], v[188:191], v[24:27], v[224:227]
  s_waitcnt vmcnt(30)
  v_mfma_f32_16x16x32_bf16 v[244:247], v[188:191], v[28:31], v[244:247]
  s_waitcnt lgkmcnt(0)
  s_waitcnt vmcnt(25)
  s_barrier
  ds_read_b128 v[168:171], v6 offset:0
  v_mfma_f32_16x16x32_bf16 v[228:231], v[32:35], v[24:27], v[228:231]
  ds_read_b128 v[172:175], v6 offset:1024
  v_mfma_f32_16x16x32_bf16 v[248:251], v[32:35], v[28:31], v[248:251]
  ds_read_b128 v[176:179], v6 offset:2048
  v_mfma_f32_16x16x32_bf16 v[232:235], v[36:39], v[24:27], v[232:235]
  ds_read_b128 v[180:183], v6 offset:3072
  s_mov_b32 m0, s51
  s_add_u32 s57, s22, 184320
  buffer_load_dwordx4 v4, s[16:19], s57 offen lds
  v_mfma_f32_16x16x32_bf16 v[252:255], v[36:39], v[28:31], v[252:255]
  ds_read_b128 v[184:187], v6 offset:4096
  buffer_load_dwordx4 v4, s[16:19], s57 offen offset:1024 lds
  v_mfma_f32_16x16x32_bf16 v[236:239], v[40:43], v[24:27], v[236:239]
  s_mov_b32 exec_hi, 0
  buffer_load_dwordx4 v4, s[16:19], s57 offen offset:2048 lds
  s_mov_b32 exec_hi, -1
  s_nop 0
  v_mfma_f32_16x16x32_bf16 v[104:107], v[40:43], v[28:31], v[104:107]
  v_mfma_f32_16x16x32_bf16 v[240:243], v[44:47], v[24:27], v[240:243]
  v_mfma_f32_16x16x32_bf16 v[108:111], v[44:47], v[28:31], v[108:111]
  s_add_u32 s56, s20, 73728
  buffer_load_dwordx4 v[24:27], v1, s[16:19], s56 offen offset:2048
  buffer_load_dwordx4 v[28:31], v3, s[16:19], s56 offen offset:2048
  s_waitcnt lgkmcnt(4)
  v_mfma_f32_16x16x32_bf16 v[224:227], v[168:171], v[192:195], v[224:227]
  ds_read_b128 v[188:191], v6 offset:5120
  v_mfma_f32_16x16x32_bf16 v[244:247], v[168:171], v[196:199], v[244:247]
  ds_read_b128 v[32:35], v6 offset:6144
  s_waitcnt lgkmcnt(5)
  v_mfma_f32_16x16x32_bf16 v[228:231], v[172:175], v[192:195], v[228:231]
  ds_read_b128 v[36:39], v6 offset:7168
  v_mfma_f32_16x16x32_bf16 v[248:251], v[172:175], v[196:199], v[248:251]
  ds_read_b128 v[40:43], v6 offset:8192
  s_waitcnt lgkmcnt(6)
  v_mfma_f32_16x16x32_bf16 v[232:235], v[176:179], v[192:195], v[232:235]
  ds_read_b128 v[44:47], v6 offset:9216
  v_mfma_f32_16x16x32_bf16 v[252:255], v[176:179], v[196:199], v[252:255]
  s_waitcnt lgkmcnt(6)
  v_mfma_f32_16x16x32_bf16 v[236:239], v[180:183], v[192:195], v[236:239]
  v_mfma_f32_16x16x32_bf16 v[104:107], v[180:183], v[196:199], v[104:107]
  s_waitcnt lgkmcnt(5)
  v_mfma_f32_16x16x32_bf16 v[240:243], v[184:187], v[192:195], v[240:243]
  v_mfma_f32_16x16x32_bf16 v[108:111], v[184:187], v[196:199], v[108:111]
  s_waitcnt vmcnt(28) lgkmcnt(4)
  v_mfma_f32_16x16x32_bf16 v[244:247], v[188:191], v[204:207], v[244:247]
  s_waitcnt lgkmcnt(3)
  v_mfma_f32_16x16x32_bf16 v[248:251], v[32:35], v[204:207], v[248:251]
  s_waitcnt lgkmcnt(0)
  s_waitcnt vmcnt(23)
  s_barrier
  ds_read_b128 v[168:171], v5 offset:0
  v_mfma_f32_16x16x32_bf16 v[252:255], v[36:39], v[204:207], v[252:255]
  ds_read_b128 v[172:175], v5 offset:1024
  v_mfma_f32_16x16x32_bf16 v[104:107], v[40:43], v[204:207], v[104:107]
  ds_read_b128 v[176:179], v5 offset:2048
  v_mfma_f32_16x16x32_bf16 v[108:111], v[44:47], v[204:207], v[108:111]
  ds_read_b128 v[180:183], v5 offset:3072
  v_mfma_f32_16x16x32_bf16 v[224:227], v[188:191], v[200:203], v[224:227]
  ds_read_b128 v[184:187], v5 offset:4096
  v_mfma_f32_16x16x32_bf16 v[228:231], v[32:35], v[200:203], v[228:231]
  v_mfma_f32_16x16x32_bf16 v[232:235], v[36:39], v[200:203], v[232:235]
  v_mfma_f32_16x16x32_bf16 v[236:239], v[40:43], v[200:203], v[236:239]
  v_mfma_f32_16x16x32_bf16 v[240:243], v[44:47], v[200:203], v[240:243]
  ds_write_b128 v8, v[244:247] offset:0
  ds_write_b128 v8, v[248:251] offset:1024
  ds_write_b128 v8, v[252:255] offset:2048
  ds_write_b128 v8, v[104:107] offset:3072
  ds_write_b128 v8, v[108:111] offset:4096
  s_waitcnt lgkmcnt(0)
  s_barrier
  ds_read_b128 v[244:247], v9 offset:0
  ds_read_b128 v[248:251], v9 offset:1024
  ds_read_b128 v[252:255], v9 offset:2048
  ds_read_b128 v[104:107], v9 offset:3072
  ds_read_b128 v[108:111], v9 offset:4096
  s_waitcnt lgkmcnt(4)
  v_add_f32 v224, v224, v244
  v_add_f32 v225, v225, v245
  v_add_f32 v226, v226, v246
  v_add_f32 v227, v227, v247
  v_cvt_pk_bf16_f32 v224, v224, v225
  v_cvt_pk_bf16_f32 v225, v226, v227
  s_waitcnt lgkmcnt(3)
  v_add_f32 v228, v228, v248
  v_add_f32 v229, v229, v249
  v_add_f32 v230, v230, v250
  v_add_f32 v231, v231, v251
  v_cvt_pk_bf16_f32 v226, v228, v229
  v_cvt_pk_bf16_f32 v227, v230, v231
  s_sub_u32 s55, s43, 40960
  buffer_store_dwordx4 v[224:227], v2, s[16:19], s55 offen offset:0 sc0 sc1
  s_waitcnt lgkmcnt(2)
  v_add_f32 v232, v232, v252
  v_add_f32 v233, v233, v253
  v_add_f32 v234, v234, v254
  v_add_f32 v235, v235, v255
  v_cvt_pk_bf16_f32 v228, v232, v233
  v_cvt_pk_bf16_f32 v229, v234, v235
  s_waitcnt lgkmcnt(1)
  v_add_f32 v236, v236, v104
  v_add_f32 v237, v237, v105
  v_add_f32 v238, v238, v106
  v_add_f32 v239, v239, v107
  v_cvt_pk_bf16_f32 v230, v236, v237
  v_cvt_pk_bf16_f32 v231, v238, v239
  buffer_store_dwordx4 v[228:231], v2, s[16:19], s55 offen offset:1024 sc0 sc1
  s_waitcnt lgkmcnt(0)
  v_add_f32 v240, v240, v108
  v_add_f32 v241, v241, v109
  v_add_f32 v242, v242, v110
  v_add_f32 v243, v243, v111
  v_cvt_pk_bf16_f32 v232, v240, v241
  v_cvt_pk_bf16_f32 v233, v242, v243
  buffer_store_dwordx2 v[232:233], v2, s[16:19], s55 offen offset:2048 sc0 sc1
  v_mfma_f32_16x16x32_bf16 v[64:67], v[168:171], v[208:211], v[64:67]
  ds_read_b128 v[188:191], v5 offset:5120
  v_mfma_f32_16x16x32_bf16 v[84:87], v[168:171], v[212:215], v[84:87]
  ds_read_b128 v[32:35], v5 offset:6144
  v_mfma_f32_16x16x32_bf16 v[68:71], v[172:175], v[208:211], v[68:71]
  ds_read_b128 v[36:39], v5 offset:7168
  v_mfma_f32_16x16x32_bf16 v[88:91], v[172:175], v[212:215], v[88:91]
  ds_read_b128 v[40:43], v5 offset:8192
  v_mfma_f32_16x16x32_bf16 v[72:75], v[176:179], v[208:211], v[72:75]
  ds_read_b128 v[44:47], v5 offset:9216
  v_mfma_f32_16x16x32_bf16 v[92:95], v[176:179], v[212:215], v[92:95]
  v_mfma_f32_16x16x32_bf16 v[76:79], v[180:183], v[208:211], v[76:79]
  v_mfma_f32_16x16x32_bf16 v[96:99], v[180:183], v[212:215], v[96:99]
  v_mfma_f32_16x16x32_bf16 v[80:83], v[184:187], v[208:211], v[80:83]
  v_mfma_f32_16x16x32_bf16 v[100:103], v[184:187], v[212:215], v[100:103]
  s_waitcnt vmcnt(25) lgkmcnt(4)
  v_mfma_f32_16x16x32_bf16 v[64:67], v[188:191], v[216:219], v[64:67]
  s_waitcnt vmcnt(24)
  v_mfma_f32_16x16x32_bf16 v[84:87], v[188:191], v[220:223], v[84:87]
  s_waitcnt lgkmcnt(0)
  s_waitcnt vmcnt(19)
  s_barrier
  ds_read_b128 v[168:171], v5 offset:20480
  v_mfma_f32_16x16x32_bf16 v[68:71], v[32:35], v[216:219], v[68:71]
  ds_read_b128 v[172:175], v5 offset:21504
  v_mfma_f32_16x16x32_bf16 v[88:91], v[32:35], v[220:223], v[88:91]
  ds_read_b128 v[176:179], v5 offset:22528
  v_mfma_f32_16x16x32_bf16 v[72:75], v[36:39], v[216:219], v[72:75]
  ds_read_b128 v[180:183], v5 offset:23552
  v_mfma_f32_16x16x32_bf16 v[92:95], v[36:39], v[220:223], v[92:95]
  ds_read_b128 v[184:187], v5 offset:24576
  v_mfma_f32_16x16x32_bf16 v[76:79], v[40:43], v[216:219], v[76:79]
  v_mfma_f32_16x16x32_bf16 v[96:99], v[40:43], v[220:223], v[96:99]
  v_mfma_f32_16x16x32_bf16 v[80:83], v[44:47], v[216:219], v[80:83]
  v_mfma_f32_16x16x32_bf16 v[100:103], v[44:47], v[220:223], v[100:103]
  s_waitcnt vmcnt(0)
  s_add_u32 s55, s45, s44
  s_sub_u32 s55, s55, 1
  v_mov_b32 v14, 1
  s_mov_b64 exec, 1
  buffer_store_byte v14, off, s[16:19], s55 sc0 sc1
  s_mov_b64 exec, -1
  s_waitcnt lgkmcnt(4)
  v_mfma_f32_16x16x32_bf16 v[64:67], v[168:171], v[48:51], v[64:67]
  ds_read_b128 v[188:191], v5 offset:25600
  v_mfma_f32_16x16x32_bf16 v[84:87], v[168:171], v[52:55], v[84:87]
  ds_read_b128 v[32:35], v5 offset:26624
  s_waitcnt lgkmcnt(5)
  v_mfma_f32_16x16x32_bf16 v[68:71], v[172:175], v[48:51], v[68:71]
  ds_read_b128 v[36:39], v5 offset:27648
  v_mfma_f32_16x16x32_bf16 v[88:91], v[172:175], v[52:55], v[88:91]
  ds_read_b128 v[40:43], v5 offset:28672
  s_waitcnt lgkmcnt(6)
  v_mfma_f32_16x16x32_bf16 v[72:75], v[176:179], v[48:51], v[72:75]
  ds_read_b128 v[44:47], v5 offset:29696
  v_mfma_f32_16x16x32_bf16 v[92:95], v[176:179], v[52:55], v[92:95]
  s_waitcnt lgkmcnt(6)
  v_mfma_f32_16x16x32_bf16 v[76:79], v[180:183], v[48:51], v[76:79]
  v_mfma_f32_16x16x32_bf16 v[96:99], v[180:183], v[52:55], v[96:99]
  s_waitcnt lgkmcnt(5)
  v_mfma_f32_16x16x32_bf16 v[80:83], v[184:187], v[48:51], v[80:83]
  v_mfma_f32_16x16x32_bf16 v[100:103], v[184:187], v[52:55], v[100:103]
  s_waitcnt lgkmcnt(4)
  v_mfma_f32_16x16x32_bf16 v[64:67], v[188:191], v[56:59], v[64:67]
  v_mfma_f32_16x16x32_bf16 v[84:87], v[188:191], v[60:63], v[84:87]
  s_waitcnt lgkmcnt(0)
  s_barrier
  ds_read_b128 v[168:171], v5 offset:40960
  v_mfma_f32_16x16x32_bf16 v[68:71], v[32:35], v[56:59], v[68:71]
  ds_read_b128 v[172:175], v5 offset:41984
  v_mfma_f32_16x16x32_bf16 v[88:91], v[32:35], v[60:63], v[88:91]
  ds_read_b128 v[176:179], v5 offset:43008
  v_mfma_f32_16x16x32_bf16 v[72:75], v[36:39], v[56:59], v[72:75]
  ds_read_b128 v[180:183], v5 offset:44032
  v_mfma_f32_16x16x32_bf16 v[92:95], v[36:39], v[60:63], v[92:95]
  ds_read_b128 v[184:187], v5 offset:45056
  v_mfma_f32_16x16x32_bf16 v[76:79], v[40:43], v[56:59], v[76:79]
  v_mfma_f32_16x16x32_bf16 v[96:99], v[40:43], v[60:63], v[96:99]
  v_mfma_f32_16x16x32_bf16 v[80:83], v[44:47], v[56:59], v[80:83]
  v_mfma_f32_16x16x32_bf16 v[100:103], v[44:47], v[60:63], v[100:103]
  s_waitcnt lgkmcnt(4)
  v_mfma_f32_16x16x32_bf16 v[64:67], v[168:171], v[112:115], v[64:67]
  ds_read_b128 v[188:191], v5 offset:46080
  v_mfma_f32_16x16x32_bf16 v[84:87], v[168:171], v[116:119], v[84:87]
  ds_read_b128 v[32:35], v5 offset:47104
  s_waitcnt lgkmcnt(5)
  v_mfma_f32_16x16x32_bf16 v[68:71], v[172:175], v[112:115], v[68:71]
  ds_read_b128 v[36:39], v5 offset:48128
  v_mfma_f32_16x16x32_bf16 v[88:91], v[172:175], v[116:119], v[88:91]
  ds_read_b128 v[40:43], v5 offset:49152
  s_waitcnt lgkmcnt(6)
  v_mfma_f32_16x16x32_bf16 v[72:75], v[176:179], v[112:115], v[72:75]
  ds_read_b128 v[44:47], v5 offset:50176
  v_mfma_f32_16x16x32_bf16 v[92:95], v[176:179], v[116:119], v[92:95]
  s_waitcnt lgkmcnt(6)
  v_mfma_f32_16x16x32_bf16 v[76:79], v[180:183], v[112:115], v[76:79]
  v_mfma_f32_16x16x32_bf16 v[96:99], v[180:183], v[116:119], v[96:99]
  s_waitcnt lgkmcnt(5)
  v_mfma_f32_16x16x32_bf16 v[80:83], v[184:187], v[112:115], v[80:83]
  v_mfma_f32_16x16x32_bf16 v[100:103], v[184:187], v[116:119], v[100:103]
  s_waitcnt lgkmcnt(4)
  v_mfma_f32_16x16x32_bf16 v[64:67], v[188:191], v[120:123], v[64:67]
  v_mfma_f32_16x16x32_bf16 v[84:87], v[188:191], v[124:127], v[84:87]
  s_waitcnt lgkmcnt(0)
  s_barrier
  ds_read_b128 v[168:171], v7 offset:0
  v_mfma_f32_16x16x32_bf16 v[68:71], v[32:35], v[120:123], v[68:71]
  ds_read_b128 v[172:175], v7 offset:1024
  v_mfma_f32_16x16x32_bf16 v[88:91], v[32:35], v[124:127], v[88:91]
  ds_read_b128 v[176:179], v7 offset:2048
  v_mfma_f32_16x16x32_bf16 v[72:75], v[36:39], v[120:123], v[72:75]
  ds_read_b128 v[180:183], v7 offset:3072
  v_mfma_f32_16x16x32_bf16 v[92:95], v[36:39], v[124:127], v[92:95]
  ds_read_b128 v[184:187], v7 offset:4096
  v_mfma_f32_16x16x32_bf16 v[76:79], v[40:43], v[120:123], v[76:79]
  v_mfma_f32_16x16x32_bf16 v[96:99], v[40:43], v[124:127], v[96:99]
  v_mfma_f32_16x16x32_bf16 v[80:83], v[44:47], v[120:123], v[80:83]
  v_mfma_f32_16x16x32_bf16 v[100:103], v[44:47], v[124:127], v[100:103]
  s_waitcnt lgkmcnt(4)
  v_mfma_f32_16x16x32_bf16 v[64:67], v[168:171], v[16:19], v[64:67]
  ds_read_b128 v[188:191], v7 offset:5120
  v_mfma_f32_16x16x32_bf16 v[84:87], v[168:171], v[20:23], v[84:87]
  ds_read_b128 v[32:35], v7 offset:6144
  s_waitcnt lgkmcnt(5)
  v_mfma_f32_16x16x32_bf16 v[68:71], v[172:175], v[16:19], v[68:71]
  ds_read_b128 v[36:39], v7 offset:7168
  v_mfma_f32_16x16x32_bf16 v[88:91], v[172:175], v[20:23], v[88:91]
  ds_read_b128 v[40:43], v7 offset:8192
  s_waitcnt lgkmcnt(6)
  v_mfma_f32_16x16x32_bf16 v[72:75], v[176:179], v[16:19], v[72:75]
  ds_read_b128 v[44:47], v7 offset:9216
  v_mfma_f32_16x16x32_bf16 v[92:95], v[176:179], v[20:23], v[92:95]
  s_waitcnt lgkmcnt(6)
  v_mfma_f32_16x16x32_bf16 v[76:79], v[180:183], v[16:19], v[76:79]
  v_mfma_f32_16x16x32_bf16 v[96:99], v[180:183], v[20:23], v[96:99]
  s_waitcnt lgkmcnt(5)
  v_mfma_f32_16x16x32_bf16 v[80:83], v[184:187], v[16:19], v[80:83]
  v_mfma_f32_16x16x32_bf16 v[100:103], v[184:187], v[20:23], v[100:103]
  s_waitcnt lgkmcnt(4)
  v_mfma_f32_16x16x32_bf16 v[84:87], v[188:191], v[28:31], v[84:87]
  s_waitcnt lgkmcnt(3)
  v_mfma_f32_16x16x32_bf16 v[88:91], v[32:35], v[28:31], v[88:91]
  s_waitcnt lgkmcnt(2)
  v_mfma_f32_16x16x32_bf16 v[92:95], v[36:39], v[28:31], v[92:95]
  s_waitcnt lgkmcnt(1)
  v_mfma_f32_16x16x32_bf16 v[96:99], v[40:43], v[28:31], v[96:99]
  s_waitcnt lgkmcnt(0)
  v_mfma_f32_16x16x32_bf16 v[100:103], v[44:47], v[28:31], v[100:103]
  v_mfma_f32_16x16x32_bf16 v[64:67], v[188:191], v[24:27], v[64:67]
  v_mfma_f32_16x16x32_bf16 v[68:71], v[32:35], v[24:27], v[68:71]
  v_mfma_f32_16x16x32_bf16 v[72:75], v[36:39], v[24:27], v[72:75]
  v_mfma_f32_16x16x32_bf16 v[76:79], v[40:43], v[24:27], v[76:79]
  v_mfma_f32_16x16x32_bf16 v[80:83], v[44:47], v[24:27], v[80:83]
  ds_write_b128 v8, v[84:87] offset:0
  ds_write_b128 v8, v[88:91] offset:1024
  ds_write_b128 v8, v[92:95] offset:2048
  ds_write_b128 v8, v[96:99] offset:3072
  ds_write_b128 v8, v[100:103] offset:4096
  s_mul_i32 s55, s42, 81920
  s_mul_i32 s56, s48, 320
  s_add_u32 s55, s55, s56
  s_waitcnt lgkmcnt(0)
  s_barrier
  ds_read_b128 v[84:87], v9 offset:0
  ds_read_b128 v[88:91], v9 offset:1024
  ds_read_b128 v[92:95], v9 offset:2048
  ds_read_b128 v[96:99], v9 offset:3072
  ds_read_b128 v[100:103], v9 offset:4096
  s_waitcnt lgkmcnt(4)
  v_add_f32 v64, v64, v84
  v_add_f32 v65, v65, v85
  v_add_f32 v66, v66, v86
  v_add_f32 v67, v67, v87
  buffer_store_dwordx4 v[64:67], v10, s[4:7], s55 offen offset:0
  s_waitcnt lgkmcnt(3)
  v_add_f32 v68, v68, v88
  v_add_f32 v69, v69, v89
  v_add_f32 v70, v70, v90
  v_add_f32 v71, v71, v91
  buffer_store_dwordx4 v[68:71], v10, s[4:7], s55 offen offset:64
  s_waitcnt lgkmcnt(2)
  v_add_f32 v72, v72, v92
  v_add_f32 v73, v73, v93
  v_add_f32 v74, v74, v94
  v_add_f32 v75, v75, v95
  buffer_store_dwordx4 v[72:75], v10, s[4:7], s55 offen offset:128
  s_waitcnt lgkmcnt(1)
  v_add_f32 v76, v76, v96
  v_add_f32 v77, v77, v97
  v_add_f32 v78, v78, v98
  v_add_f32 v79, v79, v99
  buffer_store_dwordx4 v[76:79], v10, s[4:7], s55 offen offset:192
  s_waitcnt lgkmcnt(0)
  v_add_f32 v80, v80, v100
  v_add_f32 v81, v81, v101
  v_add_f32 v82, v82, v102
  v_add_f32 v83, v83, v103
  buffer_store_dwordx4 v[80:83], v10, s[4:7], s55 offen offset:256
  s_endpgm
.Lpl125s:
  s_sub_u32 s95, s95, 1
  s_cselect_b32 s95, 0, s95
  s_cbranch_scc1 .Lpl125k
  s_sleep 4
  buffer_load_dword v11, off, s[16:19], s45 sc0 sc1
  s_waitcnt vmcnt(0)
  s_branch .Lpl125c
.Lpl128s:
  s_sub_u32 s95, s95, 1
  s_cselect_b32 s95, 0, s95
  s_cbranch_scc1 .Lpl128k
  s_sleep 4
  buffer_load_ubyte v11, v13, s[16:19], s46 offen sc0 sc1
  s_waitcnt vmcnt(0)
  s_branch .Lpl128c
.Lpl130s:
  s_sub_u32 s95, s95, 1
  s_cselect_b32 s95, 0, s95
  s_cbranch_scc1 .Lpl130k
  s_sleep 4
  buffer_load_dword v11, off, s[16:19], s45 sc0 sc1
  s_waitcnt vmcnt(0)
  s_branch .Lpl130c
.Lpl133s:
  s_sub_u32 s95, s95, 1
  s_cselect_b32 s95, 0, s95
  s_cbranch_scc1 .Lpl133k
  s_sleep 4
  buffer_load_ubyte v11, v13, s[16:19], s46 offen sc0 sc1
  s_waitcnt vmcnt(0)
  s_branch .Lpl133c
.section .rodata,"a"
.p2align 6
.amdhsa_kernel fu_kernel
  .amdhsa_next_free_vgpr 256
  .amdhsa_next_free_sgpr 102
  .amdhsa_accum_offset 256
  .amdhsa_group_segment_fixed_size 0
  .amdhsa_kernarg_size 144
  .amdhsa_user_sgpr_count 2
  .amdhsa_user_sgpr_kernarg_segment_ptr 1
  .amdhsa_system_sgpr_workgroup_id_x 1
.end_amdhsa_kernel
```
